```python
import torch

def _softmax(x, axis=-1):
    return torch.softmax(x, dim=axis)
def _gelu(x):
    return torch.nn.functional.gelu(x, approximate="tanh")
def _silu(x):
    return torch.nn.functional.silu(x)
def _sigmoid(x):
    return torch.sigmoid(x)
def _layernorm(x, axis=-1, eps=1e-5):
    m = x.mean(dim=axis, keepdim=True)
    v = x.var(dim=axis, keepdim=True, unbiased=False)
    return (x - m) / torch.sqrt(v + eps)
def _scatter_add(tgt, idx, src, axis=0):
    return tgt.clone().index_add_(axis, idx, src)
def _segment_sum(src, seg, n):
    out = torch.zeros((n,) + src.shape[1:], dtype=src.dtype)
    return out.index_add_(0, seg, src)
def _pad(x, pw):
    flat = tuple(v for pair in reversed(pw) for v in pair)
    return torch.nn.functional.pad(x, flat)

kernel_name = 'recurrent_scan__compressed_kv_cla__dense_activation_gelu__prompt'

def setup_inputs():

    _w = (lambda a: (lambda t: t.to(torch.bfloat16) if t.is_floating_point() else t)(torch.as_tensor(a)))
    def _A_setup():
        B, H, Sq, Sk, D, M = 1, 32, 2048, 2048, 128, 512
        Dc = 4 * D
        return {
            "x": _w((lambda *s: torch.randn(*s, dtype=torch.bfloat16) * 0.05)(B, Sq, M)),
            "c_kv": _w((lambda *s: torch.randn(*s, dtype=torch.bfloat16) * 0.8)(B, Sk, Dc)),
            "w_q": _w((lambda *s: torch.randn(*s, dtype=torch.bfloat16) * 1.6)(M, H, D) * (M ** -0.5)),
            "w_uk": _w((lambda *s: torch.randn(*s, dtype=torch.bfloat16) * 1.6)(Dc, H, D) * (Dc ** -0.5)),
            "w_uv": _w((lambda *s: torch.randn(*s, dtype=torch.bfloat16) * 0.8)(Dc, H, D) * (Dc ** -0.5)),
            "w_o": _w((lambda *s: torch.randn(*s, dtype=torch.bfloat16) * 0.8)(H, D, M) * ((H * D) ** -0.5)),
        }
    _A_in = _A_setup()

    def _B_setup():
        B, S, D, F = 1, 2048, 512, 1376
        return {
            "x": _w((lambda *s: torch.randn(*s, dtype=torch.bfloat16) * 0.05)(B, S, D)),
            "w1": _w((lambda *s: torch.randn(*s, dtype=torch.bfloat16) * 0.8)(D, F) * (D ** -0.5)),
            "b1": _w((lambda *s: torch.randn(*s, dtype=torch.bfloat16) * 0.8)(F) * 0.01),
            "w2": _w((lambda *s: torch.randn(*s, dtype=torch.bfloat16) * 0.2)(F, D) * (F ** -0.5)),
            "b2": _w((lambda *s: torch.randn(*s, dtype=torch.bfloat16) * 0.2)(D) * 0.01),
        }
    _B_in = _B_setup()

    return {
        "A_x": _A_in["x"],
        "A_c_kv": _A_in["c_kv"],
        "A_w_q": _A_in["w_q"],
        "A_w_uk": _A_in["w_uk"],
        "A_w_uv": _A_in["w_uv"],
        "A_w_o": _A_in["w_o"],
        "B_x": _B_in["x"],
        "B_w1": _B_in["w1"],
        "B_b1": _B_in["b1"],
        "B_w2": _B_in["w2"],
        "B_b2": _B_in["b2"],
    }

def reference(A_x, A_c_kv, A_w_q, A_w_uk, A_w_uv, A_w_o, B_x, B_w1, B_b1, B_w2, B_b2):
    def _A_ref(x, c_kv, w_q, w_uk, w_uv, w_o):
        B, Sq, M = x.shape[0], x.shape[1], x.shape[2]
        Sk = c_kv.shape[1]
        H, D = w_q.shape[1], w_q.shape[2]
        q = torch.einsum("bqm,mhd->bhqd", x, w_q)
        k = torch.einsum("bkc,chd->bhkd", c_kv, w_uk)
        v = torch.einsum("bkc,chd->bhkd", c_kv, w_uv)
        scores = torch.einsum("bhqd,bhkd->bhqk", q, k) * (D ** -0.5)
        off = Sk - Sq
        qi = torch.arange(Sq)[:, None]
        kj = torch.arange(Sk)[None, :]
        cmask = kj <= (qi + off)
        scores = torch.where(cmask[None, None], scores, -1e9)
        p = _softmax(scores, axis=-1)
        ctx = torch.einsum("bhqk,bhkd->bhqd", p, v)
        return torch.einsum("bhqd,hdm->bqm", ctx, w_o)

    def _B_ref(x, w1, b1, w2, b2):
        h = torch.einsum("bsd,df->bsf", x, w1) + b1
        h = _gelu(h)
        return torch.einsum("bsf,fd->bsd", h, w2) + b2

    x = A_x
    xn = _layernorm(x, axis=-1)
    s = _A_ref(xn, A_c_kv, A_w_q, A_w_uk, A_w_uv, A_w_o)
    g = _silu(_B_ref(xn, B_w1, B_b1, B_w2, B_b2))
    return x + s * g
```

```asm
; @launch grid=(256,1,1) block=(256,1,1) lds=163840
.amdgcn_target "amdgcn-amd-amdhsa--gfx950"
.text
.globl recurrent_scan__compressed_kv_cla__dense_activation_gelu__prompt_kernel
.p2align 8
.type recurrent_scan__compressed_kv_cla__dense_activation_gelu__prompt_kernel,@function
recurrent_scan__compressed_kv_cla__dense_activation_gelu__prompt_kernel:
    s_cmp_ge_u32 s2, 256
    s_cbranch_scc1 L_end
    s_load_dwordx16 s[16:31], s[0:1], 0
    s_load_dwordx8 s[32:39], s[0:1], 64
    s_load_dwordx4 s[40:43], s[0:1], 96
    s_getpc_b64 s[84:85]
L_pc:
    s_mov_b32 s86, L_code_end-L_pc
    s_mov_b32 s87, 0x00020000
    v_and_b32 v1, 63, v0
    v_lshrrev_b32 v3, 6, v0
    v_mul_u32_u24 v32, L_p1_1-L_p1_0, v3
    v_lshl_add_u32 v32, v1, 7, v32
    buffer_load_dword v36, v32, s[84:87], 0 offen
    v_lshlrev_b32 v2, 4, v1
    v_readfirstlane_b32 s4, v3
    s_and_b32 s8, s2, 7
    s_lshr_b32 s9, s2, 3
    s_and_b32 s10, s9, 3
    s_lshl_b32 s5, s8, 2
    s_add_u32 s5, s5, s10
    s_lshr_b32 s6, s9, 2
    v_lshrrev_b32 v28, 4, v1
    v_and_b32 v29, 15, v1
    v_lshrrev_b32 v30, 3, v1
    v_and_b32 v31, 7, v1
    s_lshl_b32 s8, s6, 8
    s_lshl_b32 s9, s4, 6
    s_add_u32 s8, s8, s9
    s_lshl_b32 s8, s8, 10
    v_lshlrev_b32 v32, 10, v30
    v_add_u32 v32, s8, v32
    v_xor_b32 v33, v31, v28
    v_lshlrev_b32 v33, 4, v33
    v_xor_b32 v34, 64, v33
    v_add_u32 v4, v32, v33
    v_add_u32 v5, v32, v34
    v_add_u32 v5, 7168, v5
    v_add_u32 v6, v32, v33
    v_add_u32 v6, 14336, v6
    v_add_u32 v7, v32, v34
    v_add_u32 v7, 21504, v7
    v_add_u32 v8, v32, v33
    v_add_u32 v8, 32768, v8
    v_add_u32 v9, v32, v34
    v_add_u32 v9, 39936, v9
    v_add_u32 v10, v32, v33
    v_add_u32 v10, 47104, v10
    v_add_u32 v11, v32, v34
    v_add_u32 v11, 54272, v11
    s_lshr_b32 s9, s4, 1
    s_lshl_b32 s9, s9, 17
    s_lshl_b32 s10, s5, 8
    s_add_u32 s9, s9, s10
    v_lshlrev_b32 v32, 13, v28
    v_add_u32 v32, s9, v32
    v_lshlrev_b32 v33, 1, v28
    v_xor_b32 v33, v33, v29
    v_lshlrev_b32 v33, 4, v33
    v_xor_b32 v34, 128, v33
    v_add_u32 v12, v32, v33
    v_add_u32 v13, v32, v33
    v_add_u32 v13, 31744, v13
    v_add_u32 v14, v32, v34
    v_add_u32 v14, 63488, v14
    v_add_u32 v15, v32, v34
    v_add_u32 v15, 95232, v15
    s_waitcnt lgkmcnt(0)
    s_mov_b32 s44, s18
    s_mov_b32 s45, s19
    s_mov_b32 s46, 2097152
    s_mov_b32 s47, 0x00020000
    s_and_b32 s7, s4, 1
    s_cmp_eq_u32 s7, 0
    s_cselect_b32 s48, s22, s24
    s_cselect_b32 s49, s23, s25
    s_mov_b32 s50, 0x400000
    s_mov_b32 s51, 0x00020000
    s_add_u32 s52, s42, 0
    s_addc_u32 s53, s43, 0
    s_mov_b32 s54, 268435456
    s_mov_b32 s55, 0x00020000
    s_mov_b32 s56, s40
    s_mov_b32 s57, s41
    s_mov_b32 s58, 256
    s_mov_b32 s59, 0x00020000
    s_mov_b32 s63, 0x00020000
    s_lshl_b32 s64, s7, 13
    s_lshr_b32 s10, s4, 1
    s_lshl_b32 s10, s10, 12
    s_add_u32 s64, s64, s10
    s_lshl_b32 s65, s4, 13
    s_add_u32 m0, s64, 0
    s_mov_b32 s66, 0
    buffer_load_dwordx4 v12, s[48:51], s66 offen offset:0 lds
    buffer_load_dwordx4 v13, s[48:51], s66 offen offset:1024 lds
    buffer_load_dwordx4 v14, s[48:51], s66 offen offset:2048 lds
    buffer_load_dwordx4 v15, s[48:51], s66 offen offset:3072 lds
    s_add_u32 m0, s65, 65536
    s_mov_b32 s67, 0
    buffer_load_dwordx4 v4, s[44:47], s67 offen offset:0 lds
    buffer_load_dwordx4 v5, s[44:47], s67 offen offset:1024 lds
    buffer_load_dwordx4 v6, s[44:47], s67 offen offset:2048 lds
    buffer_load_dwordx4 v7, s[44:47], s67 offen offset:3072 lds
    s_add_u32 m0, s65, 69632
    s_mov_b32 s67, 0
    buffer_load_dwordx4 v8, s[44:47], s67 offen offset:0 lds
    buffer_load_dwordx4 v9, s[44:47], s67 offen offset:1024 lds
    buffer_load_dwordx4 v10, s[44:47], s67 offen offset:2048 lds
    buffer_load_dwordx4 v11, s[44:47], s67 offen offset:3072 lds
    s_lshl_b32 s8, s2, 3
    s_lshr_b32 s9, s4, 1
    s_lshl_b32 s9, s9, 2
    s_add_u32 s8, s8, s9
    s_lshl_b32 s9, s8, 10
    v_and_b32 v32, 3, v1
    v_lshlrev_b32 v32, 10, v32
    v_and_b32 v33, 60, v1
    v_lshl_add_u32 v32, v33, 2, v32
    s_mov_b64 s[28:29], s[16:17]
    s_mov_b32 s92, s16
    s_mov_b32 s93, s17
    s_mov_b32 s94, 2097152
    s_mov_b32 s95, 0x00020000
    s_mov_b32 s96, s9
    v_mov_b32 v63, v32
    buffer_load_dwordx4 v[40:43], v63, s[92:95], s96 offen offset:0
    buffer_load_dwordx4 v[44:47], v63, s[92:95], s96 offen offset:256
    buffer_load_dwordx4 v[48:51], v63, s[92:95], s96 offen offset:512
    buffer_load_dwordx4 v[52:55], v63, s[92:95], s96 offen offset:768
    s_add_u32 m0, s64, 16384
    s_mov_b32 s66, 262144
    buffer_load_dwordx4 v12, s[48:51], s66 offen offset:0 lds
    buffer_load_dwordx4 v13, s[48:51], s66 offen offset:1024 lds
    buffer_load_dwordx4 v14, s[48:51], s66 offen offset:2048 lds
    buffer_load_dwordx4 v15, s[48:51], s66 offen offset:3072 lds
    v_lshrrev_b32 v32, 1, v1
    v_lshlrev_b32 v32, 13, v32
    v_and_b32 v33, 1, v1
    v_lshl_add_u32 v32, v33, 7, v32
    v_lshlrev_b32 v33, 10, v1
    s_lshl_b32 s10, s6, 18
    s_lshl_b32 s11, s5, 8
    s_add_u32 s10, s10, s11
    s_add_u32 s10, s10, 524288
    s_and_b32 s11, s5, 3
    s_lshl_b32 s11, s11, 6
    s_lshl_b32 s12, s6, 8
    s_add_u32 s11, s11, s12
    s_lshl_b32 s11, s11, 10
    s_lshl_b32 s12, s7, 7
    s_add_u32 s11, s11, s12
    s_add_u32 s11, s11, 128
    s_lshl_b32 s12, s6, 16
    s_sub_u32 s12, 2097152, s12
    s_cmp_lt_u32 s4, 2
    s_cselect_b32 s14, s10, s11
    s_cselect_b32 s15, s12, 256
    s_cselect_b32 s60, s48, s44
    s_cselect_b32 s61, s49, s45
    s_cselect_b32 s62, s50, s46
    s_cselect_b64 vcc, -1, 0
    v_cndmask_b32 v37, v33, v32, vcc
    s_lshr_b32 s10, s2, 3
    s_lshl_b32 s10, s10, 2
    s_add_u32 s10, s10, s4
    s_mul_i32 s10, s10, 768
    v_cmp_gt_u32 vcc, 6, v1
    v_lshlrev_b32 v32, 7, v1
    v_mov_b32 v33, 0x40000000
    v_cndmask_b32 v32, v33, v32, vcc
    buffer_load_dword v36, v32, s[84:87], s10 offen
    s_add_u32 m0, s65, 98304
    s_mov_b32 s67, 128
    buffer_load_dwordx4 v4, s[44:47], s67 offen offset:0 lds
    buffer_load_dwordx4 v5, s[44:47], s67 offen offset:1024 lds
    buffer_load_dwordx4 v6, s[44:47], s67 offen offset:2048 lds
    buffer_load_dwordx4 v7, s[44:47], s67 offen offset:3072 lds
    s_add_u32 m0, s65, 102400
    s_mov_b32 s67, 128
    buffer_load_dwordx4 v8, s[44:47], s67 offen offset:0 lds
    buffer_load_dwordx4 v9, s[44:47], s67 offen offset:1024 lds
    buffer_load_dwordx4 v10, s[44:47], s67 offen offset:2048 lds
    buffer_load_dwordx4 v11, s[44:47], s67 offen offset:3072 lds
    s_add_u32 m0, s64, 32768
    s_mov_b32 s66, 524288
    buffer_load_dwordx4 v12, s[48:51], s66 offen offset:0 lds
    buffer_load_dwordx4 v13, s[48:51], s66 offen offset:1024 lds
    buffer_load_dwordx4 v14, s[48:51], s66 offen offset:2048 lds
    buffer_load_dwordx4 v15, s[48:51], s66 offen offset:3072 lds
    s_add_u32 m0, s64, 49152
    s_mov_b32 s66, 786432
    buffer_load_dwordx4 v12, s[48:51], s66 offen offset:0 lds
    buffer_load_dwordx4 v13, s[48:51], s66 offen offset:1024 lds
    buffer_load_dwordx4 v14, s[48:51], s66 offen offset:2048 lds
    buffer_load_dwordx4 v15, s[48:51], s66 offen offset:3072 lds
    s_add_u32 m0, s65, 131072
    s_mov_b32 s67, 256
    buffer_load_dwordx4 v4, s[44:47], s67 offen offset:0 lds
    buffer_load_dwordx4 v5, s[44:47], s67 offen offset:1024 lds
    buffer_load_dwordx4 v6, s[44:47], s67 offen offset:2048 lds
    buffer_load_dwordx4 v7, s[44:47], s67 offen offset:3072 lds
    s_lshl_b32 s90, s2, 1
    s_lshr_b32 s11, s4, 1
    s_add_u32 s90, s90, s11
    s_lshl_b32 s90, s90, 10
    s_add_u32 s90, s90, 524288
    v_lshlrev_b32 v39, 7, v1
    v_lshrrev_b32 v38, 3, v1
    v_lshl_add_u32 v39, v38, 28, v39
    s_lshl_b32 s91, s2, 2
    s_add_u32 s91, s91, s4
    s_lshl_b32 s91, s91, 11
    v_lshlrev_b32 v37, 7, v1
    v_lshrrev_b32 v38, 4, v1
    v_lshl_add_u32 v37, v38, 28, v37
    s_cmp_eq_u32 s2, 0
    s_cbranch_scc1 L_zero
L_zero_ret:
    s_lshr_b32 s10, s4, 1
    s_lshl_b32 s10, s10, 14
    v_lshlrev_b32 v32, 7, v29
    v_add_u32 v32, s10, v32
    v_lshrrev_b32 v33, 1, v29
    v_xor_b32 v33, v33, v28
    v_lshlrev_b32 v33, 4, v33
    v_add_u32 v16, v32, v33
    v_xor_b32 v17, 64, v16
    v_add_u32 v18, 65536, v16
    v_add_u32 v19, 65536, v17
    v_bfe_u32 v32, v1, 2, 2
    v_and_b32 v33, 3, v1
    v_lshl_add_u32 v34, v28, 3, v32
    v_lshlrev_b32 v34, 8, v34
    v_lshl_add_u32 v34, v33, 3, v34
    s_lshl_b32 s10, s7, 13
    v_add_u32 v34, s10, v34
    v_and_b32 v35, 1, v28
    v_lshl_or_b32 v35, v35, 2, v32
    v_xor_b32 v38, 0, v35
    v_lshl_add_u32 v20, v38, 5, v34
    v_xor_b32 v38, 1, v35
    v_lshl_add_u32 v21, v38, 5, v34
    v_xor_b32 v38, 2, v35
    v_lshl_add_u32 v22, v38, 5, v34
    v_xor_b32 v38, 3, v35
    v_lshl_add_u32 v23, v38, 5, v34
    v_xor_b32 v38, 4, v35
    v_lshl_add_u32 v24, v38, 5, v34
    v_xor_b32 v38, 5, v35
    v_lshl_add_u32 v25, v38, 5, v34
    v_xor_b32 v38, 6, v35
    v_lshl_add_u32 v26, v38, 5, v34
    v_xor_b32 v38, 7, v35
    v_lshl_add_u32 v27, v38, 5, v34
    v_and_b32 v35, 3, v1
    v_lshlrev_b32 v35, 2, v35
    s_lshr_b32 s13, s8, 6
    s_lshl_b32 s13, s13, 16
    s_bfe_u32 s10, s8, 0x20004
    s_lshl_b32 s10, s10, 10
    s_add_u32 s13, s13, s10
    s_and_b32 s10, s8, 15
    s_lshl_b32 s10, s10, 4
    s_add_u32 s13, s13, s10
    s_lshl_b32 s10, s7, 15
    s_add_u32 s13, s13, s10
    s_add_u32 s12, s13, 16384
    v_lshlrev_b32 v34, 12, v28
    v_bfe_u32 v38, v1, 2, 2
    v_lshl_add_u32 v34, v38, 8, v34
    v_and_b32 v38, 3, v1
    v_lshl_add_u32 v34, v38, 4, v34
    s_sub_u32 s3, 15, s6
    s_cmp_eq_u32 s7, 0
    s_cselect_b32 s3, s3, s6
    s_lshl_b32 s78, s3, 8
    s_add_u32 s78, s78, 79691776
    s_lshl_b32 s74, s3, 17
    s_and_b32 s68, s5, 1
    s_lshr_b32 s69, s5, 1
    s_mul_i32 s69, s69, 192
    s_lshl_b32 s3, s68, 6
    s_add_u32 s69, s69, s3
    s_waitcnt vmcnt(29)
    s_barrier
    s_cmp_eq_u32 s7, 1
    s_cbranch_scc1 L_p1_1
L_p1_0:
    ds_read_b64_tr_b16 a[96:97], v20 offset:0
    ds_read_b64_tr_b16 a[98:99], v20 offset:1024
    ds_read_b64_tr_b16 a[100:101], v21 offset:0
    ds_read_b64_tr_b16 a[102:103], v21 offset:1024
    ds_read_b64_tr_b16 a[104:105], v22 offset:0
    ds_read_b64_tr_b16 a[106:107], v22 offset:1024
    ds_read_b64_tr_b16 a[108:109], v23 offset:0
    ds_read_b64_tr_b16 a[110:111], v23 offset:1024
    ds_read_b64_tr_b16 a[112:113], v24 offset:0
    ds_read_b64_tr_b16 a[114:115], v24 offset:1024
    ds_read_b64_tr_b16 a[116:117], v25 offset:0
    ds_read_b64_tr_b16 a[118:119], v25 offset:1024
    ds_read_b64_tr_b16 a[120:121], v26 offset:0
    ds_read_b64_tr_b16 a[122:123], v26 offset:1024
    ds_read_b64_tr_b16 a[124:125], v27 offset:0
    ds_read_b64_tr_b16 a[126:127], v27 offset:1024
    ds_read_b128 a[64:67], v18 offset:0
    ds_read_b128 a[68:71], v18 offset:2048
    ds_read_b128 a[72:75], v18 offset:4096
    ds_read_b128 a[76:79], v18 offset:6144
    ds_read_b128 a[80:83], v18 offset:8192
    ds_read_b128 a[84:87], v18 offset:10240
    ds_read_b128 a[88:91], v18 offset:12288
    ds_read_b128 a[92:95], v18 offset:14336
    s_waitcnt lgkmcnt(0)
    v_mfma_f32_16x16x32_bf16 v[128:131], a[96:99], a[64:67], 0
    s_waitcnt vmcnt(21)
    s_barrier
    v_mfma_f32_16x16x32_bf16 v[144:147], a[96:99], a[68:71], 0
    ds_read_b64_tr_b16 a[160:161], v20 offset:16384
    s_cmp_eq_u32 s2, 0
    s_cbranch_scc1 L_zpub_0
L_zpub_0_ret:
    v_mfma_f32_16x16x32_bf16 v[160:163], a[96:99], a[72:75], 0
    ds_read_b64_tr_b16 a[162:163], v20 offset:17408
    v_mfma_f32_16x16x32_bf16 v[176:179], a[96:99], a[76:79], 0
    buffer_load_dword v36, v37, s[44:47], s91 offen
    v_mfma_f32_16x16x32_bf16 v[192:195], a[96:99], a[80:83], 0
    ds_read_b128 a[128:131], v19 offset:0
    v_mfma_f32_16x16x32_bf16 v[208:211], a[96:99], a[84:87], 0
    ds_read_b64_tr_b16 a[164:165], v21 offset:16384
    v_mfma_f32_16x16x32_bf16 v[224:227], a[96:99], a[88:91], 0
    ds_read_b64_tr_b16 a[166:167], v21 offset:17408
    v_mfma_f32_16x16x32_bf16 v[240:243], a[96:99], a[92:95], 0
    ds_read_b128 a[132:135], v19 offset:2048
    v_mfma_f32_16x16x32_bf16 v[92:95], a[100:103], a[92:95], 0
    s_nop 0
    s_add_u32 m0, s64, 0
    s_mov_b32 s66, 1048576
    ds_read_b64_tr_b16 a[168:169], v22 offset:16384
    v_mfma_f32_16x16x32_bf16 v[88:91], a[100:103], a[88:91], 0
    buffer_load_dwordx4 v12, s[48:51], s66 offen offset:0 lds
    v_mfma_f32_16x16x32_bf16 v[84:87], a[100:103], a[84:87], 0
    ds_read_b64_tr_b16 a[170:171], v22 offset:17408
    v_mfma_f32_16x16x32_bf16 v[80:83], a[100:103], a[80:83], 0
    ds_read_b128 a[136:139], v19 offset:4096
    v_mfma_f32_16x16x32_bf16 v[76:79], a[100:103], a[76:79], 0
    ds_read_b64_tr_b16 a[172:173], v23 offset:16384
    v_mfma_f32_16x16x32_bf16 v[72:75], a[100:103], a[72:75], 0
    ds_read_b64_tr_b16 a[174:175], v23 offset:17408
    v_mfma_f32_16x16x32_bf16 v[68:71], a[100:103], a[68:71], 0
    ds_read_b128 a[140:143], v19 offset:6144
    v_mfma_f32_16x16x32_bf16 v[64:67], a[100:103], a[64:67], 0
    buffer_load_dwordx4 v13, s[48:51], s66 offen offset:1024 lds
    v_mfma_f32_16x16x32_bf16 v[132:135], a[104:107], a[64:67], 0
    ds_read_b64_tr_b16 a[176:177], v24 offset:16384
    v_mfma_f32_16x16x32_bf16 v[148:151], a[104:107], a[68:71], 0
    ds_read_b64_tr_b16 a[178:179], v24 offset:17408
    v_mfma_f32_16x16x32_bf16 v[164:167], a[104:107], a[72:75], 0
    ds_read_b128 a[144:147], v19 offset:8192
    v_mfma_f32_16x16x32_bf16 v[180:183], a[104:107], a[76:79], 0
    ds_read_b64_tr_b16 a[180:181], v25 offset:16384
    v_mfma_f32_16x16x32_bf16 v[196:199], a[104:107], a[80:83], 0
    ds_read_b64_tr_b16 a[182:183], v25 offset:17408
    v_mfma_f32_16x16x32_bf16 v[212:215], a[104:107], a[84:87], 0
    buffer_load_dwordx4 v14, s[48:51], s66 offen offset:2048 lds
    v_mfma_f32_16x16x32_bf16 v[228:231], a[104:107], a[88:91], 0
    ds_read_b128 a[148:151], v19 offset:10240
    v_mfma_f32_16x16x32_bf16 v[244:247], a[104:107], a[92:95], 0
    ds_read_b64_tr_b16 a[184:185], v26 offset:16384
    v_mfma_f32_16x16x32_bf16 v[124:127], a[108:111], a[92:95], 0
    ds_read_b64_tr_b16 a[186:187], v26 offset:17408
    v_mfma_f32_16x16x32_bf16 v[120:123], a[108:111], a[88:91], 0
    ds_read_b128 a[152:155], v19 offset:12288
    v_mfma_f32_16x16x32_bf16 v[116:119], a[108:111], a[84:87], 0
    ds_read_b64_tr_b16 a[188:189], v27 offset:16384
    v_mfma_f32_16x16x32_bf16 v[112:115], a[108:111], a[80:83], 0
    buffer_load_dwordx4 v15, s[48:51], s66 offen offset:3072 lds
    v_mfma_f32_16x16x32_bf16 v[108:111], a[108:111], a[76:79], 0
    ds_read_b64_tr_b16 a[190:191], v27 offset:17408
    v_mfma_f32_16x16x32_bf16 v[104:107], a[108:111], a[72:75], 0
    ds_read_b128 a[156:159], v19 offset:14336
    v_mfma_f32_16x16x32_bf16 v[100:103], a[108:111], a[68:71], 0
    v_add_u32 v18, 98304, v16
    v_add_u32 v19, 98304, v17
    v_mfma_f32_16x16x32_bf16 v[96:99], a[108:111], a[64:67], 0
    v_lshlrev_b32_e64 v28, 16, v40
    v_and_b32 v29, 0xffff0000, v40
    v_mfma_f32_16x16x32_bf16 v[136:139], a[112:115], a[64:67], 0
    s_add_u32 m0, s65, 135168
    s_mov_b32 s67, 256
    v_lshlrev_b32_e64 v32, 16, v41
    v_and_b32 v33, 0xffff0000, v41
    v_mfma_f32_16x16x32_bf16 v[152:155], a[112:115], a[68:71], 0
    buffer_load_dwordx4 v8, s[44:47], s67 offen offset:0 lds
    v_mfma_f32_16x16x32_bf16 v[168:171], a[112:115], a[72:75], 0
    v_add_f32 v28, v28, v32
    v_add_f32 v29, v29, v33
    v_mfma_f32_16x16x32_bf16 v[184:187], a[112:115], a[76:79], 0
    v_lshlrev_b32_e64 v32, 16, v42
    v_and_b32 v33, 0xffff0000, v42
    v_mfma_f32_16x16x32_bf16 v[200:203], a[112:115], a[80:83], 0
    v_add_f32 v28, v28, v32
    v_add_f32 v29, v29, v33
    v_mfma_f32_16x16x32_bf16 v[216:219], a[112:115], a[84:87], 0
    v_lshlrev_b32_e64 v32, 16, v43
    v_and_b32 v33, 0xffff0000, v43
    v_mfma_f32_16x16x32_bf16 v[232:235], a[112:115], a[88:91], 0
    v_add_f32 v28, v28, v32
    v_add_f32 v29, v29, v33
    v_mfma_f32_16x16x32_bf16 v[248:251], a[112:115], a[92:95], 0
    buffer_load_dwordx4 v9, s[44:47], s67 offen offset:1024 lds
    v_mfma_f32_16x16x32_bf16 a[220:223], a[116:119], a[92:95], 0
    v_lshlrev_b32_e64 v32, 16, v44
    v_and_b32 v33, 0xffff0000, v44
    v_mfma_f32_16x16x32_bf16 a[216:219], a[116:119], a[88:91], 0
    v_add_f32 v28, v28, v32
    v_add_f32 v29, v29, v33
    v_mfma_f32_16x16x32_bf16 a[212:215], a[116:119], a[84:87], 0
    v_lshlrev_b32_e64 v32, 16, v45
    v_and_b32 v33, 0xffff0000, v45
    v_mfma_f32_16x16x32_bf16 a[208:211], a[116:119], a[80:83], 0
    v_add_f32 v28, v28, v32
    v_add_f32 v29, v29, v33
    v_mfma_f32_16x16x32_bf16 a[204:207], a[116:119], a[76:79], 0
    v_lshlrev_b32_e64 v32, 16, v46
    v_and_b32 v33, 0xffff0000, v46
    v_mfma_f32_16x16x32_bf16 a[200:203], a[116:119], a[72:75], 0
    buffer_load_dwordx4 v10, s[44:47], s67 offen offset:2048 lds
    v_mfma_f32_16x16x32_bf16 a[196:199], a[116:119], a[68:71], 0
    v_add_f32 v28, v28, v32
    v_add_f32 v29, v29, v33
    v_mfma_f32_16x16x32_bf16 a[192:195], a[116:119], a[64:67], 0
    v_lshlrev_b32_e64 v32, 16, v47
    v_and_b32 v33, 0xffff0000, v47
    v_mfma_f32_16x16x32_bf16 v[140:143], a[120:123], a[64:67], 0
    v_add_f32 v28, v28, v32
    v_add_f32 v29, v29, v33
    v_mfma_f32_16x16x32_bf16 v[156:159], a[120:123], a[68:71], 0
    v_lshlrev_b32_e64 v32, 16, v48
    v_and_b32 v33, 0xffff0000, v48
    v_mfma_f32_16x16x32_bf16 v[172:175], a[120:123], a[72:75], 0
    s_lshl_b32 s70, s6, 1
    s_add_u32 s70, s70, s7
    s_lshl_b32 s11, s70, 18
    v_add_f32 v28, v28, v32
    v_add_f32_e64 v29, v29, v33
    v_mfma_f32_16x16x32_bf16 v[188:191], a[120:123], a[76:79], 0
    s_lshl_b32 s10, s5, 8
    s_add_u32 s11, s11, s10
    s_add_u32 s14, s14, 256
    buffer_load_dwordx4 v11, s[44:47], s67 offen offset:3072 lds
    v_mfma_f32_16x16x32_bf16 v[204:207], a[120:123], a[80:83], 0
    s_cmp_lt_u32 s4, 2
    s_cselect_b32 s14, s11, s14
    s_cselect_b32 s60, s20, s60
    v_lshlrev_b32 v32, 16, v49
    v_and_b32 v33, 0xffff0000, v49
    v_mfma_f32_16x16x32_bf16 v[220:223], a[120:123], a[84:87], 0
    s_cselect_b32 s61, s21, s61
    s_cselect_b32 s15, s11, 1073741824
    v_add_f32 v28, v28, v32
    v_add_f32 v29, v29, v33
    v_mfma_f32_16x16x32_bf16 v[236:239], a[120:123], a[88:91], 0
    v_lshlrev_b32_e64 v32, 16, v50
    v_and_b32 v33, 0xffff0000, v50
    v_mfma_f32_16x16x32_bf16 v[252:255], a[120:123], a[92:95], 0
    v_add_f32 v28, v28, v32
    v_add_f32 v29, v29, v33
    v_mfma_f32_16x16x32_bf16 a[252:255], a[124:127], a[92:95], 0
    v_lshlrev_b32_e64 v32, 16, v51
    v_and_b32 v33, 0xffff0000, v51
    v_mfma_f32_16x16x32_bf16 a[248:251], a[124:127], a[88:91], 0
    v_add_f32 v28, v28, v32
    v_add_f32 v29, v29, v33
    v_mfma_f32_16x16x32_bf16 a[244:247], a[124:127], a[84:87], 0
    v_lshlrev_b32_e64 v32, 16, v52
    v_and_b32 v33, 0xffff0000, v52
    v_mfma_f32_16x16x32_bf16 a[240:243], a[124:127], a[80:83], 0
    v_add_f32 v28, v28, v32
    v_add_f32 v29, v29, v33
    v_mfma_f32_16x16x32_bf16 a[236:239], a[124:127], a[76:79], 0
    v_lshlrev_b32_e64 v32, 16, v53
    v_and_b32 v33, 0xffff0000, v53
    v_mfma_f32_16x16x32_bf16 a[232:235], a[124:127], a[72:75], 0
    v_add_f32 v28, v28, v32
    v_add_f32 v29, v29, v33
    v_mfma_f32_16x16x32_bf16 a[228:231], a[124:127], a[68:71], 0
    s_waitcnt lgkmcnt(0)
    v_lshlrev_b32 v32, 16, v54
    v_and_b32 v33, 0xffff0000, v54
    v_mfma_f32_16x16x32_bf16 a[224:227], a[124:127], a[64:67], 0
    v_add_f32 v28, v28, v32
    v_add_f32 v29, v29, v33
    v_mfma_f32_16x16x32_bf16 v[128:131], a[160:163], a[128:131], v[128:131]
    s_waitcnt vmcnt(17)
    s_barrier
    v_mfma_f32_16x16x32_bf16 v[144:147], a[160:163], a[132:135], v[144:147]
    ds_read_b64_tr_b16 a[96:97], v20 offset:32768
    v_lshlrev_b32_e64 v32, 16, v55
    v_mfma_f32_16x16x32_bf16 v[160:163], a[160:163], a[136:139], v[160:163]
    s_add_u32 s90, s90, 524288
    ds_read_b64_tr_b16 a[98:99], v20 offset:33792
    v_and_b32 v33, 0xffff0000, v55
    v_mfma_f32_16x16x32_bf16 v[176:179], a[160:163], a[140:143], v[176:179]
    buffer_load_dword v36, v39, s[48:51], s90 offen
    v_mfma_f32_16x16x32_bf16 v[192:195], a[160:163], a[144:147], v[192:195]
    ds_read_b128 a[64:67], v18 offset:0
    v_add_f32_e64 v28, v28, v32
    v_mfma_f32_16x16x32_bf16 v[208:211], a[160:163], a[148:151], v[208:211]
    ds_read_b64_tr_b16 a[100:101], v21 offset:32768
    v_add_f32_e64 v29, v29, v33
    v_mfma_f32_16x16x32_bf16 v[224:227], a[160:163], a[152:155], v[224:227]
    ds_read_b64_tr_b16 a[102:103], v21 offset:33792
    v_add_f32_e64 v28, v28, v29
    v_mfma_f32_16x16x32_bf16 v[240:243], a[160:163], a[156:159], v[240:243]
    ds_read_b128 a[68:71], v18 offset:2048
    v_mfma_f32_16x16x32_bf16 v[92:95], a[164:167], a[156:159], v[92:95]
    s_add_u32 m0, s64, 16384
    s_mov_b32 s66, 1310720
    ds_read_b64_tr_b16 a[104:105], v22 offset:32768
    v_add_f32_dpp v28, v28, v28 row_ror:4 row_mask:0xf bank_mask:0xf
    v_mfma_f32_16x16x32_bf16 v[88:91], a[164:167], a[152:155], v[88:91]
    buffer_load_dwordx4 v12, s[48:51], s66 offen offset:0 lds
    v_mfma_f32_16x16x32_bf16 v[84:87], a[164:167], a[148:151], v[84:87]
    ds_read_b64_tr_b16 a[106:107], v22 offset:33792
    v_add_f32_dpp v28, v28, v28 row_ror:8 row_mask:0xf bank_mask:0xf
    v_mfma_f32_16x16x32_bf16 v[80:83], a[164:167], a[144:147], v[80:83]
    ds_read_b128 a[72:75], v18 offset:4096
    v_mfma_f32_16x16x32_bf16 v[76:79], a[164:167], a[140:143], v[76:79]
    ds_read_b64_tr_b16 a[108:109], v23 offset:32768
    v_mov_b32_e64 v32, v28
    v_mfma_f32_16x16x32_bf16 v[72:75], a[164:167], a[136:139], v[72:75]
    ds_read_b64_tr_b16 a[110:111], v23 offset:33792
    v_mfma_f32_16x16x32_bf16 v[68:71], a[164:167], a[132:135], v[68:71]
    s_nop 0
    ds_read_b128 a[76:79], v18 offset:6144
    v_permlane16_swap_b32 v32, v28
    v_mfma_f32_16x16x32_bf16 v[64:67], a[164:167], a[128:131], v[64:67]
    buffer_load_dwordx4 v13, s[48:51], s66 offen offset:1024 lds
    v_mfma_f32_16x16x32_bf16 v[132:135], a[168:171], a[128:131], v[132:135]
    ds_read_b64_tr_b16 a[112:113], v24 offset:32768
    v_add_f32_e64 v28, v28, v32
    v_mfma_f32_16x16x32_bf16 v[148:151], a[168:171], a[132:135], v[148:151]
    ds_read_b64_tr_b16 a[114:115], v24 offset:33792
    v_mov_b32_e64 v32, v28
    v_mfma_f32_16x16x32_bf16 v[164:167], a[168:171], a[136:139], v[164:167]
    ds_read_b128 a[80:83], v18 offset:8192
    v_mfma_f32_16x16x32_bf16 v[180:183], a[168:171], a[140:143], v[180:183]
    s_nop 0
    ds_read_b64_tr_b16 a[116:117], v25 offset:32768
    v_permlane32_swap_b32 v32, v28
    v_mfma_f32_16x16x32_bf16 v[196:199], a[168:171], a[144:147], v[196:199]
    ds_read_b64_tr_b16 a[118:119], v25 offset:33792
    v_add_f32_e64 v28, v28, v32
    v_mfma_f32_16x16x32_bf16 v[212:215], a[168:171], a[148:151], v[212:215]
    buffer_load_dwordx4 v14, s[48:51], s66 offen offset:2048 lds
    v_mfma_f32_16x16x32_bf16 v[228:231], a[168:171], a[152:155], v[228:231]
    ds_read_b128 a[84:87], v18 offset:10240
    v_mul_f32 v28, 0x3b000000, v28
    v_mfma_f32_16x16x32_bf16 v[244:247], a[168:171], a[156:159], v[244:247]
    ds_read_b64_tr_b16 a[120:121], v26 offset:32768
    v_lshlrev_b32_e64 v32, 16, v40
    v_mfma_f32_16x16x32_bf16 v[124:127], a[172:175], a[156:159], v[124:127]
    ds_read_b64_tr_b16 a[122:123], v26 offset:33792
    v_and_b32 v33, 0xffff0000, v40
    v_mfma_f32_16x16x32_bf16 v[120:123], a[172:175], a[152:155], v[120:123]
    ds_read_b128 a[88:91], v18 offset:12288
    v_sub_f32_e64 v32, v32, v28
    v_mfma_f32_16x16x32_bf16 v[116:119], a[172:175], a[148:151], v[116:119]
    ds_read_b64_tr_b16 a[124:125], v27 offset:32768
    v_sub_f32_e64 v33, v33, v28
    v_mfma_f32_16x16x32_bf16 v[112:115], a[172:175], a[144:147], v[112:115]
    buffer_load_dwordx4 v15, s[48:51], s66 offen offset:3072 lds
    v_mfma_f32_16x16x32_bf16 v[108:111], a[172:175], a[140:143], v[108:111]
    ds_read_b64_tr_b16 a[126:127], v27 offset:33792
    v_mul_f32_e64 v30, v32, v32
    v_mfma_f32_16x16x32_bf16 v[104:107], a[172:175], a[136:139], v[104:107]
    ds_read_b128 a[92:95], v18 offset:14336
    v_mul_f32_e64 v31, v33, v33
    v_mfma_f32_16x16x32_bf16 v[100:103], a[172:175], a[132:135], v[100:103]
    v_lshlrev_b32_e64 v32, 16, v41
    v_and_b32 v33, 0xffff0000, v41
    v_mfma_f32_16x16x32_bf16 v[96:99], a[172:175], a[128:131], v[96:99]
    v_sub_f32 v32, v32, v28
    v_sub_f32 v33, v33, v28
    v_mfma_f32_16x16x32_bf16 v[136:139], a[176:179], a[128:131], v[136:139]
    s_add_u32 m0, s65, 65536
    s_mov_b32 s67, 384
    v_fmac_f32 v30, v32, v32
    v_fmac_f32 v31, v33, v33
    v_mfma_f32_16x16x32_bf16 v[152:155], a[176:179], a[132:135], v[152:155]
    buffer_load_dwordx4 v4, s[44:47], s67 offen offset:0 lds
    v_mfma_f32_16x16x32_bf16 v[168:171], a[176:179], a[136:139], v[168:171]
    v_lshlrev_b32_e64 v32, 16, v42
    v_and_b32 v33, 0xffff0000, v42
    v_mfma_f32_16x16x32_bf16 v[184:187], a[176:179], a[140:143], v[184:187]
    v_sub_f32 v32, v32, v28
    v_sub_f32 v33, v33, v28
    v_mfma_f32_16x16x32_bf16 v[200:203], a[176:179], a[144:147], v[200:203]
    v_fmac_f32 v30, v32, v32
    v_fmac_f32 v31, v33, v33
    v_mfma_f32_16x16x32_bf16 v[216:219], a[176:179], a[148:151], v[216:219]
    v_lshlrev_b32_e64 v32, 16, v43
    v_and_b32 v33, 0xffff0000, v43
    v_mfma_f32_16x16x32_bf16 v[232:235], a[176:179], a[152:155], v[232:235]
    v_sub_f32 v32, v32, v28
    v_sub_f32 v33, v33, v28
    v_mfma_f32_16x16x32_bf16 v[248:251], a[176:179], a[156:159], v[248:251]
    buffer_load_dwordx4 v5, s[44:47], s67 offen offset:1024 lds
    v_mfma_f32_16x16x32_bf16 a[220:223], a[180:183], a[156:159], a[220:223]
    v_fmac_f32 v30, v32, v32
    v_fmac_f32 v31, v33, v33
    v_mfma_f32_16x16x32_bf16 a[216:219], a[180:183], a[152:155], a[216:219]
    v_lshlrev_b32_e64 v32, 16, v44
    v_and_b32 v33, 0xffff0000, v44
    v_mfma_f32_16x16x32_bf16 a[212:215], a[180:183], a[148:151], a[212:215]
    v_sub_f32 v32, v32, v28
    v_sub_f32 v33, v33, v28
    v_mfma_f32_16x16x32_bf16 a[208:211], a[180:183], a[144:147], a[208:211]
    v_fmac_f32 v30, v32, v32
    v_fmac_f32 v31, v33, v33
    v_mfma_f32_16x16x32_bf16 a[204:207], a[180:183], a[140:143], a[204:207]
    v_lshlrev_b32_e64 v32, 16, v45
    v_and_b32 v33, 0xffff0000, v45
    v_mfma_f32_16x16x32_bf16 a[200:203], a[180:183], a[136:139], a[200:203]
    buffer_load_dwordx4 v6, s[44:47], s67 offen offset:2048 lds
    v_mfma_f32_16x16x32_bf16 a[196:199], a[180:183], a[132:135], a[196:199]
    v_sub_f32 v32, v32, v28
    v_sub_f32 v33, v33, v28
    v_mfma_f32_16x16x32_bf16 a[192:195], a[180:183], a[128:131], a[192:195]
    v_fmac_f32 v30, v32, v32
    v_fmac_f32 v31, v33, v33
    v_mfma_f32_16x16x32_bf16 v[140:143], a[184:187], a[128:131], v[140:143]
    v_lshlrev_b32_e64 v32, 16, v46
    v_and_b32 v33, 0xffff0000, v46
    v_mfma_f32_16x16x32_bf16 v[156:159], a[184:187], a[132:135], v[156:159]
    v_sub_f32 v32, v32, v28
    v_sub_f32 v33, v33, v28
    v_mfma_f32_16x16x32_bf16 v[172:175], a[184:187], a[136:139], v[172:175]
    v_fmac_f32 v30, v32, v32
    v_fmac_f32 v31, v33, v33
    v_mfma_f32_16x16x32_bf16 v[188:191], a[184:187], a[140:143], v[188:191]
    buffer_load_dwordx4 v7, s[44:47], s67 offen offset:3072 lds
    v_mfma_f32_16x16x32_bf16 v[204:207], a[184:187], a[144:147], v[204:207]
    v_lshlrev_b32_e64 v32, 16, v47
    v_and_b32 v33, 0xffff0000, v47
    v_mfma_f32_16x16x32_bf16 v[220:223], a[184:187], a[148:151], v[220:223]
    v_sub_f32 v32, v32, v28
    v_sub_f32 v33, v33, v28
    v_mfma_f32_16x16x32_bf16 v[236:239], a[184:187], a[152:155], v[236:239]
    v_fmac_f32 v30, v32, v32
    v_fmac_f32 v31, v33, v33
    v_mfma_f32_16x16x32_bf16 v[252:255], a[184:187], a[156:159], v[252:255]
    v_lshlrev_b32_e64 v32, 16, v48
    v_and_b32 v33, 0xffff0000, v48
    v_mfma_f32_16x16x32_bf16 a[252:255], a[188:191], a[156:159], a[252:255]
    v_sub_f32 v32, v32, v28
    v_sub_f32 v33, v33, v28
    v_mfma_f32_16x16x32_bf16 a[248:251], a[188:191], a[152:155], a[248:251]
    v_fmac_f32 v30, v32, v32
    v_fmac_f32 v31, v33, v33
    v_mfma_f32_16x16x32_bf16 a[244:247], a[188:191], a[148:151], a[244:247]
    v_lshlrev_b32_e64 v32, 16, v49
    v_and_b32 v33, 0xffff0000, v49
    v_mfma_f32_16x16x32_bf16 a[240:243], a[188:191], a[144:147], a[240:243]
    v_sub_f32 v32, v32, v28
    v_sub_f32 v33, v33, v28
    v_mfma_f32_16x16x32_bf16 a[236:239], a[188:191], a[140:143], a[236:239]
    v_fmac_f32 v30, v32, v32
    v_fmac_f32 v31, v33, v33
    v_mfma_f32_16x16x32_bf16 a[232:235], a[188:191], a[136:139], a[232:235]
    v_lshlrev_b32_e64 v32, 16, v50
    v_and_b32 v33, 0xffff0000, v50
    v_mfma_f32_16x16x32_bf16 a[228:231], a[188:191], a[132:135], a[228:231]
    s_waitcnt lgkmcnt(0)
    v_sub_f32 v32, v32, v28
    v_sub_f32_e64 v33, v33, v28
    v_mfma_f32_16x16x32_bf16 a[224:227], a[188:191], a[128:131], a[224:227]
    v_fmac_f32 v30, v32, v32
    v_fmac_f32 v31, v33, v33
    v_mfma_f32_16x16x32_bf16 v[128:131], a[96:99], a[64:67], v[128:131]
    s_waitcnt vmcnt(22)
    s_barrier
    v_mfma_f32_16x16x32_bf16 v[144:147], a[96:99], a[68:71], v[144:147]
    ds_read_b64_tr_b16 a[160:161], v20 offset:49152
    v_lshlrev_b32_e64 v32, 16, v51
    v_mfma_f32_16x16x32_bf16 v[160:163], a[96:99], a[72:75], v[160:163]
    s_add_u32 s90, s90, 524288
    ds_read_b64_tr_b16 a[162:163], v20 offset:50176
    v_and_b32 v33, 0xffff0000, v51
    v_mfma_f32_16x16x32_bf16 v[176:179], a[96:99], a[76:79], v[176:179]
    buffer_load_dword v36, v39, s[48:51], s90 offen
    v_mfma_f32_16x16x32_bf16 v[192:195], a[96:99], a[80:83], v[192:195]
    ds_read_b128 a[128:131], v19 offset:0
    v_sub_f32_e64 v32, v32, v28
    v_mfma_f32_16x16x32_bf16 v[208:211], a[96:99], a[84:87], v[208:211]
    ds_read_b64_tr_b16 a[164:165], v21 offset:49152
    v_sub_f32_e64 v33, v33, v28
    v_mfma_f32_16x16x32_bf16 v[224:227], a[96:99], a[88:91], v[224:227]
    ds_read_b64_tr_b16 a[166:167], v21 offset:50176
    v_fmac_f32_e64 v30, v32, v32
    v_mfma_f32_16x16x32_bf16 v[240:243], a[96:99], a[92:95], v[240:243]
    ds_read_b128 a[132:135], v19 offset:2048
    v_fmac_f32_e64 v31, v33, v33
    v_mfma_f32_16x16x32_bf16 v[92:95], a[100:103], a[92:95], v[92:95]
    s_add_u32 m0, s64, 32768
    s_mov_b32 s66, 1572864
    ds_read_b64_tr_b16 a[168:169], v22 offset:49152
    v_lshlrev_b32_e64 v32, 16, v52
    v_mfma_f32_16x16x32_bf16 v[88:91], a[100:103], a[88:91], v[88:91]
    buffer_load_dwordx4 v12, s[48:51], s66 offen offset:0 lds
    v_mfma_f32_16x16x32_bf16 v[84:87], a[100:103], a[84:87], v[84:87]
    ds_read_b64_tr_b16 a[170:171], v22 offset:50176
    v_and_b32 v33, 0xffff0000, v52
    v_mfma_f32_16x16x32_bf16 v[80:83], a[100:103], a[80:83], v[80:83]
    ds_read_b128 a[136:139], v19 offset:4096
    v_sub_f32_e64 v32, v32, v28
    v_mfma_f32_16x16x32_bf16 v[76:79], a[100:103], a[76:79], v[76:79]
    ds_read_b64_tr_b16 a[172:173], v23 offset:49152
    v_sub_f32_e64 v33, v33, v28
    v_mfma_f32_16x16x32_bf16 v[72:75], a[100:103], a[72:75], v[72:75]
    ds_read_b64_tr_b16 a[174:175], v23 offset:50176
    v_fmac_f32_e64 v30, v32, v32
    v_mfma_f32_16x16x32_bf16 v[68:71], a[100:103], a[68:71], v[68:71]
    ds_read_b128 a[140:143], v19 offset:6144
    v_fmac_f32_e64 v31, v33, v33
    v_mfma_f32_16x16x32_bf16 v[64:67], a[100:103], a[64:67], v[64:67]
    buffer_load_dwordx4 v13, s[48:51], s66 offen offset:1024 lds
    v_mfma_f32_16x16x32_bf16 v[132:135], a[104:107], a[64:67], v[132:135]
    ds_read_b64_tr_b16 a[176:177], v24 offset:49152
    v_lshlrev_b32_e64 v32, 16, v53
    v_mfma_f32_16x16x32_bf16 v[148:151], a[104:107], a[68:71], v[148:151]
    ds_read_b64_tr_b16 a[178:179], v24 offset:50176
    v_and_b32 v33, 0xffff0000, v53
    v_mfma_f32_16x16x32_bf16 v[164:167], a[104:107], a[72:75], v[164:167]
    ds_read_b128 a[144:147], v19 offset:8192
    v_sub_f32_e64 v32, v32, v28
    v_mfma_f32_16x16x32_bf16 v[180:183], a[104:107], a[76:79], v[180:183]
    ds_read_b64_tr_b16 a[180:181], v25 offset:49152
    v_sub_f32_e64 v33, v33, v28
    v_mfma_f32_16x16x32_bf16 v[196:199], a[104:107], a[80:83], v[196:199]
    ds_read_b64_tr_b16 a[182:183], v25 offset:50176
    v_fmac_f32_e64 v30, v32, v32
    v_mfma_f32_16x16x32_bf16 v[212:215], a[104:107], a[84:87], v[212:215]
    buffer_load_dwordx4 v14, s[48:51], s66 offen offset:2048 lds
    v_mfma_f32_16x16x32_bf16 v[228:231], a[104:107], a[88:91], v[228:231]
    ds_read_b128 a[148:151], v19 offset:10240
    v_fmac_f32_e64 v31, v33, v33
    v_mfma_f32_16x16x32_bf16 v[244:247], a[104:107], a[92:95], v[244:247]
    ds_read_b64_tr_b16 a[184:185], v26 offset:49152
    v_lshlrev_b32_e64 v32, 16, v54
    v_mfma_f32_16x16x32_bf16 v[124:127], a[108:111], a[92:95], v[124:127]
    ds_read_b64_tr_b16 a[186:187], v26 offset:50176
    v_and_b32 v33, 0xffff0000, v54
    v_mfma_f32_16x16x32_bf16 v[120:123], a[108:111], a[88:91], v[120:123]
    ds_read_b128 a[152:155], v19 offset:12288
    v_sub_f32_e64 v32, v32, v28
    v_mfma_f32_16x16x32_bf16 v[116:119], a[108:111], a[84:87], v[116:119]
    ds_read_b64_tr_b16 a[188:189], v27 offset:49152
    v_sub_f32_e64 v33, v33, v28
    v_mfma_f32_16x16x32_bf16 v[112:115], a[108:111], a[80:83], v[112:115]
    buffer_load_dwordx4 v15, s[48:51], s66 offen offset:3072 lds
    v_mfma_f32_16x16x32_bf16 v[108:111], a[108:111], a[76:79], v[108:111]
    ds_read_b64_tr_b16 a[190:191], v27 offset:50176
    v_fmac_f32_e64 v30, v32, v32
    v_mfma_f32_16x16x32_bf16 v[104:107], a[108:111], a[72:75], v[104:107]
    ds_read_b128 a[156:159], v19 offset:14336
    v_fmac_f32_e64 v31, v33, v33
    v_mfma_f32_16x16x32_bf16 v[100:103], a[108:111], a[68:71], v[100:103]
    v_add_u32 v18, 131072, v16
    v_add_u32 v19, 131072, v17
    v_mfma_f32_16x16x32_bf16 v[96:99], a[108:111], a[64:67], v[96:99]
    v_lshlrev_b32_e64 v32, 16, v55
    v_and_b32 v33, 0xffff0000, v55
    v_mfma_f32_16x16x32_bf16 v[136:139], a[112:115], a[64:67], v[136:139]
    s_add_u32 m0, s65, 69632
    s_mov_b32 s67, 384
    v_sub_f32 v32, v32, v28
    v_sub_f32 v33, v33, v28
    v_mfma_f32_16x16x32_bf16 v[152:155], a[112:115], a[68:71], v[152:155]
    buffer_load_dwordx4 v8, s[44:47], s67 offen offset:0 lds
    v_mfma_f32_16x16x32_bf16 v[168:171], a[112:115], a[72:75], v[168:171]
    v_fmac_f32 v30, v32, v32
    v_fmac_f32 v31, v33, v33
    v_mfma_f32_16x16x32_bf16 v[184:187], a[112:115], a[76:79], v[184:187]
    v_add_f32_e64 v30, v30, v31
    v_mfma_f32_16x16x32_bf16 v[200:203], a[112:115], a[80:83], v[200:203]
    v_mfma_f32_16x16x32_bf16 v[216:219], a[112:115], a[84:87], v[216:219]
    v_add_f32_dpp v30, v30, v30 row_ror:4 row_mask:0xf bank_mask:0xf
    v_mfma_f32_16x16x32_bf16 v[232:235], a[112:115], a[88:91], v[232:235]
    v_mfma_f32_16x16x32_bf16 v[248:251], a[112:115], a[92:95], v[248:251]
    buffer_load_dwordx4 v9, s[44:47], s67 offen offset:1024 lds
    v_mfma_f32_16x16x32_bf16 a[220:223], a[116:119], a[92:95], a[220:223]
    v_add_f32_dpp v30, v30, v30 row_ror:8 row_mask:0xf bank_mask:0xf
    v_mfma_f32_16x16x32_bf16 a[216:219], a[116:119], a[88:91], a[216:219]
    v_mfma_f32_16x16x32_bf16 a[212:215], a[116:119], a[84:87], a[212:215]
    v_mov_b32_e64 v32, v30
    v_mfma_f32_16x16x32_bf16 a[208:211], a[116:119], a[80:83], a[208:211]
    v_mfma_f32_16x16x32_bf16 a[204:207], a[116:119], a[76:79], a[204:207]
    v_permlane16_swap_b32 v32, v30
    v_add_f32 v30, v30, v32
    v_mfma_f32_16x16x32_bf16 a[200:203], a[116:119], a[72:75], a[200:203]
    buffer_load_dwordx4 v10, s[44:47], s67 offen offset:2048 lds
    v_mfma_f32_16x16x32_bf16 a[196:199], a[116:119], a[68:71], a[196:199]
    v_mov_b32_e64 v32, v30
    v_mfma_f32_16x16x32_bf16 a[192:195], a[116:119], a[64:67], a[192:195]
    v_mfma_f32_16x16x32_bf16 v[140:143], a[120:123], a[64:67], v[140:143]
    v_permlane32_swap_b32 v32, v30
    v_add_f32 v30, v30, v32
    v_mfma_f32_16x16x32_bf16 v[156:159], a[120:123], a[68:71], v[156:159]
    v_mul_f32 v30, 0x3b000000, v30
    v_cvt_pk_bf16_f32 v32, v28, v30
    v_mfma_f32_16x16x32_bf16 v[172:175], a[120:123], a[72:75], v[172:175]
    v_lshlrev_b32_e64 v28, 16, v32
    v_and_b32 v30, 0xffff0000, v32
    v_mfma_f32_16x16x32_bf16 v[188:191], a[120:123], a[76:79], v[188:191]
    buffer_load_dwordx4 v11, s[44:47], s67 offen offset:3072 lds
    v_mfma_f32_16x16x32_bf16 v[204:207], a[120:123], a[80:83], v[204:207]
    v_add_f32 v30, 0x3727c5ac, v30
    v_cvt_pk_bf16_f32 v32, v30, v30
    v_mfma_f32_16x16x32_bf16 v[220:223], a[120:123], a[84:87], v[220:223]
    v_lshlrev_b32_e64 v30, 16, v32
    v_mfma_f32_16x16x32_bf16 v[236:239], a[120:123], a[88:91], v[236:239]
    v_sqrt_f32_e64 v30, v30
    v_mfma_f32_16x16x32_bf16 v[252:255], a[120:123], a[92:95], v[252:255]
    v_cvt_pk_bf16_f32 v32, v30, v30
    v_lshlrev_b32_e64 v30, 16, v32
    v_mfma_f32_16x16x32_bf16 a[252:255], a[124:127], a[92:95], a[252:255]
    v_rcp_f32_e64 v30, v30
    v_mfma_f32_16x16x32_bf16 a[248:251], a[124:127], a[88:91], a[248:251]
    v_mul_f32 v30, 0x3e0293ee, v30
    v_lshlrev_b32_e64 v32, 16, v40
    v_mfma_f32_16x16x32_bf16 a[244:247], a[124:127], a[84:87], a[244:247]
    v_and_b32 v33, 0xffff0000, v40
    v_sub_f32_e64 v32, v32, v28
    v_mfma_f32_16x16x32_bf16 a[240:243], a[124:127], a[80:83], a[240:243]
    v_sub_f32_e64 v33, v33, v28
    v_cvt_pk_bf16_f32 v31, v32, v33
    v_mfma_f32_16x16x32_bf16 a[236:239], a[124:127], a[76:79], a[236:239]
    v_lshlrev_b32_e64 v32, 16, v31
    v_and_b32 v33, 0xffff0000, v31
    v_mfma_f32_16x16x32_bf16 a[232:235], a[124:127], a[72:75], a[232:235]
    v_mul_f32 v32, v32, v30
    v_mul_f32 v33, v33, v30
    v_mfma_f32_16x16x32_bf16 a[228:231], a[124:127], a[68:71], a[228:231]
    s_waitcnt lgkmcnt(0)
    v_cvt_pk_bf16_f32 v56, v32, v33
    v_lshlrev_b32 v32, 16, v41
    v_mfma_f32_16x16x32_bf16 a[224:227], a[124:127], a[64:67], a[224:227]
    v_and_b32 v33, 0xffff0000, v41
    v_sub_f32_e64 v32, v32, v28
    v_mfma_f32_16x16x32_bf16 v[128:131], a[160:163], a[128:131], v[128:131]
    s_waitcnt vmcnt(18)
    s_barrier
    v_mfma_f32_16x16x32_bf16 v[144:147], a[160:163], a[132:135], v[144:147]
    ds_read_b64_tr_b16 a[96:97], v20 offset:0
    v_sub_f32_e64 v33, v33, v28
    v_mfma_f32_16x16x32_bf16 v[160:163], a[160:163], a[136:139], v[160:163]
    s_add_u32 s90, s90, 524288
    ds_read_b64_tr_b16 a[98:99], v20 offset:1024
    v_cvt_pk_bf16_f32 v31, v32, v33
    v_mfma_f32_16x16x32_bf16 v[176:179], a[160:163], a[140:143], v[176:179]
    buffer_load_dword v36, v39, s[48:51], s90 offen
    v_mfma_f32_16x16x32_bf16 v[192:195], a[160:163], a[144:147], v[192:195]
    ds_read_b128 a[64:67], v18 offset:0
    v_lshlrev_b32_e64 v32, 16, v31
    v_mfma_f32_16x16x32_bf16 v[208:211], a[160:163], a[148:151], v[208:211]
    ds_read_b64_tr_b16 a[100:101], v21 offset:0
    v_and_b32 v33, 0xffff0000, v31
    v_mfma_f32_16x16x32_bf16 v[224:227], a[160:163], a[152:155], v[224:227]
    ds_read_b64_tr_b16 a[102:103], v21 offset:1024
    v_mul_f32_e64 v32, v32, v30
    v_mfma_f32_16x16x32_bf16 v[240:243], a[160:163], a[156:159], v[240:243]
    ds_read_b128 a[68:71], v18 offset:2048
    v_mul_f32_e64 v33, v33, v30
    v_mfma_f32_16x16x32_bf16 v[92:95], a[164:167], a[156:159], v[92:95]
    s_add_u32 m0, s64, 49152
    s_mov_b32 s66, 1835008
    ds_read_b64_tr_b16 a[104:105], v22 offset:0
    v_cvt_pk_bf16_f32 v57, v32, v33
    v_mfma_f32_16x16x32_bf16 v[88:91], a[164:167], a[152:155], v[88:91]
    buffer_load_dwordx4 v12, s[48:51], s66 offen offset:0 lds
    v_mfma_f32_16x16x32_bf16 v[84:87], a[164:167], a[148:151], v[84:87]
    ds_read_b64_tr_b16 a[106:107], v22 offset:1024
    v_lshlrev_b32_e64 v32, 16, v42
    v_mfma_f32_16x16x32_bf16 v[80:83], a[164:167], a[144:147], v[80:83]
    ds_read_b128 a[72:75], v18 offset:4096
    v_and_b32 v33, 0xffff0000, v42
    v_mfma_f32_16x16x32_bf16 v[76:79], a[164:167], a[140:143], v[76:79]
    ds_read_b64_tr_b16 a[108:109], v23 offset:0
    v_sub_f32_e64 v32, v32, v28
    v_mfma_f32_16x16x32_bf16 v[72:75], a[164:167], a[136:139], v[72:75]
    ds_read_b64_tr_b16 a[110:111], v23 offset:1024
    v_sub_f32_e64 v33, v33, v28
    v_mfma_f32_16x16x32_bf16 v[68:71], a[164:167], a[132:135], v[68:71]
    ds_read_b128 a[76:79], v18 offset:6144
    v_cvt_pk_bf16_f32 v31, v32, v33
    v_mfma_f32_16x16x32_bf16 v[64:67], a[164:167], a[128:131], v[64:67]
    buffer_load_dwordx4 v13, s[48:51], s66 offen offset:1024 lds
    v_mfma_f32_16x16x32_bf16 v[132:135], a[168:171], a[128:131], v[132:135]
    ds_read_b64_tr_b16 a[112:113], v24 offset:0
    v_lshlrev_b32_e64 v32, 16, v31
    v_mfma_f32_16x16x32_bf16 v[148:151], a[168:171], a[132:135], v[148:151]
    ds_read_b64_tr_b16 a[114:115], v24 offset:1024
    v_and_b32 v33, 0xffff0000, v31
    v_mfma_f32_16x16x32_bf16 v[164:167], a[168:171], a[136:139], v[164:167]
    ds_read_b128 a[80:83], v18 offset:8192
    v_mul_f32_e64 v32, v32, v30
    v_mfma_f32_16x16x32_bf16 v[180:183], a[168:171], a[140:143], v[180:183]
    ds_read_b64_tr_b16 a[116:117], v25 offset:0
    v_mul_f32_e64 v33, v33, v30
    v_mfma_f32_16x16x32_bf16 v[196:199], a[168:171], a[144:147], v[196:199]
    ds_read_b64_tr_b16 a[118:119], v25 offset:1024
    v_cvt_pk_bf16_f32 v58, v32, v33
    v_mfma_f32_16x16x32_bf16 v[212:215], a[168:171], a[148:151], v[212:215]
    buffer_load_dwordx4 v14, s[48:51], s66 offen offset:2048 lds
    v_mfma_f32_16x16x32_bf16 v[228:231], a[168:171], a[152:155], v[228:231]
    ds_read_b128 a[84:87], v18 offset:10240
    v_lshlrev_b32_e64 v32, 16, v43
    v_mfma_f32_16x16x32_bf16 v[244:247], a[168:171], a[156:159], v[244:247]
    ds_read_b64_tr_b16 a[120:121], v26 offset:0
    v_and_b32 v33, 0xffff0000, v43
    v_mfma_f32_16x16x32_bf16 v[124:127], a[172:175], a[156:159], v[124:127]
    ds_read_b64_tr_b16 a[122:123], v26 offset:1024
    v_sub_f32_e64 v32, v32, v28
    v_mfma_f32_16x16x32_bf16 v[120:123], a[172:175], a[152:155], v[120:123]
    ds_read_b128 a[88:91], v18 offset:12288
    v_sub_f32_e64 v33, v33, v28
    v_mfma_f32_16x16x32_bf16 v[116:119], a[172:175], a[148:151], v[116:119]
    ds_read_b64_tr_b16 a[124:125], v27 offset:0
    v_cvt_pk_bf16_f32 v31, v32, v33
    v_mfma_f32_16x16x32_bf16 v[112:115], a[172:175], a[144:147], v[112:115]
    buffer_load_dwordx4 v15, s[48:51], s66 offen offset:3072 lds
    v_mfma_f32_16x16x32_bf16 v[108:111], a[172:175], a[140:143], v[108:111]
    ds_read_b64_tr_b16 a[126:127], v27 offset:1024
    v_lshlrev_b32_e64 v32, 16, v31
    v_mfma_f32_16x16x32_bf16 v[104:107], a[172:175], a[136:139], v[104:107]
    ds_read_b128 a[92:95], v18 offset:14336
    v_and_b32 v33, 0xffff0000, v31
    v_mfma_f32_16x16x32_bf16 v[100:103], a[172:175], a[132:135], v[100:103]
    v_mul_f32 v32, v32, v30
    v_mul_f32 v33, v33, v30
    v_mfma_f32_16x16x32_bf16 v[96:99], a[172:175], a[128:131], v[96:99]
    v_cvt_pk_bf16_f32 v59, v32, v33
    v_mfma_f32_16x16x32_bf16 v[136:139], a[176:179], a[128:131], v[136:139]
    s_add_u32 m0, s65, 98304
    s_mov_b32 s67, 512
    buffer_store_dwordx4 v[56:59], v34, s[52:55], s13 offen sc1
    v_mfma_f32_16x16x32_bf16 v[152:155], a[176:179], a[132:135], v[152:155]
    buffer_load_dwordx4 v4, s[44:47], s67 offen offset:0 lds
    v_mfma_f32_16x16x32_bf16 v[168:171], a[176:179], a[136:139], v[168:171]
    v_lshlrev_b32_e64 v32, 16, v44
    v_and_b32 v33, 0xffff0000, v44
    v_mfma_f32_16x16x32_bf16 v[184:187], a[176:179], a[140:143], v[184:187]
    v_sub_f32 v32, v32, v28
    v_sub_f32 v33, v33, v28
    v_mfma_f32_16x16x32_bf16 v[200:203], a[176:179], a[144:147], v[200:203]
    v_cvt_pk_bf16_f32 v31, v32, v33
    v_lshlrev_b32_e64 v32, 16, v31
    v_mfma_f32_16x16x32_bf16 v[216:219], a[176:179], a[148:151], v[216:219]
    v_and_b32 v33, 0xffff0000, v31
    v_mul_f32_e64 v32, v32, v30
    v_mfma_f32_16x16x32_bf16 v[232:235], a[176:179], a[152:155], v[232:235]
    v_mul_f32_e64 v33, v33, v30
    v_cvt_pk_bf16_f32 v60, v32, v33
    v_mfma_f32_16x16x32_bf16 v[248:251], a[176:179], a[156:159], v[248:251]
    buffer_load_dwordx4 v5, s[44:47], s67 offen offset:1024 lds
    v_mfma_f32_16x16x32_bf16 a[220:223], a[180:183], a[156:159], a[220:223]
    v_lshlrev_b32_e64 v32, 16, v45
    v_and_b32 v33, 0xffff0000, v45
    v_mfma_f32_16x16x32_bf16 a[216:219], a[180:183], a[152:155], a[216:219]
    v_sub_f32 v32, v32, v28
    v_sub_f32 v33, v33, v28
    v_mfma_f32_16x16x32_bf16 a[212:215], a[180:183], a[148:151], a[212:215]
    v_cvt_pk_bf16_f32 v31, v32, v33
    v_lshlrev_b32_e64 v32, 16, v31
    v_mfma_f32_16x16x32_bf16 a[208:211], a[180:183], a[144:147], a[208:211]
    v_and_b32 v33, 0xffff0000, v31
    v_mul_f32_e64 v32, v32, v30
    v_mfma_f32_16x16x32_bf16 a[204:207], a[180:183], a[140:143], a[204:207]
    v_mul_f32_e64 v33, v33, v30
    v_cvt_pk_bf16_f32 v61, v32, v33
    v_mfma_f32_16x16x32_bf16 a[200:203], a[180:183], a[136:139], a[200:203]
    buffer_load_dwordx4 v6, s[44:47], s67 offen offset:2048 lds
    v_mfma_f32_16x16x32_bf16 a[196:199], a[180:183], a[132:135], a[196:199]
    v_lshlrev_b32_e64 v32, 16, v46
    v_and_b32 v33, 0xffff0000, v46
    v_mfma_f32_16x16x32_bf16 a[192:195], a[180:183], a[128:131], a[192:195]
    v_sub_f32 v32, v32, v28
    v_sub_f32 v33, v33, v28
    v_mfma_f32_16x16x32_bf16 v[140:143], a[184:187], a[128:131], v[140:143]
    v_cvt_pk_bf16_f32 v31, v32, v33
    v_lshlrev_b32_e64 v32, 16, v31
    v_mfma_f32_16x16x32_bf16 v[156:159], a[184:187], a[132:135], v[156:159]
    v_and_b32 v33, 0xffff0000, v31
    v_mul_f32_e64 v32, v32, v30
    v_mfma_f32_16x16x32_bf16 v[172:175], a[184:187], a[136:139], v[172:175]
    v_mul_f32_e64 v33, v33, v30
    v_cvt_pk_bf16_f32 v62, v32, v33
    v_mfma_f32_16x16x32_bf16 v[188:191], a[184:187], a[140:143], v[188:191]
    buffer_load_dwordx4 v7, s[44:47], s67 offen offset:3072 lds
    v_mfma_f32_16x16x32_bf16 v[204:207], a[184:187], a[144:147], v[204:207]
    v_lshlrev_b32_e64 v32, 16, v47
    v_and_b32 v33, 0xffff0000, v47
    v_mfma_f32_16x16x32_bf16 v[220:223], a[184:187], a[148:151], v[220:223]
    v_sub_f32 v32, v32, v28
    v_sub_f32 v33, v33, v28
    v_mfma_f32_16x16x32_bf16 v[236:239], a[184:187], a[152:155], v[236:239]
    v_cvt_pk_bf16_f32 v31, v32, v33
    v_lshlrev_b32_e64 v32, 16, v31
    v_mfma_f32_16x16x32_bf16 v[252:255], a[184:187], a[156:159], v[252:255]
    v_and_b32 v33, 0xffff0000, v31
    v_mul_f32_e64 v32, v32, v30
    v_mfma_f32_16x16x32_bf16 a[252:255], a[188:191], a[156:159], a[252:255]
    v_mul_f32_e64 v33, v33, v30
    v_cvt_pk_bf16_f32 v63, v32, v33
    v_mfma_f32_16x16x32_bf16 a[248:251], a[188:191], a[152:155], a[248:251]
    buffer_store_dwordx4 v[60:63], v34, s[52:55], s12 offen sc1
    v_mfma_f32_16x16x32_bf16 a[244:247], a[188:191], a[148:151], a[244:247]
    v_mfma_f32_16x16x32_bf16 a[240:243], a[188:191], a[144:147], a[240:243]
    v_mfma_f32_16x16x32_bf16 a[236:239], a[188:191], a[140:143], a[236:239]
    v_mfma_f32_16x16x32_bf16 a[232:235], a[188:191], a[136:139], a[232:235]
    v_mfma_f32_16x16x32_bf16 a[228:231], a[188:191], a[132:135], a[228:231]
    s_nop 0
    s_waitcnt lgkmcnt(0)
    v_mfma_f32_16x16x32_bf16 a[224:227], a[188:191], a[128:131], a[224:227]
    v_mfma_f32_16x16x32_bf16 v[128:131], a[96:99], a[64:67], v[128:131]
    s_waitcnt vmcnt(24)
    s_barrier
    v_mfma_f32_16x16x32_bf16 v[144:147], a[96:99], a[68:71], v[144:147]
    ds_read_b64_tr_b16 a[160:161], v20 offset:16384
    v_mfma_f32_16x16x32_bf16 v[160:163], a[96:99], a[72:75], v[160:163]
    s_add_u32 s90, s90, 524288
    ds_read_b64_tr_b16 a[162:163], v20 offset:17408
    v_mfma_f32_16x16x32_bf16 v[176:179], a[96:99], a[76:79], v[176:179]
    buffer_load_dword v36, v39, s[48:51], s90 offen
    v_mfma_f32_16x16x32_bf16 v[192:195], a[96:99], a[80:83], v[192:195]
    ds_read_b128 a[128:131], v19 offset:0
    v_mfma_f32_16x16x32_bf16 v[208:211], a[96:99], a[84:87], v[208:211]
    ds_read_b64_tr_b16 a[164:165], v21 offset:16384
    v_mfma_f32_16x16x32_bf16 v[224:227], a[96:99], a[88:91], v[224:227]
    ds_read_b64_tr_b16 a[166:167], v21 offset:17408
    v_mfma_f32_16x16x32_bf16 v[240:243], a[96:99], a[92:95], v[240:243]
    ds_read_b128 a[132:135], v19 offset:2048
    v_mfma_f32_16x16x32_bf16 v[92:95], a[100:103], a[92:95], v[92:95]
    s_nop 0
    s_add_u32 m0, s64, 0
    s_mov_b32 s66, 2097152
    ds_read_b64_tr_b16 a[168:169], v22 offset:16384
    v_mfma_f32_16x16x32_bf16 v[88:91], a[100:103], a[88:91], v[88:91]
    buffer_load_dwordx4 v12, s[48:51], s66 offen offset:0 lds
    v_mfma_f32_16x16x32_bf16 v[84:87], a[100:103], a[84:87], v[84:87]
    ds_read_b64_tr_b16 a[170:171], v22 offset:17408
    v_mfma_f32_16x16x32_bf16 v[80:83], a[100:103], a[80:83], v[80:83]
    ds_read_b128 a[136:139], v19 offset:4096
    v_mfma_f32_16x16x32_bf16 v[76:79], a[100:103], a[76:79], v[76:79]
    ds_read_b64_tr_b16 a[172:173], v23 offset:16384
    v_mfma_f32_16x16x32_bf16 v[72:75], a[100:103], a[72:75], v[72:75]
    ds_read_b64_tr_b16 a[174:175], v23 offset:17408
    v_mfma_f32_16x16x32_bf16 v[68:71], a[100:103], a[68:71], v[68:71]
    ds_read_b128 a[140:143], v19 offset:6144
    v_mfma_f32_16x16x32_bf16 v[64:67], a[100:103], a[64:67], v[64:67]
    buffer_load_dwordx4 v13, s[48:51], s66 offen offset:1024 lds
    v_mfma_f32_16x16x32_bf16 v[132:135], a[104:107], a[64:67], v[132:135]
    ds_read_b64_tr_b16 a[176:177], v24 offset:16384
    v_mfma_f32_16x16x32_bf16 v[148:151], a[104:107], a[68:71], v[148:151]
    ds_read_b64_tr_b16 a[178:179], v24 offset:17408
    v_mfma_f32_16x16x32_bf16 v[164:167], a[104:107], a[72:75], v[164:167]
    ds_read_b128 a[144:147], v19 offset:8192
    v_mfma_f32_16x16x32_bf16 v[180:183], a[104:107], a[76:79], v[180:183]
    ds_read_b64_tr_b16 a[180:181], v25 offset:16384
    v_mfma_f32_16x16x32_bf16 v[196:199], a[104:107], a[80:83], v[196:199]
    ds_read_b64_tr_b16 a[182:183], v25 offset:17408
    v_mfma_f32_16x16x32_bf16 v[212:215], a[104:107], a[84:87], v[212:215]
    buffer_load_dwordx4 v14, s[48:51], s66 offen offset:2048 lds
    v_mfma_f32_16x16x32_bf16 v[228:231], a[104:107], a[88:91], v[228:231]
    ds_read_b128 a[148:151], v19 offset:10240
    v_mfma_f32_16x16x32_bf16 v[244:247], a[104:107], a[92:95], v[244:247]
    ds_read_b64_tr_b16 a[184:185], v26 offset:16384
    v_mfma_f32_16x16x32_bf16 v[124:127], a[108:111], a[92:95], v[124:127]
    ds_read_b64_tr_b16 a[186:187], v26 offset:17408
    v_mfma_f32_16x16x32_bf16 v[120:123], a[108:111], a[88:91], v[120:123]
    ds_read_b128 a[152:155], v19 offset:12288
    v_mfma_f32_16x16x32_bf16 v[116:119], a[108:111], a[84:87], v[116:119]
    ds_read_b64_tr_b16 a[188:189], v27 offset:16384
    v_mfma_f32_16x16x32_bf16 v[112:115], a[108:111], a[80:83], v[112:115]
    buffer_load_dwordx4 v15, s[48:51], s66 offen offset:3072 lds
    v_mfma_f32_16x16x32_bf16 v[108:111], a[108:111], a[76:79], v[108:111]
    ds_read_b64_tr_b16 a[190:191], v27 offset:17408
    v_mfma_f32_16x16x32_bf16 v[104:107], a[108:111], a[72:75], v[104:107]
    ds_read_b128 a[156:159], v19 offset:14336
    v_mfma_f32_16x16x32_bf16 v[100:103], a[108:111], a[68:71], v[100:103]
    v_add_u32 v18, 65536, v16
    v_add_u32 v19, 65536, v17
    v_mfma_f32_16x16x32_bf16 v[96:99], a[108:111], a[64:67], v[96:99]
    v_mfma_f32_16x16x32_bf16 v[136:139], a[112:115], a[64:67], v[136:139]
    s_add_u32 m0, s65, 102400
    s_mov_b32 s67, 512
    v_mfma_f32_16x16x32_bf16 v[152:155], a[112:115], a[68:71], v[152:155]
    buffer_load_dwordx4 v8, s[44:47], s67 offen offset:0 lds
    v_mfma_f32_16x16x32_bf16 v[168:171], a[112:115], a[72:75], v[168:171]
    v_mfma_f32_16x16x32_bf16 v[184:187], a[112:115], a[76:79], v[184:187]
    v_mfma_f32_16x16x32_bf16 v[200:203], a[112:115], a[80:83], v[200:203]
    v_mfma_f32_16x16x32_bf16 v[216:219], a[112:115], a[84:87], v[216:219]
    v_mfma_f32_16x16x32_bf16 v[232:235], a[112:115], a[88:91], v[232:235]
    v_mfma_f32_16x16x32_bf16 v[248:251], a[112:115], a[92:95], v[248:251]
    buffer_load_dwordx4 v9, s[44:47], s67 offen offset:1024 lds
    v_mfma_f32_16x16x32_bf16 a[220:223], a[116:119], a[92:95], a[220:223]
    v_mfma_f32_16x16x32_bf16 a[216:219], a[116:119], a[88:91], a[216:219]
    v_mfma_f32_16x16x32_bf16 a[212:215], a[116:119], a[84:87], a[212:215]
    v_mfma_f32_16x16x32_bf16 a[208:211], a[116:119], a[80:83], a[208:211]
    v_mfma_f32_16x16x32_bf16 a[204:207], a[116:119], a[76:79], a[204:207]
    v_mfma_f32_16x16x32_bf16 a[200:203], a[116:119], a[72:75], a[200:203]
    buffer_load_dwordx4 v10, s[44:47], s67 offen offset:2048 lds
    v_mfma_f32_16x16x32_bf16 a[196:199], a[116:119], a[68:71], a[196:199]
    v_mfma_f32_16x16x32_bf16 a[192:195], a[116:119], a[64:67], a[192:195]
    v_mfma_f32_16x16x32_bf16 v[140:143], a[120:123], a[64:67], v[140:143]
    v_mfma_f32_16x16x32_bf16 v[156:159], a[120:123], a[68:71], v[156:159]
    v_mfma_f32_16x16x32_bf16 v[172:175], a[120:123], a[72:75], v[172:175]
    v_mfma_f32_16x16x32_bf16 v[188:191], a[120:123], a[76:79], v[188:191]
    buffer_load_dwordx4 v11, s[44:47], s67 offen offset:3072 lds
    v_mfma_f32_16x16x32_bf16 v[204:207], a[120:123], a[80:83], v[204:207]
    v_mfma_f32_16x16x32_bf16 v[220:223], a[120:123], a[84:87], v[220:223]
    v_mfma_f32_16x16x32_bf16 v[236:239], a[120:123], a[88:91], v[236:239]
    v_mfma_f32_16x16x32_bf16 v[252:255], a[120:123], a[92:95], v[252:255]
    v_mfma_f32_16x16x32_bf16 a[252:255], a[124:127], a[92:95], a[252:255]
    v_mfma_f32_16x16x32_bf16 a[248:251], a[124:127], a[88:91], a[248:251]
    v_mfma_f32_16x16x32_bf16 a[244:247], a[124:127], a[84:87], a[244:247]
    v_mfma_f32_16x16x32_bf16 a[240:243], a[124:127], a[80:83], a[240:243]
    v_mfma_f32_16x16x32_bf16 a[236:239], a[124:127], a[76:79], a[236:239]
    v_mfma_f32_16x16x32_bf16 a[232:235], a[124:127], a[72:75], a[232:235]
    v_mfma_f32_16x16x32_bf16 a[228:231], a[124:127], a[68:71], a[228:231]
    s_nop 0
    s_waitcnt lgkmcnt(0)
    v_mfma_f32_16x16x32_bf16 a[224:227], a[124:127], a[64:67], a[224:227]
    v_mfma_f32_16x16x32_bf16 v[128:131], a[160:163], a[128:131], v[128:131]
    s_waitcnt vmcnt(20)
    s_barrier
    v_mfma_f32_16x16x32_bf16 v[144:147], a[160:163], a[132:135], v[144:147]
    ds_read_b64_tr_b16 a[96:97], v20 offset:32768
    v_mfma_f32_16x16x32_bf16 v[160:163], a[160:163], a[136:139], v[160:163]
    ds_read_b64_tr_b16 a[98:99], v20 offset:33792
    v_mfma_f32_16x16x32_bf16 v[176:179], a[160:163], a[140:143], v[176:179]
    buffer_load_dword v3, v35, s[56:59], 0 offen sc1
    v_mfma_f32_16x16x32_bf16 v[192:195], a[160:163], a[144:147], v[192:195]
    ds_read_b128 a[64:67], v18 offset:0
    v_mfma_f32_16x16x32_bf16 v[208:211], a[160:163], a[148:151], v[208:211]
    ds_read_b64_tr_b16 a[100:101], v21 offset:32768
    v_mfma_f32_16x16x32_bf16 v[224:227], a[160:163], a[152:155], v[224:227]
    ds_read_b64_tr_b16 a[102:103], v21 offset:33792
    v_mfma_f32_16x16x32_bf16 v[240:243], a[160:163], a[156:159], v[240:243]
    ds_read_b128 a[68:71], v18 offset:2048
    v_mfma_f32_16x16x32_bf16 v[92:95], a[164:167], a[156:159], v[92:95]
    s_add_u32 m0, s64, 16384
    s_mov_b32 s66, 2359296
    ds_read_b64_tr_b16 a[104:105], v22 offset:32768
    v_mfma_f32_16x16x32_bf16 v[88:91], a[164:167], a[152:155], v[88:91]
    buffer_load_dwordx4 v12, s[48:51], s66 offen offset:0 lds
    v_mfma_f32_16x16x32_bf16 v[84:87], a[164:167], a[148:151], v[84:87]
    ds_read_b64_tr_b16 a[106:107], v22 offset:33792
    v_mfma_f32_16x16x32_bf16 v[80:83], a[164:167], a[144:147], v[80:83]
    ds_read_b128 a[72:75], v18 offset:4096
    v_mfma_f32_16x16x32_bf16 v[76:79], a[164:167], a[140:143], v[76:79]
    ds_read_b64_tr_b16 a[108:109], v23 offset:32768
    v_mfma_f32_16x16x32_bf16 v[72:75], a[164:167], a[136:139], v[72:75]
    ds_read_b64_tr_b16 a[110:111], v23 offset:33792
    v_mfma_f32_16x16x32_bf16 v[68:71], a[164:167], a[132:135], v[68:71]
    ds_read_b128 a[76:79], v18 offset:6144
    v_mfma_f32_16x16x32_bf16 v[64:67], a[164:167], a[128:131], v[64:67]
    buffer_load_dwordx4 v13, s[48:51], s66 offen offset:1024 lds
    v_mfma_f32_16x16x32_bf16 v[132:135], a[168:171], a[128:131], v[132:135]
    ds_read_b64_tr_b16 a[112:113], v24 offset:32768
    v_mfma_f32_16x16x32_bf16 v[148:151], a[168:171], a[132:135], v[148:151]
    ds_read_b64_tr_b16 a[114:115], v24 offset:33792
    v_mfma_f32_16x16x32_bf16 v[164:167], a[168:171], a[136:139], v[164:167]
    ds_read_b128 a[80:83], v18 offset:8192
    v_mfma_f32_16x16x32_bf16 v[180:183], a[168:171], a[140:143], v[180:183]
    ds_read_b64_tr_b16 a[116:117], v25 offset:32768
    v_mfma_f32_16x16x32_bf16 v[196:199], a[168:171], a[144:147], v[196:199]
    ds_read_b64_tr_b16 a[118:119], v25 offset:33792
    v_mfma_f32_16x16x32_bf16 v[212:215], a[168:171], a[148:151], v[212:215]
    buffer_load_dwordx4 v14, s[48:51], s66 offen offset:2048 lds
    v_mfma_f32_16x16x32_bf16 v[228:231], a[168:171], a[152:155], v[228:231]
    ds_read_b128 a[84:87], v18 offset:10240
    v_mfma_f32_16x16x32_bf16 v[244:247], a[168:171], a[156:159], v[244:247]
    ds_read_b64_tr_b16 a[120:121], v26 offset:32768
    v_mfma_f32_16x16x32_bf16 v[124:127], a[172:175], a[156:159], v[124:127]
    ds_read_b64_tr_b16 a[122:123], v26 offset:33792
    v_mfma_f32_16x16x32_bf16 v[120:123], a[172:175], a[152:155], v[120:123]
    ds_read_b128 a[88:91], v18 offset:12288
    v_mfma_f32_16x16x32_bf16 v[116:119], a[172:175], a[148:151], v[116:119]
    ds_read_b64_tr_b16 a[124:125], v27 offset:32768
    v_mfma_f32_16x16x32_bf16 v[112:115], a[172:175], a[144:147], v[112:115]
    buffer_load_dwordx4 v15, s[48:51], s66 offen offset:3072 lds
    v_mfma_f32_16x16x32_bf16 v[108:111], a[172:175], a[140:143], v[108:111]
    ds_read_b64_tr_b16 a[126:127], v27 offset:33792
    v_mfma_f32_16x16x32_bf16 v[104:107], a[172:175], a[136:139], v[104:107]
    ds_read_b128 a[92:95], v18 offset:14336
    v_mfma_f32_16x16x32_bf16 v[100:103], a[172:175], a[132:135], v[100:103]
    v_mfma_f32_16x16x32_bf16 v[96:99], a[172:175], a[128:131], v[96:99]
    v_mfma_f32_16x16x32_bf16 v[136:139], a[176:179], a[128:131], v[136:139]
    s_add_u32 m0, s65, 131072
    s_mov_b32 s67, 640
    v_mfma_f32_16x16x32_bf16 v[152:155], a[176:179], a[132:135], v[152:155]
    buffer_load_dwordx4 v4, s[44:47], s67 offen offset:0 lds
    v_mfma_f32_16x16x32_bf16 v[168:171], a[176:179], a[136:139], v[168:171]
    v_mfma_f32_16x16x32_bf16 v[184:187], a[176:179], a[140:143], v[184:187]
    v_mfma_f32_16x16x32_bf16 v[200:203], a[176:179], a[144:147], v[200:203]
    v_mfma_f32_16x16x32_bf16 v[216:219], a[176:179], a[148:151], v[216:219]
    v_mfma_f32_16x16x32_bf16 v[232:235], a[176:179], a[152:155], v[232:235]
    v_mfma_f32_16x16x32_bf16 v[248:251], a[176:179], a[156:159], v[248:251]
    buffer_load_dwordx4 v5, s[44:47], s67 offen offset:1024 lds
    v_mfma_f32_16x16x32_bf16 a[220:223], a[180:183], a[156:159], a[220:223]
    v_mfma_f32_16x16x32_bf16 a[216:219], a[180:183], a[152:155], a[216:219]
    v_mfma_f32_16x16x32_bf16 a[212:215], a[180:183], a[148:151], a[212:215]
    v_mfma_f32_16x16x32_bf16 a[208:211], a[180:183], a[144:147], a[208:211]
    v_mfma_f32_16x16x32_bf16 a[204:207], a[180:183], a[140:143], a[204:207]
    v_mfma_f32_16x16x32_bf16 a[200:203], a[180:183], a[136:139], a[200:203]
    buffer_load_dwordx4 v6, s[44:47], s67 offen offset:2048 lds
    v_mfma_f32_16x16x32_bf16 a[196:199], a[180:183], a[132:135], a[196:199]
    v_mfma_f32_16x16x32_bf16 a[192:195], a[180:183], a[128:131], a[192:195]
    v_mfma_f32_16x16x32_bf16 v[140:143], a[184:187], a[128:131], v[140:143]
    v_mfma_f32_16x16x32_bf16 v[156:159], a[184:187], a[132:135], v[156:159]
    v_mfma_f32_16x16x32_bf16 v[172:175], a[184:187], a[136:139], v[172:175]
    v_mfma_f32_16x16x32_bf16 v[188:191], a[184:187], a[140:143], v[188:191]
    buffer_load_dwordx4 v7, s[44:47], s67 offen offset:3072 lds
    v_mfma_f32_16x16x32_bf16 v[204:207], a[184:187], a[144:147], v[204:207]
    v_mfma_f32_16x16x32_bf16 v[220:223], a[184:187], a[148:151], v[220:223]
    v_mfma_f32_16x16x32_bf16 v[236:239], a[184:187], a[152:155], v[236:239]
    v_mfma_f32_16x16x32_bf16 v[252:255], a[184:187], a[156:159], v[252:255]
    v_mfma_f32_16x16x32_bf16 a[252:255], a[188:191], a[156:159], a[252:255]
    v_mfma_f32_16x16x32_bf16 a[248:251], a[188:191], a[152:155], a[248:251]
    v_mfma_f32_16x16x32_bf16 a[244:247], a[188:191], a[148:151], a[244:247]
    v_mfma_f32_16x16x32_bf16 a[240:243], a[188:191], a[144:147], a[240:243]
    v_mfma_f32_16x16x32_bf16 a[236:239], a[188:191], a[140:143], a[236:239]
    v_mfma_f32_16x16x32_bf16 a[232:235], a[188:191], a[136:139], a[232:235]
    v_mfma_f32_16x16x32_bf16 a[228:231], a[188:191], a[132:135], a[228:231]
    s_nop 0
    s_waitcnt lgkmcnt(0)
    v_mfma_f32_16x16x32_bf16 a[224:227], a[188:191], a[128:131], a[224:227]
    v_mfma_f32_16x16x32_bf16 v[128:131], a[96:99], a[64:67], v[128:131]
    s_waitcnt vmcnt(24)
    s_barrier
    v_mfma_f32_16x16x32_bf16 v[144:147], a[96:99], a[68:71], v[144:147]
    ds_read_b64_tr_b16 a[160:161], v20 offset:49152
    v_mfma_f32_16x16x32_bf16 v[160:163], a[96:99], a[72:75], v[160:163]
    s_add_u32 s90, s90, 524288
    ds_read_b64_tr_b16 a[162:163], v20 offset:50176
    v_mfma_f32_16x16x32_bf16 v[176:179], a[96:99], a[76:79], v[176:179]
    buffer_load_dword v36, v39, s[48:51], s90 offen
    v_mfma_f32_16x16x32_bf16 v[192:195], a[96:99], a[80:83], v[192:195]
    ds_read_b128 a[128:131], v19 offset:0
    v_mfma_f32_16x16x32_bf16 v[208:211], a[96:99], a[84:87], v[208:211]
    ds_read_b64_tr_b16 a[164:165], v21 offset:49152
    v_mfma_f32_16x16x32_bf16 v[224:227], a[96:99], a[88:91], v[224:227]
    ds_read_b64_tr_b16 a[166:167], v21 offset:50176
    v_mfma_f32_16x16x32_bf16 v[240:243], a[96:99], a[92:95], v[240:243]
    ds_read_b128 a[132:135], v19 offset:2048
    v_mfma_f32_16x16x32_bf16 v[92:95], a[100:103], a[92:95], v[92:95]
    s_add_u32 m0, s64, 32768
    s_mov_b32 s66, 2621440
    ds_read_b64_tr_b16 a[168:169], v22 offset:49152
    v_mfma_f32_16x16x32_bf16 v[88:91], a[100:103], a[88:91], v[88:91]
    buffer_load_dwordx4 v12, s[48:51], s66 offen offset:0 lds
    v_mfma_f32_16x16x32_bf16 v[84:87], a[100:103], a[84:87], v[84:87]
    ds_read_b64_tr_b16 a[170:171], v22 offset:50176
    v_mfma_f32_16x16x32_bf16 v[80:83], a[100:103], a[80:83], v[80:83]
    ds_read_b128 a[136:139], v19 offset:4096
    v_mfma_f32_16x16x32_bf16 v[76:79], a[100:103], a[76:79], v[76:79]
    ds_read_b64_tr_b16 a[172:173], v23 offset:49152
    v_mfma_f32_16x16x32_bf16 v[72:75], a[100:103], a[72:75], v[72:75]
    ds_read_b64_tr_b16 a[174:175], v23 offset:50176
    v_mfma_f32_16x16x32_bf16 v[68:71], a[100:103], a[68:71], v[68:71]
    ds_read_b128 a[140:143], v19 offset:6144
    v_mfma_f32_16x16x32_bf16 v[64:67], a[100:103], a[64:67], v[64:67]
    buffer_load_dwordx4 v13, s[48:51], s66 offen offset:1024 lds
    v_mfma_f32_16x16x32_bf16 v[132:135], a[104:107], a[64:67], v[132:135]
    ds_read_b64_tr_b16 a[176:177], v24 offset:49152
    v_mfma_f32_16x16x32_bf16 v[148:151], a[104:107], a[68:71], v[148:151]
    ds_read_b64_tr_b16 a[178:179], v24 offset:50176
    v_mfma_f32_16x16x32_bf16 v[164:167], a[104:107], a[72:75], v[164:167]
    ds_read_b128 a[144:147], v19 offset:8192
    v_mfma_f32_16x16x32_bf16 v[180:183], a[104:107], a[76:79], v[180:183]
    ds_read_b64_tr_b16 a[180:181], v25 offset:49152
    v_mfma_f32_16x16x32_bf16 v[196:199], a[104:107], a[80:83], v[196:199]
    ds_read_b64_tr_b16 a[182:183], v25 offset:50176
    v_mfma_f32_16x16x32_bf16 v[212:215], a[104:107], a[84:87], v[212:215]
    buffer_load_dwordx4 v14, s[48:51], s66 offen offset:2048 lds
    v_mfma_f32_16x16x32_bf16 v[228:231], a[104:107], a[88:91], v[228:231]
    ds_read_b128 a[148:151], v19 offset:10240
    v_mfma_f32_16x16x32_bf16 v[244:247], a[104:107], a[92:95], v[244:247]
    ds_read_b64_tr_b16 a[184:185], v26 offset:49152
    v_mfma_f32_16x16x32_bf16 v[124:127], a[108:111], a[92:95], v[124:127]
    ds_read_b64_tr_b16 a[186:187], v26 offset:50176
    v_mfma_f32_16x16x32_bf16 v[120:123], a[108:111], a[88:91], v[120:123]
    ds_read_b128 a[152:155], v19 offset:12288
    v_mfma_f32_16x16x32_bf16 v[116:119], a[108:111], a[84:87], v[116:119]
    ds_read_b64_tr_b16 a[188:189], v27 offset:49152
    v_mfma_f32_16x16x32_bf16 v[112:115], a[108:111], a[80:83], v[112:115]
    buffer_load_dwordx4 v15, s[48:51], s66 offen offset:3072 lds
    v_mfma_f32_16x16x32_bf16 v[108:111], a[108:111], a[76:79], v[108:111]
    ds_read_b64_tr_b16 a[190:191], v27 offset:50176
    v_mfma_f32_16x16x32_bf16 v[104:107], a[108:111], a[72:75], v[104:107]
    ds_read_b128 a[156:159], v19 offset:14336
    v_mfma_f32_16x16x32_bf16 v[100:103], a[108:111], a[68:71], v[100:103]
    v_add_u32 v18, 98304, v16
    v_add_u32 v19, 98304, v17
    v_mfma_f32_16x16x32_bf16 v[96:99], a[108:111], a[64:67], v[96:99]
    v_mfma_f32_16x16x32_bf16 v[136:139], a[112:115], a[64:67], v[136:139]
    s_add_u32 m0, s65, 135168
    s_mov_b32 s67, 640
    v_mfma_f32_16x16x32_bf16 v[152:155], a[112:115], a[68:71], v[152:155]
    buffer_load_dwordx4 v8, s[44:47], s67 offen offset:0 lds
    v_mfma_f32_16x16x32_bf16 v[168:171], a[112:115], a[72:75], v[168:171]
    v_mfma_f32_16x16x32_bf16 v[184:187], a[112:115], a[76:79], v[184:187]
    v_mfma_f32_16x16x32_bf16 v[200:203], a[112:115], a[80:83], v[200:203]
    v_mfma_f32_16x16x32_bf16 v[216:219], a[112:115], a[84:87], v[216:219]
    v_mfma_f32_16x16x32_bf16 v[232:235], a[112:115], a[88:91], v[232:235]
    v_mfma_f32_16x16x32_bf16 v[248:251], a[112:115], a[92:95], v[248:251]
    buffer_load_dwordx4 v9, s[44:47], s67 offen offset:1024 lds
    v_mfma_f32_16x16x32_bf16 a[220:223], a[116:119], a[92:95], a[220:223]
    v_mfma_f32_16x16x32_bf16 a[216:219], a[116:119], a[88:91], a[216:219]
    v_mfma_f32_16x16x32_bf16 a[212:215], a[116:119], a[84:87], a[212:215]
    v_mfma_f32_16x16x32_bf16 a[208:211], a[116:119], a[80:83], a[208:211]
    v_mfma_f32_16x16x32_bf16 a[204:207], a[116:119], a[76:79], a[204:207]
    v_mfma_f32_16x16x32_bf16 a[200:203], a[116:119], a[72:75], a[200:203]
    buffer_load_dwordx4 v10, s[44:47], s67 offen offset:2048 lds
    v_mfma_f32_16x16x32_bf16 a[196:199], a[116:119], a[68:71], a[196:199]
    v_mfma_f32_16x16x32_bf16 a[192:195], a[116:119], a[64:67], a[192:195]
    v_mfma_f32_16x16x32_bf16 v[140:143], a[120:123], a[64:67], v[140:143]
    v_mfma_f32_16x16x32_bf16 v[156:159], a[120:123], a[68:71], v[156:159]
    v_mfma_f32_16x16x32_bf16 v[172:175], a[120:123], a[72:75], v[172:175]
    v_mfma_f32_16x16x32_bf16 v[188:191], a[120:123], a[76:79], v[188:191]
    buffer_load_dwordx4 v11, s[44:47], s67 offen offset:3072 lds
    v_mfma_f32_16x16x32_bf16 v[204:207], a[120:123], a[80:83], v[204:207]
    v_mfma_f32_16x16x32_bf16 v[220:223], a[120:123], a[84:87], v[220:223]
    v_mfma_f32_16x16x32_bf16 v[236:239], a[120:123], a[88:91], v[236:239]
    v_mfma_f32_16x16x32_bf16 v[252:255], a[120:123], a[92:95], v[252:255]
    v_mfma_f32_16x16x32_bf16 a[252:255], a[124:127], a[92:95], a[252:255]
    v_mfma_f32_16x16x32_bf16 a[248:251], a[124:127], a[88:91], a[248:251]
    v_mfma_f32_16x16x32_bf16 a[244:247], a[124:127], a[84:87], a[244:247]
    v_mfma_f32_16x16x32_bf16 a[240:243], a[124:127], a[80:83], a[240:243]
    v_mfma_f32_16x16x32_bf16 a[236:239], a[124:127], a[76:79], a[236:239]
    v_mfma_f32_16x16x32_bf16 a[232:235], a[124:127], a[72:75], a[232:235]
    v_mfma_f32_16x16x32_bf16 a[228:231], a[124:127], a[68:71], a[228:231]
    s_nop 0
    s_waitcnt lgkmcnt(0)
    v_mfma_f32_16x16x32_bf16 a[224:227], a[124:127], a[64:67], a[224:227]
    v_mfma_f32_16x16x32_bf16 v[128:131], a[160:163], a[128:131], v[128:131]
    s_waitcnt vmcnt(17)
    s_barrier
    v_mfma_f32_16x16x32_bf16 v[144:147], a[160:163], a[132:135], v[144:147]
    ds_read_b64_tr_b16 a[96:97], v20 offset:0
    s_cmp_lg_u32 s4, 0
    s_cbranch_scc1 L_sigxn_0
    v_cmp_ne_u32 vcc, 0, v3
    s_cmp_eq_u64 vcc, -1
    s_cbranch_scc0 L_pollz_0
L_pollz_0_ret:
    s_lshr_b32 s10, s2, 4
    s_lshl_b32 s10, s10, 8
    s_and_b32 s11, s2, 15
    s_lshl_b32 s11, s11, 2
    s_add_u32 s10, s10, s11
    s_add_u32 s10, s10, 79691776
    s_mov_b64 exec, 1
    v_mov_b32_e64 v3, 1
    buffer_store_dword v3, off, s[52:55], s10 sc1
    s_mov_b64 exec, -1
L_sigxn_0:
    v_mfma_f32_16x16x32_bf16 v[160:163], a[160:163], a[136:139], v[160:163]
    s_add_u32 s90, s90, 524288
    ds_read_b64_tr_b16 a[98:99], v20 offset:1024
    v_mfma_f32_16x16x32_bf16 v[176:179], a[160:163], a[140:143], v[176:179]
    buffer_load_dword v36, v39, s[48:51], s90 offen
    v_mfma_f32_16x16x32_bf16 v[192:195], a[160:163], a[144:147], v[192:195]
    ds_read_b128 a[64:67], v18 offset:0
    v_mfma_f32_16x16x32_bf16 v[208:211], a[160:163], a[148:151], v[208:211]
    ds_read_b64_tr_b16 a[100:101], v21 offset:0
    v_mfma_f32_16x16x32_bf16 v[224:227], a[160:163], a[152:155], v[224:227]
    ds_read_b64_tr_b16 a[102:103], v21 offset:1024
    v_mfma_f32_16x16x32_bf16 v[240:243], a[160:163], a[156:159], v[240:243]
    ds_read_b128 a[68:71], v18 offset:2048
    v_mfma_f32_16x16x32_bf16 v[92:95], a[164:167], a[156:159], v[92:95]
    s_add_u32 m0, s64, 49152
    s_mov_b32 s66, 2883584
    ds_read_b64_tr_b16 a[104:105], v22 offset:0
    v_mfma_f32_16x16x32_bf16 v[88:91], a[164:167], a[152:155], v[88:91]
    buffer_load_dwordx4 v12, s[48:51], s66 offen offset:0 lds
    v_mfma_f32_16x16x32_bf16 v[84:87], a[164:167], a[148:151], v[84:87]
    ds_read_b64_tr_b16 a[106:107], v22 offset:1024
    v_mfma_f32_16x16x32_bf16 v[80:83], a[164:167], a[144:147], v[80:83]
    ds_read_b128 a[72:75], v18 offset:4096
    v_mfma_f32_16x16x32_bf16 v[76:79], a[164:167], a[140:143], v[76:79]
    ds_read_b64_tr_b16 a[108:109], v23 offset:0
    v_mfma_f32_16x16x32_bf16 v[72:75], a[164:167], a[136:139], v[72:75]
    ds_read_b64_tr_b16 a[110:111], v23 offset:1024
    v_mfma_f32_16x16x32_bf16 v[68:71], a[164:167], a[132:135], v[68:71]
    ds_read_b128 a[76:79], v18 offset:6144
    v_mfma_f32_16x16x32_bf16 v[64:67], a[164:167], a[128:131], v[64:67]
    buffer_load_dwordx4 v13, s[48:51], s66 offen offset:1024 lds
    v_mfma_f32_16x16x32_bf16 v[132:135], a[168:171], a[128:131], v[132:135]
    ds_read_b64_tr_b16 a[112:113], v24 offset:0
    v_mfma_f32_16x16x32_bf16 v[148:151], a[168:171], a[132:135], v[148:151]
    ds_read_b64_tr_b16 a[114:115], v24 offset:1024
    v_mfma_f32_16x16x32_bf16 v[164:167], a[168:171], a[136:139], v[164:167]
    ds_read_b128 a[80:83], v18 offset:8192
    v_mfma_f32_16x16x32_bf16 v[180:183], a[168:171], a[140:143], v[180:183]
    ds_read_b64_tr_b16 a[116:117], v25 offset:0
    v_mfma_f32_16x16x32_bf16 v[196:199], a[168:171], a[144:147], v[196:199]
    ds_read_b64_tr_b16 a[118:119], v25 offset:1024
    v_mfma_f32_16x16x32_bf16 v[212:215], a[168:171], a[148:151], v[212:215]
    buffer_load_dwordx4 v14, s[48:51], s66 offen offset:2048 lds
    v_mfma_f32_16x16x32_bf16 v[228:231], a[168:171], a[152:155], v[228:231]
    ds_read_b128 a[84:87], v18 offset:10240
    v_mfma_f32_16x16x32_bf16 v[244:247], a[168:171], a[156:159], v[244:247]
    ds_read_b64_tr_b16 a[120:121], v26 offset:0
    v_mfma_f32_16x16x32_bf16 v[124:127], a[172:175], a[156:159], v[124:127]
    ds_read_b64_tr_b16 a[122:123], v26 offset:1024
    v_mfma_f32_16x16x32_bf16 v[120:123], a[172:175], a[152:155], v[120:123]
    ds_read_b128 a[88:91], v18 offset:12288
    v_mfma_f32_16x16x32_bf16 v[116:119], a[172:175], a[148:151], v[116:119]
    ds_read_b64_tr_b16 a[124:125], v27 offset:0
    v_mfma_f32_16x16x32_bf16 v[112:115], a[172:175], a[144:147], v[112:115]
    buffer_load_dwordx4 v15, s[48:51], s66 offen offset:3072 lds
    v_mfma_f32_16x16x32_bf16 v[108:111], a[172:175], a[140:143], v[108:111]
    ds_read_b64_tr_b16 a[126:127], v27 offset:1024
    v_mfma_f32_16x16x32_bf16 v[104:107], a[172:175], a[136:139], v[104:107]
    ds_read_b128 a[92:95], v18 offset:14336
    v_mfma_f32_16x16x32_bf16 v[100:103], a[172:175], a[132:135], v[100:103]
    v_mfma_f32_16x16x32_bf16 v[96:99], a[172:175], a[128:131], v[96:99]
    v_mfma_f32_16x16x32_bf16 v[136:139], a[176:179], a[128:131], v[136:139]
    s_add_u32 m0, s65, 65536
    s_mov_b32 s67, 768
    v_mfma_f32_16x16x32_bf16 v[152:155], a[176:179], a[132:135], v[152:155]
    buffer_load_dwordx4 v4, s[44:47], s67 offen offset:0 lds
    v_mfma_f32_16x16x32_bf16 v[168:171], a[176:179], a[136:139], v[168:171]
    v_mfma_f32_16x16x32_bf16 v[184:187], a[176:179], a[140:143], v[184:187]
    v_mfma_f32_16x16x32_bf16 v[200:203], a[176:179], a[144:147], v[200:203]
    v_mfma_f32_16x16x32_bf16 v[216:219], a[176:179], a[148:151], v[216:219]
    v_mfma_f32_16x16x32_bf16 v[232:235], a[176:179], a[152:155], v[232:235]
    v_mfma_f32_16x16x32_bf16 v[248:251], a[176:179], a[156:159], v[248:251]
    buffer_load_dwordx4 v5, s[44:47], s67 offen offset:1024 lds
    v_mfma_f32_16x16x32_bf16 a[220:223], a[180:183], a[156:159], a[220:223]
    v_mfma_f32_16x16x32_bf16 a[216:219], a[180:183], a[152:155], a[216:219]
    v_mfma_f32_16x16x32_bf16 a[212:215], a[180:183], a[148:151], a[212:215]
    v_mfma_f32_16x16x32_bf16 a[208:211], a[180:183], a[144:147], a[208:211]
    v_mfma_f32_16x16x32_bf16 a[204:207], a[180:183], a[140:143], a[204:207]
    v_mfma_f32_16x16x32_bf16 a[200:203], a[180:183], a[136:139], a[200:203]
    buffer_load_dwordx4 v6, s[44:47], s67 offen offset:2048 lds
    v_mfma_f32_16x16x32_bf16 a[196:199], a[180:183], a[132:135], a[196:199]
    v_mfma_f32_16x16x32_bf16 a[192:195], a[180:183], a[128:131], a[192:195]
    v_mfma_f32_16x16x32_bf16 v[140:143], a[184:187], a[128:131], v[140:143]
    v_mfma_f32_16x16x32_bf16 v[156:159], a[184:187], a[132:135], v[156:159]
    v_mfma_f32_16x16x32_bf16 v[172:175], a[184:187], a[136:139], v[172:175]
    v_mfma_f32_16x16x32_bf16 v[188:191], a[184:187], a[140:143], v[188:191]
    buffer_load_dwordx4 v7, s[44:47], s67 offen offset:3072 lds
    v_mfma_f32_16x16x32_bf16 v[204:207], a[184:187], a[144:147], v[204:207]
    v_mfma_f32_16x16x32_bf16 v[220:223], a[184:187], a[148:151], v[220:223]
    v_mfma_f32_16x16x32_bf16 v[236:239], a[184:187], a[152:155], v[236:239]
    v_mfma_f32_16x16x32_bf16 v[252:255], a[184:187], a[156:159], v[252:255]
    v_mfma_f32_16x16x32_bf16 a[252:255], a[188:191], a[156:159], a[252:255]
    v_mfma_f32_16x16x32_bf16 a[248:251], a[188:191], a[152:155], a[248:251]
    v_mfma_f32_16x16x32_bf16 a[244:247], a[188:191], a[148:151], a[244:247]
    v_mfma_f32_16x16x32_bf16 a[240:243], a[188:191], a[144:147], a[240:243]
    v_mfma_f32_16x16x32_bf16 a[236:239], a[188:191], a[140:143], a[236:239]
    v_mfma_f32_16x16x32_bf16 a[232:235], a[188:191], a[136:139], a[232:235]
    v_mfma_f32_16x16x32_bf16 a[228:231], a[188:191], a[132:135], a[228:231]
    s_nop 0
    s_waitcnt lgkmcnt(0)
    v_mfma_f32_16x16x32_bf16 a[224:227], a[188:191], a[128:131], a[224:227]
    v_mfma_f32_16x16x32_bf16 v[128:131], a[96:99], a[64:67], v[128:131]
    s_waitcnt vmcnt(22)
    s_barrier
    v_mfma_f32_16x16x32_bf16 v[144:147], a[96:99], a[68:71], v[144:147]
    ds_read_b64_tr_b16 a[160:161], v20 offset:16384
    v_mfma_f32_16x16x32_bf16 v[160:163], a[96:99], a[72:75], v[160:163]
    s_nop 0
    s_add_u32 m0, s64, 0
    s_mov_b32 s66, 3145728
    ds_read_b64_tr_b16 a[162:163], v20 offset:17408
    v_mfma_f32_16x16x32_bf16 v[176:179], a[96:99], a[76:79], v[176:179]
    buffer_load_dwordx4 v12, s[48:51], s66 offen offset:0 lds
    v_mfma_f32_16x16x32_bf16 v[192:195], a[96:99], a[80:83], v[192:195]
    ds_read_b128 a[128:131], v19 offset:0
    v_mfma_f32_16x16x32_bf16 v[208:211], a[96:99], a[84:87], v[208:211]
    ds_read_b64_tr_b16 a[164:165], v21 offset:16384
    v_mfma_f32_16x16x32_bf16 v[224:227], a[96:99], a[88:91], v[224:227]
    ds_read_b64_tr_b16 a[166:167], v21 offset:17408
    v_mfma_f32_16x16x32_bf16 v[240:243], a[96:99], a[92:95], v[240:243]
    ds_read_b128 a[132:135], v19 offset:2048
    v_mfma_f32_16x16x32_bf16 v[92:95], a[100:103], a[92:95], v[92:95]
    ds_read_b64_tr_b16 a[168:169], v22 offset:16384
    v_mfma_f32_16x16x32_bf16 v[88:91], a[100:103], a[88:91], v[88:91]
    buffer_load_dwordx4 v13, s[48:51], s66 offen offset:1024 lds
    v_mfma_f32_16x16x32_bf16 v[84:87], a[100:103], a[84:87], v[84:87]
    ds_read_b64_tr_b16 a[170:171], v22 offset:17408
    v_mfma_f32_16x16x32_bf16 v[80:83], a[100:103], a[80:83], v[80:83]
    ds_read_b128 a[136:139], v19 offset:4096
    v_mfma_f32_16x16x32_bf16 v[76:79], a[100:103], a[76:79], v[76:79]
    ds_read_b64_tr_b16 a[172:173], v23 offset:16384
    v_mfma_f32_16x16x32_bf16 v[72:75], a[100:103], a[72:75], v[72:75]
    ds_read_b64_tr_b16 a[174:175], v23 offset:17408
    v_mfma_f32_16x16x32_bf16 v[68:71], a[100:103], a[68:71], v[68:71]
    ds_read_b128 a[140:143], v19 offset:6144
    v_mfma_f32_16x16x32_bf16 v[64:67], a[100:103], a[64:67], v[64:67]
    buffer_load_dwordx4 v14, s[48:51], s66 offen offset:2048 lds
    v_mfma_f32_16x16x32_bf16 v[132:135], a[104:107], a[64:67], v[132:135]
    ds_read_b64_tr_b16 a[176:177], v24 offset:16384
    v_mfma_f32_16x16x32_bf16 v[148:151], a[104:107], a[68:71], v[148:151]
    ds_read_b64_tr_b16 a[178:179], v24 offset:17408
    v_mfma_f32_16x16x32_bf16 v[164:167], a[104:107], a[72:75], v[164:167]
    ds_read_b128 a[144:147], v19 offset:8192
    v_mfma_f32_16x16x32_bf16 v[180:183], a[104:107], a[76:79], v[180:183]
    ds_read_b64_tr_b16 a[180:181], v25 offset:16384
    v_mfma_f32_16x16x32_bf16 v[196:199], a[104:107], a[80:83], v[196:199]
    ds_read_b64_tr_b16 a[182:183], v25 offset:17408
    v_mfma_f32_16x16x32_bf16 v[212:215], a[104:107], a[84:87], v[212:215]
    buffer_load_dwordx4 v15, s[48:51], s66 offen offset:3072 lds
    v_mfma_f32_16x16x32_bf16 v[228:231], a[104:107], a[88:91], v[228:231]
    ds_read_b128 a[148:151], v19 offset:10240
    v_mfma_f32_16x16x32_bf16 v[244:247], a[104:107], a[92:95], v[244:247]
    ds_read_b64_tr_b16 a[184:185], v26 offset:16384
    v_mfma_f32_16x16x32_bf16 v[124:127], a[108:111], a[92:95], v[124:127]
    ds_read_b64_tr_b16 a[186:187], v26 offset:17408
    v_mfma_f32_16x16x32_bf16 v[120:123], a[108:111], a[88:91], v[120:123]
    ds_read_b128 a[152:155], v19 offset:12288
    v_mfma_f32_16x16x32_bf16 v[116:119], a[108:111], a[84:87], v[116:119]
    s_add_u32 m0, s65, 69632
    s_mov_b32 s67, 768
    ds_read_b64_tr_b16 a[188:189], v27 offset:16384
    v_mfma_f32_16x16x32_bf16 v[112:115], a[108:111], a[80:83], v[112:115]
    buffer_load_dwordx4 v8, s[44:47], s67 offen offset:0 lds
    v_mfma_f32_16x16x32_bf16 v[108:111], a[108:111], a[76:79], v[108:111]
    ds_read_b64_tr_b16 a[190:191], v27 offset:17408
    v_mfma_f32_16x16x32_bf16 v[104:107], a[108:111], a[72:75], v[104:107]
    ds_read_b128 a[156:159], v19 offset:14336
    v_mfma_f32_16x16x32_bf16 v[100:103], a[108:111], a[68:71], v[100:103]
    v_add_u32 v18, 131072, v16
    v_add_u32 v19, 131072, v17
    v_mfma_f32_16x16x32_bf16 v[96:99], a[108:111], a[64:67], v[96:99]
    v_mfma_f32_16x16x32_bf16 v[136:139], a[112:115], a[64:67], v[136:139]
    v_mfma_f32_16x16x32_bf16 v[152:155], a[112:115], a[68:71], v[152:155]
    buffer_load_dwordx4 v9, s[44:47], s67 offen offset:1024 lds
    v_mfma_f32_16x16x32_bf16 v[168:171], a[112:115], a[72:75], v[168:171]
    v_mfma_f32_16x16x32_bf16 v[184:187], a[112:115], a[76:79], v[184:187]
    v_mfma_f32_16x16x32_bf16 v[200:203], a[112:115], a[80:83], v[200:203]
    v_mfma_f32_16x16x32_bf16 v[216:219], a[112:115], a[84:87], v[216:219]
    v_mfma_f32_16x16x32_bf16 v[232:235], a[112:115], a[88:91], v[232:235]
    v_mfma_f32_16x16x32_bf16 v[248:251], a[112:115], a[92:95], v[248:251]
    buffer_load_dwordx4 v10, s[44:47], s67 offen offset:2048 lds
    v_mfma_f32_16x16x32_bf16 a[220:223], a[116:119], a[92:95], a[220:223]
    v_mfma_f32_16x16x32_bf16 a[216:219], a[116:119], a[88:91], a[216:219]
    v_mfma_f32_16x16x32_bf16 a[212:215], a[116:119], a[84:87], a[212:215]
    v_mfma_f32_16x16x32_bf16 a[208:211], a[116:119], a[80:83], a[208:211]
    v_mfma_f32_16x16x32_bf16 a[204:207], a[116:119], a[76:79], a[204:207]
    v_mfma_f32_16x16x32_bf16 a[200:203], a[116:119], a[72:75], a[200:203]
    buffer_load_dwordx4 v11, s[44:47], s67 offen offset:3072 lds
    v_mfma_f32_16x16x32_bf16 a[196:199], a[116:119], a[68:71], a[196:199]
    v_mfma_f32_16x16x32_bf16 a[192:195], a[116:119], a[64:67], a[192:195]
    v_mfma_f32_16x16x32_bf16 v[140:143], a[120:123], a[64:67], v[140:143]
    v_mfma_f32_16x16x32_bf16 v[156:159], a[120:123], a[68:71], v[156:159]
    v_mfma_f32_16x16x32_bf16 v[172:175], a[120:123], a[72:75], v[172:175]
    v_mfma_f32_16x16x32_bf16 v[188:191], a[120:123], a[76:79], v[188:191]
    v_mfma_f32_16x16x32_bf16 v[204:207], a[120:123], a[80:83], v[204:207]
    v_mfma_f32_16x16x32_bf16 v[220:223], a[120:123], a[84:87], v[220:223]
    v_mfma_f32_16x16x32_bf16 v[236:239], a[120:123], a[88:91], v[236:239]
    v_mfma_f32_16x16x32_bf16 v[252:255], a[120:123], a[92:95], v[252:255]
    v_mfma_f32_16x16x32_bf16 a[252:255], a[124:127], a[92:95], a[252:255]
    v_mfma_f32_16x16x32_bf16 a[248:251], a[124:127], a[88:91], a[248:251]
    v_lshlrev_b32 v39, 7, v1
    v_lshrrev_b32 v38, 5, v1
    v_mfma_f32_16x16x32_bf16 a[244:247], a[124:127], a[84:87], a[244:247]
    v_lshl_add_u32 v38, v38, 28, v39
    v_lshrrev_b32_e64 v37, 4, v1
    v_mfma_f32_16x16x32_bf16 a[240:243], a[124:127], a[80:83], a[240:243]
    v_lshl_add_u32 v39, v37, 28, v39
    v_mfma_f32_16x16x32_bf16 a[236:239], a[124:127], a[76:79], a[236:239]
    s_nop 0
    s_lshl_b32 s72, s2, 2
    s_add_u32 s72, s72, s4
    s_lshl_b32 s73, s72, 11
    v_mfma_f32_16x16x32_bf16 a[232:235], a[124:127], a[72:75], a[232:235]
    s_nop 0
    s_lshl_b32 s72, s72, 12
    v_mfma_f32_16x16x32_bf16 a[228:231], a[124:127], a[68:71], a[228:231]
    s_nop 0
    s_waitcnt lgkmcnt(0)
    v_mfma_f32_16x16x32_bf16 a[224:227], a[124:127], a[64:67], a[224:227]
    v_mfma_f32_16x16x32_bf16 v[128:131], a[160:163], a[128:131], v[128:131]
    s_waitcnt vmcnt(17)
    s_barrier
    v_mfma_f32_16x16x32_bf16 v[144:147], a[160:163], a[132:135], v[144:147]
    ds_read_b64_tr_b16 a[96:97], v20 offset:32768
    v_mfma_f32_16x16x32_bf16 v[160:163], a[160:163], a[136:139], v[160:163]
    s_add_u32 m0, s64, 16384
    s_mov_b32 s66, 3407872
    ds_read_b64_tr_b16 a[98:99], v20 offset:33792
    v_mfma_f32_16x16x32_bf16 v[176:179], a[160:163], a[140:143], v[176:179]
    buffer_load_dwordx4 v12, s[48:51], s66 offen offset:0 lds
    v_mfma_f32_16x16x32_bf16 v[192:195], a[160:163], a[144:147], v[192:195]
    ds_read_b128 a[64:67], v18 offset:0
    v_mfma_f32_16x16x32_bf16 v[208:211], a[160:163], a[148:151], v[208:211]
    ds_read_b64_tr_b16 a[100:101], v21 offset:32768
    v_mfma_f32_16x16x32_bf16 v[224:227], a[160:163], a[152:155], v[224:227]
    buffer_load_dwordx4 v13, s[48:51], s66 offen offset:1024 lds
    v_mfma_f32_16x16x32_bf16 v[240:243], a[160:163], a[156:159], v[240:243]
    ds_read_b64_tr_b16 a[102:103], v21 offset:33792
    v_mfma_f32_16x16x32_bf16 v[92:95], a[164:167], a[156:159], v[92:95]
    ds_read_b128 a[68:71], v18 offset:2048
    v_mfma_f32_16x16x32_bf16 v[88:91], a[164:167], a[152:155], v[88:91]
    buffer_load_dwordx4 v14, s[48:51], s66 offen offset:2048 lds
    v_mfma_f32_16x16x32_bf16 v[84:87], a[164:167], a[148:151], v[84:87]
    ds_read_b64_tr_b16 a[104:105], v22 offset:32768
    v_mfma_f32_16x16x32_bf16 v[80:83], a[164:167], a[144:147], v[80:83]
    ds_read_b64_tr_b16 a[106:107], v22 offset:33792
    v_mfma_f32_16x16x32_bf16 v[76:79], a[164:167], a[140:143], v[76:79]
    buffer_load_dwordx4 v15, s[48:51], s66 offen offset:3072 lds
    v_mfma_f32_16x16x32_bf16 v[72:75], a[164:167], a[136:139], v[72:75]
    ds_read_b128 a[72:75], v18 offset:4096
    v_mfma_f32_16x16x32_bf16 v[68:71], a[164:167], a[132:135], v[68:71]
    s_add_u32 m0, s65, 98304
    s_mov_b32 s67, 896
    ds_read_b64_tr_b16 a[108:109], v23 offset:32768
    v_mfma_f32_16x16x32_bf16 v[64:67], a[164:167], a[128:131], v[64:67]
    buffer_load_dwordx4 v4, s[44:47], s67 offen offset:0 lds
    v_mfma_f32_16x16x32_bf16 v[132:135], a[168:171], a[128:131], v[132:135]
    ds_read_b64_tr_b16 a[110:111], v23 offset:33792
    v_mfma_f32_16x16x32_bf16 v[148:151], a[168:171], a[132:135], v[148:151]
    ds_read_b128 a[76:79], v18 offset:6144
    v_mfma_f32_16x16x32_bf16 v[164:167], a[168:171], a[136:139], v[164:167]
    buffer_load_dwordx4 v5, s[44:47], s67 offen offset:1024 lds
    v_mfma_f32_16x16x32_bf16 v[180:183], a[168:171], a[140:143], v[180:183]
    ds_read_b64_tr_b16 a[112:113], v24 offset:32768
    v_mfma_f32_16x16x32_bf16 v[196:199], a[168:171], a[144:147], v[196:199]
    ds_read_b64_tr_b16 a[114:115], v24 offset:33792
    v_mfma_f32_16x16x32_bf16 v[212:215], a[168:171], a[148:151], v[212:215]
    buffer_load_dwordx4 v6, s[44:47], s67 offen offset:2048 lds
    v_mfma_f32_16x16x32_bf16 v[228:231], a[168:171], a[152:155], v[228:231]
    ds_read_b128 a[80:83], v18 offset:8192
    v_mfma_f32_16x16x32_bf16 v[244:247], a[168:171], a[156:159], v[244:247]
    ds_read_b64_tr_b16 a[116:117], v25 offset:32768
    v_mfma_f32_16x16x32_bf16 v[124:127], a[172:175], a[156:159], v[124:127]
    buffer_load_dwordx4 v7, s[44:47], s67 offen offset:3072 lds
    v_mfma_f32_16x16x32_bf16 v[120:123], a[172:175], a[152:155], v[120:123]
    ds_read_b64_tr_b16 a[118:119], v25 offset:33792
    v_mfma_f32_16x16x32_bf16 v[116:119], a[172:175], a[148:151], v[116:119]
    s_mov_b32 s60, s20
    s_mov_b32 s61, s21
    s_mov_b32 s62, 4194304
    ds_read_b128 a[84:87], v18 offset:10240
    v_mfma_f32_16x16x32_bf16 v[112:115], a[172:175], a[144:147], v[112:115]
    buffer_load_dword v36, v38, s[60:63], s72 offen
    v_mfma_f32_16x16x32_bf16 v[108:111], a[172:175], a[140:143], v[108:111]
    ds_read_b64_tr_b16 a[120:121], v26 offset:32768
    v_mfma_f32_16x16x32_bf16 v[104:107], a[172:175], a[136:139], v[104:107]
    s_mov_b32 s92, s30
    s_mov_b32 s93, s31
    s_mov_b32 s94, 1409024
    ds_read_b64_tr_b16 a[122:123], v26 offset:33792
    v_mfma_f32_16x16x32_bf16 v[100:103], a[172:175], a[132:135], v[100:103]
    buffer_load_dword v36, v39, s[92:95], s73 offen
    v_mfma_f32_16x16x32_bf16 v[96:99], a[172:175], a[128:131], v[96:99]
    ds_read_b128 a[88:91], v18 offset:12288
    v_mfma_f32_16x16x32_bf16 v[136:139], a[176:179], a[128:131], v[136:139]
    ds_read_b64_tr_b16 a[124:125], v27 offset:32768
    v_mfma_f32_16x16x32_bf16 v[152:155], a[176:179], a[132:135], v[152:155]
    ds_read_b64_tr_b16 a[126:127], v27 offset:33792
    v_mfma_f32_16x16x32_bf16 v[168:171], a[176:179], a[136:139], v[168:171]
    ds_read_b128 a[92:95], v18 offset:14336
    v_mfma_f32_16x16x32_bf16 v[184:187], a[176:179], a[140:143], v[184:187]
    v_mfma_f32_16x16x32_bf16 v[200:203], a[176:179], a[144:147], v[200:203]
    v_mfma_f32_16x16x32_bf16 v[216:219], a[176:179], a[148:151], v[216:219]
    v_mfma_f32_16x16x32_bf16 v[232:235], a[176:179], a[152:155], v[232:235]
    v_mfma_f32_16x16x32_bf16 v[248:251], a[176:179], a[156:159], v[248:251]
    v_mfma_f32_16x16x32_bf16 a[220:223], a[180:183], a[156:159], a[220:223]
    v_mfma_f32_16x16x32_bf16 a[216:219], a[180:183], a[152:155], a[216:219]
    v_mfma_f32_16x16x32_bf16 a[212:215], a[180:183], a[148:151], a[212:215]
    v_mfma_f32_16x16x32_bf16 a[208:211], a[180:183], a[144:147], a[208:211]
    v_mfma_f32_16x16x32_bf16 a[204:207], a[180:183], a[140:143], a[204:207]
    v_mfma_f32_16x16x32_bf16 a[200:203], a[180:183], a[136:139], a[200:203]
    v_mfma_f32_16x16x32_bf16 a[196:199], a[180:183], a[132:135], a[196:199]
    v_mfma_f32_16x16x32_bf16 a[192:195], a[180:183], a[128:131], a[192:195]
    v_mfma_f32_16x16x32_bf16 v[140:143], a[184:187], a[128:131], v[140:143]
    v_mfma_f32_16x16x32_bf16 v[156:159], a[184:187], a[132:135], v[156:159]
    v_mfma_f32_16x16x32_bf16 v[172:175], a[184:187], a[136:139], v[172:175]
    v_mfma_f32_16x16x32_bf16 v[188:191], a[184:187], a[140:143], v[188:191]
    v_mfma_f32_16x16x32_bf16 v[204:207], a[184:187], a[144:147], v[204:207]
    v_mfma_f32_16x16x32_bf16 v[220:223], a[184:187], a[148:151], v[220:223]
    v_mfma_f32_16x16x32_bf16 v[236:239], a[184:187], a[152:155], v[236:239]
    v_mfma_f32_16x16x32_bf16 v[252:255], a[184:187], a[156:159], v[252:255]
    v_mfma_f32_16x16x32_bf16 a[252:255], a[188:191], a[156:159], a[252:255]
    v_mfma_f32_16x16x32_bf16 a[248:251], a[188:191], a[152:155], a[248:251]
    v_mfma_f32_16x16x32_bf16 a[244:247], a[188:191], a[148:151], a[244:247]
    v_mfma_f32_16x16x32_bf16 a[240:243], a[188:191], a[144:147], a[240:243]
    v_mfma_f32_16x16x32_bf16 a[236:239], a[188:191], a[140:143], a[236:239]
    v_mfma_f32_16x16x32_bf16 a[232:235], a[188:191], a[136:139], a[232:235]
    v_mfma_f32_16x16x32_bf16 a[228:231], a[188:191], a[132:135], a[228:231]
    s_nop 0
    s_waitcnt lgkmcnt(0)
    v_mfma_f32_16x16x32_bf16 a[224:227], a[188:191], a[128:131], a[224:227]
    v_mfma_f32_16x16x32_bf16 v[128:131], a[96:99], a[64:67], v[128:131]
    s_waitcnt vmcnt(22)
    s_barrier
    v_mfma_f32_16x16x32_bf16 v[144:147], a[96:99], a[68:71], v[144:147]
    ds_read_b64_tr_b16 a[160:161], v20 offset:49152
    v_mfma_f32_16x16x32_bf16 v[160:163], a[96:99], a[72:75], v[160:163]
    s_add_u32 m0, s64, 32768
    s_mov_b32 s66, 3670016
    ds_read_b64_tr_b16 a[162:163], v20 offset:50176
    v_mfma_f32_16x16x32_bf16 v[176:179], a[96:99], a[76:79], v[176:179]
    buffer_load_dwordx4 v12, s[48:51], s66 offen offset:0 lds
    v_mfma_f32_16x16x32_bf16 v[192:195], a[96:99], a[80:83], v[192:195]
    ds_read_b128 a[128:131], v19 offset:0
    v_mfma_f32_16x16x32_bf16 v[208:211], a[96:99], a[84:87], v[208:211]
    ds_read_b64_tr_b16 a[164:165], v21 offset:49152
    v_mfma_f32_16x16x32_bf16 v[224:227], a[96:99], a[88:91], v[224:227]
    ds_read_b64_tr_b16 a[166:167], v21 offset:50176
    v_mfma_f32_16x16x32_bf16 v[240:243], a[96:99], a[92:95], v[240:243]
    ds_read_b128 a[132:135], v19 offset:2048
    v_mfma_f32_16x16x32_bf16 v[92:95], a[100:103], a[92:95], v[92:95]
    ds_read_b64_tr_b16 a[168:169], v22 offset:49152
    v_mfma_f32_16x16x32_bf16 v[88:91], a[100:103], a[88:91], v[88:91]
    buffer_load_dwordx4 v13, s[48:51], s66 offen offset:1024 lds
    v_mfma_f32_16x16x32_bf16 v[84:87], a[100:103], a[84:87], v[84:87]
    ds_read_b64_tr_b16 a[170:171], v22 offset:50176
    v_mfma_f32_16x16x32_bf16 v[80:83], a[100:103], a[80:83], v[80:83]
    ds_read_b128 a[136:139], v19 offset:4096
    v_mfma_f32_16x16x32_bf16 v[76:79], a[100:103], a[76:79], v[76:79]
    ds_read_b64_tr_b16 a[172:173], v23 offset:49152
    v_mfma_f32_16x16x32_bf16 v[72:75], a[100:103], a[72:75], v[72:75]
    ds_read_b64_tr_b16 a[174:175], v23 offset:50176
    v_mfma_f32_16x16x32_bf16 v[68:71], a[100:103], a[68:71], v[68:71]
    ds_read_b128 a[140:143], v19 offset:6144
    v_mfma_f32_16x16x32_bf16 v[64:67], a[100:103], a[64:67], v[64:67]
    buffer_load_dwordx4 v14, s[48:51], s66 offen offset:2048 lds
    v_mfma_f32_16x16x32_bf16 v[132:135], a[104:107], a[64:67], v[132:135]
    ds_read_b64_tr_b16 a[176:177], v24 offset:49152
    v_mfma_f32_16x16x32_bf16 v[148:151], a[104:107], a[68:71], v[148:151]
    ds_read_b64_tr_b16 a[178:179], v24 offset:50176
    v_mfma_f32_16x16x32_bf16 v[164:167], a[104:107], a[72:75], v[164:167]
    ds_read_b128 a[144:147], v19 offset:8192
    v_mfma_f32_16x16x32_bf16 v[180:183], a[104:107], a[76:79], v[180:183]
    ds_read_b64_tr_b16 a[180:181], v25 offset:49152
    v_mfma_f32_16x16x32_bf16 v[196:199], a[104:107], a[80:83], v[196:199]
    ds_read_b64_tr_b16 a[182:183], v25 offset:50176
    v_mfma_f32_16x16x32_bf16 v[212:215], a[104:107], a[84:87], v[212:215]
    buffer_load_dwordx4 v15, s[48:51], s66 offen offset:3072 lds
    v_mfma_f32_16x16x32_bf16 v[228:231], a[104:107], a[88:91], v[228:231]
    ds_read_b128 a[148:151], v19 offset:10240
    v_mfma_f32_16x16x32_bf16 v[244:247], a[104:107], a[92:95], v[244:247]
    ds_read_b64_tr_b16 a[184:185], v26 offset:49152
    v_mfma_f32_16x16x32_bf16 v[124:127], a[108:111], a[92:95], v[124:127]
    ds_read_b64_tr_b16 a[186:187], v26 offset:50176
    v_mfma_f32_16x16x32_bf16 v[120:123], a[108:111], a[88:91], v[120:123]
    ds_read_b128 a[152:155], v19 offset:12288
    v_mfma_f32_16x16x32_bf16 v[116:119], a[108:111], a[84:87], v[116:119]
    s_add_u32 m0, s65, 102400
    s_mov_b32 s67, 896
    ds_read_b64_tr_b16 a[188:189], v27 offset:49152
    v_mfma_f32_16x16x32_bf16 v[112:115], a[108:111], a[80:83], v[112:115]
    buffer_load_dwordx4 v8, s[44:47], s67 offen offset:0 lds
    v_mfma_f32_16x16x32_bf16 v[108:111], a[108:111], a[76:79], v[108:111]
    ds_read_b64_tr_b16 a[190:191], v27 offset:50176
    v_mfma_f32_16x16x32_bf16 v[104:107], a[108:111], a[72:75], v[104:107]
    ds_read_b128 a[156:159], v19 offset:14336
    v_mfma_f32_16x16x32_bf16 v[100:103], a[108:111], a[68:71], v[100:103]
    v_add_u32 v18, 65536, v16
    v_add_u32 v19, 65536, v17
    v_mfma_f32_16x16x32_bf16 v[96:99], a[108:111], a[64:67], v[96:99]
    v_mfma_f32_16x16x32_bf16 v[136:139], a[112:115], a[64:67], v[136:139]
    v_mfma_f32_16x16x32_bf16 v[152:155], a[112:115], a[68:71], v[152:155]
    buffer_load_dwordx4 v9, s[44:47], s67 offen offset:1024 lds
    v_mfma_f32_16x16x32_bf16 v[168:171], a[112:115], a[72:75], v[168:171]
    v_mfma_f32_16x16x32_bf16 v[184:187], a[112:115], a[76:79], v[184:187]
    v_mfma_f32_16x16x32_bf16 v[200:203], a[112:115], a[80:83], v[200:203]
    v_mfma_f32_16x16x32_bf16 v[216:219], a[112:115], a[84:87], v[216:219]
    v_mfma_f32_16x16x32_bf16 v[232:235], a[112:115], a[88:91], v[232:235]
    v_mfma_f32_16x16x32_bf16 v[248:251], a[112:115], a[92:95], v[248:251]
    buffer_load_dwordx4 v10, s[44:47], s67 offen offset:2048 lds
    v_mfma_f32_16x16x32_bf16 a[220:223], a[116:119], a[92:95], a[220:223]
    s_lshr_b32 s8, s74, 17
    s_lshl_b32 s8, s8, 17
    s_and_b32 s9, s5, 3
    v_and_b32 v35, 15, v1
    v_lshlrev_b32_e64 v35, 2, v35
    v_mfma_f32_16x16x32_bf16 a[216:219], a[116:119], a[88:91], a[216:219]
    s_lshl_b32 s9, s9, 15
    s_add_u32 s8, s8, s9
    s_lshr_b32 s9, s4, 1
    v_lshlrev_b32 v37, 7, v1
    v_mfma_f32_16x16x32_bf16 a[212:215], a[116:119], a[84:87], a[212:215]
    s_lshl_b32 s9, s9, 14
    s_add_u32 s8, s8, s9
    s_sub_u32 s15, s8, 4096
    v_mfma_f32_16x16x32_bf16 a[208:211], a[116:119], a[80:83], a[208:211]
    v_mfma_f32_16x16x32_bf16 a[204:207], a[116:119], a[76:79], a[204:207]
    v_mfma_f32_16x16x32_bf16 a[200:203], a[116:119], a[72:75], a[200:203]
    buffer_load_dwordx4 v11, s[44:47], s67 offen offset:3072 lds
    v_mfma_f32_16x16x32_bf16 a[196:199], a[116:119], a[68:71], a[196:199]
    v_mfma_f32_16x16x32_bf16 a[192:195], a[116:119], a[64:67], a[192:195]
    v_mfma_f32_16x16x32_bf16 v[140:143], a[120:123], a[64:67], v[140:143]
    v_mfma_f32_16x16x32_bf16 v[156:159], a[120:123], a[68:71], v[156:159]
    v_mfma_f32_16x16x32_bf16 v[172:175], a[120:123], a[72:75], v[172:175]
    v_mfma_f32_16x16x32_bf16 v[188:191], a[120:123], a[76:79], v[188:191]
    v_mfma_f32_16x16x32_bf16 v[204:207], a[120:123], a[80:83], v[204:207]
    v_mfma_f32_16x16x32_bf16 v[220:223], a[120:123], a[84:87], v[220:223]
    v_mfma_f32_16x16x32_bf16 v[236:239], a[120:123], a[88:91], v[236:239]
    v_mfma_f32_16x16x32_bf16 v[252:255], a[120:123], a[92:95], v[252:255]
    v_mfma_f32_16x16x32_bf16 a[252:255], a[124:127], a[92:95], a[252:255]
    v_mfma_f32_16x16x32_bf16 a[248:251], a[124:127], a[88:91], a[248:251]
    v_mfma_f32_16x16x32_bf16 a[244:247], a[124:127], a[84:87], a[244:247]
    v_mfma_f32_16x16x32_bf16 a[240:243], a[124:127], a[80:83], a[240:243]
    v_mfma_f32_16x16x32_bf16 a[236:239], a[124:127], a[76:79], a[236:239]
    v_mfma_f32_16x16x32_bf16 a[232:235], a[124:127], a[72:75], a[232:235]
    v_mfma_f32_16x16x32_bf16 a[228:231], a[124:127], a[68:71], a[228:231]
    s_nop 0
    s_waitcnt lgkmcnt(0)
    v_mfma_f32_16x16x32_bf16 a[224:227], a[124:127], a[64:67], a[224:227]
    v_mfma_f32_16x16x32_bf16 v[128:131], a[160:163], a[128:131], v[128:131]
    s_waitcnt vmcnt(18)
    s_barrier
    v_mfma_f32_16x16x32_bf16 v[144:147], a[160:163], a[132:135], v[144:147]
    ds_read_b64_tr_b16 a[96:97], v20 offset:0
    v_mfma_f32_16x16x32_bf16 v[160:163], a[160:163], a[136:139], v[160:163]
    ds_read_b64_tr_b16 a[98:99], v20 offset:1024
    v_mfma_f32_16x16x32_bf16 v[176:179], a[160:163], a[140:143], v[176:179]
    buffer_load_dword v3, v35, s[52:55], s78 offen sc1
    v_mfma_f32_16x16x32_bf16 v[192:195], a[160:163], a[144:147], v[192:195]
    ds_read_b128 a[64:67], v18 offset:0
    v_mfma_f32_16x16x32_bf16 v[208:211], a[160:163], a[148:151], v[208:211]
    ds_read_b64_tr_b16 a[100:101], v21 offset:0
    v_mfma_f32_16x16x32_bf16 v[224:227], a[160:163], a[152:155], v[224:227]
    ds_read_b64_tr_b16 a[102:103], v21 offset:1024
    v_mfma_f32_16x16x32_bf16 v[240:243], a[160:163], a[156:159], v[240:243]
    ds_read_b128 a[68:71], v18 offset:2048
    v_mfma_f32_16x16x32_bf16 v[92:95], a[164:167], a[156:159], v[92:95]
    s_add_u32 m0, s64, 49152
    s_mov_b32 s66, 3932160
    ds_read_b64_tr_b16 a[104:105], v22 offset:0
    v_mfma_f32_16x16x32_bf16 v[88:91], a[164:167], a[152:155], v[88:91]
    buffer_load_dwordx4 v12, s[48:51], s66 offen offset:0 lds
    v_mfma_f32_16x16x32_bf16 v[84:87], a[164:167], a[148:151], v[84:87]
    ds_read_b64_tr_b16 a[106:107], v22 offset:1024
    v_mfma_f32_16x16x32_bf16 v[80:83], a[164:167], a[144:147], v[80:83]
    ds_read_b128 a[72:75], v18 offset:4096
    v_mfma_f32_16x16x32_bf16 v[76:79], a[164:167], a[140:143], v[76:79]
    ds_read_b64_tr_b16 a[108:109], v23 offset:0
    v_mfma_f32_16x16x32_bf16 v[72:75], a[164:167], a[136:139], v[72:75]
    ds_read_b64_tr_b16 a[110:111], v23 offset:1024
    v_mfma_f32_16x16x32_bf16 v[68:71], a[164:167], a[132:135], v[68:71]
    ds_read_b128 a[76:79], v18 offset:6144
    v_mfma_f32_16x16x32_bf16 v[64:67], a[164:167], a[128:131], v[64:67]
    buffer_load_dwordx4 v13, s[48:51], s66 offen offset:1024 lds
    v_mfma_f32_16x16x32_bf16 v[132:135], a[168:171], a[128:131], v[132:135]
    ds_read_b64_tr_b16 a[112:113], v24 offset:0
    v_mfma_f32_16x16x32_bf16 v[148:151], a[168:171], a[132:135], v[148:151]
    ds_read_b64_tr_b16 a[114:115], v24 offset:1024
    v_mfma_f32_16x16x32_bf16 v[164:167], a[168:171], a[136:139], v[164:167]
    ds_read_b128 a[80:83], v18 offset:8192
    v_mfma_f32_16x16x32_bf16 v[180:183], a[168:171], a[140:143], v[180:183]
    ds_read_b64_tr_b16 a[116:117], v25 offset:0
    v_mfma_f32_16x16x32_bf16 v[196:199], a[168:171], a[144:147], v[196:199]
    ds_read_b64_tr_b16 a[118:119], v25 offset:1024
    v_mfma_f32_16x16x32_bf16 v[212:215], a[168:171], a[148:151], v[212:215]
    buffer_load_dwordx4 v14, s[48:51], s66 offen offset:2048 lds
    v_mfma_f32_16x16x32_bf16 v[228:231], a[168:171], a[152:155], v[228:231]
    ds_read_b128 a[84:87], v18 offset:10240
    v_mfma_f32_16x16x32_bf16 v[244:247], a[168:171], a[156:159], v[244:247]
    ds_read_b64_tr_b16 a[120:121], v26 offset:0
    v_mfma_f32_16x16x32_bf16 v[124:127], a[172:175], a[156:159], v[124:127]
    s_mov_b32 s44, s20
    s_mov_b32 s45, s21
    ds_read_b64_tr_b16 a[122:123], v26 offset:1024
    v_mfma_f32_16x16x32_bf16 v[120:123], a[172:175], a[152:155], v[120:123]
    s_mov_b32 s46, 4194304
    s_mov_b32 s47, 0x00020000
    ds_read_b128 a[88:91], v18 offset:12288
    v_mfma_f32_16x16x32_bf16 v[116:119], a[172:175], a[148:151], v[116:119]
    s_mov_b32 s60, s30
    s_mov_b32 s61, s31
    ds_read_b64_tr_b16 a[124:125], v27 offset:0
    v_mfma_f32_16x16x32_bf16 v[112:115], a[172:175], a[144:147], v[112:115]
    s_mov_b32 s62, 1409024
    s_mov_b32 s63, 0x00020000
    buffer_load_dwordx4 v15, s[48:51], s66 offen offset:3072 lds
    v_mfma_f32_16x16x32_bf16 v[108:111], a[172:175], a[140:143], v[108:111]
    s_lshl_b32 s71, s4, 11
    s_lshl_b32 s73, s4, 10
    ds_read_b64_tr_b16 a[126:127], v27 offset:1024
    v_mfma_f32_16x16x32_bf16 v[104:107], a[172:175], a[136:139], v[104:107]
    s_lshl_b32 s8, s4, 16
    s_lshl_b32 s9, s5, 8
    ds_read_b128 a[92:95], v18 offset:14336
    v_mfma_f32_16x16x32_bf16 v[100:103], a[172:175], a[132:135], v[100:103]
    s_add_u32 s8, s8, s9
    s_lshl_b32 s9, s7, 2
    v_mfma_f32_16x16x32_bf16 v[96:99], a[172:175], a[128:131], v[96:99]
    s_nop 0
    s_mul_i32 s10, s4, 22016
    s_add_u32 s10, s10, s69
    v_mfma_f32_16x16x32_bf16 v[136:139], a[176:179], a[128:131], v[136:139]
    s_lshl_b32 s11, s7, 1
    s_lshl_b32 s3, s68, 16
    v_mfma_f32_16x16x32_bf16 v[152:155], a[176:179], a[132:135], v[152:155]
    s_add_u32 s66, s74, s3
    s_sub_u32 s67, s74, s3
    v_mfma_f32_16x16x32_bf16 v[168:171], a[176:179], a[136:139], v[168:171]
    s_nop 0
    s_add_u32 s67, s67, 65536
    s_lshr_b32 s15, s4, 1
    v_mfma_f32_16x16x32_bf16 v[184:187], a[176:179], a[140:143], v[184:187]
    s_nop 0
    s_lshl_b32 s15, s15, 10
    s_sub_u32 s13, 3072, s15
    v_mfma_f32_16x16x32_bf16 v[200:203], a[176:179], a[144:147], v[200:203]
    s_lshl_b32 s76, s5, 20
    s_lshl_b32 s3, s6, 17
    v_mfma_f32_16x16x32_bf16 v[216:219], a[176:179], a[148:151], v[216:219]
    s_add_u32 s76, s76, s3
    s_lshr_b32 s3, s4, 1
    v_mfma_f32_16x16x32_bf16 v[232:235], a[176:179], a[152:155], v[232:235]
    s_lshl_b32 s3, s3, 16
    s_add_u32 s76, s76, s3
    v_mfma_f32_16x16x32_bf16 v[248:251], a[176:179], a[156:159], v[248:251]
    s_lshl_b32 s3, s7, 13
    s_add_u32 s76, s76, s3
    v_mfma_f32_16x16x32_bf16 a[220:223], a[180:183], a[156:159], a[220:223]
    s_add_u32 s76, s76, 2097152
    s_sub_u32 s14, 131072, s3
    v_mfma_f32_16x16x32_bf16 a[216:219], a[180:183], a[152:155], a[216:219]
    s_nop 0
    s_lshl_b32 s12, s68, 1
    v_mfma_f32_16x16x32_bf16 a[212:215], a[180:183], a[148:151], a[212:215]
    v_mfma_f32_16x16x32_bf16 a[208:211], a[180:183], a[144:147], a[208:211]
    v_mfma_f32_16x16x32_bf16 a[204:207], a[180:183], a[140:143], a[204:207]
    v_lshrrev_b32 v32, 4, v1
    v_and_b32 v33, 15, v1
    v_mfma_f32_16x16x32_bf16 a[200:203], a[180:183], a[136:139], a[200:203]
    v_or_b32 v34, s9, v32
    v_lshlrev_b32 v34, 1, v34
    v_mfma_f32_16x16x32_bf16 a[196:199], a[180:183], a[132:135], a[196:199]
    v_xor_b32 v34, v34, v33
    v_lshlrev_b32 v34, 4, v34
    v_mfma_f32_16x16x32_bf16 a[192:195], a[180:183], a[128:131], a[192:195]
    v_lshl_add_u32 v34, v32, 13, v34
    v_add_u32_e64 v28, s8, v34
    v_mfma_f32_16x16x32_bf16 v[140:143], a[184:187], a[128:131], v[140:143]
    v_add_u32 v29, 31744, v28
    v_and_b32_e64 v32, 1, v32
    v_mfma_f32_16x16x32_bf16 v[156:159], a[184:187], a[132:135], v[156:159]
    v_or_b32 v32, s11, v32
    v_lshlrev_b32 v32, 1, v32
    v_mfma_f32_16x16x32_bf16 v[172:175], a[184:187], a[136:139], v[172:175]
    v_and_b32 v33, 7, v1
    v_xor_b32 v32, v32, v33
    v_mfma_f32_16x16x32_bf16 v[188:191], a[184:187], a[140:143], v[188:191]
    v_lshrrev_b32_e64 v33, 3, v1
    v_mul_u32_u24 v33, 2752, v33
    v_mfma_f32_16x16x32_bf16 v[204:207], a[184:187], a[144:147], v[204:207]
    v_lshl_add_u32 v33, v32, 4, v33
    v_add_u32_e64 v30, s10, v33
    v_mfma_f32_16x16x32_bf16 v[220:223], a[184:187], a[148:151], v[220:223]
    v_lshrrev_b32_e64 v32, 4, v1
    v_bfe_u32 v33, v1, 2, 2
    v_mfma_f32_16x16x32_bf16 v[236:239], a[184:187], a[152:155], v[236:239]
    v_lshl_add_u32 v32, v32, 3, v33
    v_lshlrev_b32_e64 v32, 7, v32
    v_mfma_f32_16x16x32_bf16 v[252:255], a[184:187], a[156:159], v[252:255]
    v_and_b32_e64 v33, 3, v1
    v_lshl_add_u32 v32, v33, 3, v32
    v_mfma_f32_16x16x32_bf16 a[252:255], a[188:191], a[156:159], a[252:255]
    v_add_u32 v31, 139264, v32
    v_bfe_u32 v34, v1, 3, 2
    v_mfma_f32_16x16x32_bf16 a[248:251], a[188:191], a[152:155], a[248:251]
    v_xor_b32_e64 v34, s12, v34
    v_mfma_f32_16x16x32_bf16 a[244:247], a[188:191], a[148:151], a[244:247]
    v_mfma_f32_16x16x32_bf16 a[240:243], a[188:191], a[144:147], a[240:243]
    v_mfma_f32_16x16x32_bf16 a[236:239], a[188:191], a[140:143], a[236:239]
    v_mfma_f32_16x16x32_bf16 a[232:235], a[188:191], a[136:139], a[232:235]
    v_mfma_f32_16x16x32_bf16 a[228:231], a[188:191], a[132:135], a[228:231]
    s_nop 0
    s_waitcnt lgkmcnt(0)
    v_mfma_f32_16x16x32_bf16 a[224:227], a[188:191], a[128:131], a[224:227]
    v_mfma_f32_16x16x32_bf16 v[128:131], a[96:99], a[64:67], v[128:131]
    s_waitcnt vmcnt(19)
    s_barrier
    v_mfma_f32_16x16x32_bf16 v[144:147], a[96:99], a[68:71], v[144:147]
    ds_read_b64_tr_b16 a[160:161], v20 offset:16384
    v_mfma_f32_16x16x32_bf16 v[160:163], a[96:99], a[72:75], v[160:163]
    s_add_u32 m0, s71, 131072
    s_mov_b32 s72, 0
    ds_read_b64_tr_b16 a[162:163], v20 offset:17408
    s_waitcnt vmcnt(4)
    v_cmp_ne_u32 vcc, 0, v3
    s_cmp_eq_u64 vcc, -1
    s_cbranch_scc0 L_pollxn_0
L_pollxn_0_ret:
    s_nop 0
    v_mfma_f32_16x16x32_bf16 v[176:179], a[96:99], a[76:79], v[176:179]
    buffer_load_dwordx4 v28, s[44:47], s72 offen lds
    v_mfma_f32_16x16x32_bf16 v[192:195], a[96:99], a[80:83], v[192:195]
    ds_read_b128 a[128:131], v19 offset:0
    v_mfma_f32_16x16x32_bf16 v[208:211], a[96:99], a[84:87], v[208:211]
    ds_read_b64_tr_b16 a[164:165], v21 offset:16384
    v_mfma_f32_16x16x32_bf16 v[224:227], a[96:99], a[88:91], v[224:227]
    ds_read_b64_tr_b16 a[166:167], v21 offset:17408
    v_mfma_f32_16x16x32_bf16 v[240:243], a[96:99], a[92:95], v[240:243]
    ds_read_b128 a[132:135], v19 offset:2048
    v_mfma_f32_16x16x32_bf16 v[92:95], a[100:103], a[92:95], v[92:95]
    ds_read_b64_tr_b16 a[168:169], v22 offset:16384
    v_mfma_f32_16x16x32_bf16 v[88:91], a[100:103], a[88:91], v[88:91]
    buffer_load_dwordx4 v29, s[44:47], s72 offen offset:1024 lds
    v_mfma_f32_16x16x32_bf16 v[84:87], a[100:103], a[84:87], v[84:87]
    ds_read_b64_tr_b16 a[170:171], v22 offset:17408
    v_mfma_f32_16x16x32_bf16 v[80:83], a[100:103], a[80:83], v[80:83]
    ds_read_b128 a[136:139], v19 offset:4096
    v_mfma_f32_16x16x32_bf16 v[76:79], a[100:103], a[76:79], v[76:79]
    ds_read_b64_tr_b16 a[172:173], v23 offset:16384
    v_mfma_f32_16x16x32_bf16 v[72:75], a[100:103], a[72:75], v[72:75]
    ds_read_b64_tr_b16 a[174:175], v23 offset:17408
    v_mfma_f32_16x16x32_bf16 v[68:71], a[100:103], a[68:71], v[68:71]
    s_nop 0
    s_add_u32 m0, s73, 139264
    s_mov_b32 s72, 0
    ds_read_b128 a[140:143], v19 offset:6144
    v_mfma_f32_16x16x32_bf16 v[64:67], a[100:103], a[64:67], v[64:67]
    buffer_load_dwordx4 v30, s[60:63], s72 offen lds
    v_mfma_f32_16x16x32_bf16 v[132:135], a[104:107], a[64:67], v[132:135]
    ds_read_b64_tr_b16 a[176:177], v24 offset:16384
    v_mfma_f32_16x16x32_bf16 v[148:151], a[104:107], a[68:71], v[148:151]
    ds_read_b64_tr_b16 a[178:179], v24 offset:17408
    v_mfma_f32_16x16x32_bf16 v[164:167], a[104:107], a[72:75], v[164:167]
    ds_read_b128 a[144:147], v19 offset:8192
    v_mfma_f32_16x16x32_bf16 v[180:183], a[104:107], a[76:79], v[180:183]
    ds_read_b64_tr_b16 a[180:181], v25 offset:16384
    v_mfma_f32_16x16x32_bf16 v[196:199], a[104:107], a[80:83], v[196:199]
    s_add_u32 m0, s71, 143360
    s_mov_b32 s72, 262144
    ds_read_b64_tr_b16 a[182:183], v25 offset:17408
    v_mfma_f32_16x16x32_bf16 v[212:215], a[104:107], a[84:87], v[212:215]
    buffer_load_dwordx4 v28, s[44:47], s72 offen lds
    v_mfma_f32_16x16x32_bf16 v[228:231], a[104:107], a[88:91], v[228:231]
    ds_read_b128 a[148:151], v19 offset:10240
    v_mfma_f32_16x16x32_bf16 v[244:247], a[104:107], a[92:95], v[244:247]
    ds_read_b64_tr_b16 a[184:185], v26 offset:16384
    v_mfma_f32_16x16x32_bf16 v[124:127], a[108:111], a[92:95], v[124:127]
    ds_read_b64_tr_b16 a[186:187], v26 offset:17408
    v_mfma_f32_16x16x32_bf16 v[120:123], a[108:111], a[88:91], v[120:123]
    ds_read_b128 a[152:155], v19 offset:12288
    v_mfma_f32_16x16x32_bf16 v[116:119], a[108:111], a[84:87], v[116:119]
    ds_read_b64_tr_b16 a[188:189], v27 offset:16384
    v_mfma_f32_16x16x32_bf16 v[112:115], a[108:111], a[80:83], v[112:115]
    buffer_load_dwordx4 v29, s[44:47], s72 offen offset:1024 lds
    v_mfma_f32_16x16x32_bf16 v[108:111], a[108:111], a[76:79], v[108:111]
    ds_read_b64_tr_b16 a[190:191], v27 offset:17408
    v_mfma_f32_16x16x32_bf16 v[104:107], a[108:111], a[72:75], v[104:107]
    ds_read_b128 a[156:159], v19 offset:14336
    v_mfma_f32_16x16x32_bf16 v[100:103], a[108:111], a[68:71], v[100:103]
    v_add_u32 v18, 98304, v16
    v_add_u32 v19, 98304, v17
    v_mfma_f32_16x16x32_bf16 v[96:99], a[108:111], a[64:67], v[96:99]
    v_mfma_f32_16x16x32_bf16 v[136:139], a[112:115], a[64:67], v[136:139]
    s_add_u32 m0, s73, 151552
    s_mov_b32 s72, 88064
    v_mfma_f32_16x16x32_bf16 v[152:155], a[112:115], a[68:71], v[152:155]
    buffer_load_dwordx4 v30, s[60:63], s72 offen lds
    v_mfma_f32_16x16x32_bf16 v[168:171], a[112:115], a[72:75], v[168:171]
    v_mfma_f32_16x16x32_bf16 v[184:187], a[112:115], a[76:79], v[184:187]
    v_mfma_f32_16x16x32_bf16 v[200:203], a[112:115], a[80:83], v[200:203]
    v_mfma_f32_16x16x32_bf16 v[216:219], a[112:115], a[84:87], v[216:219]
    v_mfma_f32_16x16x32_bf16 v[232:235], a[112:115], a[88:91], v[232:235]
    s_nop 0
    s_add_u32 m0, s71, 0
    s_mov_b32 s72, 524288
    v_mfma_f32_16x16x32_bf16 v[248:251], a[112:115], a[92:95], v[248:251]
    buffer_load_dwordx4 v28, s[44:47], s72 offen lds
    v_mfma_f32_16x16x32_bf16 a[220:223], a[116:119], a[92:95], a[220:223]
    v_mfma_f32_16x16x32_bf16 a[216:219], a[116:119], a[88:91], a[216:219]
    v_mfma_f32_16x16x32_bf16 a[212:215], a[116:119], a[84:87], a[212:215]
    v_mfma_f32_16x16x32_bf16 a[208:211], a[116:119], a[80:83], a[208:211]
    v_mfma_f32_16x16x32_bf16 a[204:207], a[116:119], a[76:79], a[204:207]
    v_mfma_f32_16x16x32_bf16 a[200:203], a[116:119], a[72:75], a[200:203]
    buffer_load_dwordx4 v29, s[44:47], s72 offen offset:1024 lds
    v_mfma_f32_16x16x32_bf16 a[196:199], a[116:119], a[68:71], a[196:199]
    v_mfma_f32_16x16x32_bf16 a[192:195], a[116:119], a[64:67], a[192:195]
    v_mfma_f32_16x16x32_bf16 v[140:143], a[120:123], a[64:67], v[140:143]
    v_mfma_f32_16x16x32_bf16 v[156:159], a[120:123], a[68:71], v[156:159]
    v_mfma_f32_16x16x32_bf16 v[172:175], a[120:123], a[72:75], v[172:175]
    s_add_u32 m0, s73, 8192
    s_mov_b32 s72, 176128
    v_mfma_f32_16x16x32_bf16 v[188:191], a[120:123], a[76:79], v[188:191]
    buffer_load_dwordx4 v30, s[60:63], s72 offen lds
    v_mfma_f32_16x16x32_bf16 v[204:207], a[120:123], a[80:83], v[204:207]
    v_mfma_f32_16x16x32_bf16 v[220:223], a[120:123], a[84:87], v[220:223]
    v_mfma_f32_16x16x32_bf16 v[236:239], a[120:123], a[88:91], v[236:239]
    v_mfma_f32_16x16x32_bf16 v[252:255], a[120:123], a[92:95], v[252:255]
    v_mfma_f32_16x16x32_bf16 a[252:255], a[124:127], a[92:95], a[252:255]
    v_mfma_f32_16x16x32_bf16 a[248:251], a[124:127], a[88:91], a[248:251]
    v_mfma_f32_16x16x32_bf16 a[244:247], a[124:127], a[84:87], a[244:247]
    v_mfma_f32_16x16x32_bf16 a[240:243], a[124:127], a[80:83], a[240:243]
    v_mfma_f32_16x16x32_bf16 a[236:239], a[124:127], a[76:79], a[236:239]
    v_mfma_f32_16x16x32_bf16 a[232:235], a[124:127], a[72:75], a[232:235]
    v_mfma_f32_16x16x32_bf16 a[228:231], a[124:127], a[68:71], a[228:231]
    s_nop 0
    s_waitcnt lgkmcnt(0)
    v_mfma_f32_16x16x32_bf16 a[224:227], a[124:127], a[64:67], a[224:227]
    v_mfma_f32_16x16x32_bf16 v[128:131], a[160:163], a[128:131], v[128:131]
    s_nop 0
    s_barrier
    v_mfma_f32_16x16x32_bf16 v[144:147], a[160:163], a[132:135], v[144:147]
    ds_read_b64_tr_b16 a[96:97], v20 offset:32768
    v_mfma_f32_16x16x32_bf16 v[160:163], a[160:163], a[136:139], v[160:163]
    s_add_u32 m0, s71, 12288
    s_mov_b32 s72, 786432
    ds_read_b64_tr_b16 a[98:99], v20 offset:33792
    v_mfma_f32_16x16x32_bf16 v[176:179], a[160:163], a[140:143], v[176:179]
    buffer_load_dwordx4 v28, s[44:47], s72 offen lds
    v_mfma_f32_16x16x32_bf16 v[192:195], a[160:163], a[144:147], v[192:195]
    ds_read_b128 a[64:67], v18 offset:0
    v_mfma_f32_16x16x32_bf16 v[208:211], a[160:163], a[148:151], v[208:211]
    ds_read_b64_tr_b16 a[100:101], v21 offset:32768
    v_mfma_f32_16x16x32_bf16 v[224:227], a[160:163], a[152:155], v[224:227]
    ds_read_b64_tr_b16 a[102:103], v21 offset:33792
    v_mfma_f32_16x16x32_bf16 v[240:243], a[160:163], a[156:159], v[240:243]
    ds_read_b128 a[68:71], v18 offset:2048
    v_mfma_f32_16x16x32_bf16 v[92:95], a[164:167], a[156:159], v[92:95]
    ds_read_b64_tr_b16 a[104:105], v22 offset:32768
    v_mfma_f32_16x16x32_bf16 v[88:91], a[164:167], a[152:155], v[88:91]
    buffer_load_dwordx4 v29, s[44:47], s72 offen offset:1024 lds
    v_mfma_f32_16x16x32_bf16 v[84:87], a[164:167], a[148:151], v[84:87]
    ds_read_b64_tr_b16 a[106:107], v22 offset:33792
    v_mfma_f32_16x16x32_bf16 v[80:83], a[164:167], a[144:147], v[80:83]
    ds_read_b128 a[72:75], v18 offset:4096
    v_mfma_f32_16x16x32_bf16 v[76:79], a[164:167], a[140:143], v[76:79]
    ds_read_b64_tr_b16 a[108:109], v23 offset:32768
    v_mfma_f32_16x16x32_bf16 v[72:75], a[164:167], a[136:139], v[72:75]
    ds_read_b64_tr_b16 a[110:111], v23 offset:33792
    v_mfma_f32_16x16x32_bf16 v[68:71], a[164:167], a[132:135], v[68:71]
    s_add_u32 m0, s73, 20480
    s_mov_b32 s72, 264192
    ds_read_b128 a[76:79], v18 offset:6144
    v_mfma_f32_16x16x32_bf16 v[64:67], a[164:167], a[128:131], v[64:67]
    buffer_load_dwordx4 v30, s[60:63], s72 offen lds
    v_mfma_f32_16x16x32_bf16 v[132:135], a[168:171], a[128:131], v[132:135]
    ds_read_b64_tr_b16 a[112:113], v24 offset:32768
    v_mfma_f32_16x16x32_bf16 v[148:151], a[168:171], a[132:135], v[148:151]
    ds_read_b64_tr_b16 a[114:115], v24 offset:33792
    v_mfma_f32_16x16x32_bf16 v[164:167], a[168:171], a[136:139], v[164:167]
    ds_read_b128 a[80:83], v18 offset:8192
    v_mfma_f32_16x16x32_bf16 v[180:183], a[168:171], a[140:143], v[180:183]
    ds_read_b64_tr_b16 a[116:117], v25 offset:32768
    v_mfma_f32_16x16x32_bf16 v[196:199], a[168:171], a[144:147], v[196:199]
    s_add_u32 m0, s71, 65536
    s_mov_b32 s72, 1048576
    ds_read_b64_tr_b16 a[118:119], v25 offset:33792
    v_mfma_f32_16x16x32_bf16 v[212:215], a[168:171], a[148:151], v[212:215]
    buffer_load_dwordx4 v28, s[44:47], s72 offen lds
    v_mfma_f32_16x16x32_bf16 v[228:231], a[168:171], a[152:155], v[228:231]
    ds_read_b128 a[84:87], v18 offset:10240
    v_mfma_f32_16x16x32_bf16 v[244:247], a[168:171], a[156:159], v[244:247]
    ds_read_b64_tr_b16 a[120:121], v26 offset:32768
    v_mfma_f32_16x16x32_bf16 v[124:127], a[172:175], a[156:159], v[124:127]
    ds_read_b64_tr_b16 a[122:123], v26 offset:33792
    v_mfma_f32_16x16x32_bf16 v[120:123], a[172:175], a[152:155], v[120:123]
    ds_read_b128 a[88:91], v18 offset:12288
    v_mfma_f32_16x16x32_bf16 v[116:119], a[172:175], a[148:151], v[116:119]
    ds_read_b64_tr_b16 a[124:125], v27 offset:32768
    v_mfma_f32_16x16x32_bf16 v[112:115], a[172:175], a[144:147], v[112:115]
    buffer_load_dwordx4 v29, s[44:47], s72 offen offset:1024 lds
    v_mfma_f32_16x16x32_bf16 v[108:111], a[172:175], a[140:143], v[108:111]
    ds_read_b64_tr_b16 a[126:127], v27 offset:33792
    v_mfma_f32_16x16x32_bf16 v[104:107], a[172:175], a[136:139], v[104:107]
    ds_read_b128 a[92:95], v18 offset:14336
    v_mfma_f32_16x16x32_bf16 v[100:103], a[172:175], a[132:135], v[100:103]
    v_mfma_f32_16x16x32_bf16 v[96:99], a[172:175], a[128:131], v[96:99]
    v_mfma_f32_16x16x32_bf16 v[136:139], a[176:179], a[128:131], v[136:139]
    s_add_u32 m0, s73, 73728
    s_mov_b32 s72, 352256
    v_mfma_f32_16x16x32_bf16 v[152:155], a[176:179], a[132:135], v[152:155]
    buffer_load_dwordx4 v30, s[60:63], s72 offen lds
    v_mfma_f32_16x16x32_bf16 v[168:171], a[176:179], a[136:139], v[168:171]
    v_mfma_f32_16x16x32_bf16 v[184:187], a[176:179], a[140:143], v[184:187]
    v_mfma_f32_16x16x32_bf16 v[200:203], a[176:179], a[144:147], v[200:203]
    v_mfma_f32_16x16x32_bf16 v[216:219], a[176:179], a[148:151], v[216:219]
    v_mfma_f32_16x16x32_bf16 v[232:235], a[176:179], a[152:155], v[232:235]
    s_add_u32 m0, s71, 77824
    s_mov_b32 s72, 1310720
    v_mfma_f32_16x16x32_bf16 v[248:251], a[176:179], a[156:159], v[248:251]
    buffer_load_dwordx4 v28, s[44:47], s72 offen lds
    v_mfma_f32_16x16x32_bf16 a[220:223], a[180:183], a[156:159], a[220:223]
    v_add_u32 v36, s15, v2
    v_add_u32 v37, s13, v2
    v_mfma_f32_16x16x32_bf16 a[216:219], a[180:183], a[152:155], a[216:219]
    v_mfma_f32_16x16x32_bf16 a[212:215], a[180:183], a[148:151], a[212:215]
    v_mfma_f32_16x16x32_bf16 a[208:211], a[180:183], a[144:147], a[208:211]
    v_mfma_f32_16x16x32_bf16 a[204:207], a[180:183], a[140:143], a[204:207]
    v_mfma_f32_16x16x32_bf16 a[200:203], a[180:183], a[136:139], a[200:203]
    buffer_load_dwordx4 v29, s[44:47], s72 offen offset:1024 lds
    v_mfma_f32_16x16x32_bf16 a[196:199], a[180:183], a[132:135], a[196:199]
    v_mfma_f32_16x16x32_bf16 a[192:195], a[180:183], a[128:131], a[192:195]
    v_mfma_f32_16x16x32_bf16 v[140:143], a[184:187], a[128:131], v[140:143]
    v_mfma_f32_16x16x32_bf16 v[156:159], a[184:187], a[132:135], v[156:159]
    v_mfma_f32_16x16x32_bf16 v[172:175], a[184:187], a[136:139], v[172:175]
    s_add_u32 m0, s73, 86016
    s_mov_b32 s72, 440320
    v_mfma_f32_16x16x32_bf16 v[188:191], a[184:187], a[140:143], v[188:191]
    buffer_load_dwordx4 v30, s[60:63], s72 offen lds
    v_mfma_f32_16x16x32_bf16 v[204:207], a[184:187], a[144:147], v[204:207]
    v_mfma_f32_16x16x32_bf16 v[220:223], a[184:187], a[148:151], v[220:223]
    v_mfma_f32_16x16x32_bf16 v[236:239], a[184:187], a[152:155], v[236:239]
    v_mfma_f32_16x16x32_bf16 v[252:255], a[184:187], a[156:159], v[252:255]
    v_mfma_f32_16x16x32_bf16 a[252:255], a[188:191], a[156:159], a[252:255]
    v_mfma_f32_16x16x32_bf16 a[248:251], a[188:191], a[152:155], a[248:251]
    v_mfma_f32_16x16x32_bf16 a[244:247], a[188:191], a[148:151], a[244:247]
    v_mfma_f32_16x16x32_bf16 a[240:243], a[188:191], a[144:147], a[240:243]
    v_mfma_f32_16x16x32_bf16 a[236:239], a[188:191], a[140:143], a[236:239]
    v_mfma_f32_16x16x32_bf16 a[232:235], a[188:191], a[136:139], a[232:235]
    v_mfma_f32_16x16x32_bf16 a[228:231], a[188:191], a[132:135], a[228:231]
    s_nop 0
    s_waitcnt lgkmcnt(0)
    v_mfma_f32_16x16x32_bf16 a[224:227], a[188:191], a[128:131], a[224:227]
    v_mfma_f32_16x16x32_bf16 v[128:131], a[96:99], a[64:67], v[128:131]
    s_waitcnt vmcnt(18)
    s_barrier
    v_mfma_f32_16x16x32_bf16 v[144:147], a[96:99], a[68:71], v[144:147]
    ds_read_b64_tr_b16 a[160:161], v20 offset:49152
    v_mfma_f32_16x16x32_bf16 v[160:163], a[96:99], a[72:75], v[160:163]
    s_add_u32 m0, s71, 24576
    s_mov_b32 s72, 1572864
    ds_read_b64_tr_b16 a[162:163], v20 offset:50176
    v_mfma_f32_16x16x32_bf16 v[176:179], a[96:99], a[76:79], v[176:179]
    buffer_load_dwordx4 v28, s[44:47], s72 offen lds
    v_mfma_f32_16x16x32_bf16 v[192:195], a[96:99], a[80:83], v[192:195]
    ds_read_b128 a[128:131], v19 offset:0
    v_mfma_f32_16x16x32_bf16 v[208:211], a[96:99], a[84:87], v[208:211]
    ds_read_b64_tr_b16 a[164:165], v21 offset:49152
    v_mfma_f32_16x16x32_bf16 v[224:227], a[96:99], a[88:91], v[224:227]
    buffer_load_dwordx4 v29, s[44:47], s72 offen offset:1024 lds
    v_mfma_f32_16x16x32_bf16 v[240:243], a[96:99], a[92:95], v[240:243]
    ds_read_b64_tr_b16 a[166:167], v21 offset:50176
    v_mfma_f32_16x16x32_bf16 v[92:95], a[100:103], a[92:95], v[92:95]
    s_add_u32 m0, s73, 32768
    s_mov_b32 s72, 528384
    ds_read_b128 a[132:135], v19 offset:2048
    v_mfma_f32_16x16x32_bf16 v[88:91], a[100:103], a[88:91], v[88:91]
    buffer_load_dwordx4 v30, s[60:63], s72 offen lds
    v_mfma_f32_16x16x32_bf16 v[84:87], a[100:103], a[84:87], v[84:87]
    ds_read_b64_tr_b16 a[168:169], v22 offset:49152
    v_mfma_f32_16x16x32_bf16 v[80:83], a[100:103], a[80:83], v[80:83]
    s_add_u32 m0, s71, 36864
    s_mov_b32 s72, 1835008
    ds_read_b64_tr_b16 a[170:171], v22 offset:50176
    v_mfma_f32_16x16x32_bf16 v[76:79], a[100:103], a[76:79], v[76:79]
    buffer_load_dwordx4 v28, s[44:47], s72 offen lds
    v_mfma_f32_16x16x32_bf16 v[72:75], a[100:103], a[72:75], v[72:75]
    ds_read_b128 a[136:139], v19 offset:4096
    v_mfma_f32_16x16x32_bf16 v[68:71], a[100:103], a[68:71], v[68:71]
    ds_read_b64_tr_b16 a[172:173], v23 offset:49152
    v_mfma_f32_16x16x32_bf16 v[64:67], a[100:103], a[64:67], v[64:67]
    buffer_load_dwordx4 v29, s[44:47], s72 offen offset:1024 lds
    v_mfma_f32_16x16x32_bf16 v[132:135], a[104:107], a[64:67], v[132:135]
    ds_read_b64_tr_b16 a[174:175], v23 offset:50176
    v_mfma_f32_16x16x32_bf16 v[148:151], a[104:107], a[68:71], v[148:151]
    s_add_u32 m0, s73, 45056
    s_mov_b32 s72, 616448
    ds_read_b128 a[140:143], v19 offset:6144
    v_mfma_f32_16x16x32_bf16 v[164:167], a[104:107], a[72:75], v[164:167]
    buffer_load_dwordx4 v30, s[60:63], s72 offen lds
    v_mfma_f32_16x16x32_bf16 v[180:183], a[104:107], a[76:79], v[180:183]
    ds_read_b64_tr_b16 a[176:177], v24 offset:49152
    v_mfma_f32_16x16x32_bf16 v[196:199], a[104:107], a[80:83], v[196:199]
    s_nop 0
    s_add_u32 s75, s66, 0
    ds_read_b64_tr_b16 a[178:179], v24 offset:50176
    v_mfma_f32_16x16x32_bf16 v[212:215], a[104:107], a[84:87], v[212:215]
    buffer_load_dwordx4 a[0:3], v36, s[52:55], s75 offen sc1
    v_mfma_f32_16x16x32_bf16 v[228:231], a[104:107], a[88:91], v[228:231]
    ds_read_b128 a[144:147], v19 offset:8192
    v_mfma_f32_16x16x32_bf16 v[244:247], a[104:107], a[92:95], v[244:247]
    ds_read_b64_tr_b16 a[180:181], v25 offset:49152
    v_mfma_f32_16x16x32_bf16 v[124:127], a[108:111], a[92:95], v[124:127]
    buffer_load_dwordx4 a[4:7], v37, s[52:55], s75 offen sc1
    v_mfma_f32_16x16x32_bf16 v[120:123], a[108:111], a[88:91], v[120:123]
    ds_read_b64_tr_b16 a[182:183], v25 offset:50176
    v_mfma_f32_16x16x32_bf16 v[116:119], a[108:111], a[84:87], v[116:119]
    s_nop 0
    s_add_u32 s75, s67, 0
    ds_read_b128 a[148:151], v19 offset:10240
    v_mfma_f32_16x16x32_bf16 v[112:115], a[108:111], a[80:83], v[112:115]
    buffer_load_dwordx4 a[8:11], v36, s[52:55], s75 offen sc1
    v_mfma_f32_16x16x32_bf16 v[108:111], a[108:111], a[76:79], v[108:111]
    ds_read_b64_tr_b16 a[184:185], v26 offset:49152
    v_mfma_f32_16x16x32_bf16 v[104:107], a[108:111], a[72:75], v[104:107]
    ds_read_b64_tr_b16 a[186:187], v26 offset:50176
    v_mfma_f32_16x16x32_bf16 v[100:103], a[108:111], a[68:71], v[100:103]
    buffer_load_dwordx4 a[12:15], v37, s[52:55], s75 offen sc1
    v_mfma_f32_16x16x32_bf16 v[96:99], a[108:111], a[64:67], v[96:99]
    ds_read_b128 a[152:155], v19 offset:12288
    v_mfma_f32_16x16x32_bf16 v[136:139], a[112:115], a[64:67], v[136:139]
    s_add_u32 s75, s66, 4096
    ds_read_b64_tr_b16 a[188:189], v27 offset:49152
    v_mfma_f32_16x16x32_bf16 v[152:155], a[112:115], a[68:71], v[152:155]
    buffer_load_dwordx4 a[16:19], v36, s[52:55], s75 offen sc1
    v_mfma_f32_16x16x32_bf16 v[168:171], a[112:115], a[72:75], v[168:171]
    ds_read_b64_tr_b16 a[190:191], v27 offset:50176
    v_mfma_f32_16x16x32_bf16 v[184:187], a[112:115], a[76:79], v[184:187]
    ds_read_b128 a[156:159], v19 offset:14336
    v_mfma_f32_16x16x32_bf16 v[200:203], a[112:115], a[80:83], v[200:203]
    buffer_load_dwordx4 a[20:23], v37, s[52:55], s75 offen sc1
    v_mfma_f32_16x16x32_bf16 v[216:219], a[112:115], a[84:87], v[216:219]
    v_add_u32 v20, s14, v20
    v_add_u32 v21, s14, v21
    v_mfma_f32_16x16x32_bf16 v[232:235], a[112:115], a[88:91], v[232:235]
    s_add_u32 s75, s67, 4096
    v_add_u32 v22, s14, v22
    v_add_u32 v23, s14, v23
    v_mfma_f32_16x16x32_bf16 v[248:251], a[112:115], a[92:95], v[248:251]
    buffer_load_dwordx4 a[24:27], v36, s[52:55], s75 offen sc1
    v_mfma_f32_16x16x32_bf16 a[220:223], a[116:119], a[92:95], a[220:223]
    v_add_u32 v24, s14, v24
    v_add_u32 v25, s14, v25
    v_mfma_f32_16x16x32_bf16 a[216:219], a[116:119], a[88:91], a[216:219]
    v_add_u32 v26, s14, v26
    v_add_u32 v27, s14, v27
    v_mfma_f32_16x16x32_bf16 a[212:215], a[116:119], a[84:87], a[212:215]
    buffer_load_dwordx4 a[28:31], v37, s[52:55], s75 offen sc1
    v_mfma_f32_16x16x32_bf16 a[208:211], a[116:119], a[80:83], a[208:211]
    v_xor_b32_e64 v32, 0, v34
    v_lshl_add_u32 v16, v32, 5, v31
    v_mfma_f32_16x16x32_bf16 a[204:207], a[116:119], a[76:79], a[204:207]
    v_xor_b32_e64 v32, 1, v34
    v_lshl_add_u32 v17, v32, 5, v31
    v_mfma_f32_16x16x32_bf16 a[200:203], a[116:119], a[72:75], a[200:203]
    v_xor_b32_e64 v32, 2, v34
    v_lshl_add_u32 v18, v32, 5, v31
    v_mfma_f32_16x16x32_bf16 a[196:199], a[116:119], a[68:71], a[196:199]
    v_xor_b32_e64 v32, 3, v34
    v_lshl_add_u32 v19, v32, 5, v31
    v_mfma_f32_16x16x32_bf16 a[192:195], a[116:119], a[64:67], a[192:195]
    v_mfma_f32_16x16x32_bf16 v[140:143], a[120:123], a[64:67], v[140:143]
    v_mfma_f32_16x16x32_bf16 v[156:159], a[120:123], a[68:71], v[156:159]
    v_mfma_f32_16x16x32_bf16 v[172:175], a[120:123], a[72:75], v[172:175]
    v_mfma_f32_16x16x32_bf16 v[188:191], a[120:123], a[76:79], v[188:191]
    v_mfma_f32_16x16x32_bf16 v[204:207], a[120:123], a[80:83], v[204:207]
    v_mfma_f32_16x16x32_bf16 v[220:223], a[120:123], a[84:87], v[220:223]
    v_mfma_f32_16x16x32_bf16 v[236:239], a[120:123], a[88:91], v[236:239]
    v_mfma_f32_16x16x32_bf16 v[252:255], a[120:123], a[92:95], v[252:255]
    v_mfma_f32_16x16x32_bf16 a[252:255], a[124:127], a[92:95], a[252:255]
    v_mfma_f32_16x16x32_bf16 a[248:251], a[124:127], a[88:91], a[248:251]
    v_mfma_f32_16x16x32_bf16 a[244:247], a[124:127], a[84:87], a[244:247]
    v_mfma_f32_16x16x32_bf16 a[240:243], a[124:127], a[80:83], a[240:243]
    v_mfma_f32_16x16x32_bf16 a[236:239], a[124:127], a[76:79], a[236:239]
    v_mfma_f32_16x16x32_bf16 a[232:235], a[124:127], a[72:75], a[232:235]
    v_mfma_f32_16x16x32_bf16 a[228:231], a[124:127], a[68:71], a[228:231]
    s_nop 0
    s_waitcnt lgkmcnt(0)
    v_mfma_f32_16x16x32_bf16 a[224:227], a[124:127], a[64:67], a[224:227]
    v_mfma_f32_16x16x32_bf16 v[128:131], a[160:163], a[128:131], v[128:131]
    s_waitcnt vmcnt(29)
    s_barrier
    v_mfma_f32_16x16x32_bf16 v[144:147], a[160:163], a[132:135], v[144:147]
    ds_read_b64_tr_b16 a[64:65], v20 offset:0
    v_mfma_f32_16x16x32_bf16 v[160:163], a[160:163], a[136:139], v[160:163]
    s_add_u32 m0, s71, 49152
    s_mov_b32 s72, 2097152
    ds_read_b64_tr_b16 a[66:67], v20 offset:1024
    v_mfma_f32_16x16x32_bf16 v[176:179], a[160:163], a[140:143], v[176:179]
    buffer_load_dwordx4 v28, s[44:47], s72 offen lds
    v_mfma_f32_16x16x32_bf16 v[192:195], a[160:163], a[144:147], v[192:195]
    ds_read_b64_tr_b16 a[68:69], v21 offset:0
    v_mfma_f32_16x16x32_bf16 v[208:211], a[160:163], a[148:151], v[208:211]
    ds_read_b64_tr_b16 a[70:71], v21 offset:1024
    v_mfma_f32_16x16x32_bf16 v[224:227], a[160:163], a[152:155], v[224:227]
    buffer_load_dwordx4 v29, s[44:47], s72 offen offset:1024 lds
    v_mfma_f32_16x16x32_bf16 v[240:243], a[160:163], a[156:159], v[240:243]
    ds_read_b64_tr_b16 a[72:73], v22 offset:0
    v_mfma_f32_16x16x32_bf16 v[92:95], a[164:167], a[156:159], v[92:95]
    s_add_u32 m0, s73, 57344
    s_mov_b32 s72, 704512
    ds_read_b64_tr_b16 a[74:75], v22 offset:1024
    v_mfma_f32_16x16x32_bf16 v[88:91], a[164:167], a[152:155], v[88:91]
    buffer_load_dwordx4 v30, s[60:63], s72 offen lds
    v_mfma_f32_16x16x32_bf16 v[84:87], a[164:167], a[148:151], v[84:87]
    ds_read_b64_tr_b16 a[76:77], v23 offset:0
    v_mfma_f32_16x16x32_bf16 v[80:83], a[164:167], a[144:147], v[80:83]
    s_add_u32 m0, s71, 90112
    s_mov_b32 s72, 2359296
    ds_read_b64_tr_b16 a[78:79], v23 offset:1024
    v_mfma_f32_16x16x32_bf16 v[76:79], a[164:167], a[140:143], v[76:79]
    buffer_load_dwordx4 v28, s[44:47], s72 offen lds
    v_mfma_f32_16x16x32_bf16 v[72:75], a[164:167], a[136:139], v[72:75]
    ds_read_b64_tr_b16 a[80:81], v24 offset:0
    v_mfma_f32_16x16x32_bf16 v[68:71], a[164:167], a[132:135], v[68:71]
    ds_read_b64_tr_b16 a[82:83], v24 offset:1024
    v_mfma_f32_16x16x32_bf16 v[64:67], a[164:167], a[128:131], v[64:67]
    buffer_load_dwordx4 v29, s[44:47], s72 offen offset:1024 lds
    v_mfma_f32_16x16x32_bf16 v[132:135], a[168:171], a[128:131], v[132:135]
    ds_read_b64_tr_b16 a[84:85], v25 offset:0
    v_mfma_f32_16x16x32_bf16 v[148:151], a[168:171], a[132:135], v[148:151]
    s_add_u32 m0, s73, 98304
    s_mov_b32 s72, 792576
    ds_read_b64_tr_b16 a[86:87], v25 offset:1024
    v_mfma_f32_16x16x32_bf16 v[164:167], a[168:171], a[136:139], v[164:167]
    buffer_load_dwordx4 v30, s[60:63], s72 offen lds
    v_mfma_f32_16x16x32_bf16 v[180:183], a[168:171], a[140:143], v[180:183]
    ds_read_b64_tr_b16 a[88:89], v26 offset:0
    v_cvt_pk_bf16_f32 v128, v128, v129
    v_mfma_f32_16x16x32_bf16 v[196:199], a[168:171], a[144:147], v[196:199]
    s_add_u32 s75, s66, 8192
    ds_read_b64_tr_b16 a[90:91], v26 offset:1024
    v_cvt_pk_bf16_f32 v129, v130, v131
    v_mfma_f32_16x16x32_bf16 v[212:215], a[168:171], a[148:151], v[212:215]
    buffer_load_dwordx4 a[32:35], v36, s[52:55], s75 offen sc1
    v_mfma_f32_16x16x32_bf16 v[228:231], a[168:171], a[152:155], v[228:231]
    ds_read_b64_tr_b16 a[92:93], v27 offset:0
    v_cvt_pk_bf16_f32 v130, v64, v65
    v_mfma_f32_16x16x32_bf16 v[244:247], a[168:171], a[156:159], v[244:247]
    ds_read_b64_tr_b16 a[94:95], v27 offset:1024
    v_cvt_pk_bf16_f32 v131, v66, v67
    v_mfma_f32_16x16x32_bf16 v[124:127], a[172:175], a[156:159], v[124:127]
    buffer_load_dwordx4 a[36:39], v37, s[52:55], s75 offen sc1
    v_mfma_f32_16x16x32_bf16 v[120:123], a[172:175], a[152:155], v[120:123]
    ds_read_b64_tr_b16 a[96:97], v16 offset:0
    v_cvt_pk_bf16_f32 v144, v144, v145
    v_mfma_f32_16x16x32_bf16 v[116:119], a[172:175], a[148:151], v[116:119]
    s_add_u32 s75, s67, 8192
    ds_read_b64_tr_b16 a[98:99], v16 offset:512
    v_cvt_pk_bf16_f32 v145, v146, v147
    v_mfma_f32_16x16x32_bf16 v[112:115], a[172:175], a[144:147], v[112:115]
    buffer_load_dwordx4 a[40:43], v36, s[52:55], s75 offen sc1
    v_mfma_f32_16x16x32_bf16 v[108:111], a[172:175], a[140:143], v[108:111]
    ds_read_b64_tr_b16 a[100:101], v17 offset:0
    v_cvt_pk_bf16_f32 v146, v68, v69
    v_mfma_f32_16x16x32_bf16 v[104:107], a[172:175], a[136:139], v[104:107]
    ds_read_b64_tr_b16 a[102:103], v17 offset:512
    v_cvt_pk_bf16_f32 v147, v70, v71
    v_mfma_f32_16x16x32_bf16 v[100:103], a[172:175], a[132:135], v[100:103]
    buffer_load_dwordx4 a[44:47], v37, s[52:55], s75 offen sc1
    v_mfma_f32_16x16x32_bf16 v[96:99], a[172:175], a[128:131], v[96:99]
    ds_read_b64_tr_b16 a[104:105], v18 offset:0
    v_cvt_pk_bf16_f32 v160, v160, v161
    v_mfma_f32_16x16x32_bf16 v[136:139], a[176:179], a[128:131], v[136:139]
    s_add_u32 s75, s66, 12288
    ds_read_b64_tr_b16 a[106:107], v18 offset:512
    v_cvt_pk_bf16_f32 v161, v162, v163
    v_mfma_f32_16x16x32_bf16 v[152:155], a[176:179], a[132:135], v[152:155]
    buffer_load_dwordx4 a[48:51], v36, s[52:55], s75 offen sc1
    v_mfma_f32_16x16x32_bf16 v[168:171], a[176:179], a[136:139], v[168:171]
    ds_read_b64_tr_b16 a[108:109], v19 offset:0
    v_cvt_pk_bf16_f32 v162, v72, v73
    v_mfma_f32_16x16x32_bf16 v[184:187], a[176:179], a[140:143], v[184:187]
    ds_read_b64_tr_b16 a[110:111], v19 offset:512
    v_cvt_pk_bf16_f32 v163, v74, v75
    v_mfma_f32_16x16x32_bf16 v[200:203], a[176:179], a[144:147], v[200:203]
    buffer_load_dwordx4 a[52:55], v37, s[52:55], s75 offen sc1
    v_mfma_f32_16x16x32_bf16 v[216:219], a[176:179], a[148:151], v[216:219]
    v_cvt_pk_bf16_f32 v176, v176, v177
    v_cvt_pk_bf16_f32 v177, v178, v179
    v_mfma_f32_16x16x32_bf16 v[232:235], a[176:179], a[152:155], v[232:235]
    s_add_u32 s75, s67, 12288
    v_cvt_pk_bf16_f32 v178, v76, v77
    v_cvt_pk_bf16_f32 v179, v78, v79
    v_mfma_f32_16x16x32_bf16 v[248:251], a[176:179], a[156:159], v[248:251]
    buffer_load_dwordx4 a[56:59], v36, s[52:55], s75 offen sc1
    v_mfma_f32_16x16x32_bf16 a[220:223], a[180:183], a[156:159], a[220:223]
    v_cvt_pk_bf16_f32 v192, v192, v193
    v_cvt_pk_bf16_f32 v193, v194, v195
    v_mfma_f32_16x16x32_bf16 a[216:219], a[180:183], a[152:155], a[216:219]
    v_cvt_pk_bf16_f32 v194, v80, v81
    v_cvt_pk_bf16_f32 v195, v82, v83
    v_mfma_f32_16x16x32_bf16 a[212:215], a[180:183], a[148:151], a[212:215]
    buffer_load_dwordx4 a[60:63], v37, s[52:55], s75 offen sc1
    v_mfma_f32_16x16x32_bf16 a[208:211], a[180:183], a[144:147], a[208:211]
    v_cvt_pk_bf16_f32 v208, v208, v209
    v_cvt_pk_bf16_f32 v209, v210, v211
    v_mfma_f32_16x16x32_bf16 a[204:207], a[180:183], a[140:143], a[204:207]
    v_cvt_pk_bf16_f32 v210, v84, v85
    v_cvt_pk_bf16_f32 v211, v86, v87
    v_mfma_f32_16x16x32_bf16 a[200:203], a[180:183], a[136:139], a[200:203]
    v_cvt_pk_bf16_f32 v224, v224, v225
    v_cvt_pk_bf16_f32 v225, v226, v227
    v_mfma_f32_16x16x32_bf16 a[196:199], a[180:183], a[132:135], a[196:199]
    v_cvt_pk_bf16_f32 v226, v88, v89
    v_cvt_pk_bf16_f32 v227, v90, v91
    v_mfma_f32_16x16x32_bf16 a[192:195], a[180:183], a[128:131], a[192:195]
    v_cvt_pk_bf16_f32 v240, v240, v241
    v_cvt_pk_bf16_f32 v241, v242, v243
    v_mfma_f32_16x16x32_bf16 v[140:143], a[184:187], a[128:131], v[140:143]
    v_cvt_pk_bf16_f32 v242, v92, v93
    v_cvt_pk_bf16_f32 v243, v94, v95
    v_mfma_f32_16x16x32_bf16 v[156:159], a[184:187], a[132:135], v[156:159]
    v_cvt_pk_bf16_f32 v132, v132, v133
    v_cvt_pk_bf16_f32 v133, v134, v135
    v_mfma_f32_16x16x32_bf16 v[172:175], a[184:187], a[136:139], v[172:175]
    v_cvt_pk_bf16_f32 v134, v96, v97
    v_cvt_pk_bf16_f32 v135, v98, v99
    v_mfma_f32_16x16x32_bf16 v[188:191], a[184:187], a[140:143], v[188:191]
    v_cvt_pk_bf16_f32 v148, v148, v149
    v_cvt_pk_bf16_f32 v149, v150, v151
    v_mfma_f32_16x16x32_bf16 v[204:207], a[184:187], a[144:147], v[204:207]
    v_cvt_pk_bf16_f32 v150, v100, v101
    v_cvt_pk_bf16_f32 v151, v102, v103
    v_mfma_f32_16x16x32_bf16 v[220:223], a[184:187], a[148:151], v[220:223]
    v_cvt_pk_bf16_f32 v164, v164, v165
    v_cvt_pk_bf16_f32 v165, v166, v167
    v_mfma_f32_16x16x32_bf16 v[236:239], a[184:187], a[152:155], v[236:239]
    v_cvt_pk_bf16_f32 v166, v104, v105
    v_cvt_pk_bf16_f32 v167, v106, v107
    v_mfma_f32_16x16x32_bf16 v[252:255], a[184:187], a[156:159], v[252:255]
    v_cvt_pk_bf16_f32 v180, v180, v181
    v_cvt_pk_bf16_f32 v181, v182, v183
    v_mfma_f32_16x16x32_bf16 a[252:255], a[188:191], a[156:159], a[252:255]
    v_cvt_pk_bf16_f32 v182, v108, v109
    v_cvt_pk_bf16_f32 v183, v110, v111
    v_mfma_f32_16x16x32_bf16 a[248:251], a[188:191], a[152:155], a[248:251]
    v_cvt_pk_bf16_f32 v196, v196, v197
    v_cvt_pk_bf16_f32 v197, v198, v199
    v_mfma_f32_16x16x32_bf16 a[244:247], a[188:191], a[148:151], a[244:247]
    v_cvt_pk_bf16_f32 v198, v112, v113
    v_cvt_pk_bf16_f32 v199, v114, v115
    v_mfma_f32_16x16x32_bf16 a[240:243], a[188:191], a[144:147], a[240:243]
    v_cvt_pk_bf16_f32 v212, v212, v213
    v_cvt_pk_bf16_f32 v213, v214, v215
    v_mfma_f32_16x16x32_bf16 a[236:239], a[188:191], a[140:143], a[236:239]
    v_cvt_pk_bf16_f32 v214, v116, v117
    v_cvt_pk_bf16_f32 v215, v118, v119
    v_mfma_f32_16x16x32_bf16 a[232:235], a[188:191], a[136:139], a[232:235]
    v_cvt_pk_bf16_f32 v228, v228, v229
    v_cvt_pk_bf16_f32 v229, v230, v231
    v_mfma_f32_16x16x32_bf16 a[228:231], a[188:191], a[132:135], a[228:231]
    v_cvt_pk_bf16_f32 v230, v120, v121
    v_cvt_pk_bf16_f32 v231, v122, v123
    v_mfma_f32_16x16x32_bf16 a[224:227], a[188:191], a[128:131], a[224:227]
    v_cvt_pk_bf16_f32 v244, v244, v245
    v_cvt_pk_bf16_f32 v245, v246, v247
    v_cvt_pk_bf16_f32 v246, v124, v125
    v_cvt_pk_bf16_f32 v247, v126, v127
    v_accvgpr_read_b32 v40, a192
    v_accvgpr_read_b32 v41, a193
    v_accvgpr_read_b32 v42, a194
    v_accvgpr_read_b32 v43, a195
    v_cvt_pk_bf16_f32 v136, v136, v137
    v_cvt_pk_bf16_f32 v137, v138, v139
    v_cvt_pk_bf16_f32 v138, v40, v41
    v_cvt_pk_bf16_f32 v139, v42, v43
    v_accvgpr_read_b32 v44, a196
    v_accvgpr_read_b32 v45, a197
    v_accvgpr_read_b32 v46, a198
    v_accvgpr_read_b32 v47, a199
    v_cvt_pk_bf16_f32 v152, v152, v153
    v_cvt_pk_bf16_f32 v153, v154, v155
    v_cvt_pk_bf16_f32 v154, v44, v45
    v_cvt_pk_bf16_f32 v155, v46, v47
    v_accvgpr_read_b32 v40, a200
    v_accvgpr_read_b32 v41, a201
    v_accvgpr_read_b32 v42, a202
    v_accvgpr_read_b32 v43, a203
    v_cvt_pk_bf16_f32 v168, v168, v169
    v_cvt_pk_bf16_f32 v169, v170, v171
    v_cvt_pk_bf16_f32 v170, v40, v41
    v_cvt_pk_bf16_f32 v171, v42, v43
    v_accvgpr_read_b32 v44, a204
    v_accvgpr_read_b32 v45, a205
    v_accvgpr_read_b32 v46, a206
    v_accvgpr_read_b32 v47, a207
    v_cvt_pk_bf16_f32 v184, v184, v185
    v_cvt_pk_bf16_f32 v185, v186, v187
    v_cvt_pk_bf16_f32 v186, v44, v45
    v_cvt_pk_bf16_f32 v187, v46, v47
    v_accvgpr_read_b32 v40, a208
    v_accvgpr_read_b32 v41, a209
    v_accvgpr_read_b32 v42, a210
    v_accvgpr_read_b32 v43, a211
    v_cvt_pk_bf16_f32 v200, v200, v201
    v_cvt_pk_bf16_f32 v201, v202, v203
    v_cvt_pk_bf16_f32 v202, v40, v41
    v_cvt_pk_bf16_f32 v203, v42, v43
    v_accvgpr_read_b32 v44, a212
    v_accvgpr_read_b32 v45, a213
    v_accvgpr_read_b32 v46, a214
    v_accvgpr_read_b32 v47, a215
    v_cvt_pk_bf16_f32 v216, v216, v217
    v_cvt_pk_bf16_f32 v217, v218, v219
    v_cvt_pk_bf16_f32 v218, v44, v45
    v_cvt_pk_bf16_f32 v219, v46, v47
    v_accvgpr_read_b32 v40, a216
    v_accvgpr_read_b32 v41, a217
    v_accvgpr_read_b32 v42, a218
    v_accvgpr_read_b32 v43, a219
    v_cvt_pk_bf16_f32 v232, v232, v233
    v_cvt_pk_bf16_f32 v233, v234, v235
    v_cvt_pk_bf16_f32 v234, v40, v41
    v_cvt_pk_bf16_f32 v235, v42, v43
    v_accvgpr_read_b32 v44, a220
    v_accvgpr_read_b32 v45, a221
    v_accvgpr_read_b32 v46, a222
    v_accvgpr_read_b32 v47, a223
    v_cvt_pk_bf16_f32 v248, v248, v249
    v_cvt_pk_bf16_f32 v249, v250, v251
    v_cvt_pk_bf16_f32 v250, v44, v45
    v_cvt_pk_bf16_f32 v251, v46, v47
    v_accvgpr_read_b32 v40, a224
    v_accvgpr_read_b32 v41, a225
    v_accvgpr_read_b32 v42, a226
    v_accvgpr_read_b32 v43, a227
    v_cvt_pk_bf16_f32 v140, v140, v141
    v_cvt_pk_bf16_f32 v141, v142, v143
    v_cvt_pk_bf16_f32 v142, v40, v41
    v_cvt_pk_bf16_f32 v143, v42, v43
    v_accvgpr_read_b32 v44, a228
    v_accvgpr_read_b32 v45, a229
    v_accvgpr_read_b32 v46, a230
    v_accvgpr_read_b32 v47, a231
    v_cvt_pk_bf16_f32 v156, v156, v157
    v_cvt_pk_bf16_f32 v157, v158, v159
    v_cvt_pk_bf16_f32 v158, v44, v45
    v_cvt_pk_bf16_f32 v159, v46, v47
    v_accvgpr_read_b32 v40, a232
    v_accvgpr_read_b32 v41, a233
    v_accvgpr_read_b32 v42, a234
    v_accvgpr_read_b32 v43, a235
    v_cvt_pk_bf16_f32 v172, v172, v173
    v_cvt_pk_bf16_f32 v173, v174, v175
    v_cvt_pk_bf16_f32 v174, v40, v41
    v_cvt_pk_bf16_f32 v175, v42, v43
    v_accvgpr_read_b32 v44, a236
    v_accvgpr_read_b32 v45, a237
    v_accvgpr_read_b32 v46, a238
    v_accvgpr_read_b32 v47, a239
    v_cvt_pk_bf16_f32 v188, v188, v189
    v_cvt_pk_bf16_f32 v189, v190, v191
    v_cvt_pk_bf16_f32 v190, v44, v45
    v_cvt_pk_bf16_f32 v191, v46, v47
    v_accvgpr_read_b32 v40, a240
    v_accvgpr_read_b32 v41, a241
    v_accvgpr_read_b32 v42, a242
    v_accvgpr_read_b32 v43, a243
    v_cvt_pk_bf16_f32 v204, v204, v205
    v_cvt_pk_bf16_f32 v205, v206, v207
    v_cvt_pk_bf16_f32 v206, v40, v41
    v_cvt_pk_bf16_f32 v207, v42, v43
    v_accvgpr_read_b32 v44, a244
    v_accvgpr_read_b32 v45, a245
    v_accvgpr_read_b32 v46, a246
    v_accvgpr_read_b32 v47, a247
    v_cvt_pk_bf16_f32 v220, v220, v221
    v_cvt_pk_bf16_f32 v221, v222, v223
    v_cvt_pk_bf16_f32 v222, v44, v45
    v_cvt_pk_bf16_f32 v223, v46, v47
    v_accvgpr_read_b32 v40, a248
    v_accvgpr_read_b32 v41, a249
    v_accvgpr_read_b32 v42, a250
    v_accvgpr_read_b32 v43, a251
    v_cvt_pk_bf16_f32 v236, v236, v237
    v_cvt_pk_bf16_f32 v237, v238, v239
    v_cvt_pk_bf16_f32 v238, v40, v41
    v_cvt_pk_bf16_f32 v239, v42, v43
    v_accvgpr_read_b32 v44, a252
    v_accvgpr_read_b32 v45, a253
    v_accvgpr_read_b32 v46, a254
    v_accvgpr_read_b32 v47, a255
    v_cvt_pk_bf16_f32 v252, v252, v253
    v_cvt_pk_bf16_f32 v253, v254, v255
    v_cvt_pk_bf16_f32 v254, v44, v45
    v_cvt_pk_bf16_f32 v255, v46, v47
    s_branch L_p1_done
L_p1_1:
    ds_read_b64_tr_b16 a[96:97], v20 offset:0
    ds_read_b64_tr_b16 a[98:99], v20 offset:1024
    ds_read_b64_tr_b16 a[100:101], v21 offset:0
    ds_read_b64_tr_b16 a[102:103], v21 offset:1024
    ds_read_b64_tr_b16 a[104:105], v22 offset:0
    ds_read_b64_tr_b16 a[106:107], v22 offset:1024
    ds_read_b64_tr_b16 a[108:109], v23 offset:0
    ds_read_b64_tr_b16 a[110:111], v23 offset:1024
    ds_read_b64_tr_b16 a[112:113], v24 offset:0
    ds_read_b64_tr_b16 a[114:115], v24 offset:1024
    ds_read_b64_tr_b16 a[116:117], v25 offset:0
    ds_read_b64_tr_b16 a[118:119], v25 offset:1024
    ds_read_b64_tr_b16 a[120:121], v26 offset:0
    ds_read_b64_tr_b16 a[122:123], v26 offset:1024
    ds_read_b64_tr_b16 a[124:125], v27 offset:0
    ds_read_b64_tr_b16 a[126:127], v27 offset:1024
    ds_read_b128 a[64:67], v18 offset:0
    ds_read_b128 a[68:71], v18 offset:2048
    ds_read_b128 a[72:75], v18 offset:4096
    ds_read_b128 a[76:79], v18 offset:6144
    ds_read_b128 a[80:83], v18 offset:8192
    ds_read_b128 a[84:87], v18 offset:10240
    ds_read_b128 a[88:91], v18 offset:12288
    ds_read_b128 a[92:95], v18 offset:14336
    s_waitcnt lgkmcnt(0)
    v_mfma_f32_16x16x32_bf16 v[128:131], a[64:67], a[96:99], 0
    s_waitcnt vmcnt(21)
    s_barrier
    v_mfma_f32_16x16x32_bf16 v[132:135], a[64:67], a[100:103], 0
    ds_read_b64_tr_b16 a[160:161], v20 offset:16384
    s_cmp_eq_u32 s2, 0
    s_cbranch_scc1 L_zpub_1
L_zpub_1_ret:
    v_mfma_f32_16x16x32_bf16 v[136:139], a[64:67], a[104:107], 0
    ds_read_b64_tr_b16 a[162:163], v20 offset:17408
    v_mfma_f32_16x16x32_bf16 v[140:143], a[64:67], a[108:111], 0
    buffer_load_dword v36, v37, s[44:47], s91 offen
    v_mfma_f32_16x16x32_bf16 v[144:147], a[64:67], a[112:115], 0
    ds_read_b128 a[128:131], v19 offset:0
    v_mfma_f32_16x16x32_bf16 v[148:151], a[64:67], a[116:119], 0
    ds_read_b64_tr_b16 a[164:165], v21 offset:16384
    v_mfma_f32_16x16x32_bf16 v[152:155], a[64:67], a[120:123], 0
    ds_read_b64_tr_b16 a[166:167], v21 offset:17408
    v_mfma_f32_16x16x32_bf16 v[156:159], a[64:67], a[124:127], 0
    ds_read_b128 a[132:135], v19 offset:2048
    v_mfma_f32_16x16x32_bf16 v[92:95], a[68:71], a[124:127], 0
    s_nop 0
    s_add_u32 m0, s64, 0
    s_mov_b32 s66, 1048576
    ds_read_b64_tr_b16 a[168:169], v22 offset:16384
    v_mfma_f32_16x16x32_bf16 v[88:91], a[68:71], a[120:123], 0
    buffer_load_dwordx4 v12, s[48:51], s66 offen offset:0 lds
    v_mfma_f32_16x16x32_bf16 v[84:87], a[68:71], a[116:119], 0
    ds_read_b64_tr_b16 a[170:171], v22 offset:17408
    v_mfma_f32_16x16x32_bf16 v[80:83], a[68:71], a[112:115], 0
    ds_read_b128 a[136:139], v19 offset:4096
    v_mfma_f32_16x16x32_bf16 v[76:79], a[68:71], a[108:111], 0
    ds_read_b64_tr_b16 a[172:173], v23 offset:16384
    v_mfma_f32_16x16x32_bf16 v[72:75], a[68:71], a[104:107], 0
    ds_read_b64_tr_b16 a[174:175], v23 offset:17408
    v_mfma_f32_16x16x32_bf16 v[68:71], a[68:71], a[100:103], 0
    ds_read_b128 a[140:143], v19 offset:6144
    v_mfma_f32_16x16x32_bf16 v[64:67], a[68:71], a[96:99], 0
    buffer_load_dwordx4 v13, s[48:51], s66 offen offset:1024 lds
    v_mfma_f32_16x16x32_bf16 v[160:163], a[72:75], a[96:99], 0
    ds_read_b64_tr_b16 a[176:177], v24 offset:16384
    v_mfma_f32_16x16x32_bf16 v[164:167], a[72:75], a[100:103], 0
    ds_read_b64_tr_b16 a[178:179], v24 offset:17408
    v_mfma_f32_16x16x32_bf16 v[168:171], a[72:75], a[104:107], 0
    ds_read_b128 a[144:147], v19 offset:8192
    v_mfma_f32_16x16x32_bf16 v[172:175], a[72:75], a[108:111], 0
    ds_read_b64_tr_b16 a[180:181], v25 offset:16384
    v_mfma_f32_16x16x32_bf16 v[176:179], a[72:75], a[112:115], 0
    ds_read_b64_tr_b16 a[182:183], v25 offset:17408
    v_mfma_f32_16x16x32_bf16 v[180:183], a[72:75], a[116:119], 0
    buffer_load_dwordx4 v14, s[48:51], s66 offen offset:2048 lds
    v_mfma_f32_16x16x32_bf16 v[184:187], a[72:75], a[120:123], 0
    ds_read_b128 a[148:151], v19 offset:10240
    v_mfma_f32_16x16x32_bf16 v[188:191], a[72:75], a[124:127], 0
    ds_read_b64_tr_b16 a[184:185], v26 offset:16384
    v_mfma_f32_16x16x32_bf16 v[124:127], a[76:79], a[124:127], 0
    ds_read_b64_tr_b16 a[186:187], v26 offset:17408
    v_mfma_f32_16x16x32_bf16 v[120:123], a[76:79], a[120:123], 0
    ds_read_b128 a[152:155], v19 offset:12288
    v_mfma_f32_16x16x32_bf16 v[116:119], a[76:79], a[116:119], 0
    ds_read_b64_tr_b16 a[188:189], v27 offset:16384
    v_mfma_f32_16x16x32_bf16 v[112:115], a[76:79], a[112:115], 0
    buffer_load_dwordx4 v15, s[48:51], s66 offen offset:3072 lds
    v_mfma_f32_16x16x32_bf16 v[108:111], a[76:79], a[108:111], 0
    ds_read_b64_tr_b16 a[190:191], v27 offset:17408
    v_mfma_f32_16x16x32_bf16 v[104:107], a[76:79], a[104:107], 0
    ds_read_b128 a[156:159], v19 offset:14336
    v_mfma_f32_16x16x32_bf16 v[100:103], a[76:79], a[100:103], 0
    v_add_u32 v18, 98304, v16
    v_add_u32 v19, 98304, v17
    v_mfma_f32_16x16x32_bf16 v[96:99], a[76:79], a[96:99], 0
    v_lshlrev_b32_e64 v28, 16, v40
    v_and_b32 v29, 0xffff0000, v40
    v_mfma_f32_16x16x32_bf16 v[192:195], a[80:83], a[96:99], 0
    s_add_u32 m0, s65, 135168
    s_mov_b32 s67, 256
    v_lshlrev_b32_e64 v32, 16, v41
    v_and_b32 v33, 0xffff0000, v41
    v_mfma_f32_16x16x32_bf16 v[196:199], a[80:83], a[100:103], 0
    buffer_load_dwordx4 v8, s[44:47], s67 offen offset:0 lds
    v_mfma_f32_16x16x32_bf16 v[200:203], a[80:83], a[104:107], 0
    v_add_f32 v28, v28, v32
    v_add_f32 v29, v29, v33
    v_mfma_f32_16x16x32_bf16 v[204:207], a[80:83], a[108:111], 0
    v_lshlrev_b32_e64 v32, 16, v42
    v_and_b32 v33, 0xffff0000, v42
    v_mfma_f32_16x16x32_bf16 v[208:211], a[80:83], a[112:115], 0
    v_add_f32 v28, v28, v32
    v_add_f32 v29, v29, v33
    v_mfma_f32_16x16x32_bf16 v[212:215], a[80:83], a[116:119], 0
    v_lshlrev_b32_e64 v32, 16, v43
    v_and_b32 v33, 0xffff0000, v43
    v_mfma_f32_16x16x32_bf16 v[216:219], a[80:83], a[120:123], 0
    v_add_f32 v28, v28, v32
    v_add_f32 v29, v29, v33
    v_mfma_f32_16x16x32_bf16 v[220:223], a[80:83], a[124:127], 0
    buffer_load_dwordx4 v9, s[44:47], s67 offen offset:1024 lds
    v_mfma_f32_16x16x32_bf16 a[220:223], a[84:87], a[124:127], 0
    v_lshlrev_b32_e64 v32, 16, v44
    v_and_b32 v33, 0xffff0000, v44
    v_mfma_f32_16x16x32_bf16 a[216:219], a[84:87], a[120:123], 0
    v_add_f32 v28, v28, v32
    v_add_f32 v29, v29, v33
    v_mfma_f32_16x16x32_bf16 a[212:215], a[84:87], a[116:119], 0
    v_lshlrev_b32_e64 v32, 16, v45
    v_and_b32 v33, 0xffff0000, v45
    v_mfma_f32_16x16x32_bf16 a[208:211], a[84:87], a[112:115], 0
    v_add_f32 v28, v28, v32
    v_add_f32 v29, v29, v33
    v_mfma_f32_16x16x32_bf16 a[204:207], a[84:87], a[108:111], 0
    v_lshlrev_b32_e64 v32, 16, v46
    v_and_b32 v33, 0xffff0000, v46
    v_mfma_f32_16x16x32_bf16 a[200:203], a[84:87], a[104:107], 0
    buffer_load_dwordx4 v10, s[44:47], s67 offen offset:2048 lds
    v_mfma_f32_16x16x32_bf16 a[196:199], a[84:87], a[100:103], 0
    v_add_f32 v28, v28, v32
    v_add_f32 v29, v29, v33
    v_mfma_f32_16x16x32_bf16 a[192:195], a[84:87], a[96:99], 0
    v_lshlrev_b32_e64 v32, 16, v47
    v_and_b32 v33, 0xffff0000, v47
    v_mfma_f32_16x16x32_bf16 v[224:227], a[88:91], a[96:99], 0
    v_add_f32 v28, v28, v32
    v_add_f32 v29, v29, v33
    v_mfma_f32_16x16x32_bf16 v[228:231], a[88:91], a[100:103], 0
    v_lshlrev_b32_e64 v32, 16, v48
    v_and_b32 v33, 0xffff0000, v48
    v_mfma_f32_16x16x32_bf16 v[232:235], a[88:91], a[104:107], 0
    s_lshl_b32 s70, s6, 1
    s_add_u32 s70, s70, s7
    s_lshl_b32 s11, s70, 18
    v_add_f32 v28, v28, v32
    v_add_f32_e64 v29, v29, v33
    v_mfma_f32_16x16x32_bf16 v[236:239], a[88:91], a[108:111], 0
    s_lshl_b32 s10, s5, 8
    s_add_u32 s11, s11, s10
    s_add_u32 s14, s14, 256
    buffer_load_dwordx4 v11, s[44:47], s67 offen offset:3072 lds
    v_mfma_f32_16x16x32_bf16 v[240:243], a[88:91], a[112:115], 0
    s_cmp_lt_u32 s4, 2
    s_cselect_b32 s14, s11, s14
    s_cselect_b32 s60, s20, s60
    v_lshlrev_b32 v32, 16, v49
    v_and_b32 v33, 0xffff0000, v49
    v_mfma_f32_16x16x32_bf16 v[244:247], a[88:91], a[116:119], 0
    s_cselect_b32 s61, s21, s61
    s_cselect_b32 s15, s11, 1073741824
    v_add_f32 v28, v28, v32
    v_add_f32 v29, v29, v33
    v_mfma_f32_16x16x32_bf16 v[248:251], a[88:91], a[120:123], 0
    v_lshlrev_b32_e64 v32, 16, v50
    v_and_b32 v33, 0xffff0000, v50
    v_mfma_f32_16x16x32_bf16 v[252:255], a[88:91], a[124:127], 0
    v_add_f32 v28, v28, v32
    v_add_f32 v29, v29, v33
    v_mfma_f32_16x16x32_bf16 a[252:255], a[92:95], a[124:127], 0
    v_lshlrev_b32_e64 v32, 16, v51
    v_and_b32 v33, 0xffff0000, v51
    v_mfma_f32_16x16x32_bf16 a[248:251], a[92:95], a[120:123], 0
    v_add_f32 v28, v28, v32
    v_add_f32 v29, v29, v33
    v_mfma_f32_16x16x32_bf16 a[244:247], a[92:95], a[116:119], 0
    v_lshlrev_b32_e64 v32, 16, v52
    v_and_b32 v33, 0xffff0000, v52
    v_mfma_f32_16x16x32_bf16 a[240:243], a[92:95], a[112:115], 0
    v_add_f32 v28, v28, v32
    v_add_f32 v29, v29, v33
    v_mfma_f32_16x16x32_bf16 a[236:239], a[92:95], a[108:111], 0
    v_lshlrev_b32_e64 v32, 16, v53
    v_and_b32 v33, 0xffff0000, v53
    v_mfma_f32_16x16x32_bf16 a[232:235], a[92:95], a[104:107], 0
    v_add_f32 v28, v28, v32
    v_add_f32 v29, v29, v33
    v_mfma_f32_16x16x32_bf16 a[228:231], a[92:95], a[100:103], 0
    s_waitcnt lgkmcnt(0)
    v_lshlrev_b32 v32, 16, v54
    v_and_b32 v33, 0xffff0000, v54
    v_mfma_f32_16x16x32_bf16 a[224:227], a[92:95], a[96:99], 0
    v_add_f32 v28, v28, v32
    v_add_f32 v29, v29, v33
    v_mfma_f32_16x16x32_bf16 v[128:131], a[128:131], a[160:163], v[128:131]
    s_waitcnt vmcnt(17)
    s_barrier
    v_mfma_f32_16x16x32_bf16 v[132:135], a[128:131], a[164:167], v[132:135]
    ds_read_b64_tr_b16 a[96:97], v20 offset:32768
    v_lshlrev_b32_e64 v32, 16, v55
    v_mfma_f32_16x16x32_bf16 v[136:139], a[128:131], a[168:171], v[136:139]
    s_add_u32 s90, s90, 524288
    ds_read_b64_tr_b16 a[98:99], v20 offset:33792
    v_and_b32 v33, 0xffff0000, v55
    v_mfma_f32_16x16x32_bf16 v[140:143], a[128:131], a[172:175], v[140:143]
    buffer_load_dword v36, v39, s[48:51], s90 offen
    v_mfma_f32_16x16x32_bf16 v[144:147], a[128:131], a[176:179], v[144:147]
    ds_read_b128 a[64:67], v18 offset:0
    v_add_f32_e64 v28, v28, v32
    v_mfma_f32_16x16x32_bf16 v[148:151], a[128:131], a[180:183], v[148:151]
    ds_read_b64_tr_b16 a[100:101], v21 offset:32768
    v_add_f32_e64 v29, v29, v33
    v_mfma_f32_16x16x32_bf16 v[152:155], a[128:131], a[184:187], v[152:155]
    ds_read_b64_tr_b16 a[102:103], v21 offset:33792
    v_add_f32_e64 v28, v28, v29
    v_mfma_f32_16x16x32_bf16 v[156:159], a[128:131], a[188:191], v[156:159]
    ds_read_b128 a[68:71], v18 offset:2048
    v_mfma_f32_16x16x32_bf16 v[92:95], a[132:135], a[188:191], v[92:95]
    s_add_u32 m0, s64, 16384
    s_mov_b32 s66, 1310720
    ds_read_b64_tr_b16 a[104:105], v22 offset:32768
    v_add_f32_dpp v28, v28, v28 row_ror:4 row_mask:0xf bank_mask:0xf
    v_mfma_f32_16x16x32_bf16 v[88:91], a[132:135], a[184:187], v[88:91]
    buffer_load_dwordx4 v12, s[48:51], s66 offen offset:0 lds
    v_mfma_f32_16x16x32_bf16 v[84:87], a[132:135], a[180:183], v[84:87]
    ds_read_b64_tr_b16 a[106:107], v22 offset:33792
    v_add_f32_dpp v28, v28, v28 row_ror:8 row_mask:0xf bank_mask:0xf
    v_mfma_f32_16x16x32_bf16 v[80:83], a[132:135], a[176:179], v[80:83]
    ds_read_b128 a[72:75], v18 offset:4096
    v_mfma_f32_16x16x32_bf16 v[76:79], a[132:135], a[172:175], v[76:79]
    ds_read_b64_tr_b16 a[108:109], v23 offset:32768
    v_mov_b32_e64 v32, v28
    v_mfma_f32_16x16x32_bf16 v[72:75], a[132:135], a[168:171], v[72:75]
    ds_read_b64_tr_b16 a[110:111], v23 offset:33792
    v_mfma_f32_16x16x32_bf16 v[68:71], a[132:135], a[164:167], v[68:71]
    s_nop 0
    ds_read_b128 a[76:79], v18 offset:6144
    v_permlane16_swap_b32 v32, v28
    v_mfma_f32_16x16x32_bf16 v[64:67], a[132:135], a[160:163], v[64:67]
    buffer_load_dwordx4 v13, s[48:51], s66 offen offset:1024 lds
    v_mfma_f32_16x16x32_bf16 v[160:163], a[136:139], a[160:163], v[160:163]
    ds_read_b64_tr_b16 a[112:113], v24 offset:32768
    v_add_f32_e64 v28, v28, v32
    v_mfma_f32_16x16x32_bf16 v[164:167], a[136:139], a[164:167], v[164:167]
    ds_read_b64_tr_b16 a[114:115], v24 offset:33792
    v_mov_b32_e64 v32, v28
    v_mfma_f32_16x16x32_bf16 v[168:171], a[136:139], a[168:171], v[168:171]
    ds_read_b128 a[80:83], v18 offset:8192
    v_mfma_f32_16x16x32_bf16 v[172:175], a[136:139], a[172:175], v[172:175]
    s_nop 0
    ds_read_b64_tr_b16 a[116:117], v25 offset:32768
    v_permlane32_swap_b32 v32, v28
    v_mfma_f32_16x16x32_bf16 v[176:179], a[136:139], a[176:179], v[176:179]
    ds_read_b64_tr_b16 a[118:119], v25 offset:33792
    v_add_f32_e64 v28, v28, v32
    v_mfma_f32_16x16x32_bf16 v[180:183], a[136:139], a[180:183], v[180:183]
    buffer_load_dwordx4 v14, s[48:51], s66 offen offset:2048 lds
    v_mfma_f32_16x16x32_bf16 v[184:187], a[136:139], a[184:187], v[184:187]
    ds_read_b128 a[84:87], v18 offset:10240
    v_mul_f32 v28, 0x3b000000, v28
    v_mfma_f32_16x16x32_bf16 v[188:191], a[136:139], a[188:191], v[188:191]
    ds_read_b64_tr_b16 a[120:121], v26 offset:32768
    v_lshlrev_b32_e64 v32, 16, v40
    v_mfma_f32_16x16x32_bf16 v[124:127], a[140:143], a[188:191], v[124:127]
    ds_read_b64_tr_b16 a[122:123], v26 offset:33792
    v_and_b32 v33, 0xffff0000, v40
    v_mfma_f32_16x16x32_bf16 v[120:123], a[140:143], a[184:187], v[120:123]
    ds_read_b128 a[88:91], v18 offset:12288
    v_sub_f32_e64 v32, v32, v28
    v_mfma_f32_16x16x32_bf16 v[116:119], a[140:143], a[180:183], v[116:119]
    ds_read_b64_tr_b16 a[124:125], v27 offset:32768
    v_sub_f32_e64 v33, v33, v28
    v_mfma_f32_16x16x32_bf16 v[112:115], a[140:143], a[176:179], v[112:115]
    buffer_load_dwordx4 v15, s[48:51], s66 offen offset:3072 lds
    v_mfma_f32_16x16x32_bf16 v[108:111], a[140:143], a[172:175], v[108:111]
    ds_read_b64_tr_b16 a[126:127], v27 offset:33792
    v_mul_f32_e64 v30, v32, v32
    v_mfma_f32_16x16x32_bf16 v[104:107], a[140:143], a[168:171], v[104:107]
    ds_read_b128 a[92:95], v18 offset:14336
    v_mul_f32_e64 v31, v33, v33
    v_mfma_f32_16x16x32_bf16 v[100:103], a[140:143], a[164:167], v[100:103]
    v_lshlrev_b32_e64 v32, 16, v41
    v_and_b32 v33, 0xffff0000, v41
    v_mfma_f32_16x16x32_bf16 v[96:99], a[140:143], a[160:163], v[96:99]
    v_sub_f32 v32, v32, v28
    v_sub_f32 v33, v33, v28
    v_mfma_f32_16x16x32_bf16 v[192:195], a[144:147], a[160:163], v[192:195]
    s_add_u32 m0, s65, 65536
    s_mov_b32 s67, 384
    v_fmac_f32 v30, v32, v32
    v_fmac_f32 v31, v33, v33
    v_mfma_f32_16x16x32_bf16 v[196:199], a[144:147], a[164:167], v[196:199]
    buffer_load_dwordx4 v4, s[44:47], s67 offen offset:0 lds
    v_mfma_f32_16x16x32_bf16 v[200:203], a[144:147], a[168:171], v[200:203]
    v_lshlrev_b32_e64 v32, 16, v42
    v_and_b32 v33, 0xffff0000, v42
    v_mfma_f32_16x16x32_bf16 v[204:207], a[144:147], a[172:175], v[204:207]
    v_sub_f32 v32, v32, v28
    v_sub_f32 v33, v33, v28
    v_mfma_f32_16x16x32_bf16 v[208:211], a[144:147], a[176:179], v[208:211]
    v_fmac_f32 v30, v32, v32
    v_fmac_f32 v31, v33, v33
    v_mfma_f32_16x16x32_bf16 v[212:215], a[144:147], a[180:183], v[212:215]
    v_lshlrev_b32_e64 v32, 16, v43
    v_and_b32 v33, 0xffff0000, v43
    v_mfma_f32_16x16x32_bf16 v[216:219], a[144:147], a[184:187], v[216:219]
    v_sub_f32 v32, v32, v28
    v_sub_f32 v33, v33, v28
    v_mfma_f32_16x16x32_bf16 v[220:223], a[144:147], a[188:191], v[220:223]
    buffer_load_dwordx4 v5, s[44:47], s67 offen offset:1024 lds
    v_mfma_f32_16x16x32_bf16 a[220:223], a[148:151], a[188:191], a[220:223]
    v_fmac_f32 v30, v32, v32
    v_fmac_f32 v31, v33, v33
    v_mfma_f32_16x16x32_bf16 a[216:219], a[148:151], a[184:187], a[216:219]
    v_lshlrev_b32_e64 v32, 16, v44
    v_and_b32 v33, 0xffff0000, v44
    v_mfma_f32_16x16x32_bf16 a[212:215], a[148:151], a[180:183], a[212:215]
    v_sub_f32 v32, v32, v28
    v_sub_f32 v33, v33, v28
    v_mfma_f32_16x16x32_bf16 a[208:211], a[148:151], a[176:179], a[208:211]
    v_fmac_f32 v30, v32, v32
    v_fmac_f32 v31, v33, v33
    v_mfma_f32_16x16x32_bf16 a[204:207], a[148:151], a[172:175], a[204:207]
    v_lshlrev_b32_e64 v32, 16, v45
    v_and_b32 v33, 0xffff0000, v45
    v_mfma_f32_16x16x32_bf16 a[200:203], a[148:151], a[168:171], a[200:203]
    buffer_load_dwordx4 v6, s[44:47], s67 offen offset:2048 lds
    v_mfma_f32_16x16x32_bf16 a[196:199], a[148:151], a[164:167], a[196:199]
    v_sub_f32 v32, v32, v28
    v_sub_f32 v33, v33, v28
    v_mfma_f32_16x16x32_bf16 a[192:195], a[148:151], a[160:163], a[192:195]
    v_fmac_f32 v30, v32, v32
    v_fmac_f32 v31, v33, v33
    v_mfma_f32_16x16x32_bf16 v[224:227], a[152:155], a[160:163], v[224:227]
    v_lshlrev_b32_e64 v32, 16, v46
    v_and_b32 v33, 0xffff0000, v46
    v_mfma_f32_16x16x32_bf16 v[228:231], a[152:155], a[164:167], v[228:231]
    v_sub_f32 v32, v32, v28
    v_sub_f32 v33, v33, v28
    v_mfma_f32_16x16x32_bf16 v[232:235], a[152:155], a[168:171], v[232:235]
    v_fmac_f32 v30, v32, v32
    v_fmac_f32 v31, v33, v33
    v_mfma_f32_16x16x32_bf16 v[236:239], a[152:155], a[172:175], v[236:239]
    buffer_load_dwordx4 v7, s[44:47], s67 offen offset:3072 lds
    v_mfma_f32_16x16x32_bf16 v[240:243], a[152:155], a[176:179], v[240:243]
    v_lshlrev_b32_e64 v32, 16, v47
    v_and_b32 v33, 0xffff0000, v47
    v_mfma_f32_16x16x32_bf16 v[244:247], a[152:155], a[180:183], v[244:247]
    v_sub_f32 v32, v32, v28
    v_sub_f32 v33, v33, v28
    v_mfma_f32_16x16x32_bf16 v[248:251], a[152:155], a[184:187], v[248:251]
    v_fmac_f32 v30, v32, v32
    v_fmac_f32 v31, v33, v33
    v_mfma_f32_16x16x32_bf16 v[252:255], a[152:155], a[188:191], v[252:255]
    v_lshlrev_b32_e64 v32, 16, v48
    v_and_b32 v33, 0xffff0000, v48
    v_mfma_f32_16x16x32_bf16 a[252:255], a[156:159], a[188:191], a[252:255]
    v_sub_f32 v32, v32, v28
    v_sub_f32 v33, v33, v28
    v_mfma_f32_16x16x32_bf16 a[248:251], a[156:159], a[184:187], a[248:251]
    v_fmac_f32 v30, v32, v32
    v_fmac_f32 v31, v33, v33
    v_mfma_f32_16x16x32_bf16 a[244:247], a[156:159], a[180:183], a[244:247]
    v_lshlrev_b32_e64 v32, 16, v49
    v_and_b32 v33, 0xffff0000, v49
    v_mfma_f32_16x16x32_bf16 a[240:243], a[156:159], a[176:179], a[240:243]
    v_sub_f32 v32, v32, v28
    v_sub_f32 v33, v33, v28
    v_mfma_f32_16x16x32_bf16 a[236:239], a[156:159], a[172:175], a[236:239]
    v_fmac_f32 v30, v32, v32
    v_fmac_f32 v31, v33, v33
    v_mfma_f32_16x16x32_bf16 a[232:235], a[156:159], a[168:171], a[232:235]
    v_lshlrev_b32_e64 v32, 16, v50
    v_and_b32 v33, 0xffff0000, v50
    v_mfma_f32_16x16x32_bf16 a[228:231], a[156:159], a[164:167], a[228:231]
    s_waitcnt lgkmcnt(0)
    v_sub_f32 v32, v32, v28
    v_sub_f32_e64 v33, v33, v28
    v_mfma_f32_16x16x32_bf16 a[224:227], a[156:159], a[160:163], a[224:227]
    v_fmac_f32 v30, v32, v32
    v_fmac_f32 v31, v33, v33
    v_mfma_f32_16x16x32_bf16 v[128:131], a[64:67], a[96:99], v[128:131]
    s_waitcnt vmcnt(22)
    s_barrier
    v_mfma_f32_16x16x32_bf16 v[132:135], a[64:67], a[100:103], v[132:135]
    ds_read_b64_tr_b16 a[160:161], v20 offset:49152
    v_lshlrev_b32_e64 v32, 16, v51
    v_mfma_f32_16x16x32_bf16 v[136:139], a[64:67], a[104:107], v[136:139]
    s_add_u32 s90, s90, 524288
    ds_read_b64_tr_b16 a[162:163], v20 offset:50176
    v_and_b32 v33, 0xffff0000, v51
    v_mfma_f32_16x16x32_bf16 v[140:143], a[64:67], a[108:111], v[140:143]
    buffer_load_dword v36, v39, s[48:51], s90 offen
    v_mfma_f32_16x16x32_bf16 v[144:147], a[64:67], a[112:115], v[144:147]
    ds_read_b128 a[128:131], v19 offset:0
    v_sub_f32_e64 v32, v32, v28
    v_mfma_f32_16x16x32_bf16 v[148:151], a[64:67], a[116:119], v[148:151]
    ds_read_b64_tr_b16 a[164:165], v21 offset:49152
    v_sub_f32_e64 v33, v33, v28
    v_mfma_f32_16x16x32_bf16 v[152:155], a[64:67], a[120:123], v[152:155]
    ds_read_b64_tr_b16 a[166:167], v21 offset:50176
    v_fmac_f32_e64 v30, v32, v32
    v_mfma_f32_16x16x32_bf16 v[156:159], a[64:67], a[124:127], v[156:159]
    ds_read_b128 a[132:135], v19 offset:2048
    v_fmac_f32_e64 v31, v33, v33
    v_mfma_f32_16x16x32_bf16 v[92:95], a[68:71], a[124:127], v[92:95]
    s_add_u32 m0, s64, 32768
    s_mov_b32 s66, 1572864
    ds_read_b64_tr_b16 a[168:169], v22 offset:49152
    v_lshlrev_b32_e64 v32, 16, v52
    v_mfma_f32_16x16x32_bf16 v[88:91], a[68:71], a[120:123], v[88:91]
    buffer_load_dwordx4 v12, s[48:51], s66 offen offset:0 lds
    v_mfma_f32_16x16x32_bf16 v[84:87], a[68:71], a[116:119], v[84:87]
    ds_read_b64_tr_b16 a[170:171], v22 offset:50176
    v_and_b32 v33, 0xffff0000, v52
    v_mfma_f32_16x16x32_bf16 v[80:83], a[68:71], a[112:115], v[80:83]
    ds_read_b128 a[136:139], v19 offset:4096
    v_sub_f32_e64 v32, v32, v28
    v_mfma_f32_16x16x32_bf16 v[76:79], a[68:71], a[108:111], v[76:79]
    ds_read_b64_tr_b16 a[172:173], v23 offset:49152
    v_sub_f32_e64 v33, v33, v28
    v_mfma_f32_16x16x32_bf16 v[72:75], a[68:71], a[104:107], v[72:75]
    ds_read_b64_tr_b16 a[174:175], v23 offset:50176
    v_fmac_f32_e64 v30, v32, v32
    v_mfma_f32_16x16x32_bf16 v[68:71], a[68:71], a[100:103], v[68:71]
    ds_read_b128 a[140:143], v19 offset:6144
    v_fmac_f32_e64 v31, v33, v33
    v_mfma_f32_16x16x32_bf16 v[64:67], a[68:71], a[96:99], v[64:67]
    buffer_load_dwordx4 v13, s[48:51], s66 offen offset:1024 lds
    v_mfma_f32_16x16x32_bf16 v[160:163], a[72:75], a[96:99], v[160:163]
    ds_read_b64_tr_b16 a[176:177], v24 offset:49152
    v_lshlrev_b32_e64 v32, 16, v53
    v_mfma_f32_16x16x32_bf16 v[164:167], a[72:75], a[100:103], v[164:167]
    ds_read_b64_tr_b16 a[178:179], v24 offset:50176
    v_and_b32 v33, 0xffff0000, v53
    v_mfma_f32_16x16x32_bf16 v[168:171], a[72:75], a[104:107], v[168:171]
    ds_read_b128 a[144:147], v19 offset:8192
    v_sub_f32_e64 v32, v32, v28
    v_mfma_f32_16x16x32_bf16 v[172:175], a[72:75], a[108:111], v[172:175]
    ds_read_b64_tr_b16 a[180:181], v25 offset:49152
    v_sub_f32_e64 v33, v33, v28
    v_mfma_f32_16x16x32_bf16 v[176:179], a[72:75], a[112:115], v[176:179]
    ds_read_b64_tr_b16 a[182:183], v25 offset:50176
    v_fmac_f32_e64 v30, v32, v32
    v_mfma_f32_16x16x32_bf16 v[180:183], a[72:75], a[116:119], v[180:183]
    buffer_load_dwordx4 v14, s[48:51], s66 offen offset:2048 lds
    v_mfma_f32_16x16x32_bf16 v[184:187], a[72:75], a[120:123], v[184:187]
    ds_read_b128 a[148:151], v19 offset:10240
    v_fmac_f32_e64 v31, v33, v33
    v_mfma_f32_16x16x32_bf16 v[188:191], a[72:75], a[124:127], v[188:191]
    ds_read_b64_tr_b16 a[184:185], v26 offset:49152
    v_lshlrev_b32_e64 v32, 16, v54
    v_mfma_f32_16x16x32_bf16 v[124:127], a[76:79], a[124:127], v[124:127]
    ds_read_b64_tr_b16 a[186:187], v26 offset:50176
    v_and_b32 v33, 0xffff0000, v54
    v_mfma_f32_16x16x32_bf16 v[120:123], a[76:79], a[120:123], v[120:123]
    ds_read_b128 a[152:155], v19 offset:12288
    v_sub_f32_e64 v32, v32, v28
    v_mfma_f32_16x16x32_bf16 v[116:119], a[76:79], a[116:119], v[116:119]
    ds_read_b64_tr_b16 a[188:189], v27 offset:49152
    v_sub_f32_e64 v33, v33, v28
    v_mfma_f32_16x16x32_bf16 v[112:115], a[76:79], a[112:115], v[112:115]
    buffer_load_dwordx4 v15, s[48:51], s66 offen offset:3072 lds
    v_mfma_f32_16x16x32_bf16 v[108:111], a[76:79], a[108:111], v[108:111]
    ds_read_b64_tr_b16 a[190:191], v27 offset:50176
    v_fmac_f32_e64 v30, v32, v32
    v_mfma_f32_16x16x32_bf16 v[104:107], a[76:79], a[104:107], v[104:107]
    ds_read_b128 a[156:159], v19 offset:14336
    v_fmac_f32_e64 v31, v33, v33
    v_mfma_f32_16x16x32_bf16 v[100:103], a[76:79], a[100:103], v[100:103]
    v_add_u32 v18, 131072, v16
    v_add_u32 v19, 131072, v17
    v_mfma_f32_16x16x32_bf16 v[96:99], a[76:79], a[96:99], v[96:99]
    v_lshlrev_b32_e64 v32, 16, v55
    v_and_b32 v33, 0xffff0000, v55
    v_mfma_f32_16x16x32_bf16 v[192:195], a[80:83], a[96:99], v[192:195]
    s_add_u32 m0, s65, 69632
    s_mov_b32 s67, 384
    v_sub_f32 v32, v32, v28
    v_sub_f32 v33, v33, v28
    v_mfma_f32_16x16x32_bf16 v[196:199], a[80:83], a[100:103], v[196:199]
    buffer_load_dwordx4 v8, s[44:47], s67 offen offset:0 lds
    v_mfma_f32_16x16x32_bf16 v[200:203], a[80:83], a[104:107], v[200:203]
    v_fmac_f32 v30, v32, v32
    v_fmac_f32 v31, v33, v33
    v_mfma_f32_16x16x32_bf16 v[204:207], a[80:83], a[108:111], v[204:207]
    v_add_f32_e64 v30, v30, v31
    v_mfma_f32_16x16x32_bf16 v[208:211], a[80:83], a[112:115], v[208:211]
    v_mfma_f32_16x16x32_bf16 v[212:215], a[80:83], a[116:119], v[212:215]
    v_add_f32_dpp v30, v30, v30 row_ror:4 row_mask:0xf bank_mask:0xf
    v_mfma_f32_16x16x32_bf16 v[216:219], a[80:83], a[120:123], v[216:219]
    v_mfma_f32_16x16x32_bf16 v[220:223], a[80:83], a[124:127], v[220:223]
    buffer_load_dwordx4 v9, s[44:47], s67 offen offset:1024 lds
    v_mfma_f32_16x16x32_bf16 a[220:223], a[84:87], a[124:127], a[220:223]
    v_add_f32_dpp v30, v30, v30 row_ror:8 row_mask:0xf bank_mask:0xf
    v_mfma_f32_16x16x32_bf16 a[216:219], a[84:87], a[120:123], a[216:219]
    v_mfma_f32_16x16x32_bf16 a[212:215], a[84:87], a[116:119], a[212:215]
    v_mov_b32_e64 v32, v30
    v_mfma_f32_16x16x32_bf16 a[208:211], a[84:87], a[112:115], a[208:211]
    v_mfma_f32_16x16x32_bf16 a[204:207], a[84:87], a[108:111], a[204:207]
    v_permlane16_swap_b32 v32, v30
    v_add_f32 v30, v30, v32
    v_mfma_f32_16x16x32_bf16 a[200:203], a[84:87], a[104:107], a[200:203]
    buffer_load_dwordx4 v10, s[44:47], s67 offen offset:2048 lds
    v_mfma_f32_16x16x32_bf16 a[196:199], a[84:87], a[100:103], a[196:199]
    v_mov_b32_e64 v32, v30
    v_mfma_f32_16x16x32_bf16 a[192:195], a[84:87], a[96:99], a[192:195]
    v_mfma_f32_16x16x32_bf16 v[224:227], a[88:91], a[96:99], v[224:227]
    v_permlane32_swap_b32 v32, v30
    v_add_f32 v30, v30, v32
    v_mfma_f32_16x16x32_bf16 v[228:231], a[88:91], a[100:103], v[228:231]
    v_mul_f32 v30, 0x3b000000, v30
    v_cvt_pk_bf16_f32 v32, v28, v30
    v_mfma_f32_16x16x32_bf16 v[232:235], a[88:91], a[104:107], v[232:235]
    v_lshlrev_b32_e64 v28, 16, v32
    v_and_b32 v30, 0xffff0000, v32
    v_mfma_f32_16x16x32_bf16 v[236:239], a[88:91], a[108:111], v[236:239]
    buffer_load_dwordx4 v11, s[44:47], s67 offen offset:3072 lds
    v_mfma_f32_16x16x32_bf16 v[240:243], a[88:91], a[112:115], v[240:243]
    v_add_f32 v30, 0x3727c5ac, v30
    v_cvt_pk_bf16_f32 v32, v30, v30
    v_mfma_f32_16x16x32_bf16 v[244:247], a[88:91], a[116:119], v[244:247]
    v_lshlrev_b32_e64 v30, 16, v32
    v_mfma_f32_16x16x32_bf16 v[248:251], a[88:91], a[120:123], v[248:251]
    v_sqrt_f32_e64 v30, v30
    v_mfma_f32_16x16x32_bf16 v[252:255], a[88:91], a[124:127], v[252:255]
    v_cvt_pk_bf16_f32 v32, v30, v30
    v_lshlrev_b32_e64 v30, 16, v32
    v_mfma_f32_16x16x32_bf16 a[252:255], a[92:95], a[124:127], a[252:255]
    v_rcp_f32_e64 v30, v30
    v_mfma_f32_16x16x32_bf16 a[248:251], a[92:95], a[120:123], a[248:251]
    v_mul_f32 v30, 0x3e0293ee, v30
    v_lshlrev_b32_e64 v32, 16, v48
    v_mfma_f32_16x16x32_bf16 a[244:247], a[92:95], a[116:119], a[244:247]
    v_and_b32 v33, 0xffff0000, v48
    v_sub_f32_e64 v32, v32, v28
    v_mfma_f32_16x16x32_bf16 a[240:243], a[92:95], a[112:115], a[240:243]
    v_sub_f32_e64 v33, v33, v28
    v_cvt_pk_bf16_f32 v31, v32, v33
    v_mfma_f32_16x16x32_bf16 a[236:239], a[92:95], a[108:111], a[236:239]
    v_lshlrev_b32_e64 v32, 16, v31
    v_and_b32 v33, 0xffff0000, v31
    v_mfma_f32_16x16x32_bf16 a[232:235], a[92:95], a[104:107], a[232:235]
    v_mul_f32 v32, v32, v30
    v_mul_f32 v33, v33, v30
    v_mfma_f32_16x16x32_bf16 a[228:231], a[92:95], a[100:103], a[228:231]
    s_waitcnt lgkmcnt(0)
    v_cvt_pk_bf16_f32 v56, v32, v33
    v_lshlrev_b32 v32, 16, v49
    v_mfma_f32_16x16x32_bf16 a[224:227], a[92:95], a[96:99], a[224:227]
    v_and_b32 v33, 0xffff0000, v49
    v_sub_f32_e64 v32, v32, v28
    v_mfma_f32_16x16x32_bf16 v[128:131], a[128:131], a[160:163], v[128:131]
    s_waitcnt vmcnt(18)
    s_barrier
    v_mfma_f32_16x16x32_bf16 v[132:135], a[128:131], a[164:167], v[132:135]
    ds_read_b64_tr_b16 a[96:97], v20 offset:0
    v_sub_f32_e64 v33, v33, v28
    v_mfma_f32_16x16x32_bf16 v[136:139], a[128:131], a[168:171], v[136:139]
    s_add_u32 s90, s90, 524288
    ds_read_b64_tr_b16 a[98:99], v20 offset:1024
    v_cvt_pk_bf16_f32 v31, v32, v33
    v_mfma_f32_16x16x32_bf16 v[140:143], a[128:131], a[172:175], v[140:143]
    buffer_load_dword v36, v39, s[48:51], s90 offen
    v_mfma_f32_16x16x32_bf16 v[144:147], a[128:131], a[176:179], v[144:147]
    ds_read_b128 a[64:67], v18 offset:0
    v_lshlrev_b32_e64 v32, 16, v31
    v_mfma_f32_16x16x32_bf16 v[148:151], a[128:131], a[180:183], v[148:151]
    ds_read_b64_tr_b16 a[100:101], v21 offset:0
    v_and_b32 v33, 0xffff0000, v31
    v_mfma_f32_16x16x32_bf16 v[152:155], a[128:131], a[184:187], v[152:155]
    ds_read_b64_tr_b16 a[102:103], v21 offset:1024
    v_mul_f32_e64 v32, v32, v30
    v_mfma_f32_16x16x32_bf16 v[156:159], a[128:131], a[188:191], v[156:159]
    ds_read_b128 a[68:71], v18 offset:2048
    v_mul_f32_e64 v33, v33, v30
    v_mfma_f32_16x16x32_bf16 v[92:95], a[132:135], a[188:191], v[92:95]
    s_add_u32 m0, s64, 49152
    s_mov_b32 s66, 1835008
    ds_read_b64_tr_b16 a[104:105], v22 offset:0
    v_cvt_pk_bf16_f32 v57, v32, v33
    v_mfma_f32_16x16x32_bf16 v[88:91], a[132:135], a[184:187], v[88:91]
    buffer_load_dwordx4 v12, s[48:51], s66 offen offset:0 lds
    v_mfma_f32_16x16x32_bf16 v[84:87], a[132:135], a[180:183], v[84:87]
    ds_read_b64_tr_b16 a[106:107], v22 offset:1024
    v_lshlrev_b32_e64 v32, 16, v50
    v_mfma_f32_16x16x32_bf16 v[80:83], a[132:135], a[176:179], v[80:83]
    ds_read_b128 a[72:75], v18 offset:4096
    v_and_b32 v33, 0xffff0000, v50
    v_mfma_f32_16x16x32_bf16 v[76:79], a[132:135], a[172:175], v[76:79]
    ds_read_b64_tr_b16 a[108:109], v23 offset:0
    v_sub_f32_e64 v32, v32, v28
    v_mfma_f32_16x16x32_bf16 v[72:75], a[132:135], a[168:171], v[72:75]
    ds_read_b64_tr_b16 a[110:111], v23 offset:1024
    v_sub_f32_e64 v33, v33, v28
    v_mfma_f32_16x16x32_bf16 v[68:71], a[132:135], a[164:167], v[68:71]
    ds_read_b128 a[76:79], v18 offset:6144
    v_cvt_pk_bf16_f32 v31, v32, v33
    v_mfma_f32_16x16x32_bf16 v[64:67], a[132:135], a[160:163], v[64:67]
    buffer_load_dwordx4 v13, s[48:51], s66 offen offset:1024 lds
    v_mfma_f32_16x16x32_bf16 v[160:163], a[136:139], a[160:163], v[160:163]
    ds_read_b64_tr_b16 a[112:113], v24 offset:0
    v_lshlrev_b32_e64 v32, 16, v31
    v_mfma_f32_16x16x32_bf16 v[164:167], a[136:139], a[164:167], v[164:167]
    ds_read_b64_tr_b16 a[114:115], v24 offset:1024
    v_and_b32 v33, 0xffff0000, v31
    v_mfma_f32_16x16x32_bf16 v[168:171], a[136:139], a[168:171], v[168:171]
    ds_read_b128 a[80:83], v18 offset:8192
    v_mul_f32_e64 v32, v32, v30
    v_mfma_f32_16x16x32_bf16 v[172:175], a[136:139], a[172:175], v[172:175]
    ds_read_b64_tr_b16 a[116:117], v25 offset:0
    v_mul_f32_e64 v33, v33, v30
    v_mfma_f32_16x16x32_bf16 v[176:179], a[136:139], a[176:179], v[176:179]
    ds_read_b64_tr_b16 a[118:119], v25 offset:1024
    v_cvt_pk_bf16_f32 v58, v32, v33
    v_mfma_f32_16x16x32_bf16 v[180:183], a[136:139], a[180:183], v[180:183]
    buffer_load_dwordx4 v14, s[48:51], s66 offen offset:2048 lds
    v_mfma_f32_16x16x32_bf16 v[184:187], a[136:139], a[184:187], v[184:187]
    ds_read_b128 a[84:87], v18 offset:10240
    v_lshlrev_b32_e64 v32, 16, v51
    v_mfma_f32_16x16x32_bf16 v[188:191], a[136:139], a[188:191], v[188:191]
    ds_read_b64_tr_b16 a[120:121], v26 offset:0
    v_and_b32 v33, 0xffff0000, v51
    v_mfma_f32_16x16x32_bf16 v[124:127], a[140:143], a[188:191], v[124:127]
    ds_read_b64_tr_b16 a[122:123], v26 offset:1024
    v_sub_f32_e64 v32, v32, v28
    v_mfma_f32_16x16x32_bf16 v[120:123], a[140:143], a[184:187], v[120:123]
    ds_read_b128 a[88:91], v18 offset:12288
    v_sub_f32_e64 v33, v33, v28
    v_mfma_f32_16x16x32_bf16 v[116:119], a[140:143], a[180:183], v[116:119]
    ds_read_b64_tr_b16 a[124:125], v27 offset:0
    v_cvt_pk_bf16_f32 v31, v32, v33
    v_mfma_f32_16x16x32_bf16 v[112:115], a[140:143], a[176:179], v[112:115]
    buffer_load_dwordx4 v15, s[48:51], s66 offen offset:3072 lds
    v_mfma_f32_16x16x32_bf16 v[108:111], a[140:143], a[172:175], v[108:111]
    ds_read_b64_tr_b16 a[126:127], v27 offset:1024
    v_lshlrev_b32_e64 v32, 16, v31
    v_mfma_f32_16x16x32_bf16 v[104:107], a[140:143], a[168:171], v[104:107]
    ds_read_b128 a[92:95], v18 offset:14336
    v_and_b32 v33, 0xffff0000, v31
    v_mfma_f32_16x16x32_bf16 v[100:103], a[140:143], a[164:167], v[100:103]
    v_mul_f32 v32, v32, v30
    v_mul_f32 v33, v33, v30
    v_mfma_f32_16x16x32_bf16 v[96:99], a[140:143], a[160:163], v[96:99]
    v_cvt_pk_bf16_f32 v59, v32, v33
    v_mfma_f32_16x16x32_bf16 v[192:195], a[144:147], a[160:163], v[192:195]
    s_add_u32 m0, s65, 98304
    s_mov_b32 s67, 512
    buffer_store_dwordx4 v[56:59], v34, s[52:55], s13 offen sc1
    v_mfma_f32_16x16x32_bf16 v[196:199], a[144:147], a[164:167], v[196:199]
    buffer_load_dwordx4 v4, s[44:47], s67 offen offset:0 lds
    v_mfma_f32_16x16x32_bf16 v[200:203], a[144:147], a[168:171], v[200:203]
    v_lshlrev_b32_e64 v32, 16, v52
    v_and_b32 v33, 0xffff0000, v52
    v_mfma_f32_16x16x32_bf16 v[204:207], a[144:147], a[172:175], v[204:207]
    v_sub_f32 v32, v32, v28
    v_sub_f32 v33, v33, v28
    v_mfma_f32_16x16x32_bf16 v[208:211], a[144:147], a[176:179], v[208:211]
    v_cvt_pk_bf16_f32 v31, v32, v33
    v_lshlrev_b32_e64 v32, 16, v31
    v_mfma_f32_16x16x32_bf16 v[212:215], a[144:147], a[180:183], v[212:215]
    v_and_b32 v33, 0xffff0000, v31
    v_mul_f32_e64 v32, v32, v30
    v_mfma_f32_16x16x32_bf16 v[216:219], a[144:147], a[184:187], v[216:219]
    v_mul_f32_e64 v33, v33, v30
    v_cvt_pk_bf16_f32 v60, v32, v33
    v_mfma_f32_16x16x32_bf16 v[220:223], a[144:147], a[188:191], v[220:223]
    buffer_load_dwordx4 v5, s[44:47], s67 offen offset:1024 lds
    v_mfma_f32_16x16x32_bf16 a[220:223], a[148:151], a[188:191], a[220:223]
    v_lshlrev_b32_e64 v32, 16, v53
    v_and_b32 v33, 0xffff0000, v53
    v_mfma_f32_16x16x32_bf16 a[216:219], a[148:151], a[184:187], a[216:219]
    v_sub_f32 v32, v32, v28
    v_sub_f32 v33, v33, v28
    v_mfma_f32_16x16x32_bf16 a[212:215], a[148:151], a[180:183], a[212:215]
    v_cvt_pk_bf16_f32 v31, v32, v33
    v_lshlrev_b32_e64 v32, 16, v31
    v_mfma_f32_16x16x32_bf16 a[208:211], a[148:151], a[176:179], a[208:211]
    v_and_b32 v33, 0xffff0000, v31
    v_mul_f32_e64 v32, v32, v30
    v_mfma_f32_16x16x32_bf16 a[204:207], a[148:151], a[172:175], a[204:207]
    v_mul_f32_e64 v33, v33, v30
    v_cvt_pk_bf16_f32 v61, v32, v33
    v_mfma_f32_16x16x32_bf16 a[200:203], a[148:151], a[168:171], a[200:203]
    buffer_load_dwordx4 v6, s[44:47], s67 offen offset:2048 lds
    v_mfma_f32_16x16x32_bf16 a[196:199], a[148:151], a[164:167], a[196:199]
    v_lshlrev_b32_e64 v32, 16, v54
    v_and_b32 v33, 0xffff0000, v54
    v_mfma_f32_16x16x32_bf16 a[192:195], a[148:151], a[160:163], a[192:195]
    v_sub_f32 v32, v32, v28
    v_sub_f32 v33, v33, v28
    v_mfma_f32_16x16x32_bf16 v[224:227], a[152:155], a[160:163], v[224:227]
    v_cvt_pk_bf16_f32 v31, v32, v33
    v_lshlrev_b32_e64 v32, 16, v31
    v_mfma_f32_16x16x32_bf16 v[228:231], a[152:155], a[164:167], v[228:231]
    v_and_b32 v33, 0xffff0000, v31
    v_mul_f32_e64 v32, v32, v30
    v_mfma_f32_16x16x32_bf16 v[232:235], a[152:155], a[168:171], v[232:235]
    v_mul_f32_e64 v33, v33, v30
    v_cvt_pk_bf16_f32 v62, v32, v33
    v_mfma_f32_16x16x32_bf16 v[236:239], a[152:155], a[172:175], v[236:239]
    buffer_load_dwordx4 v7, s[44:47], s67 offen offset:3072 lds
    v_mfma_f32_16x16x32_bf16 v[240:243], a[152:155], a[176:179], v[240:243]
    v_lshlrev_b32_e64 v32, 16, v55
    v_and_b32 v33, 0xffff0000, v55
    v_mfma_f32_16x16x32_bf16 v[244:247], a[152:155], a[180:183], v[244:247]
    v_sub_f32 v32, v32, v28
    v_sub_f32 v33, v33, v28
    v_mfma_f32_16x16x32_bf16 v[248:251], a[152:155], a[184:187], v[248:251]
    v_cvt_pk_bf16_f32 v31, v32, v33
    v_lshlrev_b32_e64 v32, 16, v31
    v_mfma_f32_16x16x32_bf16 v[252:255], a[152:155], a[188:191], v[252:255]
    v_and_b32 v33, 0xffff0000, v31
    v_mul_f32_e64 v32, v32, v30
    v_mfma_f32_16x16x32_bf16 a[252:255], a[156:159], a[188:191], a[252:255]
    v_mul_f32_e64 v33, v33, v30
    v_cvt_pk_bf16_f32 v63, v32, v33
    v_mfma_f32_16x16x32_bf16 a[248:251], a[156:159], a[184:187], a[248:251]
    buffer_store_dwordx4 v[60:63], v34, s[52:55], s12 offen sc1
    v_mfma_f32_16x16x32_bf16 a[244:247], a[156:159], a[180:183], a[244:247]
    v_mfma_f32_16x16x32_bf16 a[240:243], a[156:159], a[176:179], a[240:243]
    v_mfma_f32_16x16x32_bf16 a[236:239], a[156:159], a[172:175], a[236:239]
    v_mfma_f32_16x16x32_bf16 a[232:235], a[156:159], a[168:171], a[232:235]
    v_mfma_f32_16x16x32_bf16 a[228:231], a[156:159], a[164:167], a[228:231]
    s_nop 0
    s_waitcnt lgkmcnt(0)
    v_mfma_f32_16x16x32_bf16 a[224:227], a[156:159], a[160:163], a[224:227]
    v_mfma_f32_16x16x32_bf16 v[128:131], a[64:67], a[96:99], v[128:131]
    s_waitcnt vmcnt(24)
    s_barrier
    v_mfma_f32_16x16x32_bf16 v[132:135], a[64:67], a[100:103], v[132:135]
    ds_read_b64_tr_b16 a[160:161], v20 offset:16384
    v_mfma_f32_16x16x32_bf16 v[136:139], a[64:67], a[104:107], v[136:139]
    s_add_u32 s90, s90, 524288
    ds_read_b64_tr_b16 a[162:163], v20 offset:17408
    v_mfma_f32_16x16x32_bf16 v[140:143], a[64:67], a[108:111], v[140:143]
    buffer_load_dword v36, v39, s[48:51], s90 offen
    v_mfma_f32_16x16x32_bf16 v[144:147], a[64:67], a[112:115], v[144:147]
    ds_read_b128 a[128:131], v19 offset:0
    v_mfma_f32_16x16x32_bf16 v[148:151], a[64:67], a[116:119], v[148:151]
    ds_read_b64_tr_b16 a[164:165], v21 offset:16384
    v_mfma_f32_16x16x32_bf16 v[152:155], a[64:67], a[120:123], v[152:155]
    ds_read_b64_tr_b16 a[166:167], v21 offset:17408
    v_mfma_f32_16x16x32_bf16 v[156:159], a[64:67], a[124:127], v[156:159]
    ds_read_b128 a[132:135], v19 offset:2048
    v_mfma_f32_16x16x32_bf16 v[92:95], a[68:71], a[124:127], v[92:95]
    s_nop 0
    s_add_u32 m0, s64, 0
    s_mov_b32 s66, 2097152
    ds_read_b64_tr_b16 a[168:169], v22 offset:16384
    v_mfma_f32_16x16x32_bf16 v[88:91], a[68:71], a[120:123], v[88:91]
    buffer_load_dwordx4 v12, s[48:51], s66 offen offset:0 lds
    v_mfma_f32_16x16x32_bf16 v[84:87], a[68:71], a[116:119], v[84:87]
    ds_read_b64_tr_b16 a[170:171], v22 offset:17408
    v_mfma_f32_16x16x32_bf16 v[80:83], a[68:71], a[112:115], v[80:83]
    ds_read_b128 a[136:139], v19 offset:4096
    v_mfma_f32_16x16x32_bf16 v[76:79], a[68:71], a[108:111], v[76:79]
    ds_read_b64_tr_b16 a[172:173], v23 offset:16384
    v_mfma_f32_16x16x32_bf16 v[72:75], a[68:71], a[104:107], v[72:75]
    ds_read_b64_tr_b16 a[174:175], v23 offset:17408
    v_mfma_f32_16x16x32_bf16 v[68:71], a[68:71], a[100:103], v[68:71]
    ds_read_b128 a[140:143], v19 offset:6144
    v_mfma_f32_16x16x32_bf16 v[64:67], a[68:71], a[96:99], v[64:67]
    buffer_load_dwordx4 v13, s[48:51], s66 offen offset:1024 lds
    v_mfma_f32_16x16x32_bf16 v[160:163], a[72:75], a[96:99], v[160:163]
    ds_read_b64_tr_b16 a[176:177], v24 offset:16384
    v_mfma_f32_16x16x32_bf16 v[164:167], a[72:75], a[100:103], v[164:167]
    ds_read_b64_tr_b16 a[178:179], v24 offset:17408
    v_mfma_f32_16x16x32_bf16 v[168:171], a[72:75], a[104:107], v[168:171]
    ds_read_b128 a[144:147], v19 offset:8192
    v_mfma_f32_16x16x32_bf16 v[172:175], a[72:75], a[108:111], v[172:175]
    ds_read_b64_tr_b16 a[180:181], v25 offset:16384
    v_mfma_f32_16x16x32_bf16 v[176:179], a[72:75], a[112:115], v[176:179]
    ds_read_b64_tr_b16 a[182:183], v25 offset:17408
    v_mfma_f32_16x16x32_bf16 v[180:183], a[72:75], a[116:119], v[180:183]
    buffer_load_dwordx4 v14, s[48:51], s66 offen offset:2048 lds
    v_mfma_f32_16x16x32_bf16 v[184:187], a[72:75], a[120:123], v[184:187]
    ds_read_b128 a[148:151], v19 offset:10240
    v_mfma_f32_16x16x32_bf16 v[188:191], a[72:75], a[124:127], v[188:191]
    ds_read_b64_tr_b16 a[184:185], v26 offset:16384
    v_mfma_f32_16x16x32_bf16 v[124:127], a[76:79], a[124:127], v[124:127]
    ds_read_b64_tr_b16 a[186:187], v26 offset:17408
    v_mfma_f32_16x16x32_bf16 v[120:123], a[76:79], a[120:123], v[120:123]
    ds_read_b128 a[152:155], v19 offset:12288
    v_mfma_f32_16x16x32_bf16 v[116:119], a[76:79], a[116:119], v[116:119]
    ds_read_b64_tr_b16 a[188:189], v27 offset:16384
    v_mfma_f32_16x16x32_bf16 v[112:115], a[76:79], a[112:115], v[112:115]
    buffer_load_dwordx4 v15, s[48:51], s66 offen offset:3072 lds
    v_mfma_f32_16x16x32_bf16 v[108:111], a[76:79], a[108:111], v[108:111]
    ds_read_b64_tr_b16 a[190:191], v27 offset:17408
    v_mfma_f32_16x16x32_bf16 v[104:107], a[76:79], a[104:107], v[104:107]
    ds_read_b128 a[156:159], v19 offset:14336
    v_mfma_f32_16x16x32_bf16 v[100:103], a[76:79], a[100:103], v[100:103]
    v_add_u32 v18, 65536, v16
    v_add_u32 v19, 65536, v17
    v_mfma_f32_16x16x32_bf16 v[96:99], a[76:79], a[96:99], v[96:99]
    v_mfma_f32_16x16x32_bf16 v[192:195], a[80:83], a[96:99], v[192:195]
    s_add_u32 m0, s65, 102400
    s_mov_b32 s67, 512
    v_mfma_f32_16x16x32_bf16 v[196:199], a[80:83], a[100:103], v[196:199]
    buffer_load_dwordx4 v8, s[44:47], s67 offen offset:0 lds
    v_mfma_f32_16x16x32_bf16 v[200:203], a[80:83], a[104:107], v[200:203]
    v_mfma_f32_16x16x32_bf16 v[204:207], a[80:83], a[108:111], v[204:207]
    v_mfma_f32_16x16x32_bf16 v[208:211], a[80:83], a[112:115], v[208:211]
    v_mfma_f32_16x16x32_bf16 v[212:215], a[80:83], a[116:119], v[212:215]
    v_mfma_f32_16x16x32_bf16 v[216:219], a[80:83], a[120:123], v[216:219]
    v_mfma_f32_16x16x32_bf16 v[220:223], a[80:83], a[124:127], v[220:223]
    buffer_load_dwordx4 v9, s[44:47], s67 offen offset:1024 lds
    v_mfma_f32_16x16x32_bf16 a[220:223], a[84:87], a[124:127], a[220:223]
    v_mfma_f32_16x16x32_bf16 a[216:219], a[84:87], a[120:123], a[216:219]
    v_mfma_f32_16x16x32_bf16 a[212:215], a[84:87], a[116:119], a[212:215]
    v_mfma_f32_16x16x32_bf16 a[208:211], a[84:87], a[112:115], a[208:211]
    v_mfma_f32_16x16x32_bf16 a[204:207], a[84:87], a[108:111], a[204:207]
    v_mfma_f32_16x16x32_bf16 a[200:203], a[84:87], a[104:107], a[200:203]
    buffer_load_dwordx4 v10, s[44:47], s67 offen offset:2048 lds
    v_mfma_f32_16x16x32_bf16 a[196:199], a[84:87], a[100:103], a[196:199]
    v_mfma_f32_16x16x32_bf16 a[192:195], a[84:87], a[96:99], a[192:195]
    v_mfma_f32_16x16x32_bf16 v[224:227], a[88:91], a[96:99], v[224:227]
    v_mfma_f32_16x16x32_bf16 v[228:231], a[88:91], a[100:103], v[228:231]
    v_mfma_f32_16x16x32_bf16 v[232:235], a[88:91], a[104:107], v[232:235]
    v_mfma_f32_16x16x32_bf16 v[236:239], a[88:91], a[108:111], v[236:239]
    buffer_load_dwordx4 v11, s[44:47], s67 offen offset:3072 lds
    v_mfma_f32_16x16x32_bf16 v[240:243], a[88:91], a[112:115], v[240:243]
    v_mfma_f32_16x16x32_bf16 v[244:247], a[88:91], a[116:119], v[244:247]
    v_mfma_f32_16x16x32_bf16 v[248:251], a[88:91], a[120:123], v[248:251]
    v_mfma_f32_16x16x32_bf16 v[252:255], a[88:91], a[124:127], v[252:255]
    v_mfma_f32_16x16x32_bf16 a[252:255], a[92:95], a[124:127], a[252:255]
    v_mfma_f32_16x16x32_bf16 a[248:251], a[92:95], a[120:123], a[248:251]
    v_mfma_f32_16x16x32_bf16 a[244:247], a[92:95], a[116:119], a[244:247]
    v_mfma_f32_16x16x32_bf16 a[240:243], a[92:95], a[112:115], a[240:243]
    v_mfma_f32_16x16x32_bf16 a[236:239], a[92:95], a[108:111], a[236:239]
    v_mfma_f32_16x16x32_bf16 a[232:235], a[92:95], a[104:107], a[232:235]
    v_mfma_f32_16x16x32_bf16 a[228:231], a[92:95], a[100:103], a[228:231]
    s_nop 0
    s_waitcnt lgkmcnt(0)
    v_mfma_f32_16x16x32_bf16 a[224:227], a[92:95], a[96:99], a[224:227]
    v_mfma_f32_16x16x32_bf16 v[128:131], a[128:131], a[160:163], v[128:131]
    s_waitcnt vmcnt(20)
    s_barrier
    v_mfma_f32_16x16x32_bf16 v[132:135], a[128:131], a[164:167], v[132:135]
    ds_read_b64_tr_b16 a[96:97], v20 offset:32768
    v_mfma_f32_16x16x32_bf16 v[136:139], a[128:131], a[168:171], v[136:139]
    ds_read_b64_tr_b16 a[98:99], v20 offset:33792
    v_mfma_f32_16x16x32_bf16 v[140:143], a[128:131], a[172:175], v[140:143]
    buffer_load_dword v3, v35, s[56:59], 0 offen sc1
    v_mfma_f32_16x16x32_bf16 v[144:147], a[128:131], a[176:179], v[144:147]
    ds_read_b128 a[64:67], v18 offset:0
    v_mfma_f32_16x16x32_bf16 v[148:151], a[128:131], a[180:183], v[148:151]
    ds_read_b64_tr_b16 a[100:101], v21 offset:32768
    v_mfma_f32_16x16x32_bf16 v[152:155], a[128:131], a[184:187], v[152:155]
    ds_read_b64_tr_b16 a[102:103], v21 offset:33792
    v_mfma_f32_16x16x32_bf16 v[156:159], a[128:131], a[188:191], v[156:159]
    ds_read_b128 a[68:71], v18 offset:2048
    v_mfma_f32_16x16x32_bf16 v[92:95], a[132:135], a[188:191], v[92:95]
    s_add_u32 m0, s64, 16384
    s_mov_b32 s66, 2359296
    ds_read_b64_tr_b16 a[104:105], v22 offset:32768
    v_mfma_f32_16x16x32_bf16 v[88:91], a[132:135], a[184:187], v[88:91]
    buffer_load_dwordx4 v12, s[48:51], s66 offen offset:0 lds
    v_mfma_f32_16x16x32_bf16 v[84:87], a[132:135], a[180:183], v[84:87]
    ds_read_b64_tr_b16 a[106:107], v22 offset:33792
    v_mfma_f32_16x16x32_bf16 v[80:83], a[132:135], a[176:179], v[80:83]
    ds_read_b128 a[72:75], v18 offset:4096
    v_mfma_f32_16x16x32_bf16 v[76:79], a[132:135], a[172:175], v[76:79]
    ds_read_b64_tr_b16 a[108:109], v23 offset:32768
    v_mfma_f32_16x16x32_bf16 v[72:75], a[132:135], a[168:171], v[72:75]
    ds_read_b64_tr_b16 a[110:111], v23 offset:33792
    v_mfma_f32_16x16x32_bf16 v[68:71], a[132:135], a[164:167], v[68:71]
    ds_read_b128 a[76:79], v18 offset:6144
    v_mfma_f32_16x16x32_bf16 v[64:67], a[132:135], a[160:163], v[64:67]
    buffer_load_dwordx4 v13, s[48:51], s66 offen offset:1024 lds
    v_mfma_f32_16x16x32_bf16 v[160:163], a[136:139], a[160:163], v[160:163]
    ds_read_b64_tr_b16 a[112:113], v24 offset:32768
    v_mfma_f32_16x16x32_bf16 v[164:167], a[136:139], a[164:167], v[164:167]
    ds_read_b64_tr_b16 a[114:115], v24 offset:33792
    v_mfma_f32_16x16x32_bf16 v[168:171], a[136:139], a[168:171], v[168:171]
    ds_read_b128 a[80:83], v18 offset:8192
    v_mfma_f32_16x16x32_bf16 v[172:175], a[136:139], a[172:175], v[172:175]
    ds_read_b64_tr_b16 a[116:117], v25 offset:32768
    v_mfma_f32_16x16x32_bf16 v[176:179], a[136:139], a[176:179], v[176:179]
    ds_read_b64_tr_b16 a[118:119], v25 offset:33792
    v_mfma_f32_16x16x32_bf16 v[180:183], a[136:139], a[180:183], v[180:183]
    buffer_load_dwordx4 v14, s[48:51], s66 offen offset:2048 lds
    v_mfma_f32_16x16x32_bf16 v[184:187], a[136:139], a[184:187], v[184:187]
    ds_read_b128 a[84:87], v18 offset:10240
    v_mfma_f32_16x16x32_bf16 v[188:191], a[136:139], a[188:191], v[188:191]
    ds_read_b64_tr_b16 a[120:121], v26 offset:32768
    v_mfma_f32_16x16x32_bf16 v[124:127], a[140:143], a[188:191], v[124:127]
    ds_read_b64_tr_b16 a[122:123], v26 offset:33792
    v_mfma_f32_16x16x32_bf16 v[120:123], a[140:143], a[184:187], v[120:123]
    ds_read_b128 a[88:91], v18 offset:12288
    v_mfma_f32_16x16x32_bf16 v[116:119], a[140:143], a[180:183], v[116:119]
    ds_read_b64_tr_b16 a[124:125], v27 offset:32768
    v_mfma_f32_16x16x32_bf16 v[112:115], a[140:143], a[176:179], v[112:115]
    buffer_load_dwordx4 v15, s[48:51], s66 offen offset:3072 lds
    v_mfma_f32_16x16x32_bf16 v[108:111], a[140:143], a[172:175], v[108:111]
    ds_read_b64_tr_b16 a[126:127], v27 offset:33792
    v_mfma_f32_16x16x32_bf16 v[104:107], a[140:143], a[168:171], v[104:107]
    ds_read_b128 a[92:95], v18 offset:14336
    v_mfma_f32_16x16x32_bf16 v[100:103], a[140:143], a[164:167], v[100:103]
    v_mfma_f32_16x16x32_bf16 v[96:99], a[140:143], a[160:163], v[96:99]
    v_mfma_f32_16x16x32_bf16 v[192:195], a[144:147], a[160:163], v[192:195]
    s_add_u32 m0, s65, 131072
    s_mov_b32 s67, 640
    v_mfma_f32_16x16x32_bf16 v[196:199], a[144:147], a[164:167], v[196:199]
    buffer_load_dwordx4 v4, s[44:47], s67 offen offset:0 lds
    v_mfma_f32_16x16x32_bf16 v[200:203], a[144:147], a[168:171], v[200:203]
    v_mfma_f32_16x16x32_bf16 v[204:207], a[144:147], a[172:175], v[204:207]
    v_mfma_f32_16x16x32_bf16 v[208:211], a[144:147], a[176:179], v[208:211]
    v_mfma_f32_16x16x32_bf16 v[212:215], a[144:147], a[180:183], v[212:215]
    v_mfma_f32_16x16x32_bf16 v[216:219], a[144:147], a[184:187], v[216:219]
    v_mfma_f32_16x16x32_bf16 v[220:223], a[144:147], a[188:191], v[220:223]
    buffer_load_dwordx4 v5, s[44:47], s67 offen offset:1024 lds
    v_mfma_f32_16x16x32_bf16 a[220:223], a[148:151], a[188:191], a[220:223]
    v_mfma_f32_16x16x32_bf16 a[216:219], a[148:151], a[184:187], a[216:219]
    v_mfma_f32_16x16x32_bf16 a[212:215], a[148:151], a[180:183], a[212:215]
    v_mfma_f32_16x16x32_bf16 a[208:211], a[148:151], a[176:179], a[208:211]
    v_mfma_f32_16x16x32_bf16 a[204:207], a[148:151], a[172:175], a[204:207]
    v_mfma_f32_16x16x32_bf16 a[200:203], a[148:151], a[168:171], a[200:203]
    buffer_load_dwordx4 v6, s[44:47], s67 offen offset:2048 lds
    v_mfma_f32_16x16x32_bf16 a[196:199], a[148:151], a[164:167], a[196:199]
    v_mfma_f32_16x16x32_bf16 a[192:195], a[148:151], a[160:163], a[192:195]
    v_mfma_f32_16x16x32_bf16 v[224:227], a[152:155], a[160:163], v[224:227]
    v_mfma_f32_16x16x32_bf16 v[228:231], a[152:155], a[164:167], v[228:231]
    v_mfma_f32_16x16x32_bf16 v[232:235], a[152:155], a[168:171], v[232:235]
    v_mfma_f32_16x16x32_bf16 v[236:239], a[152:155], a[172:175], v[236:239]
    buffer_load_dwordx4 v7, s[44:47], s67 offen offset:3072 lds
    v_mfma_f32_16x16x32_bf16 v[240:243], a[152:155], a[176:179], v[240:243]
    v_mfma_f32_16x16x32_bf16 v[244:247], a[152:155], a[180:183], v[244:247]
    v_mfma_f32_16x16x32_bf16 v[248:251], a[152:155], a[184:187], v[248:251]
    v_mfma_f32_16x16x32_bf16 v[252:255], a[152:155], a[188:191], v[252:255]
    v_mfma_f32_16x16x32_bf16 a[252:255], a[156:159], a[188:191], a[252:255]
    v_mfma_f32_16x16x32_bf16 a[248:251], a[156:159], a[184:187], a[248:251]
    v_mfma_f32_16x16x32_bf16 a[244:247], a[156:159], a[180:183], a[244:247]
    v_mfma_f32_16x16x32_bf16 a[240:243], a[156:159], a[176:179], a[240:243]
    v_mfma_f32_16x16x32_bf16 a[236:239], a[156:159], a[172:175], a[236:239]
    v_mfma_f32_16x16x32_bf16 a[232:235], a[156:159], a[168:171], a[232:235]
    v_mfma_f32_16x16x32_bf16 a[228:231], a[156:159], a[164:167], a[228:231]
    s_nop 0
    s_waitcnt lgkmcnt(0)
    v_mfma_f32_16x16x32_bf16 a[224:227], a[156:159], a[160:163], a[224:227]
    v_mfma_f32_16x16x32_bf16 v[128:131], a[64:67], a[96:99], v[128:131]
    s_waitcnt vmcnt(24)
    s_barrier
    v_mfma_f32_16x16x32_bf16 v[132:135], a[64:67], a[100:103], v[132:135]
    ds_read_b64_tr_b16 a[160:161], v20 offset:49152
    v_mfma_f32_16x16x32_bf16 v[136:139], a[64:67], a[104:107], v[136:139]
    s_add_u32 s90, s90, 524288
    ds_read_b64_tr_b16 a[162:163], v20 offset:50176
    v_mfma_f32_16x16x32_bf16 v[140:143], a[64:67], a[108:111], v[140:143]
    buffer_load_dword v36, v39, s[48:51], s90 offen
    v_mfma_f32_16x16x32_bf16 v[144:147], a[64:67], a[112:115], v[144:147]
    ds_read_b128 a[128:131], v19 offset:0
    v_mfma_f32_16x16x32_bf16 v[148:151], a[64:67], a[116:119], v[148:151]
    ds_read_b64_tr_b16 a[164:165], v21 offset:49152
    v_mfma_f32_16x16x32_bf16 v[152:155], a[64:67], a[120:123], v[152:155]
    ds_read_b64_tr_b16 a[166:167], v21 offset:50176
    v_mfma_f32_16x16x32_bf16 v[156:159], a[64:67], a[124:127], v[156:159]
    ds_read_b128 a[132:135], v19 offset:2048
    v_mfma_f32_16x16x32_bf16 v[92:95], a[68:71], a[124:127], v[92:95]
    s_add_u32 m0, s64, 32768
    s_mov_b32 s66, 2621440
    ds_read_b64_tr_b16 a[168:169], v22 offset:49152
    v_mfma_f32_16x16x32_bf16 v[88:91], a[68:71], a[120:123], v[88:91]
    buffer_load_dwordx4 v12, s[48:51], s66 offen offset:0 lds
    v_mfma_f32_16x16x32_bf16 v[84:87], a[68:71], a[116:119], v[84:87]
    ds_read_b64_tr_b16 a[170:171], v22 offset:50176
    v_mfma_f32_16x16x32_bf16 v[80:83], a[68:71], a[112:115], v[80:83]
    ds_read_b128 a[136:139], v19 offset:4096
    v_mfma_f32_16x16x32_bf16 v[76:79], a[68:71], a[108:111], v[76:79]
    ds_read_b64_tr_b16 a[172:173], v23 offset:49152
    v_mfma_f32_16x16x32_bf16 v[72:75], a[68:71], a[104:107], v[72:75]
    ds_read_b64_tr_b16 a[174:175], v23 offset:50176
    v_mfma_f32_16x16x32_bf16 v[68:71], a[68:71], a[100:103], v[68:71]
    ds_read_b128 a[140:143], v19 offset:6144
    v_mfma_f32_16x16x32_bf16 v[64:67], a[68:71], a[96:99], v[64:67]
    buffer_load_dwordx4 v13, s[48:51], s66 offen offset:1024 lds
    v_mfma_f32_16x16x32_bf16 v[160:163], a[72:75], a[96:99], v[160:163]
    ds_read_b64_tr_b16 a[176:177], v24 offset:49152
    v_mfma_f32_16x16x32_bf16 v[164:167], a[72:75], a[100:103], v[164:167]
    ds_read_b64_tr_b16 a[178:179], v24 offset:50176
    v_mfma_f32_16x16x32_bf16 v[168:171], a[72:75], a[104:107], v[168:171]
    ds_read_b128 a[144:147], v19 offset:8192
    v_mfma_f32_16x16x32_bf16 v[172:175], a[72:75], a[108:111], v[172:175]
    ds_read_b64_tr_b16 a[180:181], v25 offset:49152
    v_mfma_f32_16x16x32_bf16 v[176:179], a[72:75], a[112:115], v[176:179]
    ds_read_b64_tr_b16 a[182:183], v25 offset:50176
    v_mfma_f32_16x16x32_bf16 v[180:183], a[72:75], a[116:119], v[180:183]
    buffer_load_dwordx4 v14, s[48:51], s66 offen offset:2048 lds
    v_mfma_f32_16x16x32_bf16 v[184:187], a[72:75], a[120:123], v[184:187]
    ds_read_b128 a[148:151], v19 offset:10240
    v_mfma_f32_16x16x32_bf16 v[188:191], a[72:75], a[124:127], v[188:191]
    ds_read_b64_tr_b16 a[184:185], v26 offset:49152
    v_mfma_f32_16x16x32_bf16 v[124:127], a[76:79], a[124:127], v[124:127]
    ds_read_b64_tr_b16 a[186:187], v26 offset:50176
    v_mfma_f32_16x16x32_bf16 v[120:123], a[76:79], a[120:123], v[120:123]
    ds_read_b128 a[152:155], v19 offset:12288
    v_mfma_f32_16x16x32_bf16 v[116:119], a[76:79], a[116:119], v[116:119]
    ds_read_b64_tr_b16 a[188:189], v27 offset:49152
    v_mfma_f32_16x16x32_bf16 v[112:115], a[76:79], a[112:115], v[112:115]
    buffer_load_dwordx4 v15, s[48:51], s66 offen offset:3072 lds
    v_mfma_f32_16x16x32_bf16 v[108:111], a[76:79], a[108:111], v[108:111]
    ds_read_b64_tr_b16 a[190:191], v27 offset:50176
    v_mfma_f32_16x16x32_bf16 v[104:107], a[76:79], a[104:107], v[104:107]
    ds_read_b128 a[156:159], v19 offset:14336
    v_mfma_f32_16x16x32_bf16 v[100:103], a[76:79], a[100:103], v[100:103]
    v_add_u32 v18, 98304, v16
    v_add_u32 v19, 98304, v17
    v_mfma_f32_16x16x32_bf16 v[96:99], a[76:79], a[96:99], v[96:99]
    v_mfma_f32_16x16x32_bf16 v[192:195], a[80:83], a[96:99], v[192:195]
    s_add_u32 m0, s65, 135168
    s_mov_b32 s67, 640
    v_mfma_f32_16x16x32_bf16 v[196:199], a[80:83], a[100:103], v[196:199]
    buffer_load_dwordx4 v8, s[44:47], s67 offen offset:0 lds
    v_mfma_f32_16x16x32_bf16 v[200:203], a[80:83], a[104:107], v[200:203]
    v_mfma_f32_16x16x32_bf16 v[204:207], a[80:83], a[108:111], v[204:207]
    v_mfma_f32_16x16x32_bf16 v[208:211], a[80:83], a[112:115], v[208:211]
    v_mfma_f32_16x16x32_bf16 v[212:215], a[80:83], a[116:119], v[212:215]
    v_mfma_f32_16x16x32_bf16 v[216:219], a[80:83], a[120:123], v[216:219]
    v_mfma_f32_16x16x32_bf16 v[220:223], a[80:83], a[124:127], v[220:223]
    buffer_load_dwordx4 v9, s[44:47], s67 offen offset:1024 lds
    v_mfma_f32_16x16x32_bf16 a[220:223], a[84:87], a[124:127], a[220:223]
    v_mfma_f32_16x16x32_bf16 a[216:219], a[84:87], a[120:123], a[216:219]
    v_mfma_f32_16x16x32_bf16 a[212:215], a[84:87], a[116:119], a[212:215]
    v_mfma_f32_16x16x32_bf16 a[208:211], a[84:87], a[112:115], a[208:211]
    v_mfma_f32_16x16x32_bf16 a[204:207], a[84:87], a[108:111], a[204:207]
    v_mfma_f32_16x16x32_bf16 a[200:203], a[84:87], a[104:107], a[200:203]
    buffer_load_dwordx4 v10, s[44:47], s67 offen offset:2048 lds
    v_mfma_f32_16x16x32_bf16 a[196:199], a[84:87], a[100:103], a[196:199]
    v_mfma_f32_16x16x32_bf16 a[192:195], a[84:87], a[96:99], a[192:195]
    v_mfma_f32_16x16x32_bf16 v[224:227], a[88:91], a[96:99], v[224:227]
    v_mfma_f32_16x16x32_bf16 v[228:231], a[88:91], a[100:103], v[228:231]
    v_mfma_f32_16x16x32_bf16 v[232:235], a[88:91], a[104:107], v[232:235]
    v_mfma_f32_16x16x32_bf16 v[236:239], a[88:91], a[108:111], v[236:239]
    buffer_load_dwordx4 v11, s[44:47], s67 offen offset:3072 lds
    v_mfma_f32_16x16x32_bf16 v[240:243], a[88:91], a[112:115], v[240:243]
    v_mfma_f32_16x16x32_bf16 v[244:247], a[88:91], a[116:119], v[244:247]
    v_mfma_f32_16x16x32_bf16 v[248:251], a[88:91], a[120:123], v[248:251]
    v_mfma_f32_16x16x32_bf16 v[252:255], a[88:91], a[124:127], v[252:255]
    v_mfma_f32_16x16x32_bf16 a[252:255], a[92:95], a[124:127], a[252:255]
    v_mfma_f32_16x16x32_bf16 a[248:251], a[92:95], a[120:123], a[248:251]
    v_mfma_f32_16x16x32_bf16 a[244:247], a[92:95], a[116:119], a[244:247]
    v_mfma_f32_16x16x32_bf16 a[240:243], a[92:95], a[112:115], a[240:243]
    v_mfma_f32_16x16x32_bf16 a[236:239], a[92:95], a[108:111], a[236:239]
    v_mfma_f32_16x16x32_bf16 a[232:235], a[92:95], a[104:107], a[232:235]
    v_mfma_f32_16x16x32_bf16 a[228:231], a[92:95], a[100:103], a[228:231]
    s_nop 0
    s_waitcnt lgkmcnt(0)
    v_mfma_f32_16x16x32_bf16 a[224:227], a[92:95], a[96:99], a[224:227]
    v_mfma_f32_16x16x32_bf16 v[128:131], a[128:131], a[160:163], v[128:131]
    s_waitcnt vmcnt(17)
    s_barrier
    v_mfma_f32_16x16x32_bf16 v[132:135], a[128:131], a[164:167], v[132:135]
    ds_read_b64_tr_b16 a[96:97], v20 offset:0
    s_cmp_lg_u32 s4, 0
    s_cbranch_scc1 L_sigxn_1
    v_cmp_ne_u32 vcc, 0, v3
    s_cmp_eq_u64 vcc, -1
    s_cbranch_scc0 L_pollz_1
L_pollz_1_ret:
    s_lshr_b32 s10, s2, 4
    s_lshl_b32 s10, s10, 8
    s_and_b32 s11, s2, 15
    s_lshl_b32 s11, s11, 2
    s_add_u32 s10, s10, s11
    s_add_u32 s10, s10, 79691776
    s_mov_b64 exec, 1
    v_mov_b32_e64 v3, 1
    buffer_store_dword v3, off, s[52:55], s10 sc1
    s_mov_b64 exec, -1
L_sigxn_1:
    v_mfma_f32_16x16x32_bf16 v[136:139], a[128:131], a[168:171], v[136:139]
    s_add_u32 s90, s90, 524288
    ds_read_b64_tr_b16 a[98:99], v20 offset:1024
    v_mfma_f32_16x16x32_bf16 v[140:143], a[128:131], a[172:175], v[140:143]
    buffer_load_dword v36, v39, s[48:51], s90 offen
    v_mfma_f32_16x16x32_bf16 v[144:147], a[128:131], a[176:179], v[144:147]
    ds_read_b128 a[64:67], v18 offset:0
    v_mfma_f32_16x16x32_bf16 v[148:151], a[128:131], a[180:183], v[148:151]
    ds_read_b64_tr_b16 a[100:101], v21 offset:0
    v_mfma_f32_16x16x32_bf16 v[152:155], a[128:131], a[184:187], v[152:155]
    ds_read_b64_tr_b16 a[102:103], v21 offset:1024
    v_mfma_f32_16x16x32_bf16 v[156:159], a[128:131], a[188:191], v[156:159]
    ds_read_b128 a[68:71], v18 offset:2048
    v_mfma_f32_16x16x32_bf16 v[92:95], a[132:135], a[188:191], v[92:95]
    s_add_u32 m0, s64, 49152
    s_mov_b32 s66, 2883584
    ds_read_b64_tr_b16 a[104:105], v22 offset:0
    v_mfma_f32_16x16x32_bf16 v[88:91], a[132:135], a[184:187], v[88:91]
    buffer_load_dwordx4 v12, s[48:51], s66 offen offset:0 lds
    v_mfma_f32_16x16x32_bf16 v[84:87], a[132:135], a[180:183], v[84:87]
    ds_read_b64_tr_b16 a[106:107], v22 offset:1024
    v_mfma_f32_16x16x32_bf16 v[80:83], a[132:135], a[176:179], v[80:83]
    ds_read_b128 a[72:75], v18 offset:4096
    v_mfma_f32_16x16x32_bf16 v[76:79], a[132:135], a[172:175], v[76:79]
    ds_read_b64_tr_b16 a[108:109], v23 offset:0
    v_mfma_f32_16x16x32_bf16 v[72:75], a[132:135], a[168:171], v[72:75]
    ds_read_b64_tr_b16 a[110:111], v23 offset:1024
    v_mfma_f32_16x16x32_bf16 v[68:71], a[132:135], a[164:167], v[68:71]
    ds_read_b128 a[76:79], v18 offset:6144
    v_mfma_f32_16x16x32_bf16 v[64:67], a[132:135], a[160:163], v[64:67]
    buffer_load_dwordx4 v13, s[48:51], s66 offen offset:1024 lds
    v_mfma_f32_16x16x32_bf16 v[160:163], a[136:139], a[160:163], v[160:163]
    ds_read_b64_tr_b16 a[112:113], v24 offset:0
    v_mfma_f32_16x16x32_bf16 v[164:167], a[136:139], a[164:167], v[164:167]
    ds_read_b64_tr_b16 a[114:115], v24 offset:1024
    v_mfma_f32_16x16x32_bf16 v[168:171], a[136:139], a[168:171], v[168:171]
    ds_read_b128 a[80:83], v18 offset:8192
    v_mfma_f32_16x16x32_bf16 v[172:175], a[136:139], a[172:175], v[172:175]
    ds_read_b64_tr_b16 a[116:117], v25 offset:0
    v_mfma_f32_16x16x32_bf16 v[176:179], a[136:139], a[176:179], v[176:179]
    ds_read_b64_tr_b16 a[118:119], v25 offset:1024
    v_mfma_f32_16x16x32_bf16 v[180:183], a[136:139], a[180:183], v[180:183]
    buffer_load_dwordx4 v14, s[48:51], s66 offen offset:2048 lds
    v_mfma_f32_16x16x32_bf16 v[184:187], a[136:139], a[184:187], v[184:187]
    ds_read_b128 a[84:87], v18 offset:10240
    v_mfma_f32_16x16x32_bf16 v[188:191], a[136:139], a[188:191], v[188:191]
    ds_read_b64_tr_b16 a[120:121], v26 offset:0
    v_mfma_f32_16x16x32_bf16 v[124:127], a[140:143], a[188:191], v[124:127]
    ds_read_b64_tr_b16 a[122:123], v26 offset:1024
    v_mfma_f32_16x16x32_bf16 v[120:123], a[140:143], a[184:187], v[120:123]
    ds_read_b128 a[88:91], v18 offset:12288
    v_mfma_f32_16x16x32_bf16 v[116:119], a[140:143], a[180:183], v[116:119]
    ds_read_b64_tr_b16 a[124:125], v27 offset:0
    v_mfma_f32_16x16x32_bf16 v[112:115], a[140:143], a[176:179], v[112:115]
    buffer_load_dwordx4 v15, s[48:51], s66 offen offset:3072 lds
    v_mfma_f32_16x16x32_bf16 v[108:111], a[140:143], a[172:175], v[108:111]
    ds_read_b64_tr_b16 a[126:127], v27 offset:1024
    v_mfma_f32_16x16x32_bf16 v[104:107], a[140:143], a[168:171], v[104:107]
    ds_read_b128 a[92:95], v18 offset:14336
    v_mfma_f32_16x16x32_bf16 v[100:103], a[140:143], a[164:167], v[100:103]
    v_mfma_f32_16x16x32_bf16 v[96:99], a[140:143], a[160:163], v[96:99]
    v_mfma_f32_16x16x32_bf16 v[192:195], a[144:147], a[160:163], v[192:195]
    s_add_u32 m0, s65, 65536
    s_mov_b32 s67, 768
    v_mfma_f32_16x16x32_bf16 v[196:199], a[144:147], a[164:167], v[196:199]
    buffer_load_dwordx4 v4, s[44:47], s67 offen offset:0 lds
    v_mfma_f32_16x16x32_bf16 v[200:203], a[144:147], a[168:171], v[200:203]
    v_mfma_f32_16x16x32_bf16 v[204:207], a[144:147], a[172:175], v[204:207]
    v_mfma_f32_16x16x32_bf16 v[208:211], a[144:147], a[176:179], v[208:211]
    v_mfma_f32_16x16x32_bf16 v[212:215], a[144:147], a[180:183], v[212:215]
    v_mfma_f32_16x16x32_bf16 v[216:219], a[144:147], a[184:187], v[216:219]
    v_mfma_f32_16x16x32_bf16 v[220:223], a[144:147], a[188:191], v[220:223]
    buffer_load_dwordx4 v5, s[44:47], s67 offen offset:1024 lds
    v_mfma_f32_16x16x32_bf16 a[220:223], a[148:151], a[188:191], a[220:223]
    v_mfma_f32_16x16x32_bf16 a[216:219], a[148:151], a[184:187], a[216:219]
    v_mfma_f32_16x16x32_bf16 a[212:215], a[148:151], a[180:183], a[212:215]
    v_mfma_f32_16x16x32_bf16 a[208:211], a[148:151], a[176:179], a[208:211]
    v_mfma_f32_16x16x32_bf16 a[204:207], a[148:151], a[172:175], a[204:207]
    v_mfma_f32_16x16x32_bf16 a[200:203], a[148:151], a[168:171], a[200:203]
    buffer_load_dwordx4 v6, s[44:47], s67 offen offset:2048 lds
    v_mfma_f32_16x16x32_bf16 a[196:199], a[148:151], a[164:167], a[196:199]
    v_mfma_f32_16x16x32_bf16 a[192:195], a[148:151], a[160:163], a[192:195]
    v_mfma_f32_16x16x32_bf16 v[224:227], a[152:155], a[160:163], v[224:227]
    v_mfma_f32_16x16x32_bf16 v[228:231], a[152:155], a[164:167], v[228:231]
    v_mfma_f32_16x16x32_bf16 v[232:235], a[152:155], a[168:171], v[232:235]
    v_mfma_f32_16x16x32_bf16 v[236:239], a[152:155], a[172:175], v[236:239]
    buffer_load_dwordx4 v7, s[44:47], s67 offen offset:3072 lds
    v_mfma_f32_16x16x32_bf16 v[240:243], a[152:155], a[176:179], v[240:243]
    v_mfma_f32_16x16x32_bf16 v[244:247], a[152:155], a[180:183], v[244:247]
    v_mfma_f32_16x16x32_bf16 v[248:251], a[152:155], a[184:187], v[248:251]
    v_mfma_f32_16x16x32_bf16 v[252:255], a[152:155], a[188:191], v[252:255]
    v_mfma_f32_16x16x32_bf16 a[252:255], a[156:159], a[188:191], a[252:255]
    v_mfma_f32_16x16x32_bf16 a[248:251], a[156:159], a[184:187], a[248:251]
    v_mfma_f32_16x16x32_bf16 a[244:247], a[156:159], a[180:183], a[244:247]
    v_mfma_f32_16x16x32_bf16 a[240:243], a[156:159], a[176:179], a[240:243]
    v_mfma_f32_16x16x32_bf16 a[236:239], a[156:159], a[172:175], a[236:239]
    v_mfma_f32_16x16x32_bf16 a[232:235], a[156:159], a[168:171], a[232:235]
    v_mfma_f32_16x16x32_bf16 a[228:231], a[156:159], a[164:167], a[228:231]
    s_nop 0
    s_waitcnt lgkmcnt(0)
    v_mfma_f32_16x16x32_bf16 a[224:227], a[156:159], a[160:163], a[224:227]
    v_mfma_f32_16x16x32_bf16 v[128:131], a[64:67], a[96:99], v[128:131]
    s_waitcnt vmcnt(22)
    s_barrier
    v_mfma_f32_16x16x32_bf16 v[132:135], a[64:67], a[100:103], v[132:135]
    ds_read_b64_tr_b16 a[160:161], v20 offset:16384
    v_mfma_f32_16x16x32_bf16 v[136:139], a[64:67], a[104:107], v[136:139]
    s_nop 0
    s_add_u32 m0, s64, 0
    s_mov_b32 s66, 3145728
    ds_read_b64_tr_b16 a[162:163], v20 offset:17408
    v_mfma_f32_16x16x32_bf16 v[140:143], a[64:67], a[108:111], v[140:143]
    buffer_load_dwordx4 v12, s[48:51], s66 offen offset:0 lds
    v_mfma_f32_16x16x32_bf16 v[144:147], a[64:67], a[112:115], v[144:147]
    ds_read_b128 a[128:131], v19 offset:0
    v_mfma_f32_16x16x32_bf16 v[148:151], a[64:67], a[116:119], v[148:151]
    ds_read_b64_tr_b16 a[164:165], v21 offset:16384
    v_mfma_f32_16x16x32_bf16 v[152:155], a[64:67], a[120:123], v[152:155]
    ds_read_b64_tr_b16 a[166:167], v21 offset:17408
    v_mfma_f32_16x16x32_bf16 v[156:159], a[64:67], a[124:127], v[156:159]
    ds_read_b128 a[132:135], v19 offset:2048
    v_mfma_f32_16x16x32_bf16 v[92:95], a[68:71], a[124:127], v[92:95]
    ds_read_b64_tr_b16 a[168:169], v22 offset:16384
    v_mfma_f32_16x16x32_bf16 v[88:91], a[68:71], a[120:123], v[88:91]
    buffer_load_dwordx4 v13, s[48:51], s66 offen offset:1024 lds
    v_mfma_f32_16x16x32_bf16 v[84:87], a[68:71], a[116:119], v[84:87]
    ds_read_b64_tr_b16 a[170:171], v22 offset:17408
    v_mfma_f32_16x16x32_bf16 v[80:83], a[68:71], a[112:115], v[80:83]
    ds_read_b128 a[136:139], v19 offset:4096
    v_mfma_f32_16x16x32_bf16 v[76:79], a[68:71], a[108:111], v[76:79]
    ds_read_b64_tr_b16 a[172:173], v23 offset:16384
    v_mfma_f32_16x16x32_bf16 v[72:75], a[68:71], a[104:107], v[72:75]
    ds_read_b64_tr_b16 a[174:175], v23 offset:17408
    v_mfma_f32_16x16x32_bf16 v[68:71], a[68:71], a[100:103], v[68:71]
    ds_read_b128 a[140:143], v19 offset:6144
    v_mfma_f32_16x16x32_bf16 v[64:67], a[68:71], a[96:99], v[64:67]
    buffer_load_dwordx4 v14, s[48:51], s66 offen offset:2048 lds
    v_mfma_f32_16x16x32_bf16 v[160:163], a[72:75], a[96:99], v[160:163]
    ds_read_b64_tr_b16 a[176:177], v24 offset:16384
    v_mfma_f32_16x16x32_bf16 v[164:167], a[72:75], a[100:103], v[164:167]
    ds_read_b64_tr_b16 a[178:179], v24 offset:17408
    v_mfma_f32_16x16x32_bf16 v[168:171], a[72:75], a[104:107], v[168:171]
    ds_read_b128 a[144:147], v19 offset:8192
    v_mfma_f32_16x16x32_bf16 v[172:175], a[72:75], a[108:111], v[172:175]
    ds_read_b64_tr_b16 a[180:181], v25 offset:16384
    v_mfma_f32_16x16x32_bf16 v[176:179], a[72:75], a[112:115], v[176:179]
    ds_read_b64_tr_b16 a[182:183], v25 offset:17408
    v_mfma_f32_16x16x32_bf16 v[180:183], a[72:75], a[116:119], v[180:183]
    buffer_load_dwordx4 v15, s[48:51], s66 offen offset:3072 lds
    v_mfma_f32_16x16x32_bf16 v[184:187], a[72:75], a[120:123], v[184:187]
    ds_read_b128 a[148:151], v19 offset:10240
    v_mfma_f32_16x16x32_bf16 v[188:191], a[72:75], a[124:127], v[188:191]
    ds_read_b64_tr_b16 a[184:185], v26 offset:16384
    v_mfma_f32_16x16x32_bf16 v[124:127], a[76:79], a[124:127], v[124:127]
    ds_read_b64_tr_b16 a[186:187], v26 offset:17408
    v_mfma_f32_16x16x32_bf16 v[120:123], a[76:79], a[120:123], v[120:123]
    ds_read_b128 a[152:155], v19 offset:12288
    v_mfma_f32_16x16x32_bf16 v[116:119], a[76:79], a[116:119], v[116:119]
    s_add_u32 m0, s65, 69632
    s_mov_b32 s67, 768
    ds_read_b64_tr_b16 a[188:189], v27 offset:16384
    v_mfma_f32_16x16x32_bf16 v[112:115], a[76:79], a[112:115], v[112:115]
    buffer_load_dwordx4 v8, s[44:47], s67 offen offset:0 lds
    v_mfma_f32_16x16x32_bf16 v[108:111], a[76:79], a[108:111], v[108:111]
    ds_read_b64_tr_b16 a[190:191], v27 offset:17408
    v_mfma_f32_16x16x32_bf16 v[104:107], a[76:79], a[104:107], v[104:107]
    ds_read_b128 a[156:159], v19 offset:14336
    v_mfma_f32_16x16x32_bf16 v[100:103], a[76:79], a[100:103], v[100:103]
    v_add_u32 v18, 131072, v16
    v_add_u32 v19, 131072, v17
    v_mfma_f32_16x16x32_bf16 v[96:99], a[76:79], a[96:99], v[96:99]
    v_mfma_f32_16x16x32_bf16 v[192:195], a[80:83], a[96:99], v[192:195]
    v_mfma_f32_16x16x32_bf16 v[196:199], a[80:83], a[100:103], v[196:199]
    buffer_load_dwordx4 v9, s[44:47], s67 offen offset:1024 lds
    v_mfma_f32_16x16x32_bf16 v[200:203], a[80:83], a[104:107], v[200:203]
    v_mfma_f32_16x16x32_bf16 v[204:207], a[80:83], a[108:111], v[204:207]
    v_mfma_f32_16x16x32_bf16 v[208:211], a[80:83], a[112:115], v[208:211]
    v_mfma_f32_16x16x32_bf16 v[212:215], a[80:83], a[116:119], v[212:215]
    v_mfma_f32_16x16x32_bf16 v[216:219], a[80:83], a[120:123], v[216:219]
    v_mfma_f32_16x16x32_bf16 v[220:223], a[80:83], a[124:127], v[220:223]
    buffer_load_dwordx4 v10, s[44:47], s67 offen offset:2048 lds
    v_mfma_f32_16x16x32_bf16 a[220:223], a[84:87], a[124:127], a[220:223]
    v_mfma_f32_16x16x32_bf16 a[216:219], a[84:87], a[120:123], a[216:219]
    v_mfma_f32_16x16x32_bf16 a[212:215], a[84:87], a[116:119], a[212:215]
    v_mfma_f32_16x16x32_bf16 a[208:211], a[84:87], a[112:115], a[208:211]
    v_mfma_f32_16x16x32_bf16 a[204:207], a[84:87], a[108:111], a[204:207]
    v_mfma_f32_16x16x32_bf16 a[200:203], a[84:87], a[104:107], a[200:203]
    buffer_load_dwordx4 v11, s[44:47], s67 offen offset:3072 lds
    v_mfma_f32_16x16x32_bf16 a[196:199], a[84:87], a[100:103], a[196:199]
    v_mfma_f32_16x16x32_bf16 a[192:195], a[84:87], a[96:99], a[192:195]
    v_mfma_f32_16x16x32_bf16 v[224:227], a[88:91], a[96:99], v[224:227]
    v_mfma_f32_16x16x32_bf16 v[228:231], a[88:91], a[100:103], v[228:231]
    v_mfma_f32_16x16x32_bf16 v[232:235], a[88:91], a[104:107], v[232:235]
    v_mfma_f32_16x16x32_bf16 v[236:239], a[88:91], a[108:111], v[236:239]
    v_mfma_f32_16x16x32_bf16 v[240:243], a[88:91], a[112:115], v[240:243]
    v_mfma_f32_16x16x32_bf16 v[244:247], a[88:91], a[116:119], v[244:247]
    v_mfma_f32_16x16x32_bf16 v[248:251], a[88:91], a[120:123], v[248:251]
    v_mfma_f32_16x16x32_bf16 v[252:255], a[88:91], a[124:127], v[252:255]
    v_mfma_f32_16x16x32_bf16 a[252:255], a[92:95], a[124:127], a[252:255]
    v_mfma_f32_16x16x32_bf16 a[248:251], a[92:95], a[120:123], a[248:251]
    v_lshlrev_b32 v39, 7, v1
    v_lshrrev_b32 v38, 5, v1
    v_mfma_f32_16x16x32_bf16 a[244:247], a[92:95], a[116:119], a[244:247]
    v_lshl_add_u32 v38, v38, 28, v39
    v_lshrrev_b32_e64 v37, 4, v1
    v_mfma_f32_16x16x32_bf16 a[240:243], a[92:95], a[112:115], a[240:243]
    v_lshl_add_u32 v39, v37, 28, v39
    v_mfma_f32_16x16x32_bf16 a[236:239], a[92:95], a[108:111], a[236:239]
    s_nop 0
    s_lshl_b32 s72, s2, 2
    s_add_u32 s72, s72, s4
    s_lshl_b32 s73, s72, 11
    v_mfma_f32_16x16x32_bf16 a[232:235], a[92:95], a[104:107], a[232:235]
    s_nop 0
    s_lshl_b32 s72, s72, 12
    v_mfma_f32_16x16x32_bf16 a[228:231], a[92:95], a[100:103], a[228:231]
    s_nop 0
    s_waitcnt lgkmcnt(0)
    v_mfma_f32_16x16x32_bf16 a[224:227], a[92:95], a[96:99], a[224:227]
    v_mfma_f32_16x16x32_bf16 v[128:131], a[128:131], a[160:163], v[128:131]
    s_waitcnt vmcnt(17)
    s_barrier
    v_mfma_f32_16x16x32_bf16 v[132:135], a[128:131], a[164:167], v[132:135]
    ds_read_b64_tr_b16 a[96:97], v20 offset:32768
    v_mfma_f32_16x16x32_bf16 v[136:139], a[128:131], a[168:171], v[136:139]
    s_add_u32 m0, s64, 16384
    s_mov_b32 s66, 3407872
    ds_read_b64_tr_b16 a[98:99], v20 offset:33792
    v_mfma_f32_16x16x32_bf16 v[140:143], a[128:131], a[172:175], v[140:143]
    buffer_load_dwordx4 v12, s[48:51], s66 offen offset:0 lds
    v_mfma_f32_16x16x32_bf16 v[144:147], a[128:131], a[176:179], v[144:147]
    ds_read_b128 a[64:67], v18 offset:0
    v_mfma_f32_16x16x32_bf16 v[148:151], a[128:131], a[180:183], v[148:151]
    ds_read_b64_tr_b16 a[100:101], v21 offset:32768
    v_mfma_f32_16x16x32_bf16 v[152:155], a[128:131], a[184:187], v[152:155]
    buffer_load_dwordx4 v13, s[48:51], s66 offen offset:1024 lds
    v_mfma_f32_16x16x32_bf16 v[156:159], a[128:131], a[188:191], v[156:159]
    ds_read_b64_tr_b16 a[102:103], v21 offset:33792
    v_mfma_f32_16x16x32_bf16 v[92:95], a[132:135], a[188:191], v[92:95]
    ds_read_b128 a[68:71], v18 offset:2048
    v_mfma_f32_16x16x32_bf16 v[88:91], a[132:135], a[184:187], v[88:91]
    buffer_load_dwordx4 v14, s[48:51], s66 offen offset:2048 lds
    v_mfma_f32_16x16x32_bf16 v[84:87], a[132:135], a[180:183], v[84:87]
    ds_read_b64_tr_b16 a[104:105], v22 offset:32768
    v_mfma_f32_16x16x32_bf16 v[80:83], a[132:135], a[176:179], v[80:83]
    ds_read_b64_tr_b16 a[106:107], v22 offset:33792
    v_mfma_f32_16x16x32_bf16 v[76:79], a[132:135], a[172:175], v[76:79]
    buffer_load_dwordx4 v15, s[48:51], s66 offen offset:3072 lds
    v_mfma_f32_16x16x32_bf16 v[72:75], a[132:135], a[168:171], v[72:75]
    ds_read_b128 a[72:75], v18 offset:4096
    v_mfma_f32_16x16x32_bf16 v[68:71], a[132:135], a[164:167], v[68:71]
    s_add_u32 m0, s65, 98304
    s_mov_b32 s67, 896
    ds_read_b64_tr_b16 a[108:109], v23 offset:32768
    v_mfma_f32_16x16x32_bf16 v[64:67], a[132:135], a[160:163], v[64:67]
    buffer_load_dwordx4 v4, s[44:47], s67 offen offset:0 lds
    v_mfma_f32_16x16x32_bf16 v[160:163], a[136:139], a[160:163], v[160:163]
    ds_read_b64_tr_b16 a[110:111], v23 offset:33792
    v_mfma_f32_16x16x32_bf16 v[164:167], a[136:139], a[164:167], v[164:167]
    ds_read_b128 a[76:79], v18 offset:6144
    v_mfma_f32_16x16x32_bf16 v[168:171], a[136:139], a[168:171], v[168:171]
    buffer_load_dwordx4 v5, s[44:47], s67 offen offset:1024 lds
    v_mfma_f32_16x16x32_bf16 v[172:175], a[136:139], a[172:175], v[172:175]
    ds_read_b64_tr_b16 a[112:113], v24 offset:32768
    v_mfma_f32_16x16x32_bf16 v[176:179], a[136:139], a[176:179], v[176:179]
    ds_read_b64_tr_b16 a[114:115], v24 offset:33792
    v_mfma_f32_16x16x32_bf16 v[180:183], a[136:139], a[180:183], v[180:183]
    buffer_load_dwordx4 v6, s[44:47], s67 offen offset:2048 lds
    v_mfma_f32_16x16x32_bf16 v[184:187], a[136:139], a[184:187], v[184:187]
    ds_read_b128 a[80:83], v18 offset:8192
    v_mfma_f32_16x16x32_bf16 v[188:191], a[136:139], a[188:191], v[188:191]
    ds_read_b64_tr_b16 a[116:117], v25 offset:32768
    v_mfma_f32_16x16x32_bf16 v[124:127], a[140:143], a[188:191], v[124:127]
    buffer_load_dwordx4 v7, s[44:47], s67 offen offset:3072 lds
    v_mfma_f32_16x16x32_bf16 v[120:123], a[140:143], a[184:187], v[120:123]
    ds_read_b64_tr_b16 a[118:119], v25 offset:33792
    v_mfma_f32_16x16x32_bf16 v[116:119], a[140:143], a[180:183], v[116:119]
    s_mov_b32 s60, s20
    s_mov_b32 s61, s21
    s_mov_b32 s62, 4194304
    ds_read_b128 a[84:87], v18 offset:10240
    v_mfma_f32_16x16x32_bf16 v[112:115], a[140:143], a[176:179], v[112:115]
    buffer_load_dword v36, v38, s[60:63], s72 offen
    v_mfma_f32_16x16x32_bf16 v[108:111], a[140:143], a[172:175], v[108:111]
    ds_read_b64_tr_b16 a[120:121], v26 offset:32768
    v_mfma_f32_16x16x32_bf16 v[104:107], a[140:143], a[168:171], v[104:107]
    s_mov_b32 s92, s30
    s_mov_b32 s93, s31
    s_mov_b32 s94, 1409024
    ds_read_b64_tr_b16 a[122:123], v26 offset:33792
    v_mfma_f32_16x16x32_bf16 v[100:103], a[140:143], a[164:167], v[100:103]
    buffer_load_dword v36, v39, s[92:95], s73 offen
    v_mfma_f32_16x16x32_bf16 v[96:99], a[140:143], a[160:163], v[96:99]
    ds_read_b128 a[88:91], v18 offset:12288
    v_mfma_f32_16x16x32_bf16 v[192:195], a[144:147], a[160:163], v[192:195]
    ds_read_b64_tr_b16 a[124:125], v27 offset:32768
    v_mfma_f32_16x16x32_bf16 v[196:199], a[144:147], a[164:167], v[196:199]
    ds_read_b64_tr_b16 a[126:127], v27 offset:33792
    v_mfma_f32_16x16x32_bf16 v[200:203], a[144:147], a[168:171], v[200:203]
    ds_read_b128 a[92:95], v18 offset:14336
    v_mfma_f32_16x16x32_bf16 v[204:207], a[144:147], a[172:175], v[204:207]
    v_mfma_f32_16x16x32_bf16 v[208:211], a[144:147], a[176:179], v[208:211]
    v_mfma_f32_16x16x32_bf16 v[212:215], a[144:147], a[180:183], v[212:215]
    v_mfma_f32_16x16x32_bf16 v[216:219], a[144:147], a[184:187], v[216:219]
    v_mfma_f32_16x16x32_bf16 v[220:223], a[144:147], a[188:191], v[220:223]
    v_mfma_f32_16x16x32_bf16 a[220:223], a[148:151], a[188:191], a[220:223]
    v_mfma_f32_16x16x32_bf16 a[216:219], a[148:151], a[184:187], a[216:219]
    v_mfma_f32_16x16x32_bf16 a[212:215], a[148:151], a[180:183], a[212:215]
    v_mfma_f32_16x16x32_bf16 a[208:211], a[148:151], a[176:179], a[208:211]
    v_mfma_f32_16x16x32_bf16 a[204:207], a[148:151], a[172:175], a[204:207]
    v_mfma_f32_16x16x32_bf16 a[200:203], a[148:151], a[168:171], a[200:203]
    v_mfma_f32_16x16x32_bf16 a[196:199], a[148:151], a[164:167], a[196:199]
    v_mfma_f32_16x16x32_bf16 a[192:195], a[148:151], a[160:163], a[192:195]
    v_mfma_f32_16x16x32_bf16 v[224:227], a[152:155], a[160:163], v[224:227]
    v_mfma_f32_16x16x32_bf16 v[228:231], a[152:155], a[164:167], v[228:231]
    v_mfma_f32_16x16x32_bf16 v[232:235], a[152:155], a[168:171], v[232:235]
    v_mfma_f32_16x16x32_bf16 v[236:239], a[152:155], a[172:175], v[236:239]
    v_mfma_f32_16x16x32_bf16 v[240:243], a[152:155], a[176:179], v[240:243]
    v_mfma_f32_16x16x32_bf16 v[244:247], a[152:155], a[180:183], v[244:247]
    v_mfma_f32_16x16x32_bf16 v[248:251], a[152:155], a[184:187], v[248:251]
    v_mfma_f32_16x16x32_bf16 v[252:255], a[152:155], a[188:191], v[252:255]
    v_mfma_f32_16x16x32_bf16 a[252:255], a[156:159], a[188:191], a[252:255]
    v_mfma_f32_16x16x32_bf16 a[248:251], a[156:159], a[184:187], a[248:251]
    v_mfma_f32_16x16x32_bf16 a[244:247], a[156:159], a[180:183], a[244:247]
    v_mfma_f32_16x16x32_bf16 a[240:243], a[156:159], a[176:179], a[240:243]
    v_mfma_f32_16x16x32_bf16 a[236:239], a[156:159], a[172:175], a[236:239]
    v_mfma_f32_16x16x32_bf16 a[232:235], a[156:159], a[168:171], a[232:235]
    v_mfma_f32_16x16x32_bf16 a[228:231], a[156:159], a[164:167], a[228:231]
    s_nop 0
    s_waitcnt lgkmcnt(0)
    v_mfma_f32_16x16x32_bf16 a[224:227], a[156:159], a[160:163], a[224:227]
    v_mfma_f32_16x16x32_bf16 v[128:131], a[64:67], a[96:99], v[128:131]
    s_waitcnt vmcnt(22)
    s_barrier
    v_mfma_f32_16x16x32_bf16 v[132:135], a[64:67], a[100:103], v[132:135]
    ds_read_b64_tr_b16 a[160:161], v20 offset:49152
    v_mfma_f32_16x16x32_bf16 v[136:139], a[64:67], a[104:107], v[136:139]
    s_add_u32 m0, s64, 32768
    s_mov_b32 s66, 3670016
    ds_read_b64_tr_b16 a[162:163], v20 offset:50176
    v_mfma_f32_16x16x32_bf16 v[140:143], a[64:67], a[108:111], v[140:143]
    buffer_load_dwordx4 v12, s[48:51], s66 offen offset:0 lds
    v_mfma_f32_16x16x32_bf16 v[144:147], a[64:67], a[112:115], v[144:147]
    ds_read_b128 a[128:131], v19 offset:0
    v_mfma_f32_16x16x32_bf16 v[148:151], a[64:67], a[116:119], v[148:151]
    ds_read_b64_tr_b16 a[164:165], v21 offset:49152
    v_mfma_f32_16x16x32_bf16 v[152:155], a[64:67], a[120:123], v[152:155]
    ds_read_b64_tr_b16 a[166:167], v21 offset:50176
    v_mfma_f32_16x16x32_bf16 v[156:159], a[64:67], a[124:127], v[156:159]
    ds_read_b128 a[132:135], v19 offset:2048
    v_mfma_f32_16x16x32_bf16 v[92:95], a[68:71], a[124:127], v[92:95]
    ds_read_b64_tr_b16 a[168:169], v22 offset:49152
    v_mfma_f32_16x16x32_bf16 v[88:91], a[68:71], a[120:123], v[88:91]
    buffer_load_dwordx4 v13, s[48:51], s66 offen offset:1024 lds
    v_mfma_f32_16x16x32_bf16 v[84:87], a[68:71], a[116:119], v[84:87]
    ds_read_b64_tr_b16 a[170:171], v22 offset:50176
    v_mfma_f32_16x16x32_bf16 v[80:83], a[68:71], a[112:115], v[80:83]
    ds_read_b128 a[136:139], v19 offset:4096
    v_mfma_f32_16x16x32_bf16 v[76:79], a[68:71], a[108:111], v[76:79]
    ds_read_b64_tr_b16 a[172:173], v23 offset:49152
    v_mfma_f32_16x16x32_bf16 v[72:75], a[68:71], a[104:107], v[72:75]
    ds_read_b64_tr_b16 a[174:175], v23 offset:50176
    v_mfma_f32_16x16x32_bf16 v[68:71], a[68:71], a[100:103], v[68:71]
    ds_read_b128 a[140:143], v19 offset:6144
    v_mfma_f32_16x16x32_bf16 v[64:67], a[68:71], a[96:99], v[64:67]
    buffer_load_dwordx4 v14, s[48:51], s66 offen offset:2048 lds
    v_mfma_f32_16x16x32_bf16 v[160:163], a[72:75], a[96:99], v[160:163]
    ds_read_b64_tr_b16 a[176:177], v24 offset:49152
    v_mfma_f32_16x16x32_bf16 v[164:167], a[72:75], a[100:103], v[164:167]
    ds_read_b64_tr_b16 a[178:179], v24 offset:50176
    v_mfma_f32_16x16x32_bf16 v[168:171], a[72:75], a[104:107], v[168:171]
    ds_read_b128 a[144:147], v19 offset:8192
    v_mfma_f32_16x16x32_bf16 v[172:175], a[72:75], a[108:111], v[172:175]
    ds_read_b64_tr_b16 a[180:181], v25 offset:49152
    v_mfma_f32_16x16x32_bf16 v[176:179], a[72:75], a[112:115], v[176:179]
    ds_read_b64_tr_b16 a[182:183], v25 offset:50176
    v_mfma_f32_16x16x32_bf16 v[180:183], a[72:75], a[116:119], v[180:183]
    buffer_load_dwordx4 v15, s[48:51], s66 offen offset:3072 lds
    v_mfma_f32_16x16x32_bf16 v[184:187], a[72:75], a[120:123], v[184:187]
    ds_read_b128 a[148:151], v19 offset:10240
    v_mfma_f32_16x16x32_bf16 v[188:191], a[72:75], a[124:127], v[188:191]
    ds_read_b64_tr_b16 a[184:185], v26 offset:49152
    v_mfma_f32_16x16x32_bf16 v[124:127], a[76:79], a[124:127], v[124:127]
    ds_read_b64_tr_b16 a[186:187], v26 offset:50176
    v_mfma_f32_16x16x32_bf16 v[120:123], a[76:79], a[120:123], v[120:123]
    ds_read_b128 a[152:155], v19 offset:12288
    v_mfma_f32_16x16x32_bf16 v[116:119], a[76:79], a[116:119], v[116:119]
    s_add_u32 m0, s65, 102400
    s_mov_b32 s67, 896
    ds_read_b64_tr_b16 a[188:189], v27 offset:49152
    v_mfma_f32_16x16x32_bf16 v[112:115], a[76:79], a[112:115], v[112:115]
    buffer_load_dwordx4 v8, s[44:47], s67 offen offset:0 lds
    v_mfma_f32_16x16x32_bf16 v[108:111], a[76:79], a[108:111], v[108:111]
    ds_read_b64_tr_b16 a[190:191], v27 offset:50176
    v_mfma_f32_16x16x32_bf16 v[104:107], a[76:79], a[104:107], v[104:107]
    ds_read_b128 a[156:159], v19 offset:14336
    v_mfma_f32_16x16x32_bf16 v[100:103], a[76:79], a[100:103], v[100:103]
    v_add_u32 v18, 65536, v16
    v_add_u32 v19, 65536, v17
    v_mfma_f32_16x16x32_bf16 v[96:99], a[76:79], a[96:99], v[96:99]
    v_mfma_f32_16x16x32_bf16 v[192:195], a[80:83], a[96:99], v[192:195]
    v_mfma_f32_16x16x32_bf16 v[196:199], a[80:83], a[100:103], v[196:199]
    buffer_load_dwordx4 v9, s[44:47], s67 offen offset:1024 lds
    v_mfma_f32_16x16x32_bf16 v[200:203], a[80:83], a[104:107], v[200:203]
    v_mfma_f32_16x16x32_bf16 v[204:207], a[80:83], a[108:111], v[204:207]
    v_mfma_f32_16x16x32_bf16 v[208:211], a[80:83], a[112:115], v[208:211]
    v_mfma_f32_16x16x32_bf16 v[212:215], a[80:83], a[116:119], v[212:215]
    v_mfma_f32_16x16x32_bf16 v[216:219], a[80:83], a[120:123], v[216:219]
    v_mfma_f32_16x16x32_bf16 v[220:223], a[80:83], a[124:127], v[220:223]
    buffer_load_dwordx4 v10, s[44:47], s67 offen offset:2048 lds
    v_mfma_f32_16x16x32_bf16 a[220:223], a[84:87], a[124:127], a[220:223]
    s_lshr_b32 s8, s74, 17
    s_lshl_b32 s8, s8, 17
    s_and_b32 s9, s5, 3
    v_and_b32 v35, 15, v1
    v_lshlrev_b32_e64 v35, 2, v35
    v_mfma_f32_16x16x32_bf16 a[216:219], a[84:87], a[120:123], a[216:219]
    s_lshl_b32 s9, s9, 15
    s_add_u32 s8, s8, s9
    s_lshr_b32 s9, s4, 1
    v_lshlrev_b32 v37, 7, v1
    v_mfma_f32_16x16x32_bf16 a[212:215], a[84:87], a[116:119], a[212:215]
    s_lshl_b32 s9, s9, 14
    s_add_u32 s8, s8, s9
    s_sub_u32 s15, s8, 4096
    v_mfma_f32_16x16x32_bf16 a[208:211], a[84:87], a[112:115], a[208:211]
    v_mfma_f32_16x16x32_bf16 a[204:207], a[84:87], a[108:111], a[204:207]
    v_mfma_f32_16x16x32_bf16 a[200:203], a[84:87], a[104:107], a[200:203]
    buffer_load_dwordx4 v11, s[44:47], s67 offen offset:3072 lds
    v_mfma_f32_16x16x32_bf16 a[196:199], a[84:87], a[100:103], a[196:199]
    v_mfma_f32_16x16x32_bf16 a[192:195], a[84:87], a[96:99], a[192:195]
    v_mfma_f32_16x16x32_bf16 v[224:227], a[88:91], a[96:99], v[224:227]
    v_mfma_f32_16x16x32_bf16 v[228:231], a[88:91], a[100:103], v[228:231]
    v_mfma_f32_16x16x32_bf16 v[232:235], a[88:91], a[104:107], v[232:235]
    v_mfma_f32_16x16x32_bf16 v[236:239], a[88:91], a[108:111], v[236:239]
    v_mfma_f32_16x16x32_bf16 v[240:243], a[88:91], a[112:115], v[240:243]
    v_mfma_f32_16x16x32_bf16 v[244:247], a[88:91], a[116:119], v[244:247]
    v_mfma_f32_16x16x32_bf16 v[248:251], a[88:91], a[120:123], v[248:251]
    v_mfma_f32_16x16x32_bf16 v[252:255], a[88:91], a[124:127], v[252:255]
    v_mfma_f32_16x16x32_bf16 a[252:255], a[92:95], a[124:127], a[252:255]
    v_mfma_f32_16x16x32_bf16 a[248:251], a[92:95], a[120:123], a[248:251]
    v_mfma_f32_16x16x32_bf16 a[244:247], a[92:95], a[116:119], a[244:247]
    v_mfma_f32_16x16x32_bf16 a[240:243], a[92:95], a[112:115], a[240:243]
    v_mfma_f32_16x16x32_bf16 a[236:239], a[92:95], a[108:111], a[236:239]
    v_mfma_f32_16x16x32_bf16 a[232:235], a[92:95], a[104:107], a[232:235]
    v_mfma_f32_16x16x32_bf16 a[228:231], a[92:95], a[100:103], a[228:231]
    s_nop 0
    s_waitcnt lgkmcnt(0)
    v_mfma_f32_16x16x32_bf16 a[224:227], a[92:95], a[96:99], a[224:227]
    v_mfma_f32_16x16x32_bf16 v[128:131], a[128:131], a[160:163], v[128:131]
    s_waitcnt vmcnt(18)
    s_barrier
    v_mfma_f32_16x16x32_bf16 v[132:135], a[128:131], a[164:167], v[132:135]
    ds_read_b64_tr_b16 a[96:97], v20 offset:0
    v_mfma_f32_16x16x32_bf16 v[136:139], a[128:131], a[168:171], v[136:139]
    ds_read_b64_tr_b16 a[98:99], v20 offset:1024
    v_mfma_f32_16x16x32_bf16 v[140:143], a[128:131], a[172:175], v[140:143]
    buffer_load_dword v3, v35, s[52:55], s78 offen sc1
    v_mfma_f32_16x16x32_bf16 v[144:147], a[128:131], a[176:179], v[144:147]
    ds_read_b128 a[64:67], v18 offset:0
    v_mfma_f32_16x16x32_bf16 v[148:151], a[128:131], a[180:183], v[148:151]
    ds_read_b64_tr_b16 a[100:101], v21 offset:0
    v_mfma_f32_16x16x32_bf16 v[152:155], a[128:131], a[184:187], v[152:155]
    ds_read_b64_tr_b16 a[102:103], v21 offset:1024
    v_mfma_f32_16x16x32_bf16 v[156:159], a[128:131], a[188:191], v[156:159]
    ds_read_b128 a[68:71], v18 offset:2048
    v_mfma_f32_16x16x32_bf16 v[92:95], a[132:135], a[188:191], v[92:95]
    s_add_u32 m0, s64, 49152
    s_mov_b32 s66, 3932160
    ds_read_b64_tr_b16 a[104:105], v22 offset:0
    v_mfma_f32_16x16x32_bf16 v[88:91], a[132:135], a[184:187], v[88:91]
    buffer_load_dwordx4 v12, s[48:51], s66 offen offset:0 lds
    v_mfma_f32_16x16x32_bf16 v[84:87], a[132:135], a[180:183], v[84:87]
    ds_read_b64_tr_b16 a[106:107], v22 offset:1024
    v_mfma_f32_16x16x32_bf16 v[80:83], a[132:135], a[176:179], v[80:83]
    ds_read_b128 a[72:75], v18 offset:4096
    v_mfma_f32_16x16x32_bf16 v[76:79], a[132:135], a[172:175], v[76:79]
    ds_read_b64_tr_b16 a[108:109], v23 offset:0
    v_mfma_f32_16x16x32_bf16 v[72:75], a[132:135], a[168:171], v[72:75]
    ds_read_b64_tr_b16 a[110:111], v23 offset:1024
    v_mfma_f32_16x16x32_bf16 v[68:71], a[132:135], a[164:167], v[68:71]
    ds_read_b128 a[76:79], v18 offset:6144
    v_mfma_f32_16x16x32_bf16 v[64:67], a[132:135], a[160:163], v[64:67]
    buffer_load_dwordx4 v13, s[48:51], s66 offen offset:1024 lds
    v_mfma_f32_16x16x32_bf16 v[160:163], a[136:139], a[160:163], v[160:163]
    ds_read_b64_tr_b16 a[112:113], v24 offset:0
    v_mfma_f32_16x16x32_bf16 v[164:167], a[136:139], a[164:167], v[164:167]
    ds_read_b64_tr_b16 a[114:115], v24 offset:1024
    v_mfma_f32_16x16x32_bf16 v[168:171], a[136:139], a[168:171], v[168:171]
    ds_read_b128 a[80:83], v18 offset:8192
    v_mfma_f32_16x16x32_bf16 v[172:175], a[136:139], a[172:175], v[172:175]
    ds_read_b64_tr_b16 a[116:117], v25 offset:0
    v_mfma_f32_16x16x32_bf16 v[176:179], a[136:139], a[176:179], v[176:179]
    ds_read_b64_tr_b16 a[118:119], v25 offset:1024
    v_mfma_f32_16x16x32_bf16 v[180:183], a[136:139], a[180:183], v[180:183]
    buffer_load_dwordx4 v14, s[48:51], s66 offen offset:2048 lds
    v_mfma_f32_16x16x32_bf16 v[184:187], a[136:139], a[184:187], v[184:187]
    ds_read_b128 a[84:87], v18 offset:10240
    v_mfma_f32_16x16x32_bf16 v[188:191], a[136:139], a[188:191], v[188:191]
    ds_read_b64_tr_b16 a[120:121], v26 offset:0
    v_mfma_f32_16x16x32_bf16 v[124:127], a[140:143], a[188:191], v[124:127]
    s_mov_b32 s44, s20
    s_mov_b32 s45, s21
    ds_read_b64_tr_b16 a[122:123], v26 offset:1024
    v_mfma_f32_16x16x32_bf16 v[120:123], a[140:143], a[184:187], v[120:123]
    s_mov_b32 s46, 4194304
    s_mov_b32 s47, 0x00020000
    ds_read_b128 a[88:91], v18 offset:12288
    v_mfma_f32_16x16x32_bf16 v[116:119], a[140:143], a[180:183], v[116:119]
    s_mov_b32 s60, s30
    s_mov_b32 s61, s31
    ds_read_b64_tr_b16 a[124:125], v27 offset:0
    v_mfma_f32_16x16x32_bf16 v[112:115], a[140:143], a[176:179], v[112:115]
    s_mov_b32 s62, 1409024
    s_mov_b32 s63, 0x00020000
    buffer_load_dwordx4 v15, s[48:51], s66 offen offset:3072 lds
    v_mfma_f32_16x16x32_bf16 v[108:111], a[140:143], a[172:175], v[108:111]
    s_lshl_b32 s71, s4, 11
    s_lshl_b32 s73, s4, 10
    ds_read_b64_tr_b16 a[126:127], v27 offset:1024
    v_mfma_f32_16x16x32_bf16 v[104:107], a[140:143], a[168:171], v[104:107]
    s_lshl_b32 s8, s4, 16
    s_lshl_b32 s9, s5, 8
    ds_read_b128 a[92:95], v18 offset:14336
    v_mfma_f32_16x16x32_bf16 v[100:103], a[140:143], a[164:167], v[100:103]
    s_add_u32 s8, s8, s9
    s_lshl_b32 s9, s7, 2
    v_mfma_f32_16x16x32_bf16 v[96:99], a[140:143], a[160:163], v[96:99]
    s_nop 0
    s_mul_i32 s10, s4, 22016
    s_add_u32 s10, s10, s69
    v_mfma_f32_16x16x32_bf16 v[192:195], a[144:147], a[160:163], v[192:195]
    s_lshl_b32 s11, s7, 1
    s_lshl_b32 s3, s68, 16
    v_mfma_f32_16x16x32_bf16 v[196:199], a[144:147], a[164:167], v[196:199]
    s_add_u32 s66, s74, s3
    s_sub_u32 s67, s74, s3
    v_mfma_f32_16x16x32_bf16 v[200:203], a[144:147], a[168:171], v[200:203]
    s_nop 0
    s_add_u32 s67, s67, 65536
    s_lshr_b32 s15, s4, 1
    v_mfma_f32_16x16x32_bf16 v[204:207], a[144:147], a[172:175], v[204:207]
    s_nop 0
    s_lshl_b32 s15, s15, 10
    s_sub_u32 s13, 3072, s15
    v_mfma_f32_16x16x32_bf16 v[208:211], a[144:147], a[176:179], v[208:211]
    s_lshl_b32 s76, s5, 20
    s_lshl_b32 s3, s6, 17
    v_mfma_f32_16x16x32_bf16 v[212:215], a[144:147], a[180:183], v[212:215]
    s_add_u32 s76, s76, s3
    s_lshr_b32 s3, s4, 1
    v_mfma_f32_16x16x32_bf16 v[216:219], a[144:147], a[184:187], v[216:219]
    s_lshl_b32 s3, s3, 16
    s_add_u32 s76, s76, s3
    v_mfma_f32_16x16x32_bf16 v[220:223], a[144:147], a[188:191], v[220:223]
    s_lshl_b32 s3, s7, 13
    s_add_u32 s76, s76, s3
    v_mfma_f32_16x16x32_bf16 a[220:223], a[148:151], a[188:191], a[220:223]
    s_add_u32 s76, s76, 2097152
    s_sub_u32 s14, 131072, s3
    v_mfma_f32_16x16x32_bf16 a[216:219], a[148:151], a[184:187], a[216:219]
    s_nop 0
    s_lshl_b32 s12, s68, 1
    v_mfma_f32_16x16x32_bf16 a[212:215], a[148:151], a[180:183], a[212:215]
    v_mfma_f32_16x16x32_bf16 a[208:211], a[148:151], a[176:179], a[208:211]
    v_mfma_f32_16x16x32_bf16 a[204:207], a[148:151], a[172:175], a[204:207]
    v_lshrrev_b32 v32, 4, v1
    v_and_b32 v33, 15, v1
    v_mfma_f32_16x16x32_bf16 a[200:203], a[148:151], a[168:171], a[200:203]
    v_or_b32 v34, s9, v32
    v_lshlrev_b32 v34, 1, v34
    v_mfma_f32_16x16x32_bf16 a[196:199], a[148:151], a[164:167], a[196:199]
    v_xor_b32 v34, v34, v33
    v_lshlrev_b32 v34, 4, v34
    v_mfma_f32_16x16x32_bf16 a[192:195], a[148:151], a[160:163], a[192:195]
    v_lshl_add_u32 v34, v32, 13, v34
    v_add_u32_e64 v28, s8, v34
    v_mfma_f32_16x16x32_bf16 v[224:227], a[152:155], a[160:163], v[224:227]
    v_add_u32 v29, 31744, v28
    v_and_b32_e64 v32, 1, v32
    v_mfma_f32_16x16x32_bf16 v[228:231], a[152:155], a[164:167], v[228:231]
    v_or_b32 v32, s11, v32
    v_lshlrev_b32 v32, 1, v32
    v_mfma_f32_16x16x32_bf16 v[232:235], a[152:155], a[168:171], v[232:235]
    v_and_b32 v33, 7, v1
    v_xor_b32 v32, v32, v33
    v_mfma_f32_16x16x32_bf16 v[236:239], a[152:155], a[172:175], v[236:239]
    v_lshrrev_b32_e64 v33, 3, v1
    v_mul_u32_u24 v33, 2752, v33
    v_mfma_f32_16x16x32_bf16 v[240:243], a[152:155], a[176:179], v[240:243]
    v_lshl_add_u32 v33, v32, 4, v33
    v_add_u32_e64 v30, s10, v33
    v_mfma_f32_16x16x32_bf16 v[244:247], a[152:155], a[180:183], v[244:247]
    v_lshrrev_b32_e64 v32, 4, v1
    v_bfe_u32 v33, v1, 2, 2
    v_mfma_f32_16x16x32_bf16 v[248:251], a[152:155], a[184:187], v[248:251]
    v_lshl_add_u32 v32, v32, 3, v33
    v_lshlrev_b32_e64 v32, 7, v32
    v_mfma_f32_16x16x32_bf16 v[252:255], a[152:155], a[188:191], v[252:255]
    v_and_b32_e64 v33, 3, v1
    v_lshl_add_u32 v32, v33, 3, v32
    v_mfma_f32_16x16x32_bf16 a[252:255], a[156:159], a[188:191], a[252:255]
    v_add_u32 v31, 139264, v32
    v_bfe_u32 v34, v1, 3, 2
    v_mfma_f32_16x16x32_bf16 a[248:251], a[156:159], a[184:187], a[248:251]
    v_xor_b32_e64 v34, s12, v34
    v_mfma_f32_16x16x32_bf16 a[244:247], a[156:159], a[180:183], a[244:247]
    v_mfma_f32_16x16x32_bf16 a[240:243], a[156:159], a[176:179], a[240:243]
    v_mfma_f32_16x16x32_bf16 a[236:239], a[156:159], a[172:175], a[236:239]
    v_mfma_f32_16x16x32_bf16 a[232:235], a[156:159], a[168:171], a[232:235]
    v_mfma_f32_16x16x32_bf16 a[228:231], a[156:159], a[164:167], a[228:231]
    s_nop 0
    s_waitcnt lgkmcnt(0)
    v_mfma_f32_16x16x32_bf16 a[224:227], a[156:159], a[160:163], a[224:227]
    v_mfma_f32_16x16x32_bf16 v[128:131], a[64:67], a[96:99], v[128:131]
    s_waitcnt vmcnt(19)
    s_barrier
    v_mfma_f32_16x16x32_bf16 v[132:135], a[64:67], a[100:103], v[132:135]
    ds_read_b64_tr_b16 a[160:161], v20 offset:16384
    v_mfma_f32_16x16x32_bf16 v[136:139], a[64:67], a[104:107], v[136:139]
    s_add_u32 m0, s71, 131072
    s_mov_b32 s72, 0
    ds_read_b64_tr_b16 a[162:163], v20 offset:17408
    s_waitcnt vmcnt(4)
    v_cmp_ne_u32 vcc, 0, v3
    s_cmp_eq_u64 vcc, -1
    s_cbranch_scc0 L_pollxn_1
L_pollxn_1_ret:
    s_nop 0
    v_mfma_f32_16x16x32_bf16 v[140:143], a[64:67], a[108:111], v[140:143]
    buffer_load_dwordx4 v28, s[44:47], s72 offen lds
    v_mfma_f32_16x16x32_bf16 v[144:147], a[64:67], a[112:115], v[144:147]
    ds_read_b128 a[128:131], v19 offset:0
    v_mfma_f32_16x16x32_bf16 v[148:151], a[64:67], a[116:119], v[148:151]
    ds_read_b64_tr_b16 a[164:165], v21 offset:16384
    v_mfma_f32_16x16x32_bf16 v[152:155], a[64:67], a[120:123], v[152:155]
    ds_read_b64_tr_b16 a[166:167], v21 offset:17408
    v_mfma_f32_16x16x32_bf16 v[156:159], a[64:67], a[124:127], v[156:159]
    ds_read_b128 a[132:135], v19 offset:2048
    v_mfma_f32_16x16x32_bf16 v[92:95], a[68:71], a[124:127], v[92:95]
    ds_read_b64_tr_b16 a[168:169], v22 offset:16384
    v_mfma_f32_16x16x32_bf16 v[88:91], a[68:71], a[120:123], v[88:91]
    buffer_load_dwordx4 v29, s[44:47], s72 offen offset:1024 lds
    v_mfma_f32_16x16x32_bf16 v[84:87], a[68:71], a[116:119], v[84:87]
    ds_read_b64_tr_b16 a[170:171], v22 offset:17408
    v_mfma_f32_16x16x32_bf16 v[80:83], a[68:71], a[112:115], v[80:83]
    ds_read_b128 a[136:139], v19 offset:4096
    v_mfma_f32_16x16x32_bf16 v[76:79], a[68:71], a[108:111], v[76:79]
    ds_read_b64_tr_b16 a[172:173], v23 offset:16384
    v_mfma_f32_16x16x32_bf16 v[72:75], a[68:71], a[104:107], v[72:75]
    ds_read_b64_tr_b16 a[174:175], v23 offset:17408
    v_mfma_f32_16x16x32_bf16 v[68:71], a[68:71], a[100:103], v[68:71]
    s_nop 0
    s_add_u32 m0, s73, 139264
    s_mov_b32 s72, 0
    ds_read_b128 a[140:143], v19 offset:6144
    v_mfma_f32_16x16x32_bf16 v[64:67], a[68:71], a[96:99], v[64:67]
    buffer_load_dwordx4 v30, s[60:63], s72 offen lds
    v_mfma_f32_16x16x32_bf16 v[160:163], a[72:75], a[96:99], v[160:163]
    ds_read_b64_tr_b16 a[176:177], v24 offset:16384
    v_mfma_f32_16x16x32_bf16 v[164:167], a[72:75], a[100:103], v[164:167]
    ds_read_b64_tr_b16 a[178:179], v24 offset:17408
    v_mfma_f32_16x16x32_bf16 v[168:171], a[72:75], a[104:107], v[168:171]
    ds_read_b128 a[144:147], v19 offset:8192
    v_mfma_f32_16x16x32_bf16 v[172:175], a[72:75], a[108:111], v[172:175]
    ds_read_b64_tr_b16 a[180:181], v25 offset:16384
    v_mfma_f32_16x16x32_bf16 v[176:179], a[72:75], a[112:115], v[176:179]
    s_add_u32 m0, s71, 143360
    s_mov_b32 s72, 262144
    ds_read_b64_tr_b16 a[182:183], v25 offset:17408
    v_mfma_f32_16x16x32_bf16 v[180:183], a[72:75], a[116:119], v[180:183]
    buffer_load_dwordx4 v28, s[44:47], s72 offen lds
    v_mfma_f32_16x16x32_bf16 v[184:187], a[72:75], a[120:123], v[184:187]
    ds_read_b128 a[148:151], v19 offset:10240
    v_mfma_f32_16x16x32_bf16 v[188:191], a[72:75], a[124:127], v[188:191]
    ds_read_b64_tr_b16 a[184:185], v26 offset:16384
    v_mfma_f32_16x16x32_bf16 v[124:127], a[76:79], a[124:127], v[124:127]
    ds_read_b64_tr_b16 a[186:187], v26 offset:17408
    v_mfma_f32_16x16x32_bf16 v[120:123], a[76:79], a[120:123], v[120:123]
    ds_read_b128 a[152:155], v19 offset:12288
    v_mfma_f32_16x16x32_bf16 v[116:119], a[76:79], a[116:119], v[116:119]
    ds_read_b64_tr_b16 a[188:189], v27 offset:16384
    v_mfma_f32_16x16x32_bf16 v[112:115], a[76:79], a[112:115], v[112:115]
    buffer_load_dwordx4 v29, s[44:47], s72 offen offset:1024 lds
    v_mfma_f32_16x16x32_bf16 v[108:111], a[76:79], a[108:111], v[108:111]
    ds_read_b64_tr_b16 a[190:191], v27 offset:17408
    v_mfma_f32_16x16x32_bf16 v[104:107], a[76:79], a[104:107], v[104:107]
    ds_read_b128 a[156:159], v19 offset:14336
    v_mfma_f32_16x16x32_bf16 v[100:103], a[76:79], a[100:103], v[100:103]
    v_add_u32 v18, 98304, v16
    v_add_u32 v19, 98304, v17
    v_mfma_f32_16x16x32_bf16 v[96:99], a[76:79], a[96:99], v[96:99]
    v_mfma_f32_16x16x32_bf16 v[192:195], a[80:83], a[96:99], v[192:195]
    s_add_u32 m0, s73, 151552
    s_mov_b32 s72, 88064
    v_mfma_f32_16x16x32_bf16 v[196:199], a[80:83], a[100:103], v[196:199]
    buffer_load_dwordx4 v30, s[60:63], s72 offen lds
    v_mfma_f32_16x16x32_bf16 v[200:203], a[80:83], a[104:107], v[200:203]
    v_mfma_f32_16x16x32_bf16 v[204:207], a[80:83], a[108:111], v[204:207]
    v_mfma_f32_16x16x32_bf16 v[208:211], a[80:83], a[112:115], v[208:211]
    v_mfma_f32_16x16x32_bf16 v[212:215], a[80:83], a[116:119], v[212:215]
    v_mfma_f32_16x16x32_bf16 v[216:219], a[80:83], a[120:123], v[216:219]
    s_nop 0
    s_add_u32 m0, s71, 0
    s_mov_b32 s72, 524288
    v_mfma_f32_16x16x32_bf16 v[220:223], a[80:83], a[124:127], v[220:223]
    buffer_load_dwordx4 v28, s[44:47], s72 offen lds
    v_mfma_f32_16x16x32_bf16 a[220:223], a[84:87], a[124:127], a[220:223]
    v_mfma_f32_16x16x32_bf16 a[216:219], a[84:87], a[120:123], a[216:219]
    v_mfma_f32_16x16x32_bf16 a[212:215], a[84:87], a[116:119], a[212:215]
    v_mfma_f32_16x16x32_bf16 a[208:211], a[84:87], a[112:115], a[208:211]
    v_mfma_f32_16x16x32_bf16 a[204:207], a[84:87], a[108:111], a[204:207]
    v_mfma_f32_16x16x32_bf16 a[200:203], a[84:87], a[104:107], a[200:203]
    buffer_load_dwordx4 v29, s[44:47], s72 offen offset:1024 lds
    v_mfma_f32_16x16x32_bf16 a[196:199], a[84:87], a[100:103], a[196:199]
    v_mfma_f32_16x16x32_bf16 a[192:195], a[84:87], a[96:99], a[192:195]
    v_mfma_f32_16x16x32_bf16 v[224:227], a[88:91], a[96:99], v[224:227]
    v_mfma_f32_16x16x32_bf16 v[228:231], a[88:91], a[100:103], v[228:231]
    v_mfma_f32_16x16x32_bf16 v[232:235], a[88:91], a[104:107], v[232:235]
    s_add_u32 m0, s73, 8192
    s_mov_b32 s72, 176128
    v_mfma_f32_16x16x32_bf16 v[236:239], a[88:91], a[108:111], v[236:239]
    buffer_load_dwordx4 v30, s[60:63], s72 offen lds
    v_mfma_f32_16x16x32_bf16 v[240:243], a[88:91], a[112:115], v[240:243]
    v_mfma_f32_16x16x32_bf16 v[244:247], a[88:91], a[116:119], v[244:247]
    v_mfma_f32_16x16x32_bf16 v[248:251], a[88:91], a[120:123], v[248:251]
    v_mfma_f32_16x16x32_bf16 v[252:255], a[88:91], a[124:127], v[252:255]
    v_mfma_f32_16x16x32_bf16 a[252:255], a[92:95], a[124:127], a[252:255]
    v_mfma_f32_16x16x32_bf16 a[248:251], a[92:95], a[120:123], a[248:251]
    v_mfma_f32_16x16x32_bf16 a[244:247], a[92:95], a[116:119], a[244:247]
    v_mfma_f32_16x16x32_bf16 a[240:243], a[92:95], a[112:115], a[240:243]
    v_mfma_f32_16x16x32_bf16 a[236:239], a[92:95], a[108:111], a[236:239]
    v_mfma_f32_16x16x32_bf16 a[232:235], a[92:95], a[104:107], a[232:235]
    v_mfma_f32_16x16x32_bf16 a[228:231], a[92:95], a[100:103], a[228:231]
    s_nop 0
    s_waitcnt lgkmcnt(0)
    v_mfma_f32_16x16x32_bf16 a[224:227], a[92:95], a[96:99], a[224:227]
    v_mfma_f32_16x16x32_bf16 v[128:131], a[128:131], a[160:163], v[128:131]
    s_nop 0
    s_barrier
    v_mfma_f32_16x16x32_bf16 v[132:135], a[128:131], a[164:167], v[132:135]
    ds_read_b64_tr_b16 a[96:97], v20 offset:32768
    v_mfma_f32_16x16x32_bf16 v[136:139], a[128:131], a[168:171], v[136:139]
    s_add_u32 m0, s71, 12288
    s_mov_b32 s72, 786432
    ds_read_b64_tr_b16 a[98:99], v20 offset:33792
    v_mfma_f32_16x16x32_bf16 v[140:143], a[128:131], a[172:175], v[140:143]
    buffer_load_dwordx4 v28, s[44:47], s72 offen lds
    v_mfma_f32_16x16x32_bf16 v[144:147], a[128:131], a[176:179], v[144:147]
    ds_read_b128 a[64:67], v18 offset:0
    v_mfma_f32_16x16x32_bf16 v[148:151], a[128:131], a[180:183], v[148:151]
    ds_read_b64_tr_b16 a[100:101], v21 offset:32768
    v_mfma_f32_16x16x32_bf16 v[152:155], a[128:131], a[184:187], v[152:155]
    ds_read_b64_tr_b16 a[102:103], v21 offset:33792
    v_mfma_f32_16x16x32_bf16 v[156:159], a[128:131], a[188:191], v[156:159]
    ds_read_b128 a[68:71], v18 offset:2048
    v_mfma_f32_16x16x32_bf16 v[92:95], a[132:135], a[188:191], v[92:95]
    ds_read_b64_tr_b16 a[104:105], v22 offset:32768
    v_mfma_f32_16x16x32_bf16 v[88:91], a[132:135], a[184:187], v[88:91]
    buffer_load_dwordx4 v29, s[44:47], s72 offen offset:1024 lds
    v_mfma_f32_16x16x32_bf16 v[84:87], a[132:135], a[180:183], v[84:87]
    ds_read_b64_tr_b16 a[106:107], v22 offset:33792
    v_mfma_f32_16x16x32_bf16 v[80:83], a[132:135], a[176:179], v[80:83]
    ds_read_b128 a[72:75], v18 offset:4096
    v_mfma_f32_16x16x32_bf16 v[76:79], a[132:135], a[172:175], v[76:79]
    ds_read_b64_tr_b16 a[108:109], v23 offset:32768
    v_mfma_f32_16x16x32_bf16 v[72:75], a[132:135], a[168:171], v[72:75]
    ds_read_b64_tr_b16 a[110:111], v23 offset:33792
    v_mfma_f32_16x16x32_bf16 v[68:71], a[132:135], a[164:167], v[68:71]
    s_add_u32 m0, s73, 20480
    s_mov_b32 s72, 264192
    ds_read_b128 a[76:79], v18 offset:6144
    v_mfma_f32_16x16x32_bf16 v[64:67], a[132:135], a[160:163], v[64:67]
    buffer_load_dwordx4 v30, s[60:63], s72 offen lds
    v_mfma_f32_16x16x32_bf16 v[160:163], a[136:139], a[160:163], v[160:163]
    ds_read_b64_tr_b16 a[112:113], v24 offset:32768
    v_mfma_f32_16x16x32_bf16 v[164:167], a[136:139], a[164:167], v[164:167]
    ds_read_b64_tr_b16 a[114:115], v24 offset:33792
    v_mfma_f32_16x16x32_bf16 v[168:171], a[136:139], a[168:171], v[168:171]
    ds_read_b128 a[80:83], v18 offset:8192
    v_mfma_f32_16x16x32_bf16 v[172:175], a[136:139], a[172:175], v[172:175]
    ds_read_b64_tr_b16 a[116:117], v25 offset:32768
    v_mfma_f32_16x16x32_bf16 v[176:179], a[136:139], a[176:179], v[176:179]
    s_add_u32 m0, s71, 65536
    s_mov_b32 s72, 1048576
    ds_read_b64_tr_b16 a[118:119], v25 offset:33792
    v_mfma_f32_16x16x32_bf16 v[180:183], a[136:139], a[180:183], v[180:183]
    buffer_load_dwordx4 v28, s[44:47], s72 offen lds
    v_mfma_f32_16x16x32_bf16 v[184:187], a[136:139], a[184:187], v[184:187]
    ds_read_b128 a[84:87], v18 offset:10240
    v_mfma_f32_16x16x32_bf16 v[188:191], a[136:139], a[188:191], v[188:191]
    ds_read_b64_tr_b16 a[120:121], v26 offset:32768
    v_mfma_f32_16x16x32_bf16 v[124:127], a[140:143], a[188:191], v[124:127]
    ds_read_b64_tr_b16 a[122:123], v26 offset:33792
    v_mfma_f32_16x16x32_bf16 v[120:123], a[140:143], a[184:187], v[120:123]
    ds_read_b128 a[88:91], v18 offset:12288
    v_mfma_f32_16x16x32_bf16 v[116:119], a[140:143], a[180:183], v[116:119]
    ds_read_b64_tr_b16 a[124:125], v27 offset:32768
    v_mfma_f32_16x16x32_bf16 v[112:115], a[140:143], a[176:179], v[112:115]
    buffer_load_dwordx4 v29, s[44:47], s72 offen offset:1024 lds
    v_mfma_f32_16x16x32_bf16 v[108:111], a[140:143], a[172:175], v[108:111]
    ds_read_b64_tr_b16 a[126:127], v27 offset:33792
    v_mfma_f32_16x16x32_bf16 v[104:107], a[140:143], a[168:171], v[104:107]
    ds_read_b128 a[92:95], v18 offset:14336
    v_mfma_f32_16x16x32_bf16 v[100:103], a[140:143], a[164:167], v[100:103]
    v_mfma_f32_16x16x32_bf16 v[96:99], a[140:143], a[160:163], v[96:99]
    v_mfma_f32_16x16x32_bf16 v[192:195], a[144:147], a[160:163], v[192:195]
    s_add_u32 m0, s73, 73728
    s_mov_b32 s72, 352256
    v_mfma_f32_16x16x32_bf16 v[196:199], a[144:147], a[164:167], v[196:199]
    buffer_load_dwordx4 v30, s[60:63], s72 offen lds
    v_mfma_f32_16x16x32_bf16 v[200:203], a[144:147], a[168:171], v[200:203]
    v_mfma_f32_16x16x32_bf16 v[204:207], a[144:147], a[172:175], v[204:207]
    v_mfma_f32_16x16x32_bf16 v[208:211], a[144:147], a[176:179], v[208:211]
    v_mfma_f32_16x16x32_bf16 v[212:215], a[144:147], a[180:183], v[212:215]
    v_mfma_f32_16x16x32_bf16 v[216:219], a[144:147], a[184:187], v[216:219]
    s_add_u32 m0, s71, 77824
    s_mov_b32 s72, 1310720
    v_mfma_f32_16x16x32_bf16 v[220:223], a[144:147], a[188:191], v[220:223]
    buffer_load_dwordx4 v28, s[44:47], s72 offen lds
    v_mfma_f32_16x16x32_bf16 a[220:223], a[148:151], a[188:191], a[220:223]
    v_add_u32 v36, s15, v2
    v_add_u32 v37, s13, v2
    v_mfma_f32_16x16x32_bf16 a[216:219], a[148:151], a[184:187], a[216:219]
    v_mfma_f32_16x16x32_bf16 a[212:215], a[148:151], a[180:183], a[212:215]
    v_mfma_f32_16x16x32_bf16 a[208:211], a[148:151], a[176:179], a[208:211]
    v_mfma_f32_16x16x32_bf16 a[204:207], a[148:151], a[172:175], a[204:207]
    v_mfma_f32_16x16x32_bf16 a[200:203], a[148:151], a[168:171], a[200:203]
    buffer_load_dwordx4 v29, s[44:47], s72 offen offset:1024 lds
    v_mfma_f32_16x16x32_bf16 a[196:199], a[148:151], a[164:167], a[196:199]
    v_mfma_f32_16x16x32_bf16 a[192:195], a[148:151], a[160:163], a[192:195]
    v_mfma_f32_16x16x32_bf16 v[224:227], a[152:155], a[160:163], v[224:227]
    v_mfma_f32_16x16x32_bf16 v[228:231], a[152:155], a[164:167], v[228:231]
    v_mfma_f32_16x16x32_bf16 v[232:235], a[152:155], a[168:171], v[232:235]
    s_add_u32 m0, s73, 86016
    s_mov_b32 s72, 440320
    v_mfma_f32_16x16x32_bf16 v[236:239], a[152:155], a[172:175], v[236:239]
    buffer_load_dwordx4 v30, s[60:63], s72 offen lds
    v_mfma_f32_16x16x32_bf16 v[240:243], a[152:155], a[176:179], v[240:243]
    v_mfma_f32_16x16x32_bf16 v[244:247], a[152:155], a[180:183], v[244:247]
    v_mfma_f32_16x16x32_bf16 v[248:251], a[152:155], a[184:187], v[248:251]
    v_mfma_f32_16x16x32_bf16 v[252:255], a[152:155], a[188:191], v[252:255]
    v_mfma_f32_16x16x32_bf16 a[252:255], a[156:159], a[188:191], a[252:255]
    v_mfma_f32_16x16x32_bf16 a[248:251], a[156:159], a[184:187], a[248:251]
    v_mfma_f32_16x16x32_bf16 a[244:247], a[156:159], a[180:183], a[244:247]
    v_mfma_f32_16x16x32_bf16 a[240:243], a[156:159], a[176:179], a[240:243]
    v_mfma_f32_16x16x32_bf16 a[236:239], a[156:159], a[172:175], a[236:239]
    v_mfma_f32_16x16x32_bf16 a[232:235], a[156:159], a[168:171], a[232:235]
    v_mfma_f32_16x16x32_bf16 a[228:231], a[156:159], a[164:167], a[228:231]
    s_nop 0
    s_waitcnt lgkmcnt(0)
    v_mfma_f32_16x16x32_bf16 a[224:227], a[156:159], a[160:163], a[224:227]
    v_mfma_f32_16x16x32_bf16 v[128:131], a[64:67], a[96:99], v[128:131]
    s_waitcnt vmcnt(18)
    s_barrier
    v_mfma_f32_16x16x32_bf16 v[132:135], a[64:67], a[100:103], v[132:135]
    ds_read_b64_tr_b16 a[160:161], v20 offset:49152
    v_mfma_f32_16x16x32_bf16 v[136:139], a[64:67], a[104:107], v[136:139]
    s_add_u32 m0, s71, 24576
    s_mov_b32 s72, 1572864
    ds_read_b64_tr_b16 a[162:163], v20 offset:50176
    v_mfma_f32_16x16x32_bf16 v[140:143], a[64:67], a[108:111], v[140:143]
    buffer_load_dwordx4 v28, s[44:47], s72 offen lds
    v_mfma_f32_16x16x32_bf16 v[144:147], a[64:67], a[112:115], v[144:147]
    ds_read_b128 a[128:131], v19 offset:0
    v_mfma_f32_16x16x32_bf16 v[148:151], a[64:67], a[116:119], v[148:151]
    ds_read_b64_tr_b16 a[164:165], v21 offset:49152
    v_mfma_f32_16x16x32_bf16 v[152:155], a[64:67], a[120:123], v[152:155]
    buffer_load_dwordx4 v29, s[44:47], s72 offen offset:1024 lds
    v_mfma_f32_16x16x32_bf16 v[156:159], a[64:67], a[124:127], v[156:159]
    ds_read_b64_tr_b16 a[166:167], v21 offset:50176
    v_mfma_f32_16x16x32_bf16 v[92:95], a[68:71], a[124:127], v[92:95]
    s_add_u32 m0, s73, 32768
    s_mov_b32 s72, 528384
    ds_read_b128 a[132:135], v19 offset:2048
    v_mfma_f32_16x16x32_bf16 v[88:91], a[68:71], a[120:123], v[88:91]
    buffer_load_dwordx4 v30, s[60:63], s72 offen lds
    v_mfma_f32_16x16x32_bf16 v[84:87], a[68:71], a[116:119], v[84:87]
    ds_read_b64_tr_b16 a[168:169], v22 offset:49152
    v_mfma_f32_16x16x32_bf16 v[80:83], a[68:71], a[112:115], v[80:83]
    s_add_u32 m0, s71, 36864
    s_mov_b32 s72, 1835008
    ds_read_b64_tr_b16 a[170:171], v22 offset:50176
    v_mfma_f32_16x16x32_bf16 v[76:79], a[68:71], a[108:111], v[76:79]
    buffer_load_dwordx4 v28, s[44:47], s72 offen lds
    v_mfma_f32_16x16x32_bf16 v[72:75], a[68:71], a[104:107], v[72:75]
    ds_read_b128 a[136:139], v19 offset:4096
    v_mfma_f32_16x16x32_bf16 v[68:71], a[68:71], a[100:103], v[68:71]
    ds_read_b64_tr_b16 a[172:173], v23 offset:49152
    v_mfma_f32_16x16x32_bf16 v[64:67], a[68:71], a[96:99], v[64:67]
    buffer_load_dwordx4 v29, s[44:47], s72 offen offset:1024 lds
    v_mfma_f32_16x16x32_bf16 v[160:163], a[72:75], a[96:99], v[160:163]
    ds_read_b64_tr_b16 a[174:175], v23 offset:50176
    v_mfma_f32_16x16x32_bf16 v[164:167], a[72:75], a[100:103], v[164:167]
    s_add_u32 m0, s73, 45056
    s_mov_b32 s72, 616448
    ds_read_b128 a[140:143], v19 offset:6144
    v_mfma_f32_16x16x32_bf16 v[168:171], a[72:75], a[104:107], v[168:171]
    buffer_load_dwordx4 v30, s[60:63], s72 offen lds
    v_mfma_f32_16x16x32_bf16 v[172:175], a[72:75], a[108:111], v[172:175]
    ds_read_b64_tr_b16 a[176:177], v24 offset:49152
    v_mfma_f32_16x16x32_bf16 v[176:179], a[72:75], a[112:115], v[176:179]
    s_nop 0
    s_add_u32 s75, s66, 0
    ds_read_b64_tr_b16 a[178:179], v24 offset:50176
    v_mfma_f32_16x16x32_bf16 v[180:183], a[72:75], a[116:119], v[180:183]
    buffer_load_dwordx4 a[0:3], v36, s[52:55], s75 offen sc1
    v_mfma_f32_16x16x32_bf16 v[184:187], a[72:75], a[120:123], v[184:187]
    ds_read_b128 a[144:147], v19 offset:8192
    v_mfma_f32_16x16x32_bf16 v[188:191], a[72:75], a[124:127], v[188:191]
    ds_read_b64_tr_b16 a[180:181], v25 offset:49152
    v_mfma_f32_16x16x32_bf16 v[124:127], a[76:79], a[124:127], v[124:127]
    buffer_load_dwordx4 a[4:7], v37, s[52:55], s75 offen sc1
    v_mfma_f32_16x16x32_bf16 v[120:123], a[76:79], a[120:123], v[120:123]
    ds_read_b64_tr_b16 a[182:183], v25 offset:50176
    v_mfma_f32_16x16x32_bf16 v[116:119], a[76:79], a[116:119], v[116:119]
    s_nop 0
    s_add_u32 s75, s67, 0
    ds_read_b128 a[148:151], v19 offset:10240
    v_mfma_f32_16x16x32_bf16 v[112:115], a[76:79], a[112:115], v[112:115]
    buffer_load_dwordx4 a[8:11], v36, s[52:55], s75 offen sc1
    v_mfma_f32_16x16x32_bf16 v[108:111], a[76:79], a[108:111], v[108:111]
    ds_read_b64_tr_b16 a[184:185], v26 offset:49152
    v_mfma_f32_16x16x32_bf16 v[104:107], a[76:79], a[104:107], v[104:107]
    ds_read_b64_tr_b16 a[186:187], v26 offset:50176
    v_mfma_f32_16x16x32_bf16 v[100:103], a[76:79], a[100:103], v[100:103]
    buffer_load_dwordx4 a[12:15], v37, s[52:55], s75 offen sc1
    v_mfma_f32_16x16x32_bf16 v[96:99], a[76:79], a[96:99], v[96:99]
    ds_read_b128 a[152:155], v19 offset:12288
    v_mfma_f32_16x16x32_bf16 v[192:195], a[80:83], a[96:99], v[192:195]
    s_add_u32 s75, s66, 4096
    ds_read_b64_tr_b16 a[188:189], v27 offset:49152
    v_mfma_f32_16x16x32_bf16 v[196:199], a[80:83], a[100:103], v[196:199]
    buffer_load_dwordx4 a[16:19], v36, s[52:55], s75 offen sc1
    v_mfma_f32_16x16x32_bf16 v[200:203], a[80:83], a[104:107], v[200:203]
    ds_read_b64_tr_b16 a[190:191], v27 offset:50176
    v_mfma_f32_16x16x32_bf16 v[204:207], a[80:83], a[108:111], v[204:207]
    ds_read_b128 a[156:159], v19 offset:14336
    v_mfma_f32_16x16x32_bf16 v[208:211], a[80:83], a[112:115], v[208:211]
    buffer_load_dwordx4 a[20:23], v37, s[52:55], s75 offen sc1
    v_mfma_f32_16x16x32_bf16 v[212:215], a[80:83], a[116:119], v[212:215]
    v_add_u32 v20, s14, v20
    v_add_u32 v21, s14, v21
    v_mfma_f32_16x16x32_bf16 v[216:219], a[80:83], a[120:123], v[216:219]
    s_add_u32 s75, s67, 4096
    v_add_u32 v22, s14, v22
    v_add_u32 v23, s14, v23
    v_mfma_f32_16x16x32_bf16 v[220:223], a[80:83], a[124:127], v[220:223]
    buffer_load_dwordx4 a[24:27], v36, s[52:55], s75 offen sc1
    v_mfma_f32_16x16x32_bf16 a[220:223], a[84:87], a[124:127], a[220:223]
    v_add_u32 v24, s14, v24
    v_add_u32 v25, s14, v25
    v_mfma_f32_16x16x32_bf16 a[216:219], a[84:87], a[120:123], a[216:219]
    v_add_u32 v26, s14, v26
    v_add_u32 v27, s14, v27
    v_mfma_f32_16x16x32_bf16 a[212:215], a[84:87], a[116:119], a[212:215]
    buffer_load_dwordx4 a[28:31], v37, s[52:55], s75 offen sc1
    v_mfma_f32_16x16x32_bf16 a[208:211], a[84:87], a[112:115], a[208:211]
    v_xor_b32_e64 v32, 0, v34
    v_lshl_add_u32 v16, v32, 5, v31
    v_mfma_f32_16x16x32_bf16 a[204:207], a[84:87], a[108:111], a[204:207]
    v_xor_b32_e64 v32, 1, v34
    v_lshl_add_u32 v17, v32, 5, v31
    v_mfma_f32_16x16x32_bf16 a[200:203], a[84:87], a[104:107], a[200:203]
    v_xor_b32_e64 v32, 2, v34
    v_lshl_add_u32 v18, v32, 5, v31
    v_mfma_f32_16x16x32_bf16 a[196:199], a[84:87], a[100:103], a[196:199]
    v_xor_b32_e64 v32, 3, v34
    v_lshl_add_u32 v19, v32, 5, v31
    v_mfma_f32_16x16x32_bf16 a[192:195], a[84:87], a[96:99], a[192:195]
    v_mfma_f32_16x16x32_bf16 v[224:227], a[88:91], a[96:99], v[224:227]
    v_mfma_f32_16x16x32_bf16 v[228:231], a[88:91], a[100:103], v[228:231]
    v_mfma_f32_16x16x32_bf16 v[232:235], a[88:91], a[104:107], v[232:235]
    v_mfma_f32_16x16x32_bf16 v[236:239], a[88:91], a[108:111], v[236:239]
    v_mfma_f32_16x16x32_bf16 v[240:243], a[88:91], a[112:115], v[240:243]
    v_mfma_f32_16x16x32_bf16 v[244:247], a[88:91], a[116:119], v[244:247]
    v_mfma_f32_16x16x32_bf16 v[248:251], a[88:91], a[120:123], v[248:251]
    v_mfma_f32_16x16x32_bf16 v[252:255], a[88:91], a[124:127], v[252:255]
    v_mfma_f32_16x16x32_bf16 a[252:255], a[92:95], a[124:127], a[252:255]
    v_mfma_f32_16x16x32_bf16 a[248:251], a[92:95], a[120:123], a[248:251]
    v_mfma_f32_16x16x32_bf16 a[244:247], a[92:95], a[116:119], a[244:247]
    v_mfma_f32_16x16x32_bf16 a[240:243], a[92:95], a[112:115], a[240:243]
    v_mfma_f32_16x16x32_bf16 a[236:239], a[92:95], a[108:111], a[236:239]
    v_mfma_f32_16x16x32_bf16 a[232:235], a[92:95], a[104:107], a[232:235]
    v_mfma_f32_16x16x32_bf16 a[228:231], a[92:95], a[100:103], a[228:231]
    s_nop 0
    s_waitcnt lgkmcnt(0)
    v_mfma_f32_16x16x32_bf16 a[224:227], a[92:95], a[96:99], a[224:227]
    v_mfma_f32_16x16x32_bf16 v[128:131], a[128:131], a[160:163], v[128:131]
    s_waitcnt vmcnt(29)
    s_barrier
    v_mfma_f32_16x16x32_bf16 v[132:135], a[128:131], a[164:167], v[132:135]
    ds_read_b64_tr_b16 a[64:65], v20 offset:0
    v_mfma_f32_16x16x32_bf16 v[136:139], a[128:131], a[168:171], v[136:139]
    s_add_u32 m0, s71, 49152
    s_mov_b32 s72, 2097152
    ds_read_b64_tr_b16 a[66:67], v20 offset:1024
    v_mfma_f32_16x16x32_bf16 v[140:143], a[128:131], a[172:175], v[140:143]
    buffer_load_dwordx4 v28, s[44:47], s72 offen lds
    v_mfma_f32_16x16x32_bf16 v[144:147], a[128:131], a[176:179], v[144:147]
    ds_read_b64_tr_b16 a[68:69], v21 offset:0
    v_mfma_f32_16x16x32_bf16 v[148:151], a[128:131], a[180:183], v[148:151]
    ds_read_b64_tr_b16 a[70:71], v21 offset:1024
    v_mfma_f32_16x16x32_bf16 v[152:155], a[128:131], a[184:187], v[152:155]
    buffer_load_dwordx4 v29, s[44:47], s72 offen offset:1024 lds
    v_mfma_f32_16x16x32_bf16 v[156:159], a[128:131], a[188:191], v[156:159]
    ds_read_b64_tr_b16 a[72:73], v22 offset:0
    v_mfma_f32_16x16x32_bf16 v[92:95], a[132:135], a[188:191], v[92:95]
    s_add_u32 m0, s73, 57344
    s_mov_b32 s72, 704512
    ds_read_b64_tr_b16 a[74:75], v22 offset:1024
    v_mfma_f32_16x16x32_bf16 v[88:91], a[132:135], a[184:187], v[88:91]
    buffer_load_dwordx4 v30, s[60:63], s72 offen lds
    v_mfma_f32_16x16x32_bf16 v[84:87], a[132:135], a[180:183], v[84:87]
    ds_read_b64_tr_b16 a[76:77], v23 offset:0
    v_mfma_f32_16x16x32_bf16 v[80:83], a[132:135], a[176:179], v[80:83]
    s_add_u32 m0, s71, 90112
    s_mov_b32 s72, 2359296
    ds_read_b64_tr_b16 a[78:79], v23 offset:1024
    v_mfma_f32_16x16x32_bf16 v[76:79], a[132:135], a[172:175], v[76:79]
    buffer_load_dwordx4 v28, s[44:47], s72 offen lds
    v_mfma_f32_16x16x32_bf16 v[72:75], a[132:135], a[168:171], v[72:75]
    ds_read_b64_tr_b16 a[80:81], v24 offset:0
    v_mfma_f32_16x16x32_bf16 v[68:71], a[132:135], a[164:167], v[68:71]
    ds_read_b64_tr_b16 a[82:83], v24 offset:1024
    v_mfma_f32_16x16x32_bf16 v[64:67], a[132:135], a[160:163], v[64:67]
    buffer_load_dwordx4 v29, s[44:47], s72 offen offset:1024 lds
    v_mfma_f32_16x16x32_bf16 v[160:163], a[136:139], a[160:163], v[160:163]
    ds_read_b64_tr_b16 a[84:85], v25 offset:0
    v_mfma_f32_16x16x32_bf16 v[164:167], a[136:139], a[164:167], v[164:167]
    s_add_u32 m0, s73, 98304
    s_mov_b32 s72, 792576
    ds_read_b64_tr_b16 a[86:87], v25 offset:1024
    v_mfma_f32_16x16x32_bf16 v[168:171], a[136:139], a[168:171], v[168:171]
    buffer_load_dwordx4 v30, s[60:63], s72 offen lds
    v_mfma_f32_16x16x32_bf16 v[172:175], a[136:139], a[172:175], v[172:175]
    ds_read_b64_tr_b16 a[88:89], v26 offset:0
    v_cvt_pk_bf16_f32 v128, v128, v129
    v_mfma_f32_16x16x32_bf16 v[176:179], a[136:139], a[176:179], v[176:179]
    s_add_u32 s75, s66, 8192
    ds_read_b64_tr_b16 a[90:91], v26 offset:1024
    v_cvt_pk_bf16_f32 v129, v130, v131
    v_mfma_f32_16x16x32_bf16 v[180:183], a[136:139], a[180:183], v[180:183]
    buffer_load_dwordx4 a[32:35], v36, s[52:55], s75 offen sc1
    v_mfma_f32_16x16x32_bf16 v[184:187], a[136:139], a[184:187], v[184:187]
    ds_read_b64_tr_b16 a[92:93], v27 offset:0
    v_cvt_pk_bf16_f32 v130, v64, v65
    v_mfma_f32_16x16x32_bf16 v[188:191], a[136:139], a[188:191], v[188:191]
    ds_read_b64_tr_b16 a[94:95], v27 offset:1024
    v_cvt_pk_bf16_f32 v131, v66, v67
    v_mfma_f32_16x16x32_bf16 v[124:127], a[140:143], a[188:191], v[124:127]
    buffer_load_dwordx4 a[36:39], v37, s[52:55], s75 offen sc1
    v_mfma_f32_16x16x32_bf16 v[120:123], a[140:143], a[184:187], v[120:123]
    ds_read_b64_tr_b16 a[96:97], v16 offset:0
    v_cvt_pk_bf16_f32 v132, v132, v133
    v_mfma_f32_16x16x32_bf16 v[116:119], a[140:143], a[180:183], v[116:119]
    s_add_u32 s75, s67, 8192
    ds_read_b64_tr_b16 a[98:99], v16 offset:512
    v_cvt_pk_bf16_f32 v133, v134, v135
    v_mfma_f32_16x16x32_bf16 v[112:115], a[140:143], a[176:179], v[112:115]
    buffer_load_dwordx4 a[40:43], v36, s[52:55], s75 offen sc1
    v_mfma_f32_16x16x32_bf16 v[108:111], a[140:143], a[172:175], v[108:111]
    ds_read_b64_tr_b16 a[100:101], v17 offset:0
    v_cvt_pk_bf16_f32 v134, v68, v69
    v_mfma_f32_16x16x32_bf16 v[104:107], a[140:143], a[168:171], v[104:107]
    ds_read_b64_tr_b16 a[102:103], v17 offset:512
    v_cvt_pk_bf16_f32 v135, v70, v71
    v_mfma_f32_16x16x32_bf16 v[100:103], a[140:143], a[164:167], v[100:103]
    buffer_load_dwordx4 a[44:47], v37, s[52:55], s75 offen sc1
    v_mfma_f32_16x16x32_bf16 v[96:99], a[140:143], a[160:163], v[96:99]
    ds_read_b64_tr_b16 a[104:105], v18 offset:0
    v_cvt_pk_bf16_f32 v136, v136, v137
    v_mfma_f32_16x16x32_bf16 v[192:195], a[144:147], a[160:163], v[192:195]
    s_add_u32 s75, s66, 12288
    ds_read_b64_tr_b16 a[106:107], v18 offset:512
    v_cvt_pk_bf16_f32 v137, v138, v139
    v_mfma_f32_16x16x32_bf16 v[196:199], a[144:147], a[164:167], v[196:199]
    buffer_load_dwordx4 a[48:51], v36, s[52:55], s75 offen sc1
    v_mfma_f32_16x16x32_bf16 v[200:203], a[144:147], a[168:171], v[200:203]
    ds_read_b64_tr_b16 a[108:109], v19 offset:0
    v_cvt_pk_bf16_f32 v138, v72, v73
    v_mfma_f32_16x16x32_bf16 v[204:207], a[144:147], a[172:175], v[204:207]
    ds_read_b64_tr_b16 a[110:111], v19 offset:512
    v_cvt_pk_bf16_f32 v139, v74, v75
    v_mfma_f32_16x16x32_bf16 v[208:211], a[144:147], a[176:179], v[208:211]
    buffer_load_dwordx4 a[52:55], v37, s[52:55], s75 offen sc1
    v_mfma_f32_16x16x32_bf16 v[212:215], a[144:147], a[180:183], v[212:215]
    v_cvt_pk_bf16_f32 v140, v140, v141
    v_cvt_pk_bf16_f32 v141, v142, v143
    v_mfma_f32_16x16x32_bf16 v[216:219], a[144:147], a[184:187], v[216:219]
    s_add_u32 s75, s67, 12288
    v_cvt_pk_bf16_f32 v142, v76, v77
    v_cvt_pk_bf16_f32 v143, v78, v79
    v_mfma_f32_16x16x32_bf16 v[220:223], a[144:147], a[188:191], v[220:223]
    buffer_load_dwordx4 a[56:59], v36, s[52:55], s75 offen sc1
    v_mfma_f32_16x16x32_bf16 a[220:223], a[148:151], a[188:191], a[220:223]
    v_cvt_pk_bf16_f32 v144, v144, v145
    v_cvt_pk_bf16_f32 v145, v146, v147
    v_mfma_f32_16x16x32_bf16 a[216:219], a[148:151], a[184:187], a[216:219]
    v_cvt_pk_bf16_f32 v146, v80, v81
    v_cvt_pk_bf16_f32 v147, v82, v83
    v_mfma_f32_16x16x32_bf16 a[212:215], a[148:151], a[180:183], a[212:215]
    buffer_load_dwordx4 a[60:63], v37, s[52:55], s75 offen sc1
    v_mfma_f32_16x16x32_bf16 a[208:211], a[148:151], a[176:179], a[208:211]
    v_cvt_pk_bf16_f32 v148, v148, v149
    v_cvt_pk_bf16_f32 v149, v150, v151
    v_mfma_f32_16x16x32_bf16 a[204:207], a[148:151], a[172:175], a[204:207]
    v_cvt_pk_bf16_f32 v150, v84, v85
    v_cvt_pk_bf16_f32 v151, v86, v87
    v_mfma_f32_16x16x32_bf16 a[200:203], a[148:151], a[168:171], a[200:203]
    v_cvt_pk_bf16_f32 v152, v152, v153
    v_cvt_pk_bf16_f32 v153, v154, v155
    v_mfma_f32_16x16x32_bf16 a[196:199], a[148:151], a[164:167], a[196:199]
    v_cvt_pk_bf16_f32 v154, v88, v89
    v_cvt_pk_bf16_f32 v155, v90, v91
    v_mfma_f32_16x16x32_bf16 a[192:195], a[148:151], a[160:163], a[192:195]
    v_cvt_pk_bf16_f32 v156, v156, v157
    v_cvt_pk_bf16_f32 v157, v158, v159
    v_mfma_f32_16x16x32_bf16 v[224:227], a[152:155], a[160:163], v[224:227]
    v_cvt_pk_bf16_f32 v158, v92, v93
    v_cvt_pk_bf16_f32 v159, v94, v95
    v_mfma_f32_16x16x32_bf16 v[228:231], a[152:155], a[164:167], v[228:231]
    v_cvt_pk_bf16_f32 v160, v160, v161
    v_cvt_pk_bf16_f32 v161, v162, v163
    v_mfma_f32_16x16x32_bf16 v[232:235], a[152:155], a[168:171], v[232:235]
    v_cvt_pk_bf16_f32 v162, v96, v97
    v_cvt_pk_bf16_f32 v163, v98, v99
    v_mfma_f32_16x16x32_bf16 v[236:239], a[152:155], a[172:175], v[236:239]
    v_cvt_pk_bf16_f32 v164, v164, v165
    v_cvt_pk_bf16_f32 v165, v166, v167
    v_mfma_f32_16x16x32_bf16 v[240:243], a[152:155], a[176:179], v[240:243]
    v_cvt_pk_bf16_f32 v166, v100, v101
    v_cvt_pk_bf16_f32 v167, v102, v103
    v_mfma_f32_16x16x32_bf16 v[244:247], a[152:155], a[180:183], v[244:247]
    v_cvt_pk_bf16_f32 v168, v168, v169
    v_cvt_pk_bf16_f32 v169, v170, v171
    v_mfma_f32_16x16x32_bf16 v[248:251], a[152:155], a[184:187], v[248:251]
    v_cvt_pk_bf16_f32 v170, v104, v105
    v_cvt_pk_bf16_f32 v171, v106, v107
    v_mfma_f32_16x16x32_bf16 v[252:255], a[152:155], a[188:191], v[252:255]
    v_cvt_pk_bf16_f32 v172, v172, v173
    v_cvt_pk_bf16_f32 v173, v174, v175
    v_mfma_f32_16x16x32_bf16 a[252:255], a[156:159], a[188:191], a[252:255]
    v_cvt_pk_bf16_f32 v174, v108, v109
    v_cvt_pk_bf16_f32 v175, v110, v111
    v_mfma_f32_16x16x32_bf16 a[248:251], a[156:159], a[184:187], a[248:251]
    v_cvt_pk_bf16_f32 v176, v176, v177
    v_cvt_pk_bf16_f32 v177, v178, v179
    v_mfma_f32_16x16x32_bf16 a[244:247], a[156:159], a[180:183], a[244:247]
    v_cvt_pk_bf16_f32 v178, v112, v113
    v_cvt_pk_bf16_f32 v179, v114, v115
    v_mfma_f32_16x16x32_bf16 a[240:243], a[156:159], a[176:179], a[240:243]
    v_cvt_pk_bf16_f32 v180, v180, v181
    v_cvt_pk_bf16_f32 v181, v182, v183
    v_mfma_f32_16x16x32_bf16 a[236:239], a[156:159], a[172:175], a[236:239]
    v_cvt_pk_bf16_f32 v182, v116, v117
    v_cvt_pk_bf16_f32 v183, v118, v119
    v_mfma_f32_16x16x32_bf16 a[232:235], a[156:159], a[168:171], a[232:235]
    v_cvt_pk_bf16_f32 v184, v184, v185
    v_cvt_pk_bf16_f32 v185, v186, v187
    v_mfma_f32_16x16x32_bf16 a[228:231], a[156:159], a[164:167], a[228:231]
    v_cvt_pk_bf16_f32 v186, v120, v121
    v_cvt_pk_bf16_f32 v187, v122, v123
    v_mfma_f32_16x16x32_bf16 a[224:227], a[156:159], a[160:163], a[224:227]
    v_cvt_pk_bf16_f32 v188, v188, v189
    v_cvt_pk_bf16_f32 v189, v190, v191
    v_cvt_pk_bf16_f32 v190, v124, v125
    v_cvt_pk_bf16_f32 v191, v126, v127
    v_accvgpr_read_b32 v40, a192
    v_accvgpr_read_b32 v41, a193
    v_accvgpr_read_b32 v42, a194
    v_accvgpr_read_b32 v43, a195
    v_cvt_pk_bf16_f32 v192, v192, v193
    v_cvt_pk_bf16_f32 v193, v194, v195
    v_cvt_pk_bf16_f32 v194, v40, v41
    v_cvt_pk_bf16_f32 v195, v42, v43
    v_accvgpr_read_b32 v44, a196
    v_accvgpr_read_b32 v45, a197
    v_accvgpr_read_b32 v46, a198
    v_accvgpr_read_b32 v47, a199
    v_cvt_pk_bf16_f32 v196, v196, v197
    v_cvt_pk_bf16_f32 v197, v198, v199
    v_cvt_pk_bf16_f32 v198, v44, v45
    v_cvt_pk_bf16_f32 v199, v46, v47
    v_accvgpr_read_b32 v40, a200
    v_accvgpr_read_b32 v41, a201
    v_accvgpr_read_b32 v42, a202
    v_accvgpr_read_b32 v43, a203
    v_cvt_pk_bf16_f32 v200, v200, v201
    v_cvt_pk_bf16_f32 v201, v202, v203
    v_cvt_pk_bf16_f32 v202, v40, v41
    v_cvt_pk_bf16_f32 v203, v42, v43
    v_accvgpr_read_b32 v44, a204
    v_accvgpr_read_b32 v45, a205
    v_accvgpr_read_b32 v46, a206
    v_accvgpr_read_b32 v47, a207
    v_cvt_pk_bf16_f32 v204, v204, v205
    v_cvt_pk_bf16_f32 v205, v206, v207
    v_cvt_pk_bf16_f32 v206, v44, v45
    v_cvt_pk_bf16_f32 v207, v46, v47
    v_accvgpr_read_b32 v40, a208
    v_accvgpr_read_b32 v41, a209
    v_accvgpr_read_b32 v42, a210
    v_accvgpr_read_b32 v43, a211
    v_cvt_pk_bf16_f32 v208, v208, v209
    v_cvt_pk_bf16_f32 v209, v210, v211
    v_cvt_pk_bf16_f32 v210, v40, v41
    v_cvt_pk_bf16_f32 v211, v42, v43
    v_accvgpr_read_b32 v44, a212
    v_accvgpr_read_b32 v45, a213
    v_accvgpr_read_b32 v46, a214
    v_accvgpr_read_b32 v47, a215
    v_cvt_pk_bf16_f32 v212, v212, v213
    v_cvt_pk_bf16_f32 v213, v214, v215
    v_cvt_pk_bf16_f32 v214, v44, v45
    v_cvt_pk_bf16_f32 v215, v46, v47
    v_accvgpr_read_b32 v40, a216
    v_accvgpr_read_b32 v41, a217
    v_accvgpr_read_b32 v42, a218
    v_accvgpr_read_b32 v43, a219
    v_cvt_pk_bf16_f32 v216, v216, v217
    v_cvt_pk_bf16_f32 v217, v218, v219
    v_cvt_pk_bf16_f32 v218, v40, v41
    v_cvt_pk_bf16_f32 v219, v42, v43
    v_accvgpr_read_b32 v44, a220
    v_accvgpr_read_b32 v45, a221
    v_accvgpr_read_b32 v46, a222
    v_accvgpr_read_b32 v47, a223
    v_cvt_pk_bf16_f32 v220, v220, v221
    v_cvt_pk_bf16_f32 v221, v222, v223
    v_cvt_pk_bf16_f32 v222, v44, v45
    v_cvt_pk_bf16_f32 v223, v46, v47
    v_accvgpr_read_b32 v40, a224
    v_accvgpr_read_b32 v41, a225
    v_accvgpr_read_b32 v42, a226
    v_accvgpr_read_b32 v43, a227
    v_cvt_pk_bf16_f32 v224, v224, v225
    v_cvt_pk_bf16_f32 v225, v226, v227
    v_cvt_pk_bf16_f32 v226, v40, v41
    v_cvt_pk_bf16_f32 v227, v42, v43
    v_accvgpr_read_b32 v44, a228
    v_accvgpr_read_b32 v45, a229
    v_accvgpr_read_b32 v46, a230
    v_accvgpr_read_b32 v47, a231
    v_cvt_pk_bf16_f32 v228, v228, v229
    v_cvt_pk_bf16_f32 v229, v230, v231
    v_cvt_pk_bf16_f32 v230, v44, v45
    v_cvt_pk_bf16_f32 v231, v46, v47
    v_accvgpr_read_b32 v40, a232
    v_accvgpr_read_b32 v41, a233
    v_accvgpr_read_b32 v42, a234
    v_accvgpr_read_b32 v43, a235
    v_cvt_pk_bf16_f32 v232, v232, v233
    v_cvt_pk_bf16_f32 v233, v234, v235
    v_cvt_pk_bf16_f32 v234, v40, v41
    v_cvt_pk_bf16_f32 v235, v42, v43
    v_accvgpr_read_b32 v44, a236
    v_accvgpr_read_b32 v45, a237
    v_accvgpr_read_b32 v46, a238
    v_accvgpr_read_b32 v47, a239
    v_cvt_pk_bf16_f32 v236, v236, v237
    v_cvt_pk_bf16_f32 v237, v238, v239
    v_cvt_pk_bf16_f32 v238, v44, v45
    v_cvt_pk_bf16_f32 v239, v46, v47
    v_accvgpr_read_b32 v40, a240
    v_accvgpr_read_b32 v41, a241
    v_accvgpr_read_b32 v42, a242
    v_accvgpr_read_b32 v43, a243
    v_cvt_pk_bf16_f32 v240, v240, v241
    v_cvt_pk_bf16_f32 v241, v242, v243
    v_cvt_pk_bf16_f32 v242, v40, v41
    v_cvt_pk_bf16_f32 v243, v42, v43
    v_accvgpr_read_b32 v44, a244
    v_accvgpr_read_b32 v45, a245
    v_accvgpr_read_b32 v46, a246
    v_accvgpr_read_b32 v47, a247
    v_cvt_pk_bf16_f32 v244, v244, v245
    v_cvt_pk_bf16_f32 v245, v246, v247
    v_cvt_pk_bf16_f32 v246, v44, v45
    v_cvt_pk_bf16_f32 v247, v46, v47
    v_accvgpr_read_b32 v40, a248
    v_accvgpr_read_b32 v41, a249
    v_accvgpr_read_b32 v42, a250
    v_accvgpr_read_b32 v43, a251
    v_cvt_pk_bf16_f32 v248, v248, v249
    v_cvt_pk_bf16_f32 v249, v250, v251
    v_cvt_pk_bf16_f32 v250, v40, v41
    v_cvt_pk_bf16_f32 v251, v42, v43
    v_accvgpr_read_b32 v44, a252
    v_accvgpr_read_b32 v45, a253
    v_accvgpr_read_b32 v46, a254
    v_accvgpr_read_b32 v47, a255
    v_cvt_pk_bf16_f32 v252, v252, v253
    v_cvt_pk_bf16_f32 v253, v254, v255
    v_cvt_pk_bf16_f32 v254, v44, v45
    v_cvt_pk_bf16_f32 v255, v46, v47
L_p1_done:
    s_waitcnt vmcnt(18) lgkmcnt(0)
    s_nop 0
    v_mfma_f32_16x16x32_bf16 v[88:91], a[64:67], a[0:3], 0
    s_nop 0
    s_barrier
    v_mfma_f32_16x16x32_bf16 v[92:95], a[64:67], a[4:7], 0
    s_add_u32 s75, s66, 16384
    ds_read_b64_tr_b16 a[112:113], v20 offset:12288
    v_mfma_f32_16x16x32_bf16 v[96:99], a[64:67], a[8:11], 0
    buffer_load_dwordx4 v[4:7], v36, s[52:55], s75 offen sc1
    v_mfma_f32_16x16x32_bf16 v[100:103], a[64:67], a[12:15], 0
    ds_read_b64_tr_b16 a[114:115], v20 offset:13312
    v_add_u32 v20, 4294836224, v20
    v_mfma_f32_16x16x32_bf16 v[116:119], a[68:71], a[12:15], 0
    ds_read_b64_tr_b16 a[116:117], v21 offset:12288
    v_mfma_f32_16x16x32_bf16 v[112:115], a[68:71], a[8:11], 0
    ds_read_b64_tr_b16 a[118:119], v21 offset:13312
    v_add_u32 v21, 4294836224, v21
    v_mfma_f32_16x16x32_bf16 v[108:111], a[68:71], a[4:7], 0
    buffer_load_dwordx4 v[8:11], v37, s[52:55], s75 offen sc1
    v_mfma_f32_16x16x32_bf16 v[104:107], a[68:71], a[0:3], 0
    ds_read_b64_tr_b16 a[120:121], v22 offset:12288
    v_mfma_f32_16x16x32_bf16 v[120:123], a[72:75], a[0:3], 0
    ds_read_b64_tr_b16 a[122:123], v22 offset:13312
    v_add_u32 v22, 4294836224, v22
    v_mfma_f32_16x16x32_bf16 v[124:127], a[72:75], a[4:7], 0
    ds_read_b64_tr_b16 a[124:125], v23 offset:12288
    v_mfma_f32_16x16x32_bf16 a[160:163], a[72:75], a[8:11], 0
    s_add_u32 s75, s67, 16384
    ds_read_b64_tr_b16 a[126:127], v23 offset:13312
    v_add_u32 v23, 4294836224, v23
    v_mfma_f32_16x16x32_bf16 a[164:167], a[72:75], a[12:15], 0
    buffer_load_dwordx4 v[12:15], v36, s[52:55], s75 offen sc1
    v_mfma_f32_16x16x32_bf16 a[180:183], a[76:79], a[12:15], 0
    ds_read_b64_tr_b16 a[128:129], v24 offset:12288
    v_mfma_f32_16x16x32_bf16 a[176:179], a[76:79], a[8:11], 0
    ds_read_b64_tr_b16 a[130:131], v24 offset:13312
    v_add_u32 v24, 4294836224, v24
    v_mfma_f32_16x16x32_bf16 a[172:175], a[76:79], a[4:7], 0
    ds_read_b64_tr_b16 a[132:133], v25 offset:12288
    v_mfma_f32_16x16x32_bf16 a[168:171], a[76:79], a[0:3], 0
    ds_read_b64_tr_b16 a[134:135], v25 offset:13312
    v_add_u32 v25, 4294836224, v25
    v_mfma_f32_16x16x32_bf16 a[184:187], a[80:83], a[0:3], 0
    buffer_load_dwordx4 v[32:35], v37, s[52:55], s75 offen sc1
    v_mfma_f32_16x16x32_bf16 a[188:191], a[80:83], a[4:7], 0
    ds_read_b64_tr_b16 a[136:137], v26 offset:12288
    v_mfma_f32_16x16x32_bf16 a[192:195], a[80:83], a[8:11], 0
    ds_read_b64_tr_b16 a[138:139], v26 offset:13312
    v_add_u32 v26, 4294836224, v26
    v_mfma_f32_16x16x32_bf16 a[196:199], a[80:83], a[12:15], 0
    s_add_u32 m0, s71, 102400
    s_mov_b32 s72, 2621440
    ds_read_b64_tr_b16 a[140:141], v27 offset:12288
    v_mfma_f32_16x16x32_bf16 a[212:215], a[84:87], a[12:15], 0
    buffer_load_dwordx4 v28, s[44:47], s72 offen lds
    v_mfma_f32_16x16x32_bf16 a[208:211], a[84:87], a[8:11], 0
    ds_read_b64_tr_b16 a[142:143], v27 offset:13312
    v_add_u32 v27, 4294836224, v27
    v_mfma_f32_16x16x32_bf16 a[204:207], a[84:87], a[4:7], 0
    ds_read_b64_tr_b16 a[144:145], v16 offset:12288
    v_mfma_f32_16x16x32_bf16 a[200:203], a[84:87], a[0:3], 0
    ds_read_b64_tr_b16 a[146:147], v16 offset:12800
    v_add_u32 v16, 4294836224, v16
    v_mfma_f32_16x16x32_bf16 a[216:219], a[88:91], a[0:3], 0
    ds_read_b64_tr_b16 a[148:149], v17 offset:12288
    v_mfma_f32_16x16x32_bf16 a[220:223], a[88:91], a[4:7], 0
    buffer_load_dwordx4 v29, s[44:47], s72 offen offset:1024 lds
    v_mfma_f32_16x16x32_bf16 a[224:227], a[88:91], a[8:11], 0
    ds_read_b64_tr_b16 a[150:151], v17 offset:12800
    v_add_u32 v17, 4294836224, v17
    v_mfma_f32_16x16x32_bf16 a[228:231], a[88:91], a[12:15], 0
    ds_read_b64_tr_b16 a[152:153], v18 offset:12288
    v_mfma_f32_16x16x32_bf16 a[244:247], a[92:95], a[12:15], 0
    ds_read_b64_tr_b16 a[154:155], v18 offset:12800
    v_add_u32 v18, 4294836224, v18
    v_mfma_f32_16x16x32_bf16 a[240:243], a[92:95], a[8:11], 0
    s_nop 0
    s_add_u32 s77, s76, 0
    ds_read_b64_tr_b16 a[156:157], v19 offset:12288
    v_mfma_f32_16x16x32_bf16 a[236:239], a[92:95], a[4:7], 0
    s_nop 0
    s_mov_b32 s48, s32
    buffer_store_dwordx4 v[128:131], v2, s[52:55], s77 offen offset:0 sc1
    v_mfma_f32_16x16x32_bf16 a[232:235], a[92:95], a[0:3], 0
    s_nop 0
    s_mov_b32 s49, s33
    ds_read_b64_tr_b16 a[158:159], v19 offset:12800
    v_add_u32 v19, 4294836224, v19
    v_mfma_f32_16x16x32_bf16 v[40:43], a[96:99], a[0:3], 0
    s_mov_b32 s50, 2752
    v_mfma_f32_16x16x32_bf16 v[44:47], a[96:99], a[4:7], 0
    s_mov_b32 s51, 0x00020000
    v_mfma_f32_16x16x32_bf16 v[48:51], a[96:99], a[8:11], 0
    s_nop 0
    s_lshl_b32 s3, s68, 6
    v_mfma_f32_16x16x32_bf16 v[52:55], a[96:99], a[12:15], 0
    s_nop 0
    s_add_u32 s12, s69, s3
    v_mfma_f32_16x16x32_bf16 v[68:71], a[100:103], a[12:15], 0
    s_nop 0
    s_sub_u32 s13, s69, s3
    v_mfma_f32_16x16x32_bf16 v[64:67], a[100:103], a[8:11], 0
    s_nop 0
    s_add_u32 s13, s13, 64
    v_mfma_f32_16x16x32_bf16 v[60:63], a[100:103], a[4:7], 0
    s_add_u32 m0, s73, 110592
    s_mov_b32 s72, 880640
    v_mfma_f32_16x16x32_bf16 v[56:59], a[100:103], a[0:3], 0
    buffer_load_dwordx4 v30, s[60:63], s72 offen lds
    v_mfma_f32_16x16x32_bf16 v[72:75], a[104:107], a[0:3], 0
    v_lshrrev_b32_e64 v38, 4, v1
    v_mfma_f32_16x16x32_bf16 v[76:79], a[104:107], a[4:7], 0
    v_lshlrev_b32_e64 v38, 3, v38
    v_mfma_f32_16x16x32_bf16 v[84:87], a[108:111], a[4:7], 0
    s_nop 0
    s_waitcnt vmcnt(22) lgkmcnt(0)
    v_mfma_f32_16x16x32_bf16 v[80:83], a[108:111], a[0:3], 0
    v_mfma_f32_16x16x32_bf16 v[88:91], a[112:115], a[16:19], v[88:91]
    v_mfma_f32_16x16x32_bf16 v[92:95], a[112:115], a[20:23], v[92:95]
    ds_read_b64_tr_b16 a[64:65], v20 offset:0
    v_mfma_f32_16x16x32_bf16 v[96:99], a[112:115], a[24:27], v[96:99]
    buffer_load_dwordx2 a[250:251], v38, s[48:51], s12 offen offset:32
    v_mfma_f32_16x16x32_bf16 v[100:103], a[112:115], a[28:31], v[100:103]
    ds_read_b64_tr_b16 a[66:67], v20 offset:1024
    v_mfma_f32_16x16x32_bf16 v[116:119], a[116:119], a[28:31], v[116:119]
    ds_read_b64_tr_b16 a[68:69], v21 offset:0
    v_mfma_f32_16x16x32_bf16 v[112:115], a[116:119], a[24:27], v[112:115]
    buffer_load_dwordx2 a[248:249], v38, s[48:51], s12 offen offset:0
    v_mfma_f32_16x16x32_bf16 v[108:111], a[116:119], a[20:23], v[108:111]
    ds_read_b64_tr_b16 a[70:71], v21 offset:1024
    v_mfma_f32_16x16x32_bf16 v[104:107], a[116:119], a[16:19], v[104:107]
    ds_read_b64_tr_b16 a[72:73], v22 offset:0
    v_mfma_f32_16x16x32_bf16 v[120:123], a[120:123], a[16:19], v[120:123]
    s_add_u32 s75, s66, 20480
    ds_read_b64_tr_b16 a[74:75], v22 offset:1024
    v_mfma_f32_16x16x32_bf16 v[124:127], a[120:123], a[20:23], v[124:127]
    buffer_load_dwordx4 a[0:3], v36, s[52:55], s75 offen sc1
    v_mfma_f32_16x16x32_bf16 a[160:163], a[120:123], a[24:27], a[160:163]
    ds_read_b64_tr_b16 a[76:77], v23 offset:0
    v_mfma_f32_16x16x32_bf16 a[164:167], a[120:123], a[28:31], a[164:167]
    ds_read_b64_tr_b16 a[78:79], v23 offset:1024
    v_mfma_f32_16x16x32_bf16 a[180:183], a[124:127], a[28:31], a[180:183]
    ds_read_b64_tr_b16 a[80:81], v24 offset:0
    v_mfma_f32_16x16x32_bf16 a[176:179], a[124:127], a[24:27], a[176:179]
    buffer_load_dwordx4 a[4:7], v37, s[52:55], s75 offen sc1
    v_mfma_f32_16x16x32_bf16 a[172:175], a[124:127], a[20:23], a[172:175]
    ds_read_b64_tr_b16 a[82:83], v24 offset:1024
    v_mfma_f32_16x16x32_bf16 a[168:171], a[124:127], a[16:19], a[168:171]
    s_add_u32 s75, s67, 20480
    ds_read_b64_tr_b16 a[84:85], v25 offset:0
    v_mfma_f32_16x16x32_bf16 a[184:187], a[128:131], a[16:19], a[184:187]
    buffer_load_dwordx4 a[8:11], v36, s[52:55], s75 offen sc1
    v_mfma_f32_16x16x32_bf16 a[188:191], a[128:131], a[20:23], a[188:191]
    ds_read_b64_tr_b16 a[86:87], v25 offset:1024
    v_mfma_f32_16x16x32_bf16 a[192:195], a[128:131], a[24:27], a[192:195]
    ds_read_b64_tr_b16 a[88:89], v26 offset:0
    v_mfma_f32_16x16x32_bf16 a[196:199], a[128:131], a[28:31], a[196:199]
    ds_read_b64_tr_b16 a[90:91], v26 offset:1024
    v_mfma_f32_16x16x32_bf16 a[212:215], a[132:135], a[28:31], a[212:215]
    buffer_load_dwordx4 a[12:15], v37, s[52:55], s75 offen sc1
    v_mfma_f32_16x16x32_bf16 a[208:211], a[132:135], a[24:27], a[208:211]
    ds_read_b64_tr_b16 a[92:93], v27 offset:0
    v_mfma_f32_16x16x32_bf16 a[204:207], a[132:135], a[20:23], a[204:207]
    ds_read_b64_tr_b16 a[94:95], v27 offset:1024
    v_mfma_f32_16x16x32_bf16 a[200:203], a[132:135], a[16:19], a[200:203]
    s_add_u32 m0, s71, 114688
    s_mov_b32 s72, 2883584
    ds_read_b64_tr_b16 a[96:97], v16 offset:0
    v_mfma_f32_16x16x32_bf16 a[216:219], a[136:139], a[16:19], a[216:219]
    buffer_load_dwordx4 v28, s[44:47], s72 offen lds
    v_mfma_f32_16x16x32_bf16 a[220:223], a[136:139], a[20:23], a[220:223]
    ds_read_b64_tr_b16 a[98:99], v16 offset:512
    v_mfma_f32_16x16x32_bf16 a[224:227], a[136:139], a[24:27], a[224:227]
    ds_read_b64_tr_b16 a[100:101], v17 offset:0
    v_mfma_f32_16x16x32_bf16 a[228:231], a[136:139], a[28:31], a[228:231]
    buffer_load_dwordx4 v29, s[44:47], s72 offen offset:1024 lds
    v_mfma_f32_16x16x32_bf16 a[244:247], a[140:143], a[28:31], a[244:247]
    ds_read_b64_tr_b16 a[102:103], v17 offset:512
    v_mfma_f32_16x16x32_bf16 a[240:243], a[140:143], a[24:27], a[240:243]
    s_nop 0
    s_add_u32 s77, s76, 0
    ds_read_b64_tr_b16 a[104:105], v18 offset:0
    v_mfma_f32_16x16x32_bf16 a[236:239], a[140:143], a[20:23], a[236:239]
    buffer_store_dwordx4 v[132:135], v2, s[52:55], s77 offen offset:1024 sc1
    v_mfma_f32_16x16x32_bf16 a[232:235], a[140:143], a[16:19], a[232:235]
    ds_read_b64_tr_b16 a[106:107], v18 offset:512
    v_mfma_f32_16x16x32_bf16 v[40:43], a[144:147], a[16:19], v[40:43]
    ds_read_b64_tr_b16 a[108:109], v19 offset:0
    v_mfma_f32_16x16x32_bf16 v[44:47], a[144:147], a[20:23], v[44:47]
    ds_read_b64_tr_b16 a[110:111], v19 offset:512
    v_mfma_f32_16x16x32_bf16 v[48:51], a[144:147], a[24:27], v[48:51]
    v_mfma_f32_16x16x32_bf16 v[52:55], a[144:147], a[28:31], v[52:55]
    v_mfma_f32_16x16x32_bf16 v[68:71], a[148:151], a[28:31], v[68:71]
    v_mfma_f32_16x16x32_bf16 v[64:67], a[148:151], a[24:27], v[64:67]
    v_mfma_f32_16x16x32_bf16 v[60:63], a[148:151], a[20:23], v[60:63]
    v_mfma_f32_16x16x32_bf16 v[56:59], a[148:151], a[16:19], v[56:59]
    s_add_u32 m0, s73, 122880
    s_mov_b32 s72, 968704
    v_mfma_f32_16x16x32_bf16 v[72:75], a[152:155], a[16:19], v[72:75]
    buffer_load_dwordx4 v30, s[60:63], s72 offen lds
    v_mfma_f32_16x16x32_bf16 v[76:79], a[152:155], a[20:23], v[76:79]
    v_mfma_f32_16x16x32_bf16 v[84:87], a[156:159], a[20:23], v[84:87]
    s_nop 0
    s_waitcnt vmcnt(22) lgkmcnt(0)
    v_mfma_f32_16x16x32_bf16 v[80:83], a[156:159], a[16:19], v[80:83]
    v_mfma_f32_16x16x32_bf16 v[88:91], a[64:67], a[32:35], v[88:91]
    v_mfma_f32_16x16x32_bf16 v[92:95], a[64:67], a[36:39], v[92:95]
    ds_read_b64_tr_b16 a[112:113], v20 offset:12288
    v_mfma_f32_16x16x32_bf16 v[96:99], a[64:67], a[40:43], v[96:99]
    ds_read_b64_tr_b16 a[114:115], v20 offset:13312
    v_add_u32 v20, 65536, v20
    v_mfma_f32_16x16x32_bf16 v[100:103], a[64:67], a[44:47], v[100:103]
    ds_read_b64_tr_b16 a[116:117], v21 offset:12288
    v_mfma_f32_16x16x32_bf16 v[116:119], a[68:71], a[44:47], v[116:119]
    ds_read_b64_tr_b16 a[118:119], v21 offset:13312
    v_add_u32 v21, 65536, v21
    v_mfma_f32_16x16x32_bf16 v[112:115], a[68:71], a[40:43], v[112:115]
    buffer_load_dwordx2 a[254:255], v38, s[48:51], s13 offen offset:32
    v_mfma_f32_16x16x32_bf16 v[108:111], a[68:71], a[36:39], v[108:111]
    ds_read_b64_tr_b16 a[120:121], v22 offset:12288
    v_mfma_f32_16x16x32_bf16 v[104:107], a[68:71], a[32:35], v[104:107]
    buffer_load_dwordx2 a[252:253], v38, s[48:51], s13 offen offset:0
    v_mfma_f32_16x16x32_bf16 v[120:123], a[72:75], a[32:35], v[120:123]
    ds_read_b64_tr_b16 a[122:123], v22 offset:13312
    v_add_u32 v22, 65536, v22
    v_mfma_f32_16x16x32_bf16 v[124:127], a[72:75], a[36:39], v[124:127]
    s_add_u32 s75, s66, 24576
    ds_read_b64_tr_b16 a[124:125], v23 offset:12288
    v_mfma_f32_16x16x32_bf16 a[160:163], a[72:75], a[40:43], a[160:163]
    buffer_load_dwordx4 a[16:19], v36, s[52:55], s75 offen sc1
    v_mfma_f32_16x16x32_bf16 a[164:167], a[72:75], a[44:47], a[164:167]
    ds_read_b64_tr_b16 a[126:127], v23 offset:13312
    v_add_u32 v23, 65536, v23
    v_mfma_f32_16x16x32_bf16 a[180:183], a[76:79], a[44:47], a[180:183]
    ds_read_b64_tr_b16 a[128:129], v24 offset:12288
    v_mfma_f32_16x16x32_bf16 a[176:179], a[76:79], a[40:43], a[176:179]
    buffer_load_dwordx4 a[20:23], v37, s[52:55], s75 offen sc1
    v_mfma_f32_16x16x32_bf16 a[172:175], a[76:79], a[36:39], a[172:175]
    ds_read_b64_tr_b16 a[130:131], v24 offset:13312
    v_add_u32 v24, 65536, v24
    v_mfma_f32_16x16x32_bf16 a[168:171], a[76:79], a[32:35], a[168:171]
    s_nop 0
    s_add_u32 s77, s76, 0
    ds_read_b64_tr_b16 a[132:133], v25 offset:12288
    v_mfma_f32_16x16x32_bf16 a[184:187], a[80:83], a[32:35], a[184:187]
    buffer_store_dwordx4 v[136:139], v2, s[52:55], s77 offen offset:2048 sc1
    v_mfma_f32_16x16x32_bf16 a[188:191], a[80:83], a[36:39], a[188:191]
    ds_read_b64_tr_b16 a[134:135], v25 offset:13312
    v_add_u32 v25, 65536, v25
    v_mfma_f32_16x16x32_bf16 a[192:195], a[80:83], a[40:43], a[192:195]
    ds_read_b64_tr_b16 a[136:137], v26 offset:12288
    v_mfma_f32_16x16x32_bf16 a[196:199], a[80:83], a[44:47], a[196:199]
    ds_read_b64_tr_b16 a[138:139], v26 offset:13312
    v_add_u32 v26, 65536, v26
    v_mfma_f32_16x16x32_bf16 a[212:215], a[84:87], a[44:47], a[212:215]
    ds_read_b64_tr_b16 a[140:141], v27 offset:12288
    v_mfma_f32_16x16x32_bf16 a[208:211], a[84:87], a[40:43], a[208:211]
    ds_read_b64_tr_b16 a[142:143], v27 offset:13312
    v_add_u32 v27, 65536, v27
    v_mfma_f32_16x16x32_bf16 a[204:207], a[84:87], a[36:39], a[204:207]
    ds_read_b64_tr_b16 a[144:145], v16 offset:12288
    v_mfma_f32_16x16x32_bf16 a[200:203], a[84:87], a[32:35], a[200:203]
    ds_read_b64_tr_b16 a[146:147], v16 offset:12800
    v_add_u32 v16, 65536, v16
    v_mfma_f32_16x16x32_bf16 a[216:219], a[88:91], a[32:35], a[216:219]
    s_add_u32 s75, s67, 24576
    ds_read_b64_tr_b16 a[148:149], v17 offset:12288
    v_mfma_f32_16x16x32_bf16 a[220:223], a[88:91], a[36:39], a[220:223]
    buffer_load_dwordx4 a[24:27], v36, s[52:55], s75 offen sc1
    v_mfma_f32_16x16x32_bf16 a[224:227], a[88:91], a[40:43], a[224:227]
    ds_read_b64_tr_b16 a[150:151], v17 offset:12800
    v_add_u32 v17, 65536, v17
    v_mfma_f32_16x16x32_bf16 a[228:231], a[88:91], a[44:47], a[228:231]
    ds_read_b64_tr_b16 a[152:153], v18 offset:12288
    v_mfma_f32_16x16x32_bf16 a[244:247], a[92:95], a[44:47], a[244:247]
    buffer_load_dwordx4 a[28:31], v37, s[52:55], s75 offen sc1
    v_mfma_f32_16x16x32_bf16 a[240:243], a[92:95], a[40:43], a[240:243]
    ds_read_b64_tr_b16 a[154:155], v18 offset:12800
    v_add_u32 v18, 65536, v18
    v_mfma_f32_16x16x32_bf16 a[236:239], a[92:95], a[36:39], a[236:239]
    s_add_u32 m0, s71, 131072
    s_mov_b32 s72, 3145728
    ds_read_b64_tr_b16 a[156:157], v19 offset:12288
    v_mfma_f32_16x16x32_bf16 a[232:235], a[92:95], a[32:35], a[232:235]
    buffer_load_dwordx4 v28, s[44:47], s72 offen lds
    v_mfma_f32_16x16x32_bf16 v[40:43], a[96:99], a[32:35], v[40:43]
    ds_read_b64_tr_b16 a[158:159], v19 offset:12800
    v_add_u32 v19, 65536, v19
    v_mfma_f32_16x16x32_bf16 v[44:47], a[96:99], a[36:39], v[44:47]
    v_mfma_f32_16x16x32_bf16 v[48:51], a[96:99], a[40:43], v[48:51]
    buffer_load_dwordx4 v29, s[44:47], s72 offen offset:1024 lds
    v_mfma_f32_16x16x32_bf16 v[52:55], a[96:99], a[44:47], v[52:55]
    v_mfma_f32_16x16x32_bf16 v[68:71], a[100:103], a[44:47], v[68:71]
    s_add_u32 m0, s73, 139264
    s_mov_b32 s72, 1056768
    v_mfma_f32_16x16x32_bf16 v[64:67], a[100:103], a[40:43], v[64:67]
    buffer_load_dwordx4 v30, s[60:63], s72 offen lds
    v_mfma_f32_16x16x32_bf16 v[60:63], a[100:103], a[36:39], v[60:63]
    v_mfma_f32_16x16x32_bf16 v[56:59], a[100:103], a[32:35], v[56:59]
    v_mfma_f32_16x16x32_bf16 v[72:75], a[104:107], a[32:35], v[72:75]
    buffer_store_dwordx4 v[140:143], v2, s[52:55], s77 offen offset:3072 sc1
    v_mfma_f32_16x16x32_bf16 v[76:79], a[104:107], a[36:39], v[76:79]
    v_mfma_f32_16x16x32_bf16 v[84:87], a[108:111], a[36:39], v[84:87]
    s_nop 0
    s_waitcnt vmcnt(29) lgkmcnt(0)
    v_mfma_f32_16x16x32_bf16 v[80:83], a[108:111], a[32:35], v[80:83]
    v_mfma_f32_16x16x32_bf16 v[88:91], a[112:115], a[48:51], v[88:91]
    v_mfma_f32_16x16x32_bf16 v[92:95], a[112:115], a[52:55], v[92:95]
    ds_read_b64_tr_b16 a[64:65], v20 offset:0
    v_mfma_f32_16x16x32_bf16 v[96:99], a[112:115], a[56:59], v[96:99]
    ds_read_b64_tr_b16 a[66:67], v20 offset:1024
    v_mfma_f32_16x16x32_bf16 v[100:103], a[112:115], a[60:63], v[100:103]
    ds_read_b64_tr_b16 a[68:69], v21 offset:0
    v_mfma_f32_16x16x32_bf16 v[116:119], a[116:119], a[60:63], v[116:119]
    s_add_u32 s75, s66, 28672
    ds_read_b64_tr_b16 a[70:71], v21 offset:1024
    v_mfma_f32_16x16x32_bf16 v[112:115], a[116:119], a[56:59], v[112:115]
    buffer_load_dwordx4 a[32:35], v36, s[52:55], s75 offen sc1
    v_mfma_f32_16x16x32_bf16 v[108:111], a[116:119], a[52:55], v[108:111]
    ds_read_b64_tr_b16 a[72:73], v22 offset:0
    v_mfma_f32_16x16x32_bf16 v[104:107], a[116:119], a[48:51], v[104:107]
    ds_read_b64_tr_b16 a[74:75], v22 offset:1024
    v_mfma_f32_16x16x32_bf16 v[120:123], a[120:123], a[48:51], v[120:123]
    ds_read_b64_tr_b16 a[76:77], v23 offset:0
    v_mfma_f32_16x16x32_bf16 v[124:127], a[120:123], a[52:55], v[124:127]
    ds_read_b64_tr_b16 a[78:79], v23 offset:1024
    v_mfma_f32_16x16x32_bf16 a[160:163], a[120:123], a[56:59], a[160:163]
    ds_read_b64_tr_b16 a[80:81], v24 offset:0
    v_mfma_f32_16x16x32_bf16 a[164:167], a[120:123], a[60:63], a[164:167]
    buffer_load_dwordx4 a[36:39], v37, s[52:55], s75 offen sc1
    v_mfma_f32_16x16x32_bf16 a[180:183], a[124:127], a[60:63], a[180:183]
    ds_read_b64_tr_b16 a[82:83], v24 offset:1024
    v_mfma_f32_16x16x32_bf16 a[176:179], a[124:127], a[56:59], a[176:179]
    ds_read_b64_tr_b16 a[84:85], v25 offset:0
    v_mfma_f32_16x16x32_bf16 a[172:175], a[124:127], a[52:55], a[172:175]
    ds_read_b64_tr_b16 a[86:87], v25 offset:1024
    v_mfma_f32_16x16x32_bf16 a[168:171], a[124:127], a[48:51], a[168:171]
    s_add_u32 s77, s76, 4096
    ds_read_b64_tr_b16 a[88:89], v26 offset:0
    v_mfma_f32_16x16x32_bf16 a[184:187], a[128:131], a[48:51], a[184:187]
    buffer_store_dwordx4 v[144:147], v2, s[52:55], s77 offen offset:0 sc1
    v_mfma_f32_16x16x32_bf16 a[188:191], a[128:131], a[52:55], a[188:191]
    ds_read_b64_tr_b16 a[90:91], v26 offset:1024
    v_mfma_f32_16x16x32_bf16 a[192:195], a[128:131], a[56:59], a[192:195]
    ds_read_b64_tr_b16 a[92:93], v27 offset:0
    v_mfma_f32_16x16x32_bf16 a[196:199], a[128:131], a[60:63], a[196:199]
    ds_read_b64_tr_b16 a[94:95], v27 offset:1024
    v_mfma_f32_16x16x32_bf16 a[212:215], a[132:135], a[60:63], a[212:215]
    ds_read_b64_tr_b16 a[96:97], v16 offset:0
    v_mfma_f32_16x16x32_bf16 a[208:211], a[132:135], a[56:59], a[208:211]
    ds_read_b64_tr_b16 a[98:99], v16 offset:512
    v_mfma_f32_16x16x32_bf16 a[204:207], a[132:135], a[52:55], a[204:207]
    ds_read_b64_tr_b16 a[100:101], v17 offset:0
    v_mfma_f32_16x16x32_bf16 a[200:203], a[132:135], a[48:51], a[200:203]
    ds_read_b64_tr_b16 a[102:103], v17 offset:512
    v_mfma_f32_16x16x32_bf16 a[216:219], a[136:139], a[48:51], a[216:219]
    ds_read_b64_tr_b16 a[104:105], v18 offset:0
    v_mfma_f32_16x16x32_bf16 a[220:223], a[136:139], a[52:55], a[220:223]
    ds_read_b64_tr_b16 a[106:107], v18 offset:512
    v_mfma_f32_16x16x32_bf16 a[224:227], a[136:139], a[56:59], a[224:227]
    s_add_u32 s75, s67, 28672
    ds_read_b64_tr_b16 a[108:109], v19 offset:0
    v_mfma_f32_16x16x32_bf16 a[228:231], a[136:139], a[60:63], a[228:231]
    buffer_load_dwordx4 a[40:43], v36, s[52:55], s75 offen sc1
    v_mfma_f32_16x16x32_bf16 a[244:247], a[140:143], a[60:63], a[244:247]
    ds_read_b64_tr_b16 a[110:111], v19 offset:512
    v_mfma_f32_16x16x32_bf16 a[240:243], a[140:143], a[56:59], a[240:243]
    v_mfma_f32_16x16x32_bf16 a[236:239], a[140:143], a[52:55], a[236:239]
    v_mfma_f32_16x16x32_bf16 a[232:235], a[140:143], a[48:51], a[232:235]
    v_mfma_f32_16x16x32_bf16 v[40:43], a[144:147], a[48:51], v[40:43]
    v_mfma_f32_16x16x32_bf16 v[44:47], a[144:147], a[52:55], v[44:47]
    buffer_load_dwordx4 a[44:47], v37, s[52:55], s75 offen sc1
    v_mfma_f32_16x16x32_bf16 v[48:51], a[144:147], a[56:59], v[48:51]
    v_mfma_f32_16x16x32_bf16 v[52:55], a[144:147], a[60:63], v[52:55]
    v_mfma_f32_16x16x32_bf16 v[68:71], a[148:151], a[60:63], v[68:71]
    v_mfma_f32_16x16x32_bf16 v[64:67], a[148:151], a[56:59], v[64:67]
    v_mfma_f32_16x16x32_bf16 v[60:63], a[148:151], a[52:55], v[60:63]
    v_mfma_f32_16x16x32_bf16 v[56:59], a[148:151], a[48:51], v[56:59]
    v_mfma_f32_16x16x32_bf16 v[72:75], a[152:155], a[48:51], v[72:75]
    buffer_store_dwordx4 v[148:151], v2, s[52:55], s77 offen offset:1024 sc1
    v_mfma_f32_16x16x32_bf16 v[76:79], a[152:155], a[52:55], v[76:79]
    v_mfma_f32_16x16x32_bf16 v[84:87], a[156:159], a[52:55], v[84:87]
    s_nop 0
    s_waitcnt vmcnt(31) lgkmcnt(0)
    v_mfma_f32_16x16x32_bf16 v[80:83], a[156:159], a[48:51], v[80:83]
    v_mfma_f32_16x16x32_bf16 v[88:91], a[64:67], v[4:7], v[88:91]
    s_waitcnt vmcnt(27)
    s_barrier
    v_mfma_f32_16x16x32_bf16 v[92:95], a[64:67], v[8:11], v[92:95]
    ds_read_b64_tr_b16 a[112:113], v20 offset:12288
    v_mfma_f32_16x16x32_bf16 v[96:99], a[64:67], v[12:15], v[96:99]
    ds_read_b64_tr_b16 a[114:115], v20 offset:13312
    v_add_u32 v20, 4294901760, v20
    v_mfma_f32_16x16x32_bf16 v[100:103], a[64:67], v[32:35], v[100:103]
    ds_read_b64_tr_b16 a[116:117], v21 offset:12288
    v_mfma_f32_16x16x32_bf16 v[116:119], a[68:71], v[32:35], v[116:119]
    s_add_u32 s75, s66, 32768
    ds_read_b64_tr_b16 a[118:119], v21 offset:13312
    v_add_u32 v21, 4294901760, v21
    v_mfma_f32_16x16x32_bf16 v[112:115], a[68:71], v[12:15], v[112:115]
    buffer_load_dwordx4 a[48:51], v36, s[52:55], s75 offen sc1
    v_mfma_f32_16x16x32_bf16 v[108:111], a[68:71], v[8:11], v[108:111]
    ds_read_b64_tr_b16 a[120:121], v22 offset:12288
    v_mfma_f32_16x16x32_bf16 v[104:107], a[68:71], v[4:7], v[104:107]
    ds_read_b64_tr_b16 a[122:123], v22 offset:13312
    v_add_u32 v22, 4294901760, v22
    v_mfma_f32_16x16x32_bf16 v[120:123], a[72:75], v[4:7], v[120:123]
    buffer_load_dwordx4 a[52:55], v37, s[52:55], s75 offen sc1
    v_mfma_f32_16x16x32_bf16 v[124:127], a[72:75], v[8:11], v[124:127]
    ds_read_b64_tr_b16 a[124:125], v23 offset:12288
    v_mfma_f32_16x16x32_bf16 a[160:163], a[72:75], v[12:15], a[160:163]
    ds_read_b64_tr_b16 a[126:127], v23 offset:13312
    v_add_u32 v23, 4294901760, v23
    v_mfma_f32_16x16x32_bf16 a[164:167], a[72:75], v[32:35], a[164:167]
    s_add_u32 s75, s67, 32768
    ds_read_b64_tr_b16 a[128:129], v24 offset:12288
    v_mfma_f32_16x16x32_bf16 a[180:183], a[76:79], v[32:35], a[180:183]
    buffer_load_dwordx4 a[56:59], v36, s[52:55], s75 offen sc1
    v_mfma_f32_16x16x32_bf16 a[176:179], a[76:79], v[12:15], a[176:179]
    ds_read_b64_tr_b16 a[130:131], v24 offset:13312
    v_add_u32 v24, 4294901760, v24
    v_mfma_f32_16x16x32_bf16 a[172:175], a[76:79], v[8:11], a[172:175]
    ds_read_b64_tr_b16 a[132:133], v25 offset:12288
    v_mfma_f32_16x16x32_bf16 a[168:171], a[76:79], v[4:7], a[168:171]
    s_add_u32 s77, s76, 4096
    ds_read_b64_tr_b16 a[134:135], v25 offset:13312
    v_add_u32 v25, 4294901760, v25
    v_mfma_f32_16x16x32_bf16 a[184:187], a[80:83], v[4:7], a[184:187]
    buffer_store_dwordx4 v[152:155], v2, s[52:55], s77 offen offset:2048 sc1
    v_mfma_f32_16x16x32_bf16 a[188:191], a[80:83], v[8:11], a[188:191]
    ds_read_b64_tr_b16 a[136:137], v26 offset:12288
    v_mfma_f32_16x16x32_bf16 a[192:195], a[80:83], v[12:15], a[192:195]
    ds_read_b64_tr_b16 a[138:139], v26 offset:13312
    v_add_u32 v26, 4294901760, v26
    v_mfma_f32_16x16x32_bf16 a[196:199], a[80:83], v[32:35], a[196:199]
    ds_read_b64_tr_b16 a[140:141], v27 offset:12288
    v_mfma_f32_16x16x32_bf16 a[212:215], a[84:87], v[32:35], a[212:215]
    ds_read_b64_tr_b16 a[142:143], v27 offset:13312
    v_add_u32 v27, 4294901760, v27
    v_mfma_f32_16x16x32_bf16 a[208:211], a[84:87], v[12:15], a[208:211]
    ds_read_b64_tr_b16 a[144:145], v16 offset:12288
    v_mfma_f32_16x16x32_bf16 a[204:207], a[84:87], v[8:11], a[204:207]
    ds_read_b64_tr_b16 a[146:147], v16 offset:12800
    v_add_u32 v16, 4294901760, v16
    v_mfma_f32_16x16x32_bf16 a[200:203], a[84:87], v[4:7], a[200:203]
    ds_read_b64_tr_b16 a[148:149], v17 offset:12288
    v_mfma_f32_16x16x32_bf16 a[216:219], a[88:91], v[4:7], a[216:219]
    ds_read_b64_tr_b16 a[150:151], v17 offset:12800
    v_add_u32 v17, 4294901760, v17
    v_mfma_f32_16x16x32_bf16 a[220:223], a[88:91], v[8:11], a[220:223]
    buffer_load_dwordx4 a[60:63], v37, s[52:55], s75 offen sc1
    v_mfma_f32_16x16x32_bf16 a[224:227], a[88:91], v[12:15], a[224:227]
    ds_read_b64_tr_b16 a[152:153], v18 offset:12288
    v_mfma_f32_16x16x32_bf16 a[228:231], a[88:91], v[32:35], a[228:231]
    s_add_u32 m0, s71, 143360
    s_mov_b32 s72, 3407872
    ds_read_b64_tr_b16 a[154:155], v18 offset:12800
    v_add_u32 v18, 4294901760, v18
    v_mfma_f32_16x16x32_bf16 a[244:247], a[92:95], v[32:35], a[244:247]
    buffer_load_dwordx4 v28, s[44:47], s72 offen lds
    v_mfma_f32_16x16x32_bf16 a[240:243], a[92:95], v[12:15], a[240:243]
    ds_read_b64_tr_b16 a[156:157], v19 offset:12288
    v_mfma_f32_16x16x32_bf16 a[236:239], a[92:95], v[8:11], a[236:239]
    ds_read_b64_tr_b16 a[158:159], v19 offset:12800
    v_add_u32 v19, 4294901760, v19
    v_mfma_f32_16x16x32_bf16 a[232:235], a[92:95], v[4:7], a[232:235]
    v_mfma_f32_16x16x32_bf16 v[40:43], a[96:99], v[4:7], v[40:43]
    buffer_load_dwordx4 v29, s[44:47], s72 offen offset:1024 lds
    v_mfma_f32_16x16x32_bf16 v[44:47], a[96:99], v[8:11], v[44:47]
    v_mfma_f32_16x16x32_bf16 v[48:51], a[96:99], v[12:15], v[48:51]
    v_mfma_f32_16x16x32_bf16 v[52:55], a[96:99], v[32:35], v[52:55]
    s_add_u32 m0, s73, 151552
    s_mov_b32 s72, 1144832
    v_mfma_f32_16x16x32_bf16 v[68:71], a[100:103], v[32:35], v[68:71]
    buffer_load_dwordx4 v30, s[60:63], s72 offen lds
    v_mfma_f32_16x16x32_bf16 v[64:67], a[100:103], v[12:15], v[64:67]
    v_mfma_f32_16x16x32_bf16 v[60:63], a[100:103], v[8:11], v[60:63]
    v_mfma_f32_16x16x32_bf16 v[56:59], a[100:103], v[4:7], v[56:59]
    v_mfma_f32_16x16x32_bf16 v[72:75], a[104:107], v[4:7], v[72:75]
    buffer_store_dwordx4 v[156:159], v2, s[52:55], s77 offen offset:3072 sc1
    v_mfma_f32_16x16x32_bf16 v[76:79], a[104:107], v[8:11], v[76:79]
    v_mfma_f32_16x16x32_bf16 v[84:87], a[108:111], v[8:11], v[84:87]
    s_nop 0
    s_waitcnt vmcnt(30) lgkmcnt(0)
    v_mfma_f32_16x16x32_bf16 v[80:83], a[108:111], v[4:7], v[80:83]
    v_mfma_f32_16x16x32_bf16 v[88:91], a[112:115], a[0:3], v[88:91]
    v_mfma_f32_16x16x32_bf16 v[92:95], a[112:115], a[4:7], v[92:95]
    ds_read_b64_tr_b16 a[64:65], v20 offset:24576
    v_mfma_f32_16x16x32_bf16 v[96:99], a[112:115], a[8:11], v[96:99]
    ds_read_b64_tr_b16 a[66:67], v20 offset:25600
    v_mfma_f32_16x16x32_bf16 v[100:103], a[112:115], a[12:15], v[100:103]
    ds_read_b64_tr_b16 a[68:69], v21 offset:24576
    v_mfma_f32_16x16x32_bf16 v[116:119], a[116:119], a[12:15], v[116:119]
    s_add_u32 s75, s66, 36864
    ds_read_b64_tr_b16 a[70:71], v21 offset:25600
    v_mfma_f32_16x16x32_bf16 v[112:115], a[116:119], a[8:11], v[112:115]
    buffer_load_dwordx4 v[4:7], v36, s[52:55], s75 offen sc1
    v_mfma_f32_16x16x32_bf16 v[108:111], a[116:119], a[4:7], v[108:111]
    ds_read_b64_tr_b16 a[72:73], v22 offset:24576
    v_mfma_f32_16x16x32_bf16 v[104:107], a[116:119], a[0:3], v[104:107]
    ds_read_b64_tr_b16 a[74:75], v22 offset:25600
    v_mfma_f32_16x16x32_bf16 v[120:123], a[120:123], a[0:3], v[120:123]
    buffer_load_dwordx4 v[8:11], v37, s[52:55], s75 offen sc1
    v_mfma_f32_16x16x32_bf16 v[124:127], a[120:123], a[4:7], v[124:127]
    ds_read_b64_tr_b16 a[76:77], v23 offset:24576
    v_mfma_f32_16x16x32_bf16 a[160:163], a[120:123], a[8:11], a[160:163]
    ds_read_b64_tr_b16 a[78:79], v23 offset:25600
    v_mfma_f32_16x16x32_bf16 a[164:167], a[120:123], a[12:15], a[164:167]
    s_add_u32 s75, s67, 36864
    ds_read_b64_tr_b16 a[80:81], v24 offset:24576
    v_mfma_f32_16x16x32_bf16 a[180:183], a[124:127], a[12:15], a[180:183]
    buffer_load_dwordx4 v[12:15], v36, s[52:55], s75 offen sc1
    v_mfma_f32_16x16x32_bf16 a[176:179], a[124:127], a[8:11], a[176:179]
    ds_read_b64_tr_b16 a[82:83], v24 offset:25600
    v_mfma_f32_16x16x32_bf16 a[172:175], a[124:127], a[4:7], a[172:175]
    ds_read_b64_tr_b16 a[84:85], v25 offset:24576
    v_mfma_f32_16x16x32_bf16 a[168:171], a[124:127], a[0:3], a[168:171]
    s_add_u32 s77, s76, 16384
    ds_read_b64_tr_b16 a[86:87], v25 offset:25600
    v_mfma_f32_16x16x32_bf16 a[184:187], a[128:131], a[0:3], a[184:187]
    buffer_store_dwordx4 v[160:163], v2, s[52:55], s77 offen offset:0 sc1
    v_mfma_f32_16x16x32_bf16 a[188:191], a[128:131], a[4:7], a[188:191]
    ds_read_b64_tr_b16 a[88:89], v26 offset:24576
    v_mfma_f32_16x16x32_bf16 a[192:195], a[128:131], a[8:11], a[192:195]
    ds_read_b64_tr_b16 a[90:91], v26 offset:25600
    v_mfma_f32_16x16x32_bf16 a[196:199], a[128:131], a[12:15], a[196:199]
    ds_read_b64_tr_b16 a[92:93], v27 offset:24576
    v_mfma_f32_16x16x32_bf16 a[212:215], a[132:135], a[12:15], a[212:215]
    ds_read_b64_tr_b16 a[94:95], v27 offset:25600
    v_mfma_f32_16x16x32_bf16 a[208:211], a[132:135], a[8:11], a[208:211]
    ds_read_b64_tr_b16 a[96:97], v16 offset:24576
    v_mfma_f32_16x16x32_bf16 a[204:207], a[132:135], a[4:7], a[204:207]
    ds_read_b64_tr_b16 a[98:99], v16 offset:25088
    v_mfma_f32_16x16x32_bf16 a[200:203], a[132:135], a[0:3], a[200:203]
    ds_read_b64_tr_b16 a[100:101], v17 offset:24576
    v_mfma_f32_16x16x32_bf16 a[216:219], a[136:139], a[0:3], a[216:219]
    ds_read_b64_tr_b16 a[102:103], v17 offset:25088
    v_mfma_f32_16x16x32_bf16 a[220:223], a[136:139], a[4:7], a[220:223]
    buffer_load_dwordx4 v[32:35], v37, s[52:55], s75 offen sc1
    v_mfma_f32_16x16x32_bf16 a[224:227], a[136:139], a[8:11], a[224:227]
    ds_read_b64_tr_b16 a[104:105], v18 offset:24576
    v_mfma_f32_16x16x32_bf16 a[228:231], a[136:139], a[12:15], a[228:231]
    s_nop 0
    s_add_u32 m0, s71, 0
    s_mov_b32 s72, 3670016
    ds_read_b64_tr_b16 a[106:107], v18 offset:25088
    v_mfma_f32_16x16x32_bf16 a[244:247], a[140:143], a[12:15], a[244:247]
    buffer_load_dwordx4 v28, s[44:47], s72 offen lds
    v_mfma_f32_16x16x32_bf16 a[240:243], a[140:143], a[8:11], a[240:243]
    ds_read_b64_tr_b16 a[108:109], v19 offset:24576
    v_mfma_f32_16x16x32_bf16 a[236:239], a[140:143], a[4:7], a[236:239]
    ds_read_b64_tr_b16 a[110:111], v19 offset:25088
    v_mfma_f32_16x16x32_bf16 a[232:235], a[140:143], a[0:3], a[232:235]
    v_mfma_f32_16x16x32_bf16 v[40:43], a[144:147], a[0:3], v[40:43]
    buffer_load_dwordx4 v29, s[44:47], s72 offen offset:1024 lds
    v_mfma_f32_16x16x32_bf16 v[44:47], a[144:147], a[4:7], v[44:47]
    v_mfma_f32_16x16x32_bf16 v[48:51], a[144:147], a[8:11], v[48:51]
    v_mfma_f32_16x16x32_bf16 v[52:55], a[144:147], a[12:15], v[52:55]
    s_add_u32 m0, s73, 8192
    s_mov_b32 s72, 1232896
    v_mfma_f32_16x16x32_bf16 v[68:71], a[148:151], a[12:15], v[68:71]
    buffer_load_dwordx4 v30, s[60:63], s72 offen lds
    v_mfma_f32_16x16x32_bf16 v[64:67], a[148:151], a[8:11], v[64:67]
    v_mfma_f32_16x16x32_bf16 v[60:63], a[148:151], a[4:7], v[60:63]
    v_mfma_f32_16x16x32_bf16 v[56:59], a[148:151], a[0:3], v[56:59]
    v_mfma_f32_16x16x32_bf16 v[72:75], a[152:155], a[0:3], v[72:75]
    buffer_store_dwordx4 v[164:167], v2, s[52:55], s77 offen offset:1024 sc1
    v_mfma_f32_16x16x32_bf16 v[76:79], a[152:155], a[4:7], v[76:79]
    v_mfma_f32_16x16x32_bf16 v[84:87], a[156:159], a[4:7], v[84:87]
    s_nop 0
    s_waitcnt vmcnt(28) lgkmcnt(0)
    v_mfma_f32_16x16x32_bf16 v[80:83], a[156:159], a[0:3], v[80:83]
    v_mfma_f32_16x16x32_bf16 v[88:91], a[64:67], a[16:19], v[88:91]
    v_mfma_f32_16x16x32_bf16 v[92:95], a[64:67], a[20:23], v[92:95]
    ds_read_b64_tr_b16 a[112:113], v20 offset:36864
    v_mfma_f32_16x16x32_bf16 v[96:99], a[64:67], a[24:27], v[96:99]
    ds_read_b64_tr_b16 a[114:115], v20 offset:37888
    v_mfma_f32_16x16x32_bf16 v[100:103], a[64:67], a[28:31], v[100:103]
    ds_read_b64_tr_b16 a[116:117], v21 offset:36864
    v_mfma_f32_16x16x32_bf16 v[116:119], a[68:71], a[28:31], v[116:119]
    s_add_u32 s75, s66, 40960
    ds_read_b64_tr_b16 a[118:119], v21 offset:37888
    v_mfma_f32_16x16x32_bf16 v[112:115], a[68:71], a[24:27], v[112:115]
    buffer_load_dwordx4 a[0:3], v36, s[52:55], s75 offen sc1
    v_mfma_f32_16x16x32_bf16 v[108:111], a[68:71], a[20:23], v[108:111]
    ds_read_b64_tr_b16 a[120:121], v22 offset:36864
    v_mfma_f32_16x16x32_bf16 v[104:107], a[68:71], a[16:19], v[104:107]
    ds_read_b64_tr_b16 a[122:123], v22 offset:37888
    v_mfma_f32_16x16x32_bf16 v[120:123], a[72:75], a[16:19], v[120:123]
    buffer_load_dwordx4 a[4:7], v37, s[52:55], s75 offen sc1
    v_mfma_f32_16x16x32_bf16 v[124:127], a[72:75], a[20:23], v[124:127]
    ds_read_b64_tr_b16 a[124:125], v23 offset:36864
    v_mfma_f32_16x16x32_bf16 a[160:163], a[72:75], a[24:27], a[160:163]
    ds_read_b64_tr_b16 a[126:127], v23 offset:37888
    v_mfma_f32_16x16x32_bf16 a[164:167], a[72:75], a[28:31], a[164:167]
    s_add_u32 s75, s67, 40960
    ds_read_b64_tr_b16 a[128:129], v24 offset:36864
    v_mfma_f32_16x16x32_bf16 a[180:183], a[76:79], a[28:31], a[180:183]
    buffer_load_dwordx4 a[8:11], v36, s[52:55], s75 offen sc1
    v_mfma_f32_16x16x32_bf16 a[176:179], a[76:79], a[24:27], a[176:179]
    ds_read_b64_tr_b16 a[130:131], v24 offset:37888
    v_mfma_f32_16x16x32_bf16 a[172:175], a[76:79], a[20:23], a[172:175]
    ds_read_b64_tr_b16 a[132:133], v25 offset:36864
    v_mfma_f32_16x16x32_bf16 a[168:171], a[76:79], a[16:19], a[168:171]
    s_add_u32 s77, s76, 16384
    ds_read_b64_tr_b16 a[134:135], v25 offset:37888
    v_mfma_f32_16x16x32_bf16 a[184:187], a[80:83], a[16:19], a[184:187]
    buffer_store_dwordx4 v[168:171], v2, s[52:55], s77 offen offset:2048 sc1
    v_mfma_f32_16x16x32_bf16 a[188:191], a[80:83], a[20:23], a[188:191]
    ds_read_b64_tr_b16 a[136:137], v26 offset:36864
    v_mfma_f32_16x16x32_bf16 a[192:195], a[80:83], a[24:27], a[192:195]
    ds_read_b64_tr_b16 a[138:139], v26 offset:37888
    v_mfma_f32_16x16x32_bf16 a[196:199], a[80:83], a[28:31], a[196:199]
    ds_read_b64_tr_b16 a[140:141], v27 offset:36864
    v_mfma_f32_16x16x32_bf16 a[212:215], a[84:87], a[28:31], a[212:215]
    ds_read_b64_tr_b16 a[142:143], v27 offset:37888
    v_mfma_f32_16x16x32_bf16 a[208:211], a[84:87], a[24:27], a[208:211]
    ds_read_b64_tr_b16 a[144:145], v16 offset:36864
    v_mfma_f32_16x16x32_bf16 a[204:207], a[84:87], a[20:23], a[204:207]
    ds_read_b64_tr_b16 a[146:147], v16 offset:37376
    v_mfma_f32_16x16x32_bf16 a[200:203], a[84:87], a[16:19], a[200:203]
    ds_read_b64_tr_b16 a[148:149], v17 offset:36864
    v_mfma_f32_16x16x32_bf16 a[216:219], a[88:91], a[16:19], a[216:219]
    ds_read_b64_tr_b16 a[150:151], v17 offset:37376
    v_mfma_f32_16x16x32_bf16 a[220:223], a[88:91], a[20:23], a[220:223]
    buffer_load_dwordx4 a[12:15], v37, s[52:55], s75 offen sc1
    v_mfma_f32_16x16x32_bf16 a[224:227], a[88:91], a[24:27], a[224:227]
    ds_read_b64_tr_b16 a[152:153], v18 offset:36864
    v_mfma_f32_16x16x32_bf16 a[228:231], a[88:91], a[28:31], a[228:231]
    s_add_u32 m0, s71, 12288
    s_mov_b32 s72, 3932160
    ds_read_b64_tr_b16 a[154:155], v18 offset:37376
    v_mfma_f32_16x16x32_bf16 a[244:247], a[92:95], a[28:31], a[244:247]
    buffer_load_dwordx4 v28, s[44:47], s72 offen lds
    v_mfma_f32_16x16x32_bf16 a[240:243], a[92:95], a[24:27], a[240:243]
    ds_read_b64_tr_b16 a[156:157], v19 offset:36864
    v_mfma_f32_16x16x32_bf16 a[236:239], a[92:95], a[20:23], a[236:239]
    ds_read_b64_tr_b16 a[158:159], v19 offset:37376
    v_mfma_f32_16x16x32_bf16 a[232:235], a[92:95], a[16:19], a[232:235]
    v_mfma_f32_16x16x32_bf16 v[40:43], a[96:99], a[16:19], v[40:43]
    buffer_load_dwordx4 v29, s[44:47], s72 offen offset:1024 lds
    v_mfma_f32_16x16x32_bf16 v[44:47], a[96:99], a[20:23], v[44:47]
    v_mfma_f32_16x16x32_bf16 v[48:51], a[96:99], a[24:27], v[48:51]
    v_mfma_f32_16x16x32_bf16 v[52:55], a[96:99], a[28:31], v[52:55]
    s_add_u32 m0, s73, 20480
    s_mov_b32 s72, 1320960
    v_mfma_f32_16x16x32_bf16 v[68:71], a[100:103], a[28:31], v[68:71]
    buffer_load_dwordx4 v30, s[60:63], s72 offen lds
    v_mfma_f32_16x16x32_bf16 v[64:67], a[100:103], a[24:27], v[64:67]
    v_mfma_f32_16x16x32_bf16 v[60:63], a[100:103], a[20:23], v[60:63]
    v_mfma_f32_16x16x32_bf16 v[56:59], a[100:103], a[16:19], v[56:59]
    v_mfma_f32_16x16x32_bf16 v[72:75], a[104:107], a[16:19], v[72:75]
    buffer_store_dwordx4 v[172:175], v2, s[52:55], s77 offen offset:3072 sc1
    v_mfma_f32_16x16x32_bf16 v[76:79], a[104:107], a[20:23], v[76:79]
    v_mfma_f32_16x16x32_bf16 v[84:87], a[108:111], a[20:23], v[84:87]
    s_nop 0
    s_waitcnt vmcnt(28) lgkmcnt(0)
    v_mfma_f32_16x16x32_bf16 v[80:83], a[108:111], a[16:19], v[80:83]
    v_mfma_f32_16x16x32_bf16 v[88:91], a[112:115], a[32:35], v[88:91]
    v_mfma_f32_16x16x32_bf16 v[92:95], a[112:115], a[36:39], v[92:95]
    s_nop 0
    s_lshl_b32 s78, s5, 8
    ds_read_b64_tr_b16 a[64:65], v20 offset:49152
    v_mfma_f32_16x16x32_bf16 v[96:99], a[112:115], a[40:43], v[96:99]
    s_add_u32 s78, s78, 79695872
    ds_read_b64_tr_b16 a[66:67], v20 offset:50176
    v_add_u32 v20, 65536, v20
    v_mfma_f32_16x16x32_bf16 v[100:103], a[112:115], a[44:47], v[100:103]
    s_nop 0
    s_mov_b32 s1, s78
    ds_read_b64_tr_b16 a[68:69], v21 offset:49152
    v_mfma_f32_16x16x32_bf16 v[116:119], a[116:119], a[44:47], v[116:119]
    s_add_u32 s75, s66, 45056
    ds_read_b64_tr_b16 a[70:71], v21 offset:50176
    v_add_u32 v21, 65536, v21
    v_mfma_f32_16x16x32_bf16 v[112:115], a[116:119], a[40:43], v[112:115]
    s_nop 0
    s_lshl_b32 s0, s6, 2
    buffer_load_dwordx4 a[16:19], v36, s[52:55], s75 offen sc1
    v_mfma_f32_16x16x32_bf16 v[108:111], a[116:119], a[36:39], v[108:111]
    s_nop 0
    s_add_u32 s0, s0, s78
    ds_read_b64_tr_b16 a[72:73], v22 offset:49152
    v_mfma_f32_16x16x32_bf16 v[104:107], a[116:119], a[32:35], v[104:107]
    s_nop 0
    s_lshr_b32 s8, s4, 1
    ds_read_b64_tr_b16 a[74:75], v22 offset:50176
    v_add_u32 v22, 65536, v22
    v_mfma_f32_16x16x32_bf16 v[120:123], a[120:123], a[32:35], v[120:123]
    s_nop 0
    s_lshl_b32 s9, s8, 12
    ds_read_b64_tr_b16 a[76:77], v23 offset:49152
    v_mfma_f32_16x16x32_bf16 v[124:127], a[120:123], a[36:39], v[124:127]
    s_nop 0
    s_lshl_b32 s10, s7, 13
    ds_read_b64_tr_b16 a[78:79], v23 offset:50176
    v_add_u32 v23, 65536, v23
    v_mfma_f32_16x16x32_bf16 a[160:163], a[120:123], a[40:43], a[160:163]
    s_nop 0
    s_add_u32 s80, s9, s10
    ds_read_b64_tr_b16 a[80:81], v24 offset:49152
    v_mfma_f32_16x16x32_bf16 a[164:167], a[120:123], a[44:47], a[164:167]
    s_add_u32 s81, s80, 65536
    buffer_load_dwordx4 a[20:23], v37, s[52:55], s75 offen sc1
    v_mfma_f32_16x16x32_bf16 a[180:183], a[124:127], a[44:47], a[180:183]
    s_nop 0
    s_lshl_b32 s84, s5, 20
    ds_read_b64_tr_b16 a[82:83], v24 offset:50176
    v_add_u32 v24, 65536, v24
    v_mfma_f32_16x16x32_bf16 a[176:179], a[124:127], a[40:43], a[176:179]
    s_add_u32 s84, s84, 2097152
    ds_read_b64_tr_b16 a[84:85], v25 offset:49152
    v_mfma_f32_16x16x32_bf16 a[172:175], a[124:127], a[36:39], a[172:175]
    s_nop 0
    s_lshl_b32 s10, s7, 14
    ds_read_b64_tr_b16 a[86:87], v25 offset:50176
    v_add_u32 v25, 65536, v25
    v_mfma_f32_16x16x32_bf16 a[168:171], a[124:127], a[32:35], a[168:171]
    s_add_u32 s77, s76, 20480
    ds_read_b64_tr_b16 a[88:89], v26 offset:49152
    v_mfma_f32_16x16x32_bf16 a[184:187], a[128:131], a[32:35], a[184:187]
    s_nop 0
    s_add_u32 s84, s84, s10
    buffer_store_dwordx4 v[176:179], v2, s[52:55], s77 offen offset:0 sc1
    v_mfma_f32_16x16x32_bf16 a[188:191], a[128:131], a[36:39], a[188:191]
    ds_read_b64_tr_b16 a[90:91], v26 offset:50176
    v_add_u32 v26, 65536, v26
    v_mfma_f32_16x16x32_bf16 a[192:195], a[128:131], a[40:43], a[192:195]
    ds_read_b64_tr_b16 a[92:93], v27 offset:49152
    v_mfma_f32_16x16x32_bf16 a[196:199], a[128:131], a[44:47], a[196:199]
    ds_read_b64_tr_b16 a[94:95], v27 offset:50176
    v_add_u32 v27, 65536, v27
    v_mfma_f32_16x16x32_bf16 a[212:215], a[132:135], a[44:47], a[212:215]
    ds_read_b64_tr_b16 a[96:97], v16 offset:49152
    v_mfma_f32_16x16x32_bf16 a[208:211], a[132:135], a[40:43], a[208:211]
    ds_read_b64_tr_b16 a[98:99], v16 offset:49664
    v_add_u32 v16, 65536, v16
    v_mfma_f32_16x16x32_bf16 a[204:207], a[132:135], a[36:39], a[204:207]
    ds_read_b64_tr_b16 a[100:101], v17 offset:49152
    v_mfma_f32_16x16x32_bf16 a[200:203], a[132:135], a[32:35], a[200:203]
    ds_read_b64_tr_b16 a[102:103], v17 offset:49664
    v_add_u32 v17, 65536, v17
    v_mfma_f32_16x16x32_bf16 a[216:219], a[136:139], a[32:35], a[216:219]
    ds_read_b64_tr_b16 a[104:105], v18 offset:49152
    v_mfma_f32_16x16x32_bf16 a[220:223], a[136:139], a[36:39], a[220:223]
    ds_read_b64_tr_b16 a[106:107], v18 offset:49664
    v_add_u32 v18, 65536, v18
    v_mfma_f32_16x16x32_bf16 a[224:227], a[136:139], a[40:43], a[224:227]
    s_add_u32 s75, s67, 45056
    ds_read_b64_tr_b16 a[108:109], v19 offset:49152
    v_mfma_f32_16x16x32_bf16 a[228:231], a[136:139], a[44:47], a[228:231]
    buffer_load_dwordx4 a[24:27], v36, s[52:55], s75 offen sc1
    v_mfma_f32_16x16x32_bf16 a[244:247], a[140:143], a[44:47], a[244:247]
    ds_read_b64_tr_b16 a[110:111], v19 offset:49664
    v_add_u32 v19, 65536, v19
    v_mfma_f32_16x16x32_bf16 a[240:243], a[140:143], a[40:43], a[240:243]
    v_mfma_f32_16x16x32_bf16 a[236:239], a[140:143], a[36:39], a[236:239]
    v_mfma_f32_16x16x32_bf16 a[232:235], a[140:143], a[32:35], a[232:235]
    v_mfma_f32_16x16x32_bf16 v[40:43], a[144:147], a[32:35], v[40:43]
    v_mfma_f32_16x16x32_bf16 v[44:47], a[144:147], a[36:39], v[44:47]
    buffer_load_dwordx4 a[28:31], v37, s[52:55], s75 offen sc1
    v_mfma_f32_16x16x32_bf16 v[48:51], a[144:147], a[40:43], v[48:51]
    v_mfma_f32_16x16x32_bf16 v[52:55], a[144:147], a[44:47], v[52:55]
    v_mfma_f32_16x16x32_bf16 v[68:71], a[148:151], a[44:47], v[68:71]
    v_mfma_f32_16x16x32_bf16 v[64:67], a[148:151], a[40:43], v[64:67]
    v_mfma_f32_16x16x32_bf16 v[60:63], a[148:151], a[36:39], v[60:63]
    v_mfma_f32_16x16x32_bf16 v[56:59], a[148:151], a[32:35], v[56:59]
    v_mfma_f32_16x16x32_bf16 v[72:75], a[152:155], a[32:35], v[72:75]
    buffer_store_dwordx4 v[180:183], v2, s[52:55], s77 offen offset:1024 sc1
    v_mfma_f32_16x16x32_bf16 v[76:79], a[152:155], a[36:39], v[76:79]
    v_mfma_f32_16x16x32_bf16 v[84:87], a[156:159], a[36:39], v[84:87]
    s_nop 0
    s_waitcnt vmcnt(28) lgkmcnt(0)
    v_mfma_f32_16x16x32_bf16 v[80:83], a[156:159], a[32:35], v[80:83]
    v_mfma_f32_16x16x32_bf16 v[88:91], a[64:67], a[48:51], v[88:91]
    v_mfma_f32_16x16x32_bf16 v[92:95], a[64:67], a[52:55], v[92:95]
    s_nop 0
    s_add_u32 s84, s84, s9
    ds_read_b64_tr_b16 a[112:113], v20 offset:24576
    v_mfma_f32_16x16x32_bf16 v[96:99], a[64:67], a[56:59], v[96:99]
    s_add_u32 s88, s84, 8192
    ds_read_b64_tr_b16 a[114:115], v20 offset:25600
    v_mfma_f32_16x16x32_bf16 v[100:103], a[64:67], a[60:63], v[100:103]
    s_add_u32 s82, s84, 131072
    ds_read_b64_tr_b16 a[116:117], v21 offset:24576
    v_mfma_f32_16x16x32_bf16 v[116:119], a[68:71], a[60:63], v[116:119]
    s_add_u32 s75, s66, 49152
    ds_read_b64_tr_b16 a[118:119], v21 offset:25600
    v_mfma_f32_16x16x32_bf16 v[112:115], a[68:71], a[56:59], v[112:115]
    s_nop 0
    s_sub_u32 s83, 14, s6
    buffer_load_dwordx4 a[32:35], v36, s[52:55], s75 offen sc1
    v_mfma_f32_16x16x32_bf16 v[108:111], a[68:71], a[52:55], v[108:111]
    s_nop 0
    s_add_u32 s85, s6, 1
    ds_read_b64_tr_b16 a[120:121], v22 offset:24576
    v_mfma_f32_16x16x32_bf16 v[104:107], a[68:71], a[48:51], v[104:107]
    s_add_u32 s86, s88, 65536
    ds_read_b64_tr_b16 a[122:123], v22 offset:25600
    v_mfma_f32_16x16x32_bf16 v[120:123], a[72:75], a[48:51], v[120:123]
    s_nop 0
    s_sub_u32 s87, 15, s6
    ds_read_b64_tr_b16 a[124:125], v23 offset:24576
    v_mfma_f32_16x16x32_bf16 v[124:127], a[72:75], a[52:55], v[124:127]
    s_nop 0
    s_add_u32 s89, s6, 1
    ds_read_b64_tr_b16 a[126:127], v23 offset:25600
    v_mfma_f32_16x16x32_bf16 a[160:163], a[72:75], a[56:59], a[160:163]
    s_mov_b32 s94, 0x4e800000
    ds_read_b64_tr_b16 a[128:129], v24 offset:24576
    v_mfma_f32_16x16x32_bf16 a[164:167], a[72:75], a[60:63], a[164:167]
    s_nop 0
    s_mov_b32 s91, 0
    buffer_load_dwordx4 a[36:39], v37, s[52:55], s75 offen sc1
    v_mfma_f32_16x16x32_bf16 a[180:183], a[76:79], a[60:63], a[180:183]
    s_nop 0
    s_sub_u32 s92, 15, s6
    ds_read_b64_tr_b16 a[130:131], v24 offset:25600
    v_mfma_f32_16x16x32_bf16 a[176:179], a[76:79], a[56:59], a[176:179]
    s_nop 0
    s_lshr_b32 s3, s74, 17
    ds_read_b64_tr_b16 a[132:133], v25 offset:24576
    v_mfma_f32_16x16x32_bf16 a[172:175], a[76:79], a[52:55], a[172:175]
    s_mul_i32 s10, s3, 1400832
    ds_read_b64_tr_b16 a[134:135], v25 offset:25600
    v_mfma_f32_16x16x32_bf16 a[168:171], a[76:79], a[48:51], a[168:171]
    s_add_u32 s77, s76, 20480
    ds_read_b64_tr_b16 a[136:137], v26 offset:24576
    v_mfma_f32_16x16x32_bf16 a[184:187], a[80:83], a[48:51], a[184:187]
    s_add_u32 s10, s10, 36700160
    buffer_store_dwordx4 v[184:187], v2, s[52:55], s77 offen offset:2048 sc1
    v_mfma_f32_16x16x32_bf16 a[188:191], a[80:83], a[52:55], a[188:191]
    ds_read_b64_tr_b16 a[138:139], v26 offset:25600
    v_mfma_f32_16x16x32_bf16 a[192:195], a[80:83], a[56:59], a[192:195]
    ds_read_b64_tr_b16 a[140:141], v27 offset:24576
    v_mfma_f32_16x16x32_bf16 a[196:199], a[80:83], a[60:63], a[196:199]
    ds_read_b64_tr_b16 a[142:143], v27 offset:25600
    v_mfma_f32_16x16x32_bf16 a[212:215], a[84:87], a[60:63], a[212:215]
    ds_read_b64_tr_b16 a[144:145], v16 offset:24576
    v_mfma_f32_16x16x32_bf16 a[208:211], a[84:87], a[56:59], a[208:211]
    ds_read_b64_tr_b16 a[146:147], v16 offset:25088
    v_mfma_f32_16x16x32_bf16 a[204:207], a[84:87], a[52:55], a[204:207]
    ds_read_b64_tr_b16 a[148:149], v17 offset:24576
    v_mfma_f32_16x16x32_bf16 a[200:203], a[84:87], a[48:51], a[200:203]
    ds_read_b64_tr_b16 a[150:151], v17 offset:25088
    v_mfma_f32_16x16x32_bf16 a[216:219], a[88:91], a[48:51], a[216:219]
    ds_read_b64_tr_b16 a[152:153], v18 offset:24576
    v_mfma_f32_16x16x32_bf16 a[220:223], a[88:91], a[52:55], a[220:223]
    ds_read_b64_tr_b16 a[154:155], v18 offset:25088
    v_mfma_f32_16x16x32_bf16 a[224:227], a[88:91], a[56:59], a[224:227]
    s_add_u32 s75, s67, 49152
    ds_read_b64_tr_b16 a[156:157], v19 offset:24576
    v_mfma_f32_16x16x32_bf16 a[228:231], a[88:91], a[60:63], a[228:231]
    buffer_load_dwordx4 a[40:43], v36, s[52:55], s75 offen sc1
    v_mfma_f32_16x16x32_bf16 a[244:247], a[92:95], a[60:63], a[244:247]
    ds_read_b64_tr_b16 a[158:159], v19 offset:25088
    v_mfma_f32_16x16x32_bf16 a[240:243], a[92:95], a[56:59], a[240:243]
    v_mfma_f32_16x16x32_bf16 a[236:239], a[92:95], a[52:55], a[236:239]
    v_mfma_f32_16x16x32_bf16 a[232:235], a[92:95], a[48:51], a[232:235]
    v_mfma_f32_16x16x32_bf16 v[40:43], a[96:99], a[48:51], v[40:43]
    v_mfma_f32_16x16x32_bf16 v[44:47], a[96:99], a[52:55], v[44:47]
    buffer_load_dwordx4 a[44:47], v37, s[52:55], s75 offen sc1
    v_mfma_f32_16x16x32_bf16 v[48:51], a[96:99], a[56:59], v[48:51]
    v_mfma_f32_16x16x32_bf16 v[52:55], a[96:99], a[60:63], v[52:55]
    v_mfma_f32_16x16x32_bf16 v[68:71], a[100:103], a[60:63], v[68:71]
    v_mfma_f32_16x16x32_bf16 v[64:67], a[100:103], a[56:59], v[64:67]
    v_mfma_f32_16x16x32_bf16 v[60:63], a[100:103], a[52:55], v[60:63]
    v_mfma_f32_16x16x32_bf16 v[56:59], a[100:103], a[48:51], v[56:59]
    v_mfma_f32_16x16x32_bf16 v[72:75], a[104:107], a[48:51], v[72:75]
    buffer_store_dwordx4 v[188:191], v2, s[52:55], s77 offen offset:3072 sc1
    v_mfma_f32_16x16x32_bf16 v[76:79], a[104:107], a[52:55], v[76:79]
    v_mfma_f32_16x16x32_bf16 v[84:87], a[108:111], a[52:55], v[84:87]
    s_nop 0
    s_waitcnt vmcnt(25) lgkmcnt(0)
    v_mfma_f32_16x16x32_bf16 v[80:83], a[108:111], a[48:51], v[80:83]
    v_mfma_f32_16x16x32_bf16 v[88:91], a[112:115], v[4:7], v[88:91]
    v_mfma_f32_16x16x32_bf16 v[92:95], a[112:115], v[8:11], v[92:95]
    s_nop 0
    s_lshr_b32 s11, s5, 1
    ds_read_b64_tr_b16 a[64:65], v20 offset:36864
    v_mfma_f32_16x16x32_bf16 v[96:99], a[112:115], v[12:15], v[96:99]
    s_nop 0
    s_mul_i32 s11, s11, 3
    ds_read_b64_tr_b16 a[66:67], v20 offset:37888
    v_mfma_f32_16x16x32_bf16 v[100:103], a[112:115], v[32:35], v[100:103]
    s_nop 0
    s_lshl_b32 s3, s68, 1
    ds_read_b64_tr_b16 a[68:69], v21 offset:36864
    v_mfma_f32_16x16x32_bf16 v[116:119], a[116:119], v[32:35], v[116:119]
    s_nop 0
    s_add_u32 s14, s11, s3
    ds_read_b64_tr_b16 a[70:71], v21 offset:37888
    v_mfma_f32_16x16x32_bf16 v[112:115], a[116:119], v[12:15], v[112:115]
    s_nop 0
    s_add_u32 s11, s11, 1
    ds_read_b64_tr_b16 a[72:73], v22 offset:36864
    v_mfma_f32_16x16x32_bf16 v[108:111], a[116:119], v[8:11], v[108:111]
    s_add_u32 s75, s66, 53248
    ds_read_b64_tr_b16 a[74:75], v22 offset:37888
    v_mfma_f32_16x16x32_bf16 v[104:107], a[116:119], v[4:7], v[104:107]
    s_nop 0
    s_lshl_b32 s15, s68, 12
    buffer_load_dwordx4 a[48:51], v36, s[52:55], s75 offen sc1
    v_mfma_f32_16x16x32_bf16 v[120:123], a[120:123], v[4:7], v[120:123]
    s_nop 0
    s_lshl_b32 s3, s14, 13
    ds_read_b64_tr_b16 a[76:77], v23 offset:36864
    v_mfma_f32_16x16x32_bf16 v[124:127], a[120:123], v[8:11], v[124:127]
    s_add_u32 s77, s76, 32768
    ds_read_b64_tr_b16 a[78:79], v23 offset:37888
    v_mfma_f32_16x16x32_bf16 a[160:163], a[120:123], v[12:15], a[160:163]
    s_nop 0
    s_add_u32 s3, s3, s10
    buffer_store_dwordx4 v[192:195], v2, s[52:55], s77 offen offset:0 sc1
    v_mfma_f32_16x16x32_bf16 a[164:167], a[120:123], v[32:35], a[164:167]
    s_nop 0
    s_add_u32 s16, s3, s15
    ds_read_b64_tr_b16 a[80:81], v24 offset:36864
    v_mfma_f32_16x16x32_bf16 a[180:183], a[124:127], v[32:35], a[180:183]
    s_nop 0
    s_sub_u32 s17, s3, s15
    ds_read_b64_tr_b16 a[82:83], v24 offset:37888
    v_mfma_f32_16x16x32_bf16 a[176:179], a[124:127], v[12:15], a[176:179]
    s_add_u32 s17, s17, 4096
    ds_read_b64_tr_b16 a[84:85], v25 offset:36864
    v_mfma_f32_16x16x32_bf16 a[172:175], a[124:127], v[8:11], a[172:175]
    s_nop 0
    s_lshl_b32 s3, s11, 13
    ds_read_b64_tr_b16 a[86:87], v25 offset:37888
    v_mfma_f32_16x16x32_bf16 a[168:171], a[124:127], v[4:7], a[168:171]
    s_nop 0
    s_add_u32 s3, s3, s10
    ds_read_b64_tr_b16 a[88:89], v26 offset:36864
    v_mfma_f32_16x16x32_bf16 a[184:187], a[128:131], v[4:7], a[184:187]
    s_nop 0
    s_add_u32 s18, s3, s15
    ds_read_b64_tr_b16 a[90:91], v26 offset:37888
    v_mfma_f32_16x16x32_bf16 a[188:191], a[128:131], v[8:11], a[188:191]
    ds_read_b64_tr_b16 a[92:93], v27 offset:36864
    v_mfma_f32_16x16x32_bf16 a[192:195], a[128:131], v[12:15], a[192:195]
    ds_read_b64_tr_b16 a[94:95], v27 offset:37888
    v_mfma_f32_16x16x32_bf16 a[196:199], a[128:131], v[32:35], a[196:199]
    ds_read_b64_tr_b16 a[96:97], v16 offset:36864
    v_mfma_f32_16x16x32_bf16 a[212:215], a[132:135], v[32:35], a[212:215]
    buffer_load_dwordx4 a[52:55], v37, s[52:55], s75 offen sc1
    v_mfma_f32_16x16x32_bf16 a[208:211], a[132:135], v[12:15], a[208:211]
    ds_read_b64_tr_b16 a[98:99], v16 offset:37376
    v_mfma_f32_16x16x32_bf16 a[204:207], a[132:135], v[8:11], a[204:207]
    ds_read_b64_tr_b16 a[100:101], v17 offset:36864
    v_mfma_f32_16x16x32_bf16 a[200:203], a[132:135], v[4:7], a[200:203]
    s_add_u32 s75, s67, 53248
    ds_read_b64_tr_b16 a[102:103], v17 offset:37376
    v_mfma_f32_16x16x32_bf16 a[216:219], a[136:139], v[4:7], a[216:219]
    buffer_load_dwordx4 a[56:59], v36, s[52:55], s75 offen sc1
    v_mfma_f32_16x16x32_bf16 a[220:223], a[136:139], v[8:11], a[220:223]
    ds_read_b64_tr_b16 a[104:105], v18 offset:36864
    v_mfma_f32_16x16x32_bf16 a[224:227], a[136:139], v[12:15], a[224:227]
    buffer_store_dwordx4 v[196:199], v2, s[52:55], s77 offen offset:1024 sc1
    v_mfma_f32_16x16x32_bf16 a[228:231], a[136:139], v[32:35], a[228:231]
    ds_read_b64_tr_b16 a[106:107], v18 offset:37376
    v_mfma_f32_16x16x32_bf16 a[244:247], a[140:143], v[32:35], a[244:247]
    ds_read_b64_tr_b16 a[108:109], v19 offset:36864
    v_mfma_f32_16x16x32_bf16 a[240:243], a[140:143], v[12:15], a[240:243]
    ds_read_b64_tr_b16 a[110:111], v19 offset:37376
    v_mfma_f32_16x16x32_bf16 a[236:239], a[140:143], v[8:11], a[236:239]
    v_mfma_f32_16x16x32_bf16 a[232:235], a[140:143], v[4:7], a[232:235]
    v_mfma_f32_16x16x32_bf16 v[40:43], a[144:147], v[4:7], v[40:43]
    v_mfma_f32_16x16x32_bf16 v[44:47], a[144:147], v[8:11], v[44:47]
    v_mfma_f32_16x16x32_bf16 v[48:51], a[144:147], v[12:15], v[48:51]
    v_mfma_f32_16x16x32_bf16 v[52:55], a[144:147], v[32:35], v[52:55]
    v_mfma_f32_16x16x32_bf16 v[68:71], a[148:151], v[32:35], v[68:71]
    v_mfma_f32_16x16x32_bf16 v[64:67], a[148:151], v[12:15], v[64:67]
    buffer_load_dwordx4 a[60:63], v37, s[52:55], s75 offen sc1
    v_mfma_f32_16x16x32_bf16 v[60:63], a[148:151], v[8:11], v[60:63]
    v_mfma_f32_16x16x32_bf16 v[56:59], a[148:151], v[4:7], v[56:59]
    v_mfma_f32_16x16x32_bf16 v[72:75], a[152:155], v[4:7], v[72:75]
    v_mfma_f32_16x16x32_bf16 v[76:79], a[152:155], v[8:11], v[76:79]
    v_mfma_f32_16x16x32_bf16 v[84:87], a[156:159], v[8:11], v[84:87]
    s_nop 0
    s_waitcnt vmcnt(22) lgkmcnt(0)
    buffer_store_dwordx4 v[200:203], v2, s[52:55], s77 offen offset:2048 sc1
    v_mfma_f32_16x16x32_bf16 v[80:83], a[156:159], v[4:7], v[80:83]
    v_mfma_f32_16x16x32_bf16 v[88:91], a[64:67], a[0:3], v[88:91]
    s_waitcnt vmcnt(20)
    s_barrier
    v_mfma_f32_16x16x32_bf16 v[92:95], a[64:67], a[4:7], v[92:95]
    s_nop 0
    s_lshl_b32 s15, s68, 11
    ds_read_b64_tr_b16 a[112:113], v20 offset:49152
    v_mfma_f32_16x16x32_bf16 v[96:99], a[64:67], a[8:11], v[96:99]
    s_nop 0
    s_cmp_lt_u32 s14, 43
    s_cselect_b32 s16, s16, 1073741824
    s_cselect_b32 s17, s17, 1073741824
    ds_read_b64_tr_b16 a[114:115], v20 offset:50176
    v_add_u32 v20, 65536, v20
    v_mfma_f32_16x16x32_bf16 v[100:103], a[64:67], a[12:15], v[100:103]
    s_cmp_lt_u32 s11, 43
    s_cselect_b32 s18, s18, 1073741824
    ds_read_b64_tr_b16 a[116:117], v21 offset:49152
    v_mfma_f32_16x16x32_bf16 v[116:119], a[68:71], a[12:15], v[116:119]
    s_nop 0
    s_lshl_b32 s3, s4, 14
    ds_read_b64_tr_b16 a[118:119], v21 offset:50176
    v_add_u32 v21, 65536, v21
    v_mfma_f32_16x16x32_bf16 v[112:115], a[68:71], a[8:11], v[112:115]
    s_add_u32 s3, s3, 98304
    ds_read_b64_tr_b16 a[120:121], v22 offset:49152
    v_mfma_f32_16x16x32_bf16 v[108:111], a[68:71], a[4:7], v[108:111]
    s_nop 0
    s_add_u32 s19, s3, s15
    ds_read_b64_tr_b16 a[122:123], v22 offset:50176
    v_add_u32 v22, 65536, v22
    v_mfma_f32_16x16x32_bf16 v[104:107], a[68:71], a[0:3], v[104:107]
    s_nop 0
    s_sub_u32 s20, s3, s15
    ds_read_b64_tr_b16 a[124:125], v23 offset:49152
    v_mfma_f32_16x16x32_bf16 v[120:123], a[72:75], a[0:3], v[120:123]
    s_nop 0
    s_lshl_b32 s21, s8, 15
    ds_read_b64_tr_b16 a[126:127], v23 offset:50176
    v_add_u32 v23, 65536, v23
    v_mfma_f32_16x16x32_bf16 v[124:127], a[72:75], a[4:7], v[124:127]
    s_add_u32 s77, s76, 32768
    ds_read_b64_tr_b16 a[128:129], v24 offset:49152
    v_mfma_f32_16x16x32_bf16 a[160:163], a[72:75], a[8:11], a[160:163]
    s_add_u32 s21, s21, 98304
    buffer_store_dwordx4 v[204:207], v2, s[52:55], s77 offen offset:3072 sc1
    v_mfma_f32_16x16x32_bf16 a[164:167], a[72:75], a[12:15], a[164:167]
    s_nop 0
    s_sub_u32 s22, s7, s8
    ds_read_b64_tr_b16 a[130:131], v24 offset:50176
    v_add_u32 v24, 65536, v24
    v_mfma_f32_16x16x32_bf16 a[180:183], a[76:79], a[12:15], a[180:183]
    s_nop 0
    s_lshl_b32 s23, s7, 13
    ds_read_b64_tr_b16 a[132:133], v25 offset:49152
    v_mfma_f32_16x16x32_bf16 a[176:179], a[76:79], a[8:11], a[176:179]
    ds_read_b64_tr_b16 a[134:135], v25 offset:50176
    v_add_u32 v25, 65536, v25
    v_mfma_f32_16x16x32_bf16 a[172:175], a[76:79], a[4:7], a[172:175]
    ds_read_b64_tr_b16 a[136:137], v26 offset:49152
    v_mfma_f32_16x16x32_bf16 a[168:171], a[76:79], a[0:3], a[168:171]
    ds_read_b64_tr_b16 a[138:139], v26 offset:50176
    v_add_u32 v26, 65536, v26
    v_mfma_f32_16x16x32_bf16 a[184:187], a[80:83], a[0:3], a[184:187]
    ds_read_b64_tr_b16 a[140:141], v27 offset:49152
    v_mfma_f32_16x16x32_bf16 a[188:191], a[80:83], a[4:7], a[188:191]
    ds_read_b64_tr_b16 a[142:143], v27 offset:50176
    v_add_u32 v27, 65536, v27
    v_mfma_f32_16x16x32_bf16 a[192:195], a[80:83], a[8:11], a[192:195]
    ds_read_b64_tr_b16 a[144:145], v16 offset:49152
    v_mfma_f32_16x16x32_bf16 a[196:199], a[80:83], a[12:15], a[196:199]
    ds_read_b64_tr_b16 a[146:147], v16 offset:49664
    v_add_u32 v16, 65536, v16
    v_mfma_f32_16x16x32_bf16 a[212:215], a[84:87], a[12:15], a[212:215]
    ds_read_b64_tr_b16 a[148:149], v17 offset:49152
    v_mfma_f32_16x16x32_bf16 a[208:211], a[84:87], a[8:11], a[208:211]
    ds_read_b64_tr_b16 a[150:151], v17 offset:49664
    v_add_u32 v17, 65536, v17
    v_mfma_f32_16x16x32_bf16 a[204:207], a[84:87], a[4:7], a[204:207]
    ds_read_b64_tr_b16 a[152:153], v18 offset:49152
    v_mfma_f32_16x16x32_bf16 a[200:203], a[84:87], a[0:3], a[200:203]
    ds_read_b64_tr_b16 a[154:155], v18 offset:49664
    v_add_u32 v18, 65536, v18
    v_mfma_f32_16x16x32_bf16 a[216:219], a[88:91], a[0:3], a[216:219]
    ds_read_b64_tr_b16 a[156:157], v19 offset:49152
    v_mfma_f32_16x16x32_bf16 a[220:223], a[88:91], a[4:7], a[220:223]
    s_add_u32 s77, s76, 36864
    ds_read_b64_tr_b16 a[158:159], v19 offset:49664
    v_add_u32 v19, 65536, v19
    v_mfma_f32_16x16x32_bf16 a[224:227], a[88:91], a[8:11], a[224:227]
    buffer_store_dwordx4 v[208:211], v2, s[52:55], s77 offen offset:0 sc1
    v_mfma_f32_16x16x32_bf16 a[228:231], a[88:91], a[12:15], a[228:231]
    v_mfma_f32_16x16x32_bf16 a[244:247], a[92:95], a[12:15], a[244:247]
    v_mfma_f32_16x16x32_bf16 a[240:243], a[92:95], a[8:11], a[240:243]
    v_mfma_f32_16x16x32_bf16 a[236:239], a[92:95], a[4:7], a[236:239]
    v_mfma_f32_16x16x32_bf16 a[232:235], a[92:95], a[0:3], a[232:235]
    v_mfma_f32_16x16x32_bf16 v[40:43], a[96:99], a[0:3], v[40:43]
    v_mfma_f32_16x16x32_bf16 v[44:47], a[96:99], a[4:7], v[44:47]
    v_mfma_f32_16x16x32_bf16 v[48:51], a[96:99], a[8:11], v[48:51]
    v_mfma_f32_16x16x32_bf16 v[52:55], a[96:99], a[12:15], v[52:55]
    v_mfma_f32_16x16x32_bf16 v[68:71], a[100:103], a[12:15], v[68:71]
    v_mfma_f32_16x16x32_bf16 v[64:67], a[100:103], a[8:11], v[64:67]
    v_mfma_f32_16x16x32_bf16 v[60:63], a[100:103], a[4:7], v[60:63]
    v_mfma_f32_16x16x32_bf16 v[56:59], a[100:103], a[0:3], v[56:59]
    v_mfma_f32_16x16x32_bf16 v[72:75], a[104:107], a[0:3], v[72:75]
    v_mfma_f32_16x16x32_bf16 v[76:79], a[104:107], a[4:7], v[76:79]
    v_mfma_f32_16x16x32_bf16 v[84:87], a[108:111], a[4:7], v[84:87]
    s_nop 0
    s_waitcnt vmcnt(16) lgkmcnt(0)
    buffer_store_dwordx4 v[212:215], v2, s[52:55], s77 offen offset:1024 sc1
    v_mfma_f32_16x16x32_bf16 v[80:83], a[108:111], a[0:3], v[80:83]
    v_mfma_f32_16x16x32_bf16 v[88:91], a[112:115], a[16:19], v[88:91]
    v_mfma_f32_16x16x32_bf16 v[92:95], a[112:115], a[20:23], v[92:95]
    ds_read_b64_tr_b16 a[64:65], v20 offset:0
    v_mfma_f32_16x16x32_bf16 v[96:99], a[112:115], a[24:27], v[96:99]
    ds_read_b64_tr_b16 a[66:67], v20 offset:1024
    v_mfma_f32_16x16x32_bf16 v[100:103], a[112:115], a[28:31], v[100:103]
    ds_read_b64_tr_b16 a[68:69], v21 offset:0
    v_mfma_f32_16x16x32_bf16 v[116:119], a[116:119], a[28:31], v[116:119]
    ds_read_b64_tr_b16 a[70:71], v21 offset:1024
    v_mfma_f32_16x16x32_bf16 v[112:115], a[116:119], a[24:27], v[112:115]
    ds_read_b64_tr_b16 a[72:73], v22 offset:0
    v_mfma_f32_16x16x32_bf16 v[108:111], a[116:119], a[20:23], v[108:111]
    s_add_u32 s75, s66, 57344
    ds_read_b64_tr_b16 a[74:75], v22 offset:1024
    v_mfma_f32_16x16x32_bf16 v[104:107], a[116:119], a[16:19], v[104:107]
    buffer_load_dwordx4 a[0:3], v36, s[52:55], s75 offen sc1
    v_mfma_f32_16x16x32_bf16 v[120:123], a[120:123], a[16:19], v[120:123]
    ds_read_b64_tr_b16 a[76:77], v23 offset:0
    v_mfma_f32_16x16x32_bf16 v[124:127], a[120:123], a[20:23], v[124:127]
    s_add_u32 s77, s76, 36864
    ds_read_b64_tr_b16 a[78:79], v23 offset:1024
    v_mfma_f32_16x16x32_bf16 a[160:163], a[120:123], a[24:27], a[160:163]
    buffer_store_dwordx4 v[216:219], v2, s[52:55], s77 offen offset:2048 sc1
    v_mfma_f32_16x16x32_bf16 a[164:167], a[120:123], a[28:31], a[164:167]
    ds_read_b64_tr_b16 a[80:81], v24 offset:0
    v_mfma_f32_16x16x32_bf16 a[180:183], a[124:127], a[28:31], a[180:183]
    ds_read_b64_tr_b16 a[82:83], v24 offset:1024
    v_mfma_f32_16x16x32_bf16 a[176:179], a[124:127], a[24:27], a[176:179]
    ds_read_b64_tr_b16 a[84:85], v25 offset:0
    v_mfma_f32_16x16x32_bf16 a[172:175], a[124:127], a[20:23], a[172:175]
    ds_read_b64_tr_b16 a[86:87], v25 offset:1024
    v_mfma_f32_16x16x32_bf16 a[168:171], a[124:127], a[16:19], a[168:171]
    ds_read_b64_tr_b16 a[88:89], v26 offset:0
    v_mfma_f32_16x16x32_bf16 a[184:187], a[128:131], a[16:19], a[184:187]
    ds_read_b64_tr_b16 a[90:91], v26 offset:1024
    v_mfma_f32_16x16x32_bf16 a[188:191], a[128:131], a[20:23], a[188:191]
    ds_read_b64_tr_b16 a[92:93], v27 offset:0
    v_mfma_f32_16x16x32_bf16 a[192:195], a[128:131], a[24:27], a[192:195]
    ds_read_b64_tr_b16 a[94:95], v27 offset:1024
    v_mfma_f32_16x16x32_bf16 a[196:199], a[128:131], a[28:31], a[196:199]
    ds_read_b64_tr_b16 a[96:97], v16 offset:0
    v_mfma_f32_16x16x32_bf16 a[212:215], a[132:135], a[28:31], a[212:215]
    buffer_load_dwordx4 a[4:7], v37, s[52:55], s75 offen sc1
    v_mfma_f32_16x16x32_bf16 a[208:211], a[132:135], a[24:27], a[208:211]
    ds_read_b64_tr_b16 a[98:99], v16 offset:512
    v_mfma_f32_16x16x32_bf16 a[204:207], a[132:135], a[20:23], a[204:207]
    ds_read_b64_tr_b16 a[100:101], v17 offset:0
    v_mfma_f32_16x16x32_bf16 a[200:203], a[132:135], a[16:19], a[200:203]
    s_add_u32 s75, s67, 57344
    ds_read_b64_tr_b16 a[102:103], v17 offset:512
    v_mfma_f32_16x16x32_bf16 a[216:219], a[136:139], a[16:19], a[216:219]
    buffer_load_dwordx4 a[8:11], v36, s[52:55], s75 offen sc1
    v_mfma_f32_16x16x32_bf16 a[220:223], a[136:139], a[20:23], a[220:223]
    ds_read_b64_tr_b16 a[104:105], v18 offset:0
    v_mfma_f32_16x16x32_bf16 a[224:227], a[136:139], a[24:27], a[224:227]
    buffer_store_dwordx4 v[220:223], v2, s[52:55], s77 offen offset:3072 sc1
    v_mfma_f32_16x16x32_bf16 a[228:231], a[136:139], a[28:31], a[228:231]
    ds_read_b64_tr_b16 a[106:107], v18 offset:512
    v_mfma_f32_16x16x32_bf16 a[244:247], a[140:143], a[28:31], a[244:247]
    ds_read_b64_tr_b16 a[108:109], v19 offset:0
    v_mfma_f32_16x16x32_bf16 a[240:243], a[140:143], a[24:27], a[240:243]
    ds_read_b64_tr_b16 a[110:111], v19 offset:512
    v_mfma_f32_16x16x32_bf16 a[236:239], a[140:143], a[20:23], a[236:239]
    v_and_b32 v39, 7, v1
    v_lshlrev_b32 v39, 2, v39
    v_mfma_f32_16x16x32_bf16 a[232:235], a[140:143], a[16:19], a[232:235]
    v_mfma_f32_16x16x32_bf16 v[40:43], a[144:147], a[16:19], v[40:43]
    v_mfma_f32_16x16x32_bf16 v[44:47], a[144:147], a[20:23], v[44:47]
    v_mfma_f32_16x16x32_bf16 v[48:51], a[144:147], a[24:27], v[48:51]
    v_mfma_f32_16x16x32_bf16 v[52:55], a[144:147], a[28:31], v[52:55]
    v_mfma_f32_16x16x32_bf16 v[68:71], a[148:151], a[28:31], v[68:71]
    v_mfma_f32_16x16x32_bf16 v[64:67], a[148:151], a[24:27], v[64:67]
    buffer_load_dwordx4 a[12:15], v37, s[52:55], s75 offen sc1
    v_mfma_f32_16x16x32_bf16 v[60:63], a[148:151], a[20:23], v[60:63]
    v_mfma_f32_16x16x32_bf16 v[56:59], a[148:151], a[16:19], v[56:59]
    v_mfma_f32_16x16x32_bf16 v[72:75], a[152:155], a[16:19], v[72:75]
    v_mfma_f32_16x16x32_bf16 v[76:79], a[152:155], a[20:23], v[76:79]
    s_add_u32 s77, s76, 49152
    v_mfma_f32_16x16x32_bf16 v[84:87], a[156:159], a[20:23], v[84:87]
    s_nop 0
    s_waitcnt vmcnt(17) lgkmcnt(0)
    buffer_store_dwordx4 v[224:227], v2, s[52:55], s77 offen offset:0 sc1
    v_mfma_f32_16x16x32_bf16 v[80:83], a[156:159], a[16:19], v[80:83]
    v_mfma_f32_16x16x32_bf16 v[88:91], a[64:67], a[32:35], v[88:91]
    v_mfma_f32_16x16x32_bf16 v[92:95], a[64:67], a[36:39], v[92:95]
    ds_read_b64_tr_b16 a[112:113], v20 offset:12288
    v_mfma_f32_16x16x32_bf16 v[96:99], a[64:67], a[40:43], v[96:99]
    ds_read_b64_tr_b16 a[114:115], v20 offset:13312
    v_add_u32 v20, 4294836224, v20
    v_mfma_f32_16x16x32_bf16 v[100:103], a[64:67], a[44:47], v[100:103]
    ds_read_b64_tr_b16 a[116:117], v21 offset:12288
    v_mfma_f32_16x16x32_bf16 v[116:119], a[68:71], a[44:47], v[116:119]
    ds_read_b64_tr_b16 a[118:119], v21 offset:13312
    v_add_u32 v21, 4294836224, v21
    v_mfma_f32_16x16x32_bf16 v[112:115], a[68:71], a[40:43], v[112:115]
    s_add_u32 s77, s76, 49152
    ds_read_b64_tr_b16 a[120:121], v22 offset:12288
    v_mfma_f32_16x16x32_bf16 v[108:111], a[68:71], a[36:39], v[108:111]
    buffer_store_dwordx4 v[228:231], v2, s[52:55], s77 offen offset:1024 sc1
    v_mfma_f32_16x16x32_bf16 v[104:107], a[68:71], a[32:35], v[104:107]
    ds_read_b64_tr_b16 a[122:123], v22 offset:13312
    v_add_u32 v22, 4294836224, v22
    v_mfma_f32_16x16x32_bf16 v[120:123], a[72:75], a[32:35], v[120:123]
    ds_read_b64_tr_b16 a[124:125], v23 offset:12288
    v_mfma_f32_16x16x32_bf16 v[124:127], a[72:75], a[36:39], v[124:127]
    ds_read_b64_tr_b16 a[126:127], v23 offset:13312
    v_add_u32 v23, 4294836224, v23
    v_mfma_f32_16x16x32_bf16 a[160:163], a[72:75], a[40:43], a[160:163]
    ds_read_b64_tr_b16 a[128:129], v24 offset:12288
    v_mfma_f32_16x16x32_bf16 a[164:167], a[72:75], a[44:47], a[164:167]
    ds_read_b64_tr_b16 a[130:131], v24 offset:13312
    v_add_u32 v24, 4294836224, v24
    v_mfma_f32_16x16x32_bf16 a[180:183], a[76:79], a[44:47], a[180:183]
    ds_read_b64_tr_b16 a[132:133], v25 offset:12288
    v_mfma_f32_16x16x32_bf16 a[176:179], a[76:79], a[40:43], a[176:179]
    ds_read_b64_tr_b16 a[134:135], v25 offset:13312
    v_add_u32 v25, 4294836224, v25
    v_mfma_f32_16x16x32_bf16 a[172:175], a[76:79], a[36:39], a[172:175]
    s_add_u32 s75, s66, 61440
    ds_read_b64_tr_b16 a[136:137], v26 offset:12288
    v_mfma_f32_16x16x32_bf16 a[168:171], a[76:79], a[32:35], a[168:171]
    buffer_load_dwordx4 a[16:19], v36, s[52:55], s75 offen sc1
    v_mfma_f32_16x16x32_bf16 a[184:187], a[80:83], a[32:35], a[184:187]
    ds_read_b64_tr_b16 a[138:139], v26 offset:13312
    v_add_u32 v26, 4294836224, v26
    v_mfma_f32_16x16x32_bf16 a[188:191], a[80:83], a[36:39], a[188:191]
    buffer_load_dwordx4 a[20:23], v37, s[52:55], s75 offen sc1
    v_mfma_f32_16x16x32_bf16 a[192:195], a[80:83], a[40:43], a[192:195]
    buffer_store_dwordx4 v[232:235], v2, s[52:55], s77 offen offset:2048 sc1
    v_mfma_f32_16x16x32_bf16 a[196:199], a[80:83], a[44:47], a[196:199]
    ds_read_b64_tr_b16 a[140:141], v27 offset:12288
    v_mfma_f32_16x16x32_bf16 a[212:215], a[84:87], a[44:47], a[212:215]
    ds_read_b64_tr_b16 a[142:143], v27 offset:13312
    v_add_u32 v27, 4294836224, v27
    v_mfma_f32_16x16x32_bf16 a[208:211], a[84:87], a[40:43], a[208:211]
    ds_read_b64_tr_b16 a[144:145], v16 offset:12288
    v_mfma_f32_16x16x32_bf16 a[204:207], a[84:87], a[36:39], a[204:207]
    ds_read_b64_tr_b16 a[146:147], v16 offset:12800
    v_add_u32 v16, 4294836224, v16
    v_mfma_f32_16x16x32_bf16 a[200:203], a[84:87], a[32:35], a[200:203]
    ds_read_b64_tr_b16 a[148:149], v17 offset:12288
    v_mfma_f32_16x16x32_bf16 a[216:219], a[88:91], a[32:35], a[216:219]
    ds_read_b64_tr_b16 a[150:151], v17 offset:12800
    v_add_u32 v17, 4294836224, v17
    v_mfma_f32_16x16x32_bf16 a[220:223], a[88:91], a[36:39], a[220:223]
    ds_read_b64_tr_b16 a[152:153], v18 offset:12288
    v_mfma_f32_16x16x32_bf16 a[224:227], a[88:91], a[40:43], a[224:227]
    ds_read_b64_tr_b16 a[154:155], v18 offset:12800
    v_add_u32 v18, 4294836224, v18
    v_mfma_f32_16x16x32_bf16 a[228:231], a[88:91], a[44:47], a[228:231]
    s_add_u32 s75, s67, 61440
    ds_read_b64_tr_b16 a[156:157], v19 offset:12288
    v_mfma_f32_16x16x32_bf16 a[244:247], a[92:95], a[44:47], a[244:247]
    buffer_load_dwordx4 a[24:27], v36, s[52:55], s75 offen sc1
    v_mfma_f32_16x16x32_bf16 a[240:243], a[92:95], a[40:43], a[240:243]
    ds_read_b64_tr_b16 a[158:159], v19 offset:12800
    v_add_u32 v19, 4294836224, v19
    v_mfma_f32_16x16x32_bf16 a[236:239], a[92:95], a[36:39], a[236:239]
    buffer_store_dwordx4 v[236:239], v2, s[52:55], s77 offen offset:3072 sc1
    v_mfma_f32_16x16x32_bf16 a[232:235], a[92:95], a[32:35], a[232:235]
    v_mfma_f32_16x16x32_bf16 v[40:43], a[96:99], a[32:35], v[40:43]
    v_mfma_f32_16x16x32_bf16 v[44:47], a[96:99], a[36:39], v[44:47]
    v_mfma_f32_16x16x32_bf16 v[48:51], a[96:99], a[40:43], v[48:51]
    v_mfma_f32_16x16x32_bf16 v[52:55], a[96:99], a[44:47], v[52:55]
    v_mfma_f32_16x16x32_bf16 v[68:71], a[100:103], a[44:47], v[68:71]
    v_mfma_f32_16x16x32_bf16 v[64:67], a[100:103], a[40:43], v[64:67]
    v_mfma_f32_16x16x32_bf16 v[60:63], a[100:103], a[36:39], v[60:63]
    v_mfma_f32_16x16x32_bf16 v[56:59], a[100:103], a[32:35], v[56:59]
    buffer_load_dwordx4 a[28:31], v37, s[52:55], s75 offen sc1
    v_mfma_f32_16x16x32_bf16 v[72:75], a[104:107], a[32:35], v[72:75]
    v_mfma_f32_16x16x32_bf16 v[76:79], a[104:107], a[36:39], v[76:79]
    s_add_u32 s77, s76, 53248
    v_mfma_f32_16x16x32_bf16 v[84:87], a[108:111], a[36:39], v[84:87]
    s_nop 0
    s_waitcnt vmcnt(18) lgkmcnt(0)
    buffer_store_dwordx4 v[240:243], v2, s[52:55], s77 offen offset:0 sc1
    v_mfma_f32_16x16x32_bf16 v[80:83], a[108:111], a[32:35], v[80:83]
    v_mfma_f32_16x16x32_bf16 v[88:91], a[112:115], a[48:51], v[88:91]
    v_mfma_f32_16x16x32_bf16 v[92:95], a[112:115], a[52:55], v[92:95]
    ds_read_b64_tr_b16 a[64:65], v20 offset:0
    v_mfma_f32_16x16x32_bf16 v[96:99], a[112:115], a[56:59], v[96:99]
    ds_read_b64_tr_b16 a[66:67], v20 offset:1024
    v_mfma_f32_16x16x32_bf16 v[100:103], a[112:115], a[60:63], v[100:103]
    ds_read_b64_tr_b16 a[68:69], v21 offset:0
    v_mfma_f32_16x16x32_bf16 v[116:119], a[116:119], a[60:63], v[116:119]
    ds_read_b64_tr_b16 a[70:71], v21 offset:1024
    v_mfma_f32_16x16x32_bf16 v[112:115], a[116:119], a[56:59], v[112:115]
    ds_read_b64_tr_b16 a[72:73], v22 offset:0
    v_mfma_f32_16x16x32_bf16 v[108:111], a[116:119], a[52:55], v[108:111]
    ds_read_b64_tr_b16 a[74:75], v22 offset:1024
    v_mfma_f32_16x16x32_bf16 v[104:107], a[116:119], a[48:51], v[104:107]
    ds_read_b64_tr_b16 a[76:77], v23 offset:0
    v_mfma_f32_16x16x32_bf16 v[120:123], a[120:123], a[48:51], v[120:123]
    ds_read_b64_tr_b16 a[78:79], v23 offset:1024
    v_mfma_f32_16x16x32_bf16 v[124:127], a[120:123], a[52:55], v[124:127]
    s_add_u32 s77, s76, 53248
    ds_read_b64_tr_b16 a[80:81], v24 offset:0
    v_mfma_f32_16x16x32_bf16 a[160:163], a[120:123], a[56:59], a[160:163]
    buffer_store_dwordx4 v[244:247], v2, s[52:55], s77 offen offset:1024 sc1
    v_mfma_f32_16x16x32_bf16 a[164:167], a[120:123], a[60:63], a[164:167]
    ds_read_b64_tr_b16 a[82:83], v24 offset:1024
    v_mfma_f32_16x16x32_bf16 a[180:183], a[124:127], a[60:63], a[180:183]
    ds_read_b64_tr_b16 a[84:85], v25 offset:0
    v_mfma_f32_16x16x32_bf16 a[176:179], a[124:127], a[56:59], a[176:179]
    ds_read_b64_tr_b16 a[86:87], v25 offset:1024
    v_mfma_f32_16x16x32_bf16 a[172:175], a[124:127], a[52:55], a[172:175]
    ds_read_b64_tr_b16 a[88:89], v26 offset:0
    v_mfma_f32_16x16x32_bf16 a[168:171], a[124:127], a[48:51], a[168:171]
    ds_read_b64_tr_b16 a[90:91], v26 offset:1024
    v_mfma_f32_16x16x32_bf16 a[184:187], a[128:131], a[48:51], a[184:187]
    ds_read_b64_tr_b16 a[92:93], v27 offset:0
    v_mfma_f32_16x16x32_bf16 a[188:191], a[128:131], a[52:55], a[188:191]
    ds_read_b64_tr_b16 a[94:95], v27 offset:1024
    v_mfma_f32_16x16x32_bf16 a[192:195], a[128:131], a[56:59], a[192:195]
    ds_read_b64_tr_b16 a[96:97], v16 offset:0
    v_mfma_f32_16x16x32_bf16 a[196:199], a[128:131], a[60:63], a[196:199]
    ds_read_b64_tr_b16 a[98:99], v16 offset:512
    v_mfma_f32_16x16x32_bf16 a[212:215], a[132:135], a[60:63], a[212:215]
    ds_read_b64_tr_b16 a[100:101], v17 offset:0
    v_mfma_f32_16x16x32_bf16 a[208:211], a[132:135], a[56:59], a[208:211]
    ds_read_b64_tr_b16 a[102:103], v17 offset:512
    v_mfma_f32_16x16x32_bf16 a[204:207], a[132:135], a[52:55], a[204:207]
    ds_read_b64_tr_b16 a[104:105], v18 offset:0
    v_mfma_f32_16x16x32_bf16 a[200:203], a[132:135], a[48:51], a[200:203]
    ds_read_b64_tr_b16 a[106:107], v18 offset:512
    v_mfma_f32_16x16x32_bf16 a[216:219], a[136:139], a[48:51], a[216:219]
    ds_read_b64_tr_b16 a[108:109], v19 offset:0
    v_mfma_f32_16x16x32_bf16 a[220:223], a[136:139], a[52:55], a[220:223]
    ds_read_b64_tr_b16 a[110:111], v19 offset:512
    v_mfma_f32_16x16x32_bf16 a[224:227], a[136:139], a[56:59], a[224:227]
    buffer_store_dwordx4 v[248:251], v2, s[52:55], s77 offen offset:2048 sc1
    v_mfma_f32_16x16x32_bf16 a[228:231], a[136:139], a[60:63], a[228:231]
    v_accvgpr_read_b32 v28, a248
    v_accvgpr_read_b32 v29, a249
    v_mfma_f32_16x16x32_bf16 a[244:247], a[140:143], a[60:63], a[244:247]
    v_accvgpr_read_b32 v30, a250
    v_accvgpr_read_b32 v31, a251
    v_mfma_f32_16x16x32_bf16 a[240:243], a[140:143], a[56:59], a[240:243]
    v_accvgpr_read_b32 v32, a252
    v_accvgpr_read_b32 v33, a253
    v_mfma_f32_16x16x32_bf16 a[236:239], a[140:143], a[52:55], a[236:239]
    v_accvgpr_read_b32 v34, a254
    v_accvgpr_read_b32 v35, a255
    v_mfma_f32_16x16x32_bf16 a[232:235], a[140:143], a[48:51], a[232:235]
    v_mfma_f32_16x16x32_bf16 v[40:43], a[144:147], a[48:51], v[40:43]
    v_mfma_f32_16x16x32_bf16 v[44:47], a[144:147], a[52:55], v[44:47]
    v_mfma_f32_16x16x32_bf16 v[48:51], a[144:147], a[56:59], v[48:51]
    v_mfma_f32_16x16x32_bf16 v[52:55], a[144:147], a[60:63], v[52:55]
    v_mfma_f32_16x16x32_bf16 v[68:71], a[148:151], a[60:63], v[68:71]
    v_mfma_f32_16x16x32_bf16 v[64:67], a[148:151], a[56:59], v[64:67]
    v_mfma_f32_16x16x32_bf16 v[60:63], a[148:151], a[52:55], v[60:63]
    v_mfma_f32_16x16x32_bf16 v[56:59], a[148:151], a[48:51], v[56:59]
    v_mfma_f32_16x16x32_bf16 v[72:75], a[152:155], a[48:51], v[72:75]
    v_mfma_f32_16x16x32_bf16 v[76:79], a[152:155], a[52:55], v[76:79]
    v_mfma_f32_16x16x32_bf16 v[84:87], a[156:159], a[52:55], v[84:87]
    s_nop 0
    s_waitcnt vmcnt(11) lgkmcnt(0)
    buffer_store_dwordx4 v[252:255], v2, s[52:55], s77 offen offset:3072 sc1
    v_mfma_f32_16x16x32_bf16 v[80:83], a[156:159], a[48:51], v[80:83]
    v_mfma_f32_16x16x32_bf16 v[88:91], a[64:67], a[0:3], v[88:91]
    v_mfma_f32_16x16x32_bf16 v[92:95], a[64:67], a[4:7], v[92:95]
    ds_read_b64_tr_b16 a[112:113], v20 offset:12288
    v_mfma_f32_16x16x32_bf16 v[96:99], a[64:67], a[8:11], v[96:99]
    ds_read_b64_tr_b16 a[114:115], v20 offset:13312
    v_mfma_f32_16x16x32_bf16 v[100:103], a[64:67], a[12:15], v[100:103]
    ds_read_b64_tr_b16 a[116:117], v21 offset:12288
    v_mfma_f32_16x16x32_bf16 v[116:119], a[68:71], a[12:15], v[116:119]
    ds_read_b64_tr_b16 a[118:119], v21 offset:13312
    v_mfma_f32_16x16x32_bf16 v[112:115], a[68:71], a[8:11], v[112:115]
    ds_read_b64_tr_b16 a[120:121], v22 offset:12288
    v_mfma_f32_16x16x32_bf16 v[108:111], a[68:71], a[4:7], v[108:111]
    ds_read_b64_tr_b16 a[122:123], v22 offset:13312
    v_mfma_f32_16x16x32_bf16 v[104:107], a[68:71], a[0:3], v[104:107]
    ds_read_b64_tr_b16 a[124:125], v23 offset:12288
    v_mfma_f32_16x16x32_bf16 v[120:123], a[72:75], a[0:3], v[120:123]
    ds_read_b64_tr_b16 a[126:127], v23 offset:13312
    v_mfma_f32_16x16x32_bf16 v[124:127], a[72:75], a[4:7], v[124:127]
    ds_read_b64_tr_b16 a[128:129], v24 offset:12288
    v_mfma_f32_16x16x32_bf16 a[160:163], a[72:75], a[8:11], a[160:163]
    ds_read_b64_tr_b16 a[130:131], v24 offset:13312
    v_mfma_f32_16x16x32_bf16 a[164:167], a[72:75], a[12:15], a[164:167]
    ds_read_b64_tr_b16 a[132:133], v25 offset:12288
    v_mfma_f32_16x16x32_bf16 a[180:183], a[76:79], a[12:15], a[180:183]
    ds_read_b64_tr_b16 a[134:135], v25 offset:13312
    v_mfma_f32_16x16x32_bf16 a[176:179], a[76:79], a[8:11], a[176:179]
    ds_read_b64_tr_b16 a[136:137], v26 offset:12288
    v_mfma_f32_16x16x32_bf16 a[172:175], a[76:79], a[4:7], a[172:175]
    ds_read_b64_tr_b16 a[138:139], v26 offset:13312
    v_mfma_f32_16x16x32_bf16 a[168:171], a[76:79], a[0:3], a[168:171]
    ds_read_b64_tr_b16 a[140:141], v27 offset:12288
    v_mfma_f32_16x16x32_bf16 a[184:187], a[80:83], a[0:3], a[184:187]
    ds_read_b64_tr_b16 a[142:143], v27 offset:13312
    v_mfma_f32_16x16x32_bf16 a[188:191], a[80:83], a[4:7], a[188:191]
    ds_read_b64_tr_b16 a[144:145], v16 offset:12288
    v_mfma_f32_16x16x32_bf16 a[192:195], a[80:83], a[8:11], a[192:195]
    ds_read_b64_tr_b16 a[146:147], v16 offset:12800
    v_mfma_f32_16x16x32_bf16 a[196:199], a[80:83], a[12:15], a[196:199]
    ds_read_b64_tr_b16 a[148:149], v17 offset:12288
    v_mfma_f32_16x16x32_bf16 a[212:215], a[84:87], a[12:15], a[212:215]
    ds_read_b64_tr_b16 a[150:151], v17 offset:12800
    v_mfma_f32_16x16x32_bf16 a[208:211], a[84:87], a[8:11], a[208:211]
    ds_read_b64_tr_b16 a[152:153], v18 offset:12288
    v_mfma_f32_16x16x32_bf16 a[204:207], a[84:87], a[4:7], a[204:207]
    ds_read_b64_tr_b16 a[154:155], v18 offset:12800
    v_mfma_f32_16x16x32_bf16 a[200:203], a[84:87], a[0:3], a[200:203]
    ds_read_b64_tr_b16 a[156:157], v19 offset:12288
    v_mfma_f32_16x16x32_bf16 a[216:219], a[88:91], a[0:3], a[216:219]
    ds_read_b64_tr_b16 a[158:159], v19 offset:12800
    v_mfma_f32_16x16x32_bf16 a[220:223], a[88:91], a[4:7], a[220:223]
    v_mfma_f32_16x16x32_bf16 a[224:227], a[88:91], a[8:11], a[224:227]
    v_mfma_f32_16x16x32_bf16 a[228:231], a[88:91], a[12:15], a[228:231]
    v_mfma_f32_16x16x32_bf16 a[244:247], a[92:95], a[12:15], a[244:247]
    v_mfma_f32_16x16x32_bf16 a[240:243], a[92:95], a[8:11], a[240:243]
    v_mfma_f32_16x16x32_bf16 a[236:239], a[92:95], a[4:7], a[236:239]
    v_mov_b32 v245, v36
    v_mov_b32 v246, v37
    v_mfma_f32_16x16x32_bf16 a[232:235], a[92:95], a[0:3], a[232:235]
    v_add_u32 v36, s19, v2
    v_add_u32 v37, s20, v2
    v_mfma_f32_16x16x32_bf16 v[40:43], a[96:99], a[0:3], v[40:43]
    v_add_u32_e64 v38, s21, v2
    v_mfma_f32_16x16x32_bf16 v[44:47], a[96:99], a[4:7], v[44:47]
    v_mfma_f32_16x16x32_bf16 v[48:51], a[96:99], a[8:11], v[48:51]
    v_mfma_f32_16x16x32_bf16 v[52:55], a[96:99], a[12:15], v[52:55]
    v_mfma_f32_16x16x32_bf16 v[68:71], a[100:103], a[12:15], v[68:71]
    v_mfma_f32_16x16x32_bf16 v[64:67], a[100:103], a[8:11], v[64:67]
    v_mfma_f32_16x16x32_bf16 v[60:63], a[100:103], a[4:7], v[60:63]
    v_mfma_f32_16x16x32_bf16 v[56:59], a[100:103], a[0:3], v[56:59]
    v_mfma_f32_16x16x32_bf16 v[72:75], a[104:107], a[0:3], v[72:75]
    v_mfma_f32_16x16x32_bf16 v[76:79], a[104:107], a[4:7], v[76:79]
    v_mfma_f32_16x16x32_bf16 v[84:87], a[108:111], a[4:7], v[84:87]
    s_nop 0
    s_waitcnt vmcnt(4) lgkmcnt(0)
    v_mfma_f32_16x16x32_bf16 v[80:83], a[108:111], a[0:3], v[80:83]
    v_mfma_f32_16x16x32_bf16 v[88:91], a[112:115], a[16:19], v[88:91]
    s_waitcnt vmcnt(0)
    s_barrier
    v_mfma_f32_16x16x32_bf16 v[92:95], a[112:115], a[20:23], v[92:95]
    s_cmp_lg_u32 s4, 0
    s_cbranch_scc1 L_sigkv
    s_lshl_b32 s9, s6, 2
    s_add_u32 s8, s78, s9
    s_mov_b64 exec, 1
    v_mov_b32_e64 v3, 1
    buffer_store_dword v3, off, s[52:55], s8 sc1
    s_mov_b64 exec, -1
L_sigkv:
    v_mfma_f32_16x16x32_bf16 v[96:99], a[112:115], a[24:27], v[96:99]
    v_mfma_f32_16x16x32_bf16 v[100:103], a[112:115], a[28:31], v[100:103]
    v_mfma_f32_16x16x32_bf16 v[116:119], a[116:119], a[28:31], v[116:119]
    v_mfma_f32_16x16x32_bf16 v[112:115], a[116:119], a[24:27], v[112:115]
    v_mfma_f32_16x16x32_bf16 v[108:111], a[116:119], a[20:23], v[108:111]
    v_mfma_f32_16x16x32_bf16 v[104:107], a[116:119], a[16:19], v[104:107]
    v_mfma_f32_16x16x32_bf16 v[120:123], a[120:123], a[16:19], v[120:123]
    v_mfma_f32_16x16x32_bf16 v[124:127], a[120:123], a[20:23], v[124:127]
    v_mfma_f32_16x16x32_bf16 a[160:163], a[120:123], a[24:27], a[160:163]
    v_mfma_f32_16x16x32_bf16 a[164:167], a[120:123], a[28:31], a[164:167]
    v_mfma_f32_16x16x32_bf16 a[180:183], a[124:127], a[28:31], a[180:183]
    v_cvt_pk_bf16_f32 v128, v88, v89
    v_cvt_pk_bf16_f32 v129, v90, v91
    v_mfma_f32_16x16x32_bf16 a[176:179], a[124:127], a[24:27], a[176:179]
    v_cvt_pk_bf16_f32 v130, v104, v105
    v_cvt_pk_bf16_f32 v131, v106, v107
    v_mfma_f32_16x16x32_bf16 a[172:175], a[124:127], a[20:23], a[172:175]
    ds_write_b128 v36, v[128:131] offset:0
    v_mfma_f32_16x16x32_bf16 a[168:171], a[124:127], a[16:19], a[168:171]
    v_cvt_pk_bf16_f32 v132, v92, v93
    v_cvt_pk_bf16_f32 v133, v94, v95
    v_mfma_f32_16x16x32_bf16 a[184:187], a[128:131], a[16:19], a[184:187]
    v_cvt_pk_bf16_f32 v134, v108, v109
    v_cvt_pk_bf16_f32 v135, v110, v111
    v_mfma_f32_16x16x32_bf16 a[188:191], a[128:131], a[20:23], a[188:191]
    ds_write_b128 v36, v[132:135] offset:1024
    v_mfma_f32_16x16x32_bf16 a[192:195], a[128:131], a[24:27], a[192:195]
    v_cvt_pk_bf16_f32 v136, v96, v97
    v_cvt_pk_bf16_f32 v137, v98, v99
    v_mfma_f32_16x16x32_bf16 a[196:199], a[128:131], a[28:31], a[196:199]
    v_cvt_pk_bf16_f32 v138, v112, v113
    v_cvt_pk_bf16_f32 v139, v114, v115
    v_mfma_f32_16x16x32_bf16 a[212:215], a[132:135], a[28:31], a[212:215]
    ds_write_b128 v37, v[136:139] offset:2048
    v_mfma_f32_16x16x32_bf16 a[208:211], a[132:135], a[24:27], a[208:211]
    v_cvt_pk_bf16_f32 v140, v100, v101
    v_cvt_pk_bf16_f32 v141, v102, v103
    v_mfma_f32_16x16x32_bf16 a[204:207], a[132:135], a[20:23], a[204:207]
    v_cvt_pk_bf16_f32 v142, v116, v117
    v_cvt_pk_bf16_f32 v143, v118, v119
    v_mfma_f32_16x16x32_bf16 a[200:203], a[132:135], a[16:19], a[200:203]
    ds_write_b128 v37, v[140:143] offset:3072
    v_mfma_f32_16x16x32_bf16 a[216:219], a[136:139], a[16:19], a[216:219]
    v_cvt_pk_bf16_f32 v144, v120, v121
    v_cvt_pk_bf16_f32 v145, v122, v123
    v_mfma_f32_16x16x32_bf16 a[220:223], a[136:139], a[20:23], a[220:223]
    v_accvgpr_read_b32 v196, a168
    v_accvgpr_read_b32 v197, a169
    v_mfma_f32_16x16x32_bf16 a[224:227], a[136:139], a[24:27], a[224:227]
    v_accvgpr_read_b32 v198, a170
    v_accvgpr_read_b32 v199, a171
    v_mfma_f32_16x16x32_bf16 a[228:231], a[136:139], a[28:31], a[228:231]
    v_cvt_pk_bf16_f32 v146, v196, v197
    v_cvt_pk_bf16_f32 v147, v198, v199
    v_mfma_f32_16x16x32_bf16 a[244:247], a[140:143], a[28:31], a[244:247]
    ds_write_b128 v36, v[144:147] offset:4096
    v_mfma_f32_16x16x32_bf16 a[240:243], a[140:143], a[24:27], a[240:243]
    v_cvt_pk_bf16_f32 v148, v124, v125
    v_cvt_pk_bf16_f32 v149, v126, v127
    v_mfma_f32_16x16x32_bf16 a[236:239], a[140:143], a[20:23], a[236:239]
    v_accvgpr_read_b32 v204, a172
    v_accvgpr_read_b32 v205, a173
    v_mfma_f32_16x16x32_bf16 a[232:235], a[140:143], a[16:19], a[232:235]
    v_accvgpr_read_b32 v206, a174
    v_accvgpr_read_b32 v207, a175
    v_mfma_f32_16x16x32_bf16 v[40:43], a[144:147], a[16:19], v[40:43]
    v_cvt_pk_bf16_f32 v150, v204, v205
    v_cvt_pk_bf16_f32 v151, v206, v207
    v_mfma_f32_16x16x32_bf16 v[44:47], a[144:147], a[20:23], v[44:47]
    ds_write_b128 v36, v[148:151] offset:5120
    v_mfma_f32_16x16x32_bf16 v[48:51], a[144:147], a[24:27], v[48:51]
    v_accvgpr_read_b32 v192, a160
    v_accvgpr_read_b32 v193, a161
    v_mfma_f32_16x16x32_bf16 v[52:55], a[144:147], a[28:31], v[52:55]
    v_accvgpr_read_b32 v194, a162
    v_accvgpr_read_b32 v195, a163
    v_mfma_f32_16x16x32_bf16 v[68:71], a[148:151], a[28:31], v[68:71]
    v_cvt_pk_bf16_f32 v152, v192, v193
    v_cvt_pk_bf16_f32 v153, v194, v195
    v_mfma_f32_16x16x32_bf16 v[64:67], a[148:151], a[24:27], v[64:67]
    v_accvgpr_read_b32 v196, a176
    v_accvgpr_read_b32 v197, a177
    v_mfma_f32_16x16x32_bf16 v[60:63], a[148:151], a[20:23], v[60:63]
    v_accvgpr_read_b32 v198, a178
    v_accvgpr_read_b32 v199, a179
    v_mfma_f32_16x16x32_bf16 v[56:59], a[148:151], a[16:19], v[56:59]
    v_cvt_pk_bf16_f32 v154, v196, v197
    v_cvt_pk_bf16_f32 v155, v198, v199
    v_mfma_f32_16x16x32_bf16 v[72:75], a[152:155], a[16:19], v[72:75]
    ds_write_b128 v37, v[152:155] offset:6144
    v_mfma_f32_16x16x32_bf16 v[76:79], a[152:155], a[20:23], v[76:79]
    v_accvgpr_read_b32 v200, a164
    v_accvgpr_read_b32 v201, a165
    v_mfma_f32_16x16x32_bf16 v[84:87], a[156:159], a[20:23], v[84:87]
    v_accvgpr_read_b32 v202, a166
    v_accvgpr_read_b32 v203, a167
    v_mfma_f32_16x16x32_bf16 v[80:83], a[156:159], a[16:19], v[80:83]
    v_cvt_pk_bf16_f32 v156, v200, v201
    v_cvt_pk_bf16_f32 v157, v202, v203
    buffer_load_dword v3, v39, s[52:55], s78 offen sc1
    v_accvgpr_read_b32 v204, a180
    v_accvgpr_read_b32 v205, a181
    v_accvgpr_read_b32 v206, a182
    v_accvgpr_read_b32 v207, a183
    v_cvt_pk_bf16_f32 v158, v204, v205
    v_cvt_pk_bf16_f32 v159, v206, v207
    ds_write_b128 v37, v[156:159] offset:7168
    v_accvgpr_read_b32 v192, a184
    v_accvgpr_read_b32 v193, a185
    v_accvgpr_read_b32 v194, a186
    v_accvgpr_read_b32 v195, a187
    v_cvt_pk_bf16_f32 v160, v192, v193
    v_cvt_pk_bf16_f32 v161, v194, v195
    v_accvgpr_read_b32 v196, a200
    v_accvgpr_read_b32 v197, a201
    v_accvgpr_read_b32 v198, a202
    v_accvgpr_read_b32 v199, a203
    v_cvt_pk_bf16_f32 v162, v196, v197
    v_cvt_pk_bf16_f32 v163, v198, v199
    ds_write_b128 v36, v[160:163] offset:8192
    v_accvgpr_read_b32 v200, a188
    v_accvgpr_read_b32 v201, a189
    v_accvgpr_read_b32 v202, a190
    v_accvgpr_read_b32 v203, a191
    v_cvt_pk_bf16_f32 v164, v200, v201
    v_cvt_pk_bf16_f32 v165, v202, v203
    v_accvgpr_read_b32 v204, a204
    v_accvgpr_read_b32 v205, a205
    v_accvgpr_read_b32 v206, a206
    v_accvgpr_read_b32 v207, a207
    v_cvt_pk_bf16_f32 v166, v204, v205
    v_cvt_pk_bf16_f32 v167, v206, v207
    ds_write_b128 v36, v[164:167] offset:9216
    v_accvgpr_read_b32 v192, a192
    v_accvgpr_read_b32 v193, a193
    v_accvgpr_read_b32 v194, a194
    v_accvgpr_read_b32 v195, a195
    v_cvt_pk_bf16_f32 v168, v192, v193
    v_cvt_pk_bf16_f32 v169, v194, v195
    v_accvgpr_read_b32 v196, a208
    v_accvgpr_read_b32 v197, a209
    v_accvgpr_read_b32 v198, a210
    v_accvgpr_read_b32 v199, a211
    v_cvt_pk_bf16_f32 v170, v196, v197
    v_cvt_pk_bf16_f32 v171, v198, v199
    ds_write_b128 v37, v[168:171] offset:10240
    v_accvgpr_read_b32 v200, a196
    v_accvgpr_read_b32 v201, a197
    v_accvgpr_read_b32 v202, a198
    v_accvgpr_read_b32 v203, a199
    v_cvt_pk_bf16_f32 v172, v200, v201
    v_cvt_pk_bf16_f32 v173, v202, v203
    v_accvgpr_read_b32 v204, a212
    v_accvgpr_read_b32 v205, a213
    v_accvgpr_read_b32 v206, a214
    v_accvgpr_read_b32 v207, a215
    v_cvt_pk_bf16_f32 v174, v204, v205
    v_cvt_pk_bf16_f32 v175, v206, v207
    ds_write_b128 v37, v[172:175] offset:11264
    v_accvgpr_read_b32 v192, a216
    v_accvgpr_read_b32 v193, a217
    v_accvgpr_read_b32 v194, a218
    v_accvgpr_read_b32 v195, a219
    v_cvt_pk_bf16_f32 v176, v192, v193
    v_cvt_pk_bf16_f32 v177, v194, v195
    v_accvgpr_read_b32 v196, a232
    v_accvgpr_read_b32 v197, a233
    v_accvgpr_read_b32 v198, a234
    v_accvgpr_read_b32 v199, a235
    v_cvt_pk_bf16_f32 v178, v196, v197
    v_cvt_pk_bf16_f32 v179, v198, v199
    ds_write_b128 v36, v[176:179] offset:12288
    v_accvgpr_read_b32 v200, a220
    v_accvgpr_read_b32 v201, a221
    v_accvgpr_read_b32 v202, a222
    v_accvgpr_read_b32 v203, a223
    v_cvt_pk_bf16_f32 v180, v200, v201
    v_cvt_pk_bf16_f32 v181, v202, v203
    v_accvgpr_read_b32 v204, a236
    v_accvgpr_read_b32 v205, a237
    v_accvgpr_read_b32 v206, a238
    v_accvgpr_read_b32 v207, a239
    v_cvt_pk_bf16_f32 v182, v204, v205
    v_cvt_pk_bf16_f32 v183, v206, v207
    ds_write_b128 v36, v[180:183] offset:13312
    v_accvgpr_read_b32 v192, a224
    v_accvgpr_read_b32 v193, a225
    v_accvgpr_read_b32 v194, a226
    v_accvgpr_read_b32 v195, a227
    v_cvt_pk_bf16_f32 v184, v192, v193
    v_cvt_pk_bf16_f32 v185, v194, v195
    v_accvgpr_read_b32 v196, a240
    v_accvgpr_read_b32 v197, a241
    v_accvgpr_read_b32 v198, a242
    v_accvgpr_read_b32 v199, a243
    v_cvt_pk_bf16_f32 v186, v196, v197
    v_cvt_pk_bf16_f32 v187, v198, v199
    ds_write_b128 v37, v[184:187] offset:14336
    v_accvgpr_read_b32 v200, a228
    v_accvgpr_read_b32 v201, a229
    v_accvgpr_read_b32 v202, a230
    v_accvgpr_read_b32 v203, a231
    v_cvt_pk_bf16_f32 v188, v200, v201
    v_cvt_pk_bf16_f32 v189, v202, v203
    v_accvgpr_read_b32 v204, a244
    v_accvgpr_read_b32 v205, a245
    v_accvgpr_read_b32 v206, a246
    v_accvgpr_read_b32 v207, a247
    v_cvt_pk_bf16_f32 v190, v204, v205
    v_cvt_pk_bf16_f32 v191, v206, v207
    ds_write_b128 v37, v[188:191] offset:15360
    s_mov_b32 s8, 0x40faf233
    s_mov_b32 s9, 0x40faf233
    s_mov_b32 s10, 0xbdd2d3e8
    s_mov_b32 s11, 0xbdd2d3e8
    s_mov_b32 s12, 1.0
    s_mov_b32 s13, 1.0
    v_mov_b32 v224, 0xc0135761
    v_mov_b32 v225, 0xc0135761
    v_lshlrev_b32 v192, 16, v28
    v_and_b32 v193, 0xffff0000, v28
    v_lshlrev_b32 v194, 16, v29
    v_and_b32 v195, 0xffff0000, v29
    v_lshlrev_b32 v196, 16, v30
    v_and_b32 v197, 0xffff0000, v30
    v_lshlrev_b32 v198, 16, v31
    v_and_b32 v199, 0xffff0000, v31
    v_lshlrev_b32 v200, 16, v32
    v_and_b32 v201, 0xffff0000, v32
    v_lshlrev_b32 v202, 16, v33
    v_and_b32 v203, 0xffff0000, v33
    v_lshlrev_b32 v204, 16, v34
    v_and_b32 v205, 0xffff0000, v34
    v_lshlrev_b32 v206, 16, v35
    v_and_b32 v207, 0xffff0000, v35
    s_waitcnt vmcnt(0)
    v_cmp_ne_u32 vcc, 0, v3
    s_cmp_eq_u64 vcc, -1
    s_cbranch_scc0 L_pollkv
L_pollkv_ret:
    s_waitcnt lgkmcnt(0)
    s_barrier
    v_pk_fma_f32 v[40:41], v[40:41], s[8:9], v[192:193]
    v_pk_fma_f32 v[42:43], v[42:43], s[8:9], v[194:195]
    v_pk_fma_f32 v[56:57], v[56:57], s[8:9], v[196:197]
    v_pk_fma_f32 v[58:59], v[58:59], s[8:9], v[198:199]
    ds_read_b128 a[128:131], v38 offset:0
    v_pk_mul_f32 v[208:209], v[40:41], v[40:41]
    v_pk_mul_f32 v[210:211], v[42:43], v[42:43]
    v_pk_mul_f32 v[212:213], v[56:57], v[56:57]
    v_pk_mul_f32 v[214:215], v[58:59], v[58:59]
    s_add_u32 m0, s80, 0
    s_add_u32 s3, s84, 0
    buffer_load_dwordx4 v2, s[52:55], s3 offen offset:0 sc1 lds
    v_pk_fma_f32 v[208:209], v[208:209], s[10:11], v[224:225]
    v_pk_fma_f32 v[210:211], v[210:211], s[10:11], v[224:225]
    v_pk_fma_f32 v[212:213], v[212:213], s[10:11], v[224:225]
    v_pk_fma_f32 v[214:215], v[214:215], s[10:11], v[224:225]
    ds_read_b128 a[132:135], v38 offset:1024
    v_pk_mul_f32 v[208:209], v[208:209], v[40:41]
    v_pk_mul_f32 v[210:211], v[210:211], v[42:43]
    v_pk_mul_f32 v[212:213], v[212:213], v[56:57]
    v_pk_mul_f32 v[214:215], v[214:215], v[58:59]
    buffer_load_dwordx4 v2, s[52:55], s3 offen offset:1024 sc1 lds
    v_exp_f32 v208, v208
    v_exp_f32 v209, v209
    v_exp_f32 v210, v210
    v_exp_f32 v211, v211
    ds_read_b128 a[136:139], v38 offset:2048
    v_exp_f32 v212, v212
    v_exp_f32 v213, v213
    v_exp_f32 v214, v214
    v_exp_f32 v215, v215
    buffer_load_dwordx4 v2, s[52:55], s3 offen offset:2048 sc1 lds
    v_pk_add_f32 v[208:209], v[208:209], s[12:13]
    v_pk_add_f32 v[210:211], v[210:211], s[12:13]
    v_pk_add_f32 v[212:213], v[212:213], s[12:13]
    v_pk_add_f32 v[214:215], v[214:215], s[12:13]
    ds_read_b128 a[140:143], v38 offset:3072
    v_rcp_f32 v208, v208
    v_rcp_f32 v209, v209
    v_rcp_f32 v210, v210
    v_rcp_f32 v211, v211
    buffer_load_dwordx4 v2, s[52:55], s3 offen offset:3072 sc1 lds
    v_rcp_f32 v212, v212
    v_rcp_f32 v213, v213
    v_rcp_f32 v214, v214
    v_rcp_f32 v215, v215
    ds_read_b128 a[144:147], v38 offset:4096
    v_pk_mul_f32 v[40:41], v[40:41], v[208:209]
    v_pk_mul_f32 v[42:43], v[42:43], v[210:211]
    v_pk_mul_f32 v[56:57], v[56:57], v[212:213]
    v_pk_mul_f32 v[58:59], v[58:59], v[214:215]
    s_add_u32 m0, s80, 16384
    s_add_u32 s3, s84, 32768
    buffer_load_dwordx4 v2, s[52:55], s3 offen offset:0 sc1 lds
    v_cvt_pk_bf16_f32 v4, v40, v41
    v_cvt_pk_bf16_f32 v5, v42, v43
    v_cvt_pk_bf16_f32 v6, v56, v57
    v_cvt_pk_bf16_f32 v7, v58, v59
    ds_read_b128 a[148:151], v38 offset:5120
    v_pk_fma_f32 v[44:45], v[44:45], s[8:9], v[192:193]
    v_pk_fma_f32 v[46:47], v[46:47], s[8:9], v[194:195]
    v_pk_fma_f32 v[60:61], v[60:61], s[8:9], v[196:197]
    v_pk_fma_f32 v[62:63], v[62:63], s[8:9], v[198:199]
    buffer_load_dwordx4 v2, s[52:55], s3 offen offset:1024 sc1 lds
    v_pk_mul_f32 v[208:209], v[44:45], v[44:45]
    v_pk_mul_f32 v[210:211], v[46:47], v[46:47]
    v_pk_mul_f32 v[212:213], v[60:61], v[60:61]
    v_pk_mul_f32 v[214:215], v[62:63], v[62:63]
    ds_read_b128 a[152:155], v38 offset:6144
    v_pk_fma_f32 v[208:209], v[208:209], s[10:11], v[224:225]
    v_pk_fma_f32 v[210:211], v[210:211], s[10:11], v[224:225]
    v_pk_fma_f32 v[212:213], v[212:213], s[10:11], v[224:225]
    v_pk_fma_f32 v[214:215], v[214:215], s[10:11], v[224:225]
    buffer_load_dwordx4 v2, s[52:55], s3 offen offset:2048 sc1 lds
    v_pk_mul_f32 v[208:209], v[208:209], v[44:45]
    v_pk_mul_f32 v[210:211], v[210:211], v[46:47]
    v_pk_mul_f32 v[212:213], v[212:213], v[60:61]
    v_pk_mul_f32 v[214:215], v[214:215], v[62:63]
    ds_read_b128 a[156:159], v38 offset:7168
    v_exp_f32 v208, v208
    v_exp_f32 v209, v209
    v_exp_f32 v210, v210
    v_exp_f32 v211, v211
    buffer_load_dwordx4 v2, s[52:55], s3 offen offset:3072 sc1 lds
    v_exp_f32 v212, v212
    v_exp_f32 v213, v213
    v_exp_f32 v214, v214
    v_exp_f32 v215, v215
    ds_read_b128 a[160:163], v38 offset:8192
    v_pk_add_f32 v[208:209], v[208:209], s[12:13]
    v_pk_add_f32 v[210:211], v[210:211], s[12:13]
    v_pk_add_f32 v[212:213], v[212:213], s[12:13]
    v_pk_add_f32 v[214:215], v[214:215], s[12:13]
    s_add_u32 m0, s80, 32768
    s_add_u32 s3, s88, 0
    buffer_load_dwordx4 v2, s[52:55], s3 offen offset:0 sc1 lds
    v_rcp_f32 v208, v208
    v_rcp_f32 v209, v209
    v_rcp_f32 v210, v210
    v_rcp_f32 v211, v211
    ds_read_b128 a[164:167], v38 offset:9216
    v_rcp_f32 v212, v212
    v_rcp_f32 v213, v213
    v_rcp_f32 v214, v214
    v_rcp_f32 v215, v215
    buffer_load_dwordx4 v2, s[52:55], s3 offen offset:1024 sc1 lds
    v_pk_mul_f32 v[44:45], v[44:45], v[208:209]
    v_pk_mul_f32 v[46:47], v[46:47], v[210:211]
    v_pk_mul_f32 v[60:61], v[60:61], v[212:213]
    v_pk_mul_f32 v[62:63], v[62:63], v[214:215]
    ds_read_b128 a[168:171], v38 offset:10240
    v_cvt_pk_bf16_f32 v8, v44, v45
    v_cvt_pk_bf16_f32 v9, v46, v47
    v_cvt_pk_bf16_f32 v10, v60, v61
    v_cvt_pk_bf16_f32 v11, v62, v63
    buffer_load_dwordx4 v2, s[52:55], s3 offen offset:2048 sc1 lds
    v_pk_fma_f32 v[48:49], v[48:49], s[8:9], v[192:193]
    v_pk_fma_f32 v[50:51], v[50:51], s[8:9], v[194:195]
    v_pk_fma_f32 v[64:65], v[64:65], s[8:9], v[196:197]
    v_pk_fma_f32 v[66:67], v[66:67], s[8:9], v[198:199]
    ds_read_b128 a[172:175], v38 offset:11264
    v_pk_mul_f32 v[208:209], v[48:49], v[48:49]
    v_pk_mul_f32 v[210:211], v[50:51], v[50:51]
    v_pk_mul_f32 v[212:213], v[64:65], v[64:65]
    v_pk_mul_f32 v[214:215], v[66:67], v[66:67]
    buffer_load_dwordx4 v2, s[52:55], s3 offen offset:3072 sc1 lds
    v_pk_fma_f32 v[208:209], v[208:209], s[10:11], v[224:225]
    v_pk_fma_f32 v[210:211], v[210:211], s[10:11], v[224:225]
    v_pk_fma_f32 v[212:213], v[212:213], s[10:11], v[224:225]
    v_pk_fma_f32 v[214:215], v[214:215], s[10:11], v[224:225]
    ds_read_b128 a[176:179], v38 offset:12288
    v_pk_mul_f32 v[208:209], v[208:209], v[48:49]
    v_pk_mul_f32 v[210:211], v[210:211], v[50:51]
    v_pk_mul_f32 v[212:213], v[212:213], v[64:65]
    v_pk_mul_f32 v[214:215], v[214:215], v[66:67]
    s_add_u32 m0, s80, 65536
    s_add_u32 s3, s84, 65536
    buffer_load_dwordx4 v2, s[52:55], s3 offen offset:0 sc1 lds
    v_exp_f32 v208, v208
    v_exp_f32 v209, v209
    v_exp_f32 v210, v210
    v_exp_f32 v211, v211
    ds_read_b128 a[180:183], v38 offset:13312
    v_exp_f32 v212, v212
    v_exp_f32 v213, v213
    v_exp_f32 v214, v214
    v_exp_f32 v215, v215
    buffer_load_dwordx4 v2, s[52:55], s3 offen offset:1024 sc1 lds
    v_pk_add_f32 v[208:209], v[208:209], s[12:13]
    v_pk_add_f32 v[210:211], v[210:211], s[12:13]
    v_pk_add_f32 v[212:213], v[212:213], s[12:13]
    v_pk_add_f32 v[214:215], v[214:215], s[12:13]
    ds_read_b128 a[184:187], v38 offset:14336
    v_rcp_f32 v208, v208
    v_rcp_f32 v209, v209
    v_rcp_f32 v210, v210
    v_rcp_f32 v211, v211
    buffer_load_dwordx4 v2, s[52:55], s3 offen offset:2048 sc1 lds
    v_rcp_f32 v212, v212
    v_rcp_f32 v213, v213
    v_rcp_f32 v214, v214
    v_rcp_f32 v215, v215
    ds_read_b128 a[188:191], v38 offset:15360
    v_pk_mul_f32 v[48:49], v[48:49], v[208:209]
    v_pk_mul_f32 v[50:51], v[50:51], v[210:211]
    v_pk_mul_f32 v[64:65], v[64:65], v[212:213]
    v_pk_mul_f32 v[66:67], v[66:67], v[214:215]
    buffer_load_dwordx4 v2, s[52:55], s3 offen offset:3072 sc1 lds
    v_cvt_pk_bf16_f32 v12, v48, v49
    v_cvt_pk_bf16_f32 v13, v50, v51
    v_cvt_pk_bf16_f32 v14, v64, v65
    v_cvt_pk_bf16_f32 v15, v66, v67
    ds_read_b128 a[192:195], v38 offset:16384
    v_pk_fma_f32 v[52:53], v[52:53], s[8:9], v[192:193]
    v_pk_fma_f32 v[54:55], v[54:55], s[8:9], v[194:195]
    v_pk_fma_f32 v[68:69], v[68:69], s[8:9], v[196:197]
    v_pk_fma_f32 v[70:71], v[70:71], s[8:9], v[198:199]
    s_add_u32 m0, s80, 81920
    s_add_u32 s3, s84, 98304
    buffer_load_dwordx4 v2, s[52:55], s3 offen offset:0 sc1 lds
    v_pk_mul_f32 v[208:209], v[52:53], v[52:53]
    v_pk_mul_f32 v[210:211], v[54:55], v[54:55]
    v_pk_mul_f32 v[212:213], v[68:69], v[68:69]
    v_pk_mul_f32 v[214:215], v[70:71], v[70:71]
    ds_read_b128 a[196:199], v38 offset:17408
    v_pk_fma_f32 v[208:209], v[208:209], s[10:11], v[224:225]
    v_pk_fma_f32 v[210:211], v[210:211], s[10:11], v[224:225]
    v_pk_fma_f32 v[212:213], v[212:213], s[10:11], v[224:225]
    v_pk_fma_f32 v[214:215], v[214:215], s[10:11], v[224:225]
    buffer_load_dwordx4 v2, s[52:55], s3 offen offset:1024 sc1 lds
    v_pk_mul_f32 v[208:209], v[208:209], v[52:53]
    v_pk_mul_f32 v[210:211], v[210:211], v[54:55]
    v_pk_mul_f32 v[212:213], v[212:213], v[68:69]
    v_pk_mul_f32 v[214:215], v[214:215], v[70:71]
    ds_read_b128 a[200:203], v38 offset:18432
    v_exp_f32 v208, v208
    v_exp_f32 v209, v209
    v_exp_f32 v210, v210
    v_exp_f32 v211, v211
    buffer_load_dwordx4 v2, s[52:55], s3 offen offset:2048 sc1 lds
    v_exp_f32 v212, v212
    v_exp_f32 v213, v213
    v_exp_f32 v214, v214
    v_exp_f32 v215, v215
    ds_read_b128 a[204:207], v38 offset:19456
    v_pk_add_f32 v[208:209], v[208:209], s[12:13]
    v_pk_add_f32 v[210:211], v[210:211], s[12:13]
    v_pk_add_f32 v[212:213], v[212:213], s[12:13]
    v_pk_add_f32 v[214:215], v[214:215], s[12:13]
    buffer_load_dwordx4 v2, s[52:55], s3 offen offset:3072 sc1 lds
    v_rcp_f32 v208, v208
    v_rcp_f32 v209, v209
    v_rcp_f32 v210, v210
    v_rcp_f32 v211, v211
    ds_read_b128 a[208:211], v38 offset:20480
    v_rcp_f32 v212, v212
    v_rcp_f32 v213, v213
    v_rcp_f32 v214, v214
    v_rcp_f32 v215, v215
    s_add_u32 m0, s80, 49152
    s_add_u32 s3, s88, 32768
    buffer_load_dwordx4 v2, s[52:55], s3 offen offset:0 sc1 lds
    v_pk_mul_f32 v[52:53], v[52:53], v[208:209]
    v_pk_mul_f32 v[54:55], v[54:55], v[210:211]
    v_pk_mul_f32 v[68:69], v[68:69], v[212:213]
    v_pk_mul_f32 v[70:71], v[70:71], v[214:215]
    ds_read_b128 a[212:215], v38 offset:21504
    v_cvt_pk_bf16_f32 v16, v52, v53
    v_cvt_pk_bf16_f32 v17, v54, v55
    v_cvt_pk_bf16_f32 v18, v68, v69
    v_cvt_pk_bf16_f32 v19, v70, v71
    buffer_load_dwordx4 v2, s[52:55], s3 offen offset:1024 sc1 lds
    v_pk_fma_f32 v[72:73], v[72:73], s[8:9], v[200:201]
    v_pk_fma_f32 v[74:75], v[74:75], s[8:9], v[202:203]
    v_pk_fma_f32 v[80:81], v[80:81], s[8:9], v[204:205]
    v_pk_fma_f32 v[82:83], v[82:83], s[8:9], v[206:207]
    ds_read_b128 a[216:219], v38 offset:22528
    v_pk_mul_f32 v[208:209], v[72:73], v[72:73]
    v_pk_mul_f32 v[210:211], v[74:75], v[74:75]
    v_pk_mul_f32 v[212:213], v[80:81], v[80:81]
    v_pk_mul_f32 v[214:215], v[82:83], v[82:83]
    buffer_load_dwordx4 v2, s[52:55], s3 offen offset:2048 sc1 lds
    v_pk_fma_f32 v[208:209], v[208:209], s[10:11], v[224:225]
    v_pk_fma_f32 v[210:211], v[210:211], s[10:11], v[224:225]
    v_pk_fma_f32 v[212:213], v[212:213], s[10:11], v[224:225]
    v_pk_fma_f32 v[214:215], v[214:215], s[10:11], v[224:225]
    ds_read_b128 a[220:223], v38 offset:23552
    v_pk_mul_f32 v[208:209], v[208:209], v[72:73]
    v_pk_mul_f32 v[210:211], v[210:211], v[74:75]
    v_pk_mul_f32 v[212:213], v[212:213], v[80:81]
    v_pk_mul_f32 v[214:215], v[214:215], v[82:83]
    buffer_load_dwordx4 v2, s[52:55], s3 offen offset:3072 sc1 lds
    v_exp_f32 v208, v208
    v_exp_f32 v209, v209
    v_exp_f32 v210, v210
    v_exp_f32 v211, v211
    ds_read_b128 a[224:227], v38 offset:24576
    v_exp_f32 v212, v212
    v_exp_f32 v213, v213
    v_exp_f32 v214, v214
    v_exp_f32 v215, v215
    ds_read_b128 a[228:231], v38 offset:25600
    v_pk_add_f32 v[208:209], v[208:209], s[12:13]
    v_pk_add_f32 v[210:211], v[210:211], s[12:13]
    v_pk_add_f32 v[212:213], v[212:213], s[12:13]
    v_pk_add_f32 v[214:215], v[214:215], s[12:13]
    ds_read_b128 a[232:235], v38 offset:26624
    v_rcp_f32 v208, v208
    v_rcp_f32 v209, v209
    v_rcp_f32 v210, v210
    v_rcp_f32 v211, v211
    ds_read_b128 a[236:239], v38 offset:27648
    v_rcp_f32 v212, v212
    v_rcp_f32 v213, v213
    v_rcp_f32 v214, v214
    v_rcp_f32 v215, v215
    ds_read_b128 a[240:243], v38 offset:28672
    v_pk_mul_f32 v[72:73], v[72:73], v[208:209]
    v_pk_mul_f32 v[74:75], v[74:75], v[210:211]
    v_pk_mul_f32 v[80:81], v[80:81], v[212:213]
    v_pk_mul_f32 v[82:83], v[82:83], v[214:215]
    ds_read_b128 a[244:247], v38 offset:29696
    v_cvt_pk_bf16_f32 v20, v72, v73
    v_cvt_pk_bf16_f32 v21, v74, v75
    v_cvt_pk_bf16_f32 v22, v80, v81
    v_cvt_pk_bf16_f32 v23, v82, v83
    ds_read_b128 a[248:251], v38 offset:30720
    v_pk_fma_f32 v[76:77], v[76:77], s[8:9], v[200:201]
    v_pk_fma_f32 v[78:79], v[78:79], s[8:9], v[202:203]
    v_pk_fma_f32 v[84:85], v[84:85], s[8:9], v[204:205]
    v_pk_fma_f32 v[86:87], v[86:87], s[8:9], v[206:207]
    ds_read_b128 a[252:255], v38 offset:31744
    v_pk_mul_f32 v[208:209], v[76:77], v[76:77]
    v_pk_mul_f32 v[210:211], v[78:79], v[78:79]
    v_pk_mul_f32 v[212:213], v[84:85], v[84:85]
    v_pk_mul_f32 v[214:215], v[86:87], v[86:87]
    v_pk_fma_f32 v[208:209], v[208:209], s[10:11], v[224:225]
    v_pk_fma_f32 v[210:211], v[210:211], s[10:11], v[224:225]
    v_pk_fma_f32 v[212:213], v[212:213], s[10:11], v[224:225]
    v_pk_fma_f32 v[214:215], v[214:215], s[10:11], v[224:225]
    v_pk_mul_f32 v[208:209], v[208:209], v[76:77]
    v_pk_mul_f32 v[210:211], v[210:211], v[78:79]
    v_pk_mul_f32 v[212:213], v[212:213], v[84:85]
    v_pk_mul_f32 v[214:215], v[214:215], v[86:87]
    v_exp_f32 v208, v208
    v_exp_f32 v209, v209
    v_exp_f32 v210, v210
    v_exp_f32 v211, v211
    v_exp_f32 v212, v212
    v_exp_f32 v213, v213
    v_exp_f32 v214, v214
    v_exp_f32 v215, v215
    v_pk_add_f32 v[208:209], v[208:209], s[12:13]
    v_pk_add_f32 v[210:211], v[210:211], s[12:13]
    v_pk_add_f32 v[212:213], v[212:213], s[12:13]
    v_pk_add_f32 v[214:215], v[214:215], s[12:13]
    v_rcp_f32 v208, v208
    v_rcp_f32 v209, v209
    v_rcp_f32 v210, v210
    v_rcp_f32 v211, v211
    v_rcp_f32 v212, v212
    v_rcp_f32 v213, v213
    v_rcp_f32 v214, v214
    v_rcp_f32 v215, v215
    v_pk_mul_f32 v[76:77], v[76:77], v[208:209]
    v_pk_mul_f32 v[78:79], v[78:79], v[210:211]
    v_pk_mul_f32 v[84:85], v[84:85], v[212:213]
    v_pk_mul_f32 v[86:87], v[86:87], v[214:215]
    v_cvt_pk_bf16_f32 v24, v76, v77
    v_cvt_pk_bf16_f32 v25, v78, v79
    v_cvt_pk_bf16_f32 v26, v84, v85
    v_cvt_pk_bf16_f32 v27, v86, v87
    s_mov_b32 s19, 1073741824
    v_add_u32 v232, s23, v2
    s_waitcnt vmcnt(16) lgkmcnt(0)
    s_barrier
    ds_read_b128 v[176:179], v232 offset:0
    ds_read_b128 v[180:183], v232 offset:1024
    ds_read_b128 v[192:195], v232 offset:2048
    ds_read_b128 v[196:199], v232 offset:3072
    s_waitcnt lgkmcnt(2)
    v_mfma_f32_16x16x32_bf16 v[64:67], v[176:179], a[128:131], 0
    s_and_b32 s8, s2, 7
    s_lshr_b32 s9, s2, 3
    s_lshr_b32 s64, s8, 1
    s_and_b32 s8, s8, 1
    v_xor_b32 v233, 0x10000, v232
    v_lshrrev_b32_e64 v38, 4, v1
    v_mfma_f32_16x16x32_bf16 v[64:67], v[180:183], a[144:147], v[64:67]
    s_lshl_b32 s76, s8, 5
    s_add_u32 s76, s76, s9
    s_sub_u32 s65, 15, s6
    v_lshlrev_b32 v38, 2, v38
    v_and_b32_e64 v39, 15, v1
    v_mfma_f32_16x16x32_bf16 v[72:75], v[180:183], a[148:151], 0
    s_cmp_eq_u32 s8, 0
    s_cselect_b32 s65, s6, s65
    s_and_b32 s66, s9, 3
    s_mul_i32 s68, s64, 43
    v_sub_u32_e64 v234, v38, v39
    v_mov_b32 v235, 0xff800000
    v_mfma_f32_16x16x32_bf16 v[72:75], v[176:179], a[132:135], v[72:75]
    s_lshl_b32 s70, s68, 15
    s_mov_b32 s46, 0x400000
    s_cmp_eq_u32 s64, 3
    s_cselect_b32 s68, 128, s68
    s_cselect_b32 s44, s34, s26
    s_cmp_eq_u32 s64, 3
    s_cselect_b32 s45, s35, s27
    s_cselect_b32 s46, 1409024, s46
    v_lshlrev_b32_e64 v239, 7, v1
    v_cmp_gt_u32 vcc, 11, v1
    v_mfma_f32_16x16x32_bf16 v[80:83], v[176:179], a[136:139], 0
    s_cmp_eq_u32 s64, 3
    s_cselect_b32 s70, 0, s70
    s_mov_b32 s47, 0x00020000
    s_lshl_b32 s74, s4, 11
    v_mov_b32 v247, 0x40000000
    v_lshrrev_b32_e64 v38, 5, v1
    v_mfma_f32_16x16x32_bf16 v[80:83], v[180:183], a[152:155], v[80:83]
    s_mov_b32 s48, s36
    s_mov_b32 s49, s37
    s_mov_b32 s50, 1024
    v_cndmask_b32_e64 v247, v247, v239, vcc
    v_lshl_add_u32 v239, v38, 28, v239
    v_mfma_f32_16x16x32_bf16 v[88:91], v[180:183], a[156:159], 0
    s_mov_b32 s51, 0x00020000
    s_mov_b32 s60, s26
    s_mov_b32 s61, s27
    v_mfma_f32_16x16x32_bf16 v[88:91], v[176:179], a[140:143], v[88:91]
    s_nop 0
    s_waitcnt lgkmcnt(0)
    s_mov_b32 s62, 4194304
    s_mov_b32 s63, 0x00020000
    s_lshl_b32 s3, s2, 2
    s_add_u32 s3, s3, s4
    v_mfma_f32_16x16x32_bf16 v[64:67], v[192:195], a[160:163], v[64:67]
    s_lshl_b32 s97, s3, 12
    s_mul_i32 s79, s3, 1408
    s_mov_b32 s72, 0
    ds_read_b128 v[176:179], v232 offset:4096
    v_mfma_f32_16x16x32_bf16 v[64:67], v[196:199], a[176:179], v[64:67]
    s_mul_i32 s69, s65, 1400832
    s_lshl_b32 s8, s68, 13
    s_add_u32 s69, s69, s8
    ds_read_b128 v[180:183], v232 offset:5120
    v_mfma_f32_16x16x32_bf16 v[72:75], v[196:199], a[180:183], v[72:75]
    s_add_u32 s69, s69, s74
    s_add_u32 s69, s69, 35651584
    s_lshl_b32 s8, s6, 8
    s_add_u32 s8, s8, 79704064
    v_mfma_f32_16x16x32_bf16 v[72:75], v[192:195], a[164:167], v[72:75]
    s_nop 0
    s_lshl_b32 s78, s65, 8
    s_add_u32 s78, s78, 79706112
    s_cmp_eq_u32 s64, 3
    s_cselect_b32 s78, s8, s78
    v_mfma_f32_16x16x32_bf16 v[80:83], v[192:195], a[168:171], v[80:83]
    s_nop 0
    s_lshl_b32 s20, s4, 13
    s_lshl_b32 s3, s66, 8
    s_add_u32 s20, s20, s3
    v_mfma_f32_16x16x32_bf16 v[80:83], v[196:199], a[184:187], v[80:83]
    s_nop 0
    s_and_b32 s21, s4, 2
    s_lshl_b32 s21, s21, 1
    s_lshl_b32 s75, s7, 12
    v_mfma_f32_16x16x32_bf16 v[88:91], v[196:199], a[188:191], v[88:91]
    v_mfma_f32_16x16x32_bf16 v[88:91], v[192:195], a[172:175], v[88:91]
    s_waitcnt lgkmcnt(0)
    v_lshrrev_b32 v62, 4, v1
    v_and_b32_e64 v63, 15, v1
    v_mfma_f32_16x16x32_bf16 v[68:71], v[176:179], a[128:131], 0
    ds_read_b128 v[192:195], v232 offset:6144
    v_lshlrev_b32_e64 v56, 1, v62
    v_mfma_f32_16x16x32_bf16 v[68:71], v[180:183], a[144:147], v[68:71]
    ds_read_b128 v[196:199], v232 offset:7168
    v_xor_b32_e64 v56, v56, v63
    v_mfma_f32_16x16x32_bf16 v[76:79], v[180:183], a[148:151], 0
    v_lshlrev_b32_e64 v56, 4, v56
    v_lshl_add_u32 v57, v62, 10, s20
    v_mfma_f32_16x16x32_bf16 v[76:79], v[176:179], a[132:135], v[76:79]
    v_add_u32_e64 v48, v57, v56
    v_xor_b32 v56, 128, v56
    v_mfma_f32_16x16x32_bf16 v[84:87], v[176:179], a[136:139], 0
    v_add_u32_e64 v49, v57, v56
    v_add_u32 v49, 3072, v49
    v_mfma_f32_16x16x32_bf16 v[84:87], v[180:183], a[152:155], v[84:87]
    v_lshrrev_b32 v56, 2, v1
    v_and_b32 v57, 7, v56
    v_mfma_f32_16x16x32_bf16 v[92:95], v[180:183], a[156:159], 0
    v_lshlrev_b32 v56, 8, v56
    v_and_b32 v58, 3, v1
    v_mfma_f32_16x16x32_bf16 v[92:95], v[176:179], a[140:143], v[92:95]
    s_waitcnt lgkmcnt(0)
    v_lshl_add_u32 v56, v58, 3, v56
    v_xor_b32 v57, s21, v57
    v_mfma_f32_16x16x32_bf16 v[68:71], v[192:195], a[160:163], v[68:71]
    ds_read_b128 v[176:179], v232 offset:16384
    v_xor_b32_e64 v58, 0, v57
    v_mfma_f32_16x16x32_bf16 v[68:71], v[196:199], a[176:179], v[68:71]
    ds_read_b128 v[180:183], v232 offset:17408
    v_lshl_add_u32 v50, v58, 5, v56
    v_mfma_f32_16x16x32_bf16 v[76:79], v[196:199], a[180:183], v[76:79]
    v_xor_b32_e64 v58, 1, v57
    v_lshl_add_u32 v51, v58, 5, v56
    v_mfma_f32_16x16x32_bf16 v[76:79], v[192:195], a[164:167], v[76:79]
    v_xor_b32_e64 v58, 2, v57
    v_lshl_add_u32 v52, v58, 5, v56
    v_mfma_f32_16x16x32_bf16 v[84:87], v[192:195], a[168:171], v[84:87]
    v_xor_b32_e64 v58, 3, v57
    v_lshl_add_u32 v53, v58, 5, v56
    v_mfma_f32_16x16x32_bf16 v[84:87], v[196:199], a[184:187], v[84:87]
    v_add_u32 v54, s75, v2
    v_and_b32 v55, 31, v1
    v_mfma_f32_16x16x32_bf16 v[92:95], v[196:199], a[188:191], v[92:95]
    v_lshlrev_b32 v55, 2, v55
    v_and_b32 v61, 7, v1
    v_mfma_f32_16x16x32_bf16 v[92:95], v[192:195], a[172:175], v[92:95]
    v_lshlrev_b32 v61, 2, v61
    v_add_u32 v56, 65536, v50
    s_mov_b32 s90, s92
    v_add_u32 v57, 65536, v51
    v_add_u32 v58, 65536, v52
    v_add_u32 v59, 65536, v53
    v_add_u32 v60, 65536, v54
    s_nop 3
    v_max3_f32 v208, v64, v65, v66
    v_max3_f32 v209, v72, v73, v74
    v_max3_f32 v210, v80, v81, v82
    v_max3_f32 v211, v88, v89, v90
    v_max3_f32 v208, v208, v67, v68
    v_max3_f32 v209, v209, v75, v76
    v_max3_f32 v210, v210, v83, v84
    v_max3_f32 v211, v211, v91, v92
    v_max3_f32 v208, v208, v69, v70
    v_max3_f32 v209, v209, v77, v78
    v_max3_f32 v210, v210, v85, v86
    v_max3_f32 v211, v211, v93, v94
    v_max_f32 v208, v208, v71
    v_max_f32 v209, v209, v79
    v_max_f32 v210, v210, v87
    v_max_f32 v211, v211, v95
    v_mov_b32 v212, v208
    v_mov_b32 v213, v209
    v_mov_b32 v214, v210
    v_mov_b32 v215, v211
    v_permlane16_swap_b32 v212, v208
    v_permlane16_swap_b32 v213, v209
    v_permlane16_swap_b32 v214, v210
    v_permlane16_swap_b32 v215, v211
    v_max_f32 v208, v208, v212
    v_max_f32 v209, v209, v213
    v_max_f32 v210, v210, v214
    v_max_f32 v211, v211, v215
    v_mov_b32 v212, v208
    v_mov_b32 v213, v209
    v_mov_b32 v214, v210
    v_mov_b32 v215, v211
    v_permlane32_swap_b32 v212, v208
    v_permlane32_swap_b32 v213, v209
    v_permlane32_swap_b32 v214, v210
    v_permlane32_swap_b32 v215, v211
    v_max_f32 v208, v208, v212
    v_max_f32 v209, v209, v213
    v_max_f32 v210, v210, v214
    v_max_f32 v211, v211, v215
    v_max_f32 v208, 0xff61b1e6, v208
    v_max_f32 v209, 0xff61b1e6, v209
    v_max_f32 v210, 0xff61b1e6, v210
    v_max_f32 v211, 0xff61b1e6, v211
    v_sub_f32 v160, 0, v208
    v_sub_f32 v161, 0, v208
    v_sub_f32 v162, 0, v208
    v_sub_f32 v163, 0, v208
    v_sub_f32 v64, v64, v208
    v_sub_f32 v65, v65, v208
    v_sub_f32 v66, v66, v208
    v_sub_f32 v67, v67, v208
    v_sub_f32 v68, v68, v208
    v_sub_f32 v69, v69, v208
    v_sub_f32 v70, v70, v208
    v_sub_f32 v71, v71, v208
    v_sub_f32 v164, 0, v209
    v_sub_f32 v165, 0, v209
    v_sub_f32 v166, 0, v209
    v_sub_f32 v167, 0, v209
    v_sub_f32 v72, v72, v209
    v_sub_f32 v73, v73, v209
    v_sub_f32 v74, v74, v209
    v_sub_f32 v75, v75, v209
    v_sub_f32 v76, v76, v209
    v_sub_f32 v77, v77, v209
    v_sub_f32 v78, v78, v209
    v_sub_f32 v79, v79, v209
    v_sub_f32 v168, 0, v210
    v_sub_f32 v169, 0, v210
    v_sub_f32 v170, 0, v210
    v_sub_f32 v171, 0, v210
    v_sub_f32 v80, v80, v210
    v_sub_f32 v81, v81, v210
    v_sub_f32 v82, v82, v210
    v_sub_f32 v83, v83, v210
    v_sub_f32 v84, v84, v210
    v_sub_f32 v85, v85, v210
    v_sub_f32 v86, v86, v210
    v_sub_f32 v87, v87, v210
    v_sub_f32 v172, 0, v211
    v_sub_f32 v173, 0, v211
    v_sub_f32 v174, 0, v211
    v_sub_f32 v175, 0, v211
    v_sub_f32 v88, v88, v211
    v_sub_f32 v89, v89, v211
    v_sub_f32 v90, v90, v211
    v_sub_f32 v91, v91, v211
    v_sub_f32 v92, v92, v211
    v_sub_f32 v93, v93, v211
    v_sub_f32 v94, v94, v211
    v_sub_f32 v95, v95, v211
    s_waitcnt lgkmcnt(0)
L_first:
    v_mfma_f32_16x16x32_bf16 v[96:99], v[176:179], a[128:131], v[160:163]
    s_waitcnt vmcnt(8)
    s_barrier
    ds_read_b128 v[192:195], v232 offset:18432
    v_exp_f32 v208, v64
    v_exp_f32 v209, v65
    v_mov_b32_e64 v32, v208
    v_mfma_f32_16x16x32_bf16 v[96:99], v[180:183], a[144:147], v[96:99]
    s_add_u32 m0, s80, 0
    s_add_u32 s95, s82, 0
    s_add_u32 s93, s86, 0
    ds_read_b128 v[196:199], v232 offset:19456
    v_exp_f32 v210, v66
    v_add_f32_e64 v32, v32, v209
    v_cvt_pk_bf16_f32 v128, v208, v209
    v_mfma_f32_16x16x32_bf16 v[104:107], v[180:183], a[148:151], v[164:167]
    buffer_load_dwordx4 v2, s[52:55], s95 offen offset:0 sc1 lds
    v_exp_f32 v211, v67
    v_add_f32 v32, v32, v210
    v_mfma_f32_16x16x32_bf16 v[104:107], v[176:179], a[132:135], v[104:107]
    v_exp_f32 v212, v68
    v_add_f32 v32, v32, v211
    v_cvt_pk_bf16_f32 v129, v210, v211
    v_mfma_f32_16x16x32_bf16 v[112:115], v[176:179], a[136:139], v[168:171]
    v_exp_f32 v213, v69
    v_add_f32 v32, v32, v212
    v_mfma_f32_16x16x32_bf16 v[112:115], v[180:183], a[152:155], v[112:115]
    v_exp_f32 v214, v70
    v_add_f32 v32, v32, v213
    v_cvt_pk_bf16_f32 v130, v212, v213
    v_exp_f32_e64 v215, v71
    v_mfma_f32_16x16x32_bf16 v[120:123], v[180:183], a[156:159], v[172:175]
    buffer_load_dwordx4 v2, s[52:55], s95 offen offset:1024 sc1 lds
    v_add_f32_e64 v32, v32, v214
    v_mfma_f32_16x16x32_bf16 v[120:123], v[176:179], a[140:143], v[120:123]
    s_waitcnt lgkmcnt(0)
    ds_read_b128 v[176:179], v232 offset:20480
    buffer_store_dwordx4 v[4:7], v245, s[52:55], s16 offen sc1
    v_exp_f32 v216, v72
    v_mfma_f32_16x16x32_bf16 v[96:99], v[192:195], a[160:163], v[96:99]
    ds_read_b128 v[180:183], v232 offset:21504
    v_add_f32 v32, v32, v215
    v_cvt_pk_bf16_f32 v131, v214, v215
    v_exp_f32 v217, v73
    v_mov_b32_e64 v33, v216
    v_mfma_f32_16x16x32_bf16 v[96:99], v[196:199], a[176:179], v[96:99]
    v_exp_f32 v218, v74
    v_add_f32 v33, v33, v217
    v_cvt_pk_bf16_f32 v132, v216, v217
    v_mfma_f32_16x16x32_bf16 v[104:107], v[196:199], a[180:183], v[104:107]
    buffer_load_dwordx4 v2, s[52:55], s95 offen offset:2048 sc1 lds
    v_exp_f32 v219, v75
    v_add_f32 v33, v33, v218
    v_mfma_f32_16x16x32_bf16 v[104:107], v[192:195], a[164:167], v[104:107]
    v_exp_f32 v220, v76
    v_add_f32 v33, v33, v219
    v_cvt_pk_bf16_f32 v133, v218, v219
    v_mfma_f32_16x16x32_bf16 v[112:115], v[192:195], a[168:171], v[112:115]
    v_exp_f32 v221, v77
    v_add_f32 v33, v33, v220
    v_mfma_f32_16x16x32_bf16 v[112:115], v[196:199], a[184:187], v[112:115]
    v_exp_f32 v222, v78
    v_add_f32 v33, v33, v221
    v_cvt_pk_bf16_f32 v134, v220, v221
    v_exp_f32_e64 v223, v79
    v_mfma_f32_16x16x32_bf16 v[120:123], v[196:199], a[188:191], v[120:123]
    buffer_load_dwordx4 v2, s[52:55], s95 offen offset:3072 sc1 lds
    v_add_f32_e64 v33, v33, v222
    v_mfma_f32_16x16x32_bf16 v[120:123], v[192:195], a[172:175], v[120:123]
    s_waitcnt lgkmcnt(0)
    s_add_u32 m0, s81, 32768
    ds_read_b128 v[192:195], v232 offset:22528
    buffer_store_dwordx4 v[8:11], v246, s[52:55], s16 offen sc1
    v_exp_f32 v208, v80
    v_mfma_f32_16x16x32_bf16 v[100:103], v[176:179], a[128:131], v[160:163]
    ds_read_b128 v[196:199], v232 offset:23552
    v_add_f32 v33, v33, v223
    v_cvt_pk_bf16_f32 v135, v222, v223
    v_exp_f32 v209, v81
    v_mov_b32_e64 v34, v208
    v_mfma_f32_16x16x32_bf16 v[100:103], v[180:183], a[144:147], v[100:103]
    v_exp_f32 v210, v82
    v_add_f32 v34, v34, v209
    v_cvt_pk_bf16_f32 v136, v208, v209
    v_mfma_f32_16x16x32_bf16 v[108:111], v[180:183], a[148:151], v[164:167]
    buffer_load_dwordx4 v2, s[52:55], s93 offen offset:0 sc1 lds
    v_exp_f32 v211, v83
    v_add_f32 v34, v34, v210
    v_mfma_f32_16x16x32_bf16 v[108:111], v[176:179], a[132:135], v[108:111]
    v_exp_f32 v212, v84
    v_add_f32 v34, v34, v211
    v_cvt_pk_bf16_f32 v137, v210, v211
    v_mfma_f32_16x16x32_bf16 v[116:119], v[176:179], a[136:139], v[168:171]
    v_exp_f32 v213, v85
    v_add_f32 v34, v34, v212
    v_mfma_f32_16x16x32_bf16 v[116:119], v[180:183], a[152:155], v[116:119]
    v_exp_f32 v214, v86
    v_add_f32 v34, v34, v213
    v_cvt_pk_bf16_f32 v138, v212, v213
    v_exp_f32_e64 v215, v87
    v_mfma_f32_16x16x32_bf16 v[124:127], v[180:183], a[156:159], v[172:175]
    buffer_load_dwordx4 v2, s[52:55], s93 offen offset:1024 sc1 lds
    v_add_f32_e64 v34, v34, v214
    v_mfma_f32_16x16x32_bf16 v[124:127], v[176:179], a[140:143], v[124:127]
    s_waitcnt lgkmcnt(0)
    ds_read_b128 v[176:179], v233 offset:0
    buffer_store_dwordx4 v[12:15], v245, s[52:55], s17 offen sc1
    v_exp_f32 v216, v88
    v_mfma_f32_16x16x32_bf16 v[100:103], v[192:195], a[160:163], v[100:103]
    ds_read_b128 v[180:183], v233 offset:1024
    v_add_f32 v34, v34, v215
    v_cvt_pk_bf16_f32 v139, v214, v215
    v_exp_f32 v217, v89
    v_mov_b32_e64 v35, v216
    v_mfma_f32_16x16x32_bf16 v[100:103], v[196:199], a[176:179], v[100:103]
    v_exp_f32 v218, v90
    v_add_f32 v35, v35, v217
    v_cvt_pk_bf16_f32 v140, v216, v217
    v_mfma_f32_16x16x32_bf16 v[108:111], v[196:199], a[180:183], v[108:111]
    ds_read_b128 v[184:187], v232 offset:32768
    buffer_load_dwordx4 v2, s[52:55], s93 offen offset:2048 sc1 lds
    v_exp_f32 v219, v91
    v_add_f32 v35, v35, v218
    v_mfma_f32_16x16x32_bf16 v[108:111], v[192:195], a[164:167], v[108:111]
    v_exp_f32 v220, v92
    v_add_f32 v35, v35, v219
    v_cvt_pk_bf16_f32 v141, v218, v219
    v_mfma_f32_16x16x32_bf16 v[116:119], v[192:195], a[168:171], v[116:119]
    ds_read_b128 v[188:191], v232 offset:33792
    v_exp_f32 v221, v93
    v_add_f32 v35, v35, v220
    v_mfma_f32_16x16x32_bf16 v[116:119], v[196:199], a[184:187], v[116:119]
    v_exp_f32 v222, v94
    v_add_f32 v35, v35, v221
    v_cvt_pk_bf16_f32 v142, v220, v221
    v_exp_f32_e64 v223, v95
    v_mfma_f32_16x16x32_bf16 v[124:127], v[196:199], a[188:191], v[124:127]
    buffer_load_dwordx4 v2, s[52:55], s93 offen offset:3072 sc1 lds
    v_add_f32_e64 v35, v35, v222
    v_mfma_f32_16x16x32_bf16 v[124:127], v[192:195], a[172:175], v[124:127]
    s_waitcnt lgkmcnt(2)
    buffer_store_dwordx4 v[16:19], v246, s[52:55], s17 offen sc1
    v_add_f32 v35, v35, v223
    v_cvt_pk_bf16_f32 v143, v222, v223
    v_max3_f32 v224, v32, v33, v34
    v_max_f32_e64 v224, v224, v35
    v_cmp_nge_f32 vcc, s94, v224
    s_cbranch_vccnz L_chk_first
L_second:
    v_mfma_f32_16x16x32_bf16 v[64:67], v[176:179], a[128:131], v[160:163]
    s_waitcnt vmcnt(8)
    s_barrier
    v_exp_f32_e64 v208, v96
    v_mfma_f32_16x16x32_bf16 v[64:67], v[180:183], a[144:147], v[64:67]
    s_add_u32 m0, s80, 16384
    ds_read_b128 v[192:195], v233 offset:2048
    v_add_f32_e64 v36, v32, v208
    v_mfma_f32_16x16x32_bf16 v[72:75], v[180:183], a[148:151], v[164:167]
    s_add_u32 s95, s82, 32768
    v_exp_f32_e64 v209, v97
    v_mfma_f32_16x16x32_bf16 v[72:75], v[176:179], a[132:135], v[72:75]
    s_add_u32 s93, s86, 32768
    v_add_f32_e64 v36, v36, v209
    v_cvt_pk_bf16_f32 v144, v208, v209
    v_mfma_f32_16x16x32_bf16 v[80:83], v[176:179], a[136:139], v[168:171]
    s_xor_b32 s80, s80, 0x10000
    v_exp_f32_e64 v210, v98
    v_mfma_f32_16x16x32_bf16 v[80:83], v[180:183], a[152:155], v[80:83]
    s_add_u32 s82, s82, 65536
    ds_read_b128 v[196:199], v233 offset:3072
    v_add_f32_e64 v36, v36, v210
    v_mfma_f32_16x16x32_bf16 v[88:91], v[180:183], a[156:159], v[172:175]
    s_sub_u32 s83, s83, 1
    v_exp_f32 v211, v99
    v_mfma_f32_16x16x32_bf16 v[88:91], v[176:179], a[140:143], v[88:91]
    s_waitcnt lgkmcnt(3)
    buffer_load_dwordx4 v2, s[52:55], s95 offen offset:0 sc1 lds
    v_add_f32 v36, v36, v211
    v_cvt_pk_bf16_f32 v145, v210, v211
    v_mfma_f32_16x16x32_bf16 a[0:3], v[184:187], v[128:131], 0
    s_cmp_eq_u32 s83, 0
    v_exp_f32 v212, v100
    v_mfma_f32_16x16x32_bf16 a[4:7], v[184:187], v[132:135], 0
    s_cselect_b32 s82, s84, s82
    ds_read_b128 v[200:203], v232 offset:34816
    v_add_f32 v36, v36, v212
    v_mfma_f32_16x16x32_bf16 a[8:11], v[184:187], v[136:139], 0
    s_cselect_b32 s83, s85, s83
    buffer_store_dwordx4 v[20:23], v245, s[52:55], s18 offen sc1
    v_exp_f32 v213, v101
    v_mfma_f32_16x16x32_bf16 a[12:15], v[184:187], v[140:143], 0
    s_waitcnt lgkmcnt(3)
    v_add_f32 v36, v36, v213
    v_cvt_pk_bf16_f32 v146, v212, v213
    v_mfma_f32_16x16x32_bf16 a[28:31], v[188:191], v[140:143], 0
    s_cselect_b32 s84, 1073741824, s84
    v_exp_f32 v214, v102
    v_mfma_f32_16x16x32_bf16 a[24:27], v[188:191], v[136:139], 0
    s_cselect_b32 s85, -1, s85
    ds_read_b128 v[204:207], v232 offset:35840
    v_add_f32 v36, v36, v214
    v_mfma_f32_16x16x32_bf16 a[20:23], v[188:191], v[132:135], 0
    s_add_u32 s86, s86, 65536
    v_exp_f32_e64 v215, v103
    v_mfma_f32_16x16x32_bf16 a[16:19], v[188:191], v[128:131], 0
    s_waitcnt lgkmcnt(2)
    buffer_load_dwordx4 v2, s[52:55], s95 offen offset:1024 sc1 lds
    v_add_f32 v36, v36, v215
    v_cvt_pk_bf16_f32 v147, v214, v215
    v_mfma_f32_16x16x32_bf16 v[64:67], v[192:195], a[160:163], v[64:67]
    s_sub_u32 s87, s87, 1
    v_exp_f32 v216, v104
    v_mfma_f32_16x16x32_bf16 v[64:67], v[196:199], a[176:179], v[64:67]
    s_cmp_eq_u32 s87, 0
    ds_read_b128 v[176:179], v233 offset:4096
    v_add_f32 v37, v33, v216
    v_mfma_f32_16x16x32_bf16 v[72:75], v[196:199], a[180:183], v[72:75]
    s_cselect_b32 s86, s88, s86
    v_exp_f32 v217, v105
    v_mfma_f32_16x16x32_bf16 v[72:75], v[192:195], a[164:167], v[72:75]
    s_cselect_b32 s87, s89, s87
    v_add_f32 v37, v37, v217
    v_cvt_pk_bf16_f32 v148, v216, v217
    v_mfma_f32_16x16x32_bf16 v[80:83], v[192:195], a[168:171], v[80:83]
    s_cselect_b32 s88, 1073741824, s88
    v_exp_f32 v218, v106
    v_mfma_f32_16x16x32_bf16 v[80:83], v[196:199], a[184:187], v[80:83]
    s_cselect_b32 s89, -1, s89
    ds_read_b128 v[180:183], v233 offset:5120
    v_add_f32 v37, v37, v218
    v_mfma_f32_16x16x32_bf16 v[88:91], v[196:199], a[188:191], v[88:91]
    v_exp_f32_e64 v219, v107
    v_mfma_f32_16x16x32_bf16 v[88:91], v[192:195], a[172:175], v[88:91]
    s_waitcnt lgkmcnt(3)
    buffer_load_dwordx4 v2, s[52:55], s95 offen offset:2048 sc1 lds
    v_add_f32 v37, v37, v219
    v_cvt_pk_bf16_f32 v149, v218, v219
    v_mfma_f32_16x16x32_bf16 a[32:35], v[200:203], v[128:131], 0
    v_exp_f32_e64 v220, v108
    v_mfma_f32_16x16x32_bf16 a[36:39], v[200:203], v[132:135], 0
    ds_read_b128 v[184:187], v232 offset:36864
    v_add_f32_e64 v37, v37, v220
    v_mfma_f32_16x16x32_bf16 a[40:43], v[200:203], v[136:139], 0
    buffer_store_dwordx4 v[24:27], v246, s[52:55], s18 offen sc1
    v_exp_f32_e64 v221, v109
    v_mfma_f32_16x16x32_bf16 a[44:47], v[200:203], v[140:143], 0
    s_waitcnt lgkmcnt(3)
    v_add_f32 v37, v37, v221
    v_cvt_pk_bf16_f32 v150, v220, v221
    v_mfma_f32_16x16x32_bf16 a[60:63], v[204:207], v[140:143], 0
    v_exp_f32_e64 v222, v110
    v_mfma_f32_16x16x32_bf16 a[56:59], v[204:207], v[136:139], 0
    ds_read_b128 v[188:191], v232 offset:37888
    v_add_f32_e64 v37, v37, v222
    v_mfma_f32_16x16x32_bf16 a[52:55], v[204:207], v[132:135], 0
    v_exp_f32_e64 v223, v111
    v_mfma_f32_16x16x32_bf16 a[48:51], v[204:207], v[128:131], 0
    s_waitcnt lgkmcnt(2)
    buffer_load_dwordx4 v2, s[52:55], s95 offen offset:3072 sc1 lds
    v_add_f32 v37, v37, v223
    v_cvt_pk_bf16_f32 v151, v222, v223
    v_mfma_f32_16x16x32_bf16 v[68:71], v[176:179], a[128:131], v[160:163]
    s_add_u32 m0, s81, 49152
    v_exp_f32_e64 v208, v112
    v_mfma_f32_16x16x32_bf16 v[68:71], v[180:183], a[144:147], v[68:71]
    s_xor_b32 s81, s81, 0x10000
    ds_read_b128 v[192:195], v233 offset:6144
    v_add_f32_e64 v38, v34, v208
    v_mfma_f32_16x16x32_bf16 v[76:79], v[180:183], a[148:151], v[164:167]
    s_sub_u32 s90, s90, 1
    v_exp_f32 v209, v113
    v_mfma_f32_16x16x32_bf16 v[76:79], v[176:179], a[132:135], v[76:79]
    s_cmp_eq_u32 s90, 0
    v_add_f32 v38, v38, v209
    v_cvt_pk_bf16_f32 v152, v208, v209
    v_mfma_f32_16x16x32_bf16 v[84:87], v[176:179], a[136:139], v[168:171]
    s_cselect_b32 s94, -1.0, s94
    v_exp_f32 v210, v114
    v_mfma_f32_16x16x32_bf16 v[84:87], v[180:183], a[152:155], v[84:87]
    ds_read_b128 v[196:199], v233 offset:7168
    v_add_f32_e64 v38, v38, v210
    v_mfma_f32_16x16x32_bf16 v[92:95], v[180:183], a[156:159], v[172:175]
    v_exp_f32_e64 v211, v115
    v_mfma_f32_16x16x32_bf16 v[92:95], v[176:179], a[140:143], v[92:95]
    s_waitcnt lgkmcnt(3)
    buffer_load_dwordx4 v2, s[52:55], s93 offen offset:0 sc1 lds
    v_add_f32 v38, v38, v211
    v_cvt_pk_bf16_f32 v153, v210, v211
    v_mfma_f32_16x16x32_bf16 a[64:67], v[184:187], v[128:131], 0
    v_exp_f32_e64 v212, v116
    v_mfma_f32_16x16x32_bf16 a[68:71], v[184:187], v[132:135], 0
    ds_read_b128 v[200:203], v232 offset:38912
    v_add_f32_e64 v38, v38, v212
    v_mfma_f32_16x16x32_bf16 a[72:75], v[184:187], v[136:139], 0
    buffer_store_dwordx4 v[28:31], v245, s[52:55], s19 offen sc1
    v_exp_f32_e64 v213, v117
    v_mfma_f32_16x16x32_bf16 a[76:79], v[184:187], v[140:143], 0
    s_waitcnt lgkmcnt(3)
    v_add_f32 v38, v38, v213
    v_cvt_pk_bf16_f32 v154, v212, v213
    v_mfma_f32_16x16x32_bf16 a[92:95], v[188:191], v[140:143], 0
    v_exp_f32_e64 v214, v118
    v_mfma_f32_16x16x32_bf16 a[88:91], v[188:191], v[136:139], 0
    ds_read_b128 v[204:207], v232 offset:39936
    v_add_f32_e64 v38, v38, v214
    v_mfma_f32_16x16x32_bf16 a[84:87], v[188:191], v[132:135], 0
    v_exp_f32_e64 v215, v119
    v_mfma_f32_16x16x32_bf16 a[80:83], v[188:191], v[128:131], 0
    s_waitcnt lgkmcnt(2)
    buffer_load_dwordx4 v2, s[52:55], s93 offen offset:1024 sc1 lds
    v_add_f32 v38, v38, v215
    v_cvt_pk_bf16_f32 v155, v214, v215
    v_mfma_f32_16x16x32_bf16 v[68:71], v[192:195], a[160:163], v[68:71]
    v_exp_f32_e64 v216, v120
    v_mfma_f32_16x16x32_bf16 v[68:71], v[196:199], a[176:179], v[68:71]
    ds_read_b128 v[176:179], v233 offset:16384
    v_add_f32_e64 v39, v35, v216
    v_mfma_f32_16x16x32_bf16 v[76:79], v[196:199], a[180:183], v[76:79]
    v_exp_f32_e64 v217, v121
    v_max3_f32 v224, v36, v37, v38
    v_mfma_f32_16x16x32_bf16 v[76:79], v[192:195], a[164:167], v[76:79]
    v_add_f32_e64 v39, v39, v217
    v_cvt_pk_bf16_f32 v156, v216, v217
    v_mfma_f32_16x16x32_bf16 v[84:87], v[192:195], a[168:171], v[84:87]
    v_exp_f32_e64 v218, v122
    v_mfma_f32_16x16x32_bf16 v[84:87], v[196:199], a[184:187], v[84:87]
    ds_read_b128 v[180:183], v233 offset:17408
    v_add_f32_e64 v39, v39, v218
    v_mfma_f32_16x16x32_bf16 v[92:95], v[196:199], a[188:191], v[92:95]
    v_exp_f32_e64 v219, v123
    v_mfma_f32_16x16x32_bf16 v[92:95], v[192:195], a[172:175], v[92:95]
    s_waitcnt lgkmcnt(3)
    buffer_load_dwordx4 v2, s[52:55], s93 offen offset:2048 sc1 lds
    v_add_f32 v39, v39, v219
    v_cvt_pk_bf16_f32 v157, v218, v219
    v_mfma_f32_16x16x32_bf16 a[96:99], v[200:203], v[128:131], 0
    v_exp_f32_e64 v220, v124
    v_mfma_f32_16x16x32_bf16 a[100:103], v[200:203], v[132:135], 0
    ds_read_b128 v[184:187], v232 offset:49152
    v_add_f32_e64 v39, v39, v220
    v_mfma_f32_16x16x32_bf16 a[104:107], v[200:203], v[136:139], 0
    buffer_store_dwordx4 v[44:47], v246, s[52:55], s19 offen sc1
    v_exp_f32_e64 v221, v125
    v_mfma_f32_16x16x32_bf16 a[108:111], v[200:203], v[140:143], 0
    s_waitcnt lgkmcnt(3)
    v_add_f32 v39, v39, v221
    v_cvt_pk_bf16_f32 v158, v220, v221
    v_mfma_f32_16x16x32_bf16 a[124:127], v[204:207], v[140:143], 0
    v_exp_f32_e64 v222, v126
    v_mfma_f32_16x16x32_bf16 a[120:123], v[204:207], v[136:139], 0
    ds_read_b128 v[188:191], v232 offset:50176
    v_add_f32_e64 v39, v39, v222
    v_mfma_f32_16x16x32_bf16 a[116:119], v[204:207], v[132:135], 0
    v_exp_f32_e64 v223, v127
    v_xor_b32 v232, 0x10000, v232
    v_xor_b32 v233, 0x10000, v233
    v_mfma_f32_16x16x32_bf16 a[112:115], v[204:207], v[128:131], 0
    s_waitcnt lgkmcnt(2)
    buffer_load_dwordx4 v2, s[52:55], s93 offen offset:3072 sc1 lds
    v_add_f32 v39, v39, v223
    v_cvt_pk_bf16_f32 v159, v222, v223
    v_max_f32 v224, v224, v39
    v_cmp_nge_f32 vcc, s94, v224
    s_cbranch_vccz L_mid0
    s_branch L_chk_mid1
.p2align 6
L_loop:
    v_mfma_f32_16x16x32_bf16 v[64:67], v[176:179], a[128:131], v[160:163]
    s_waitcnt vmcnt(8)
    s_barrier
    v_exp_f32_e64 v208, v96
    v_mfma_f32_16x16x32_bf16 v[64:67], v[180:183], a[144:147], v[64:67]
    s_add_u32 m0, s80, 16384
    ds_read_b128 v[192:195], v233 offset:2048
    v_add_f32_e64 v36, v32, v208
    v_mfma_f32_16x16x32_bf16 v[72:75], v[180:183], a[148:151], v[164:167]
    s_add_u32 s95, s82, 32768
    v_exp_f32_e64 v209, v97
    v_mfma_f32_16x16x32_bf16 v[72:75], v[176:179], a[132:135], v[72:75]
    s_add_u32 s93, s86, 32768
    v_add_f32_e64 v36, v36, v209
    v_cvt_pk_bf16_f32 v144, v208, v209
    v_mfma_f32_16x16x32_bf16 v[80:83], v[176:179], a[136:139], v[168:171]
    s_xor_b32 s80, s80, 0x10000
    v_exp_f32_e64 v210, v98
    v_mfma_f32_16x16x32_bf16 v[80:83], v[180:183], a[152:155], v[80:83]
    s_add_u32 s82, s82, 65536
    ds_read_b128 v[196:199], v233 offset:3072
    v_add_f32_e64 v36, v36, v210
    v_mfma_f32_16x16x32_bf16 v[88:91], v[180:183], a[156:159], v[172:175]
    s_sub_u32 s83, s83, 1
    v_exp_f32 v211, v99
    v_mfma_f32_16x16x32_bf16 v[88:91], v[176:179], a[140:143], v[88:91]
    s_waitcnt lgkmcnt(3)
    buffer_load_dwordx4 v2, s[52:55], s95 offen offset:0 sc1 lds
    v_add_f32 v36, v36, v211
    v_cvt_pk_bf16_f32 v145, v210, v211
    v_mfma_f32_16x16x32_bf16 a[0:3], v[184:187], v[128:131], a[0:3]
    s_cmp_eq_u32 s83, 0
    v_exp_f32 v212, v100
    v_mfma_f32_16x16x32_bf16 a[4:7], v[184:187], v[132:135], a[4:7]
    s_cselect_b32 s82, s84, s82
    ds_read_b128 v[200:203], v232 offset:34816
    v_add_f32 v36, v36, v212
    v_mfma_f32_16x16x32_bf16 a[8:11], v[184:187], v[136:139], a[8:11]
    s_cselect_b32 s83, s85, s83
    v_exp_f32 v213, v101
    v_mfma_f32_16x16x32_bf16 a[12:15], v[184:187], v[140:143], a[12:15]
    s_waitcnt lgkmcnt(3)
    v_add_f32 v36, v36, v213
    v_cvt_pk_bf16_f32 v146, v212, v213
    v_mfma_f32_16x16x32_bf16 a[28:31], v[188:191], v[140:143], a[28:31]
    s_cselect_b32 s84, 1073741824, s84
    v_exp_f32 v214, v102
    v_mfma_f32_16x16x32_bf16 a[24:27], v[188:191], v[136:139], a[24:27]
    s_cselect_b32 s85, -1, s85
    ds_read_b128 v[204:207], v232 offset:35840
    v_add_f32 v36, v36, v214
    v_mfma_f32_16x16x32_bf16 a[20:23], v[188:191], v[132:135], a[20:23]
    s_add_u32 s86, s86, 65536
    v_exp_f32_e64 v215, v103
    v_mfma_f32_16x16x32_bf16 a[16:19], v[188:191], v[128:131], a[16:19]
    s_waitcnt lgkmcnt(2)
    buffer_load_dwordx4 v2, s[52:55], s95 offen offset:1024 sc1 lds
    v_add_f32 v36, v36, v215
    v_cvt_pk_bf16_f32 v147, v214, v215
    v_mfma_f32_16x16x32_bf16 v[64:67], v[192:195], a[160:163], v[64:67]
    s_sub_u32 s87, s87, 1
    v_exp_f32 v216, v104
    v_mfma_f32_16x16x32_bf16 v[64:67], v[196:199], a[176:179], v[64:67]
    s_cmp_eq_u32 s87, 0
    ds_read_b128 v[176:179], v233 offset:4096
    v_add_f32 v37, v33, v216
    v_mfma_f32_16x16x32_bf16 v[72:75], v[196:199], a[180:183], v[72:75]
    s_cselect_b32 s86, s88, s86
    v_exp_f32 v217, v105
    v_mfma_f32_16x16x32_bf16 v[72:75], v[192:195], a[164:167], v[72:75]
    s_cselect_b32 s87, s89, s87
    v_add_f32 v37, v37, v217
    v_cvt_pk_bf16_f32 v148, v216, v217
    v_mfma_f32_16x16x32_bf16 v[80:83], v[192:195], a[168:171], v[80:83]
    s_cselect_b32 s88, 1073741824, s88
    v_exp_f32 v218, v106
    v_mfma_f32_16x16x32_bf16 v[80:83], v[196:199], a[184:187], v[80:83]
    s_cselect_b32 s89, -1, s89
    ds_read_b128 v[180:183], v233 offset:5120
    v_add_f32 v37, v37, v218
    v_mfma_f32_16x16x32_bf16 v[88:91], v[196:199], a[188:191], v[88:91]
    v_exp_f32_e64 v219, v107
    v_mfma_f32_16x16x32_bf16 v[88:91], v[192:195], a[172:175], v[88:91]
    s_waitcnt lgkmcnt(3)
    buffer_load_dwordx4 v2, s[52:55], s95 offen offset:2048 sc1 lds
    v_add_f32 v37, v37, v219
    v_cvt_pk_bf16_f32 v149, v218, v219
    v_mfma_f32_16x16x32_bf16 a[32:35], v[200:203], v[128:131], a[32:35]
    v_exp_f32_e64 v220, v108
    v_mfma_f32_16x16x32_bf16 a[36:39], v[200:203], v[132:135], a[36:39]
    ds_read_b128 v[184:187], v232 offset:36864
    v_add_f32_e64 v37, v37, v220
    v_mfma_f32_16x16x32_bf16 a[40:43], v[200:203], v[136:139], a[40:43]
    v_exp_f32_e64 v221, v109
    v_mfma_f32_16x16x32_bf16 a[44:47], v[200:203], v[140:143], a[44:47]
    s_waitcnt lgkmcnt(3)
    v_add_f32 v37, v37, v221
    v_cvt_pk_bf16_f32 v150, v220, v221
    v_mfma_f32_16x16x32_bf16 a[60:63], v[204:207], v[140:143], a[60:63]
    v_exp_f32_e64 v222, v110
    v_mfma_f32_16x16x32_bf16 a[56:59], v[204:207], v[136:139], a[56:59]
    ds_read_b128 v[188:191], v232 offset:37888
    v_add_f32_e64 v37, v37, v222
    v_mfma_f32_16x16x32_bf16 a[52:55], v[204:207], v[132:135], a[52:55]
    v_exp_f32_e64 v223, v111
    v_mfma_f32_16x16x32_bf16 a[48:51], v[204:207], v[128:131], a[48:51]
    s_waitcnt lgkmcnt(2)
    buffer_load_dwordx4 v2, s[52:55], s95 offen offset:3072 sc1 lds
    v_add_f32 v37, v37, v223
    v_cvt_pk_bf16_f32 v151, v222, v223
    v_mfma_f32_16x16x32_bf16 v[68:71], v[176:179], a[128:131], v[160:163]
    s_add_u32 m0, s81, 49152
    v_exp_f32_e64 v208, v112
    v_mfma_f32_16x16x32_bf16 v[68:71], v[180:183], a[144:147], v[68:71]
    s_xor_b32 s81, s81, 0x10000
    ds_read_b128 v[192:195], v233 offset:6144
    v_add_f32_e64 v38, v34, v208
    v_mfma_f32_16x16x32_bf16 v[76:79], v[180:183], a[148:151], v[164:167]
    s_sub_u32 s90, s90, 1
    v_exp_f32 v209, v113
    v_mfma_f32_16x16x32_bf16 v[76:79], v[176:179], a[132:135], v[76:79]
    s_cmp_eq_u32 s90, 0
    v_add_f32 v38, v38, v209
    v_cvt_pk_bf16_f32 v152, v208, v209
    v_mfma_f32_16x16x32_bf16 v[84:87], v[176:179], a[136:139], v[168:171]
    s_cselect_b32 s94, -1.0, s94
    v_exp_f32 v210, v114
    v_mfma_f32_16x16x32_bf16 v[84:87], v[180:183], a[152:155], v[84:87]
    ds_read_b128 v[196:199], v233 offset:7168
    v_add_f32_e64 v38, v38, v210
    v_mfma_f32_16x16x32_bf16 v[92:95], v[180:183], a[156:159], v[172:175]
    v_exp_f32_e64 v211, v115
    v_mfma_f32_16x16x32_bf16 v[92:95], v[176:179], a[140:143], v[92:95]
    s_waitcnt lgkmcnt(3)
    buffer_load_dwordx4 v2, s[52:55], s93 offen offset:0 sc1 lds
    v_add_f32 v38, v38, v211
    v_cvt_pk_bf16_f32 v153, v210, v211
    v_mfma_f32_16x16x32_bf16 a[64:67], v[184:187], v[128:131], a[64:67]
    v_exp_f32_e64 v212, v116
    v_mfma_f32_16x16x32_bf16 a[68:71], v[184:187], v[132:135], a[68:71]
    ds_read_b128 v[200:203], v232 offset:38912
    v_add_f32_e64 v38, v38, v212
    v_mfma_f32_16x16x32_bf16 a[72:75], v[184:187], v[136:139], a[72:75]
    v_exp_f32_e64 v213, v117
    v_mfma_f32_16x16x32_bf16 a[76:79], v[184:187], v[140:143], a[76:79]
    s_waitcnt lgkmcnt(3)
    v_add_f32 v38, v38, v213
    v_cvt_pk_bf16_f32 v154, v212, v213
    v_mfma_f32_16x16x32_bf16 a[92:95], v[188:191], v[140:143], a[92:95]
    v_exp_f32_e64 v214, v118
    v_mfma_f32_16x16x32_bf16 a[88:91], v[188:191], v[136:139], a[88:91]
    ds_read_b128 v[204:207], v232 offset:39936
    v_add_f32_e64 v38, v38, v214
    v_mfma_f32_16x16x32_bf16 a[84:87], v[188:191], v[132:135], a[84:87]
    v_exp_f32_e64 v215, v119
    v_mfma_f32_16x16x32_bf16 a[80:83], v[188:191], v[128:131], a[80:83]
    s_waitcnt lgkmcnt(2)
    buffer_load_dwordx4 v2, s[52:55], s93 offen offset:1024 sc1 lds
    v_add_f32 v38, v38, v215
    v_cvt_pk_bf16_f32 v155, v214, v215
    v_mfma_f32_16x16x32_bf16 v[68:71], v[192:195], a[160:163], v[68:71]
    v_exp_f32_e64 v216, v120
    v_mfma_f32_16x16x32_bf16 v[68:71], v[196:199], a[176:179], v[68:71]
    ds_read_b128 v[176:179], v233 offset:16384
    v_add_f32_e64 v39, v35, v216
    v_mfma_f32_16x16x32_bf16 v[76:79], v[196:199], a[180:183], v[76:79]
    v_exp_f32_e64 v217, v121
    v_max3_f32 v224, v36, v37, v38
    v_mfma_f32_16x16x32_bf16 v[76:79], v[192:195], a[164:167], v[76:79]
    v_add_f32_e64 v39, v39, v217
    v_cvt_pk_bf16_f32 v156, v216, v217
    v_mfma_f32_16x16x32_bf16 v[84:87], v[192:195], a[168:171], v[84:87]
    v_exp_f32_e64 v218, v122
    v_mfma_f32_16x16x32_bf16 v[84:87], v[196:199], a[184:187], v[84:87]
    ds_read_b128 v[180:183], v233 offset:17408
    v_add_f32_e64 v39, v39, v218
    v_mfma_f32_16x16x32_bf16 v[92:95], v[196:199], a[188:191], v[92:95]
    v_exp_f32_e64 v219, v123
    v_mfma_f32_16x16x32_bf16 v[92:95], v[192:195], a[172:175], v[92:95]
    s_waitcnt lgkmcnt(3)
    buffer_load_dwordx4 v2, s[52:55], s93 offen offset:2048 sc1 lds
    v_add_f32 v39, v39, v219
    v_cvt_pk_bf16_f32 v157, v218, v219
    v_mfma_f32_16x16x32_bf16 a[96:99], v[200:203], v[128:131], a[96:99]
    v_exp_f32_e64 v220, v124
    v_mfma_f32_16x16x32_bf16 a[100:103], v[200:203], v[132:135], a[100:103]
    ds_read_b128 v[184:187], v232 offset:49152
    v_add_f32_e64 v39, v39, v220
    v_mfma_f32_16x16x32_bf16 a[104:107], v[200:203], v[136:139], a[104:107]
    v_exp_f32_e64 v221, v125
    v_mfma_f32_16x16x32_bf16 a[108:111], v[200:203], v[140:143], a[108:111]
    s_waitcnt lgkmcnt(3)
    v_add_f32 v39, v39, v221
    v_cvt_pk_bf16_f32 v158, v220, v221
    v_mfma_f32_16x16x32_bf16 a[124:127], v[204:207], v[140:143], a[124:127]
    v_exp_f32_e64 v222, v126
    v_mfma_f32_16x16x32_bf16 a[120:123], v[204:207], v[136:139], a[120:123]
    ds_read_b128 v[188:191], v232 offset:50176
    v_add_f32_e64 v39, v39, v222
    v_mfma_f32_16x16x32_bf16 a[116:119], v[204:207], v[132:135], a[116:119]
    v_exp_f32_e64 v223, v127
    v_xor_b32 v232, 0x10000, v232
    v_xor_b32 v233, 0x10000, v233
    v_mfma_f32_16x16x32_bf16 a[112:115], v[204:207], v[128:131], a[112:115]
    s_waitcnt lgkmcnt(2)
    buffer_load_dwordx4 v2, s[52:55], s93 offen offset:3072 sc1 lds
    v_add_f32 v39, v39, v223
    v_cvt_pk_bf16_f32 v159, v222, v223
    v_max_f32_e64 v224, v224, v39
    v_cmp_nge_f32 vcc, s94, v224
    s_cbranch_vccnz L_chk_mid1
L_mid0:
    v_mfma_f32_16x16x32_bf16 v[96:99], v[176:179], a[128:131], v[160:163]
    s_waitcnt vmcnt(8)
    s_barrier
    v_exp_f32_e64 v208, v64
    v_mfma_f32_16x16x32_bf16 v[96:99], v[180:183], a[144:147], v[96:99]
    s_add_u32 m0, s80, 0
    ds_read_b128 v[192:195], v232 offset:18432
    v_add_f32 v32, v36, v208
    v_mfma_f32_16x16x32_bf16 v[104:107], v[180:183], a[148:151], v[164:167]
    s_add_u32 s95, s82, 0
    v_exp_f32 v209, v65
    v_mfma_f32_16x16x32_bf16 v[104:107], v[176:179], a[132:135], v[104:107]
    s_add_u32 s93, s86, 0
    v_add_f32 v32, v32, v209
    v_cvt_pk_bf16_f32 v128, v208, v209
    v_mfma_f32_16x16x32_bf16 v[112:115], v[176:179], a[136:139], v[168:171]
    v_exp_f32_e64 v210, v66
    v_mfma_f32_16x16x32_bf16 v[112:115], v[180:183], a[152:155], v[112:115]
    ds_read_b128 v[196:199], v232 offset:19456
    v_add_f32_e64 v32, v32, v210
    v_mfma_f32_16x16x32_bf16 v[120:123], v[180:183], a[156:159], v[172:175]
    v_exp_f32_e64 v211, v67
    v_mfma_f32_16x16x32_bf16 v[120:123], v[176:179], a[140:143], v[120:123]
    s_waitcnt lgkmcnt(3)
    buffer_load_dwordx4 v2, s[52:55], s95 offen offset:0 sc1 lds
    v_add_f32 v32, v32, v211
    v_cvt_pk_bf16_f32 v129, v210, v211
    v_mfma_f32_16x16x32_bf16 a[0:3], v[184:187], v[144:147], a[0:3]
    v_exp_f32_e64 v212, v68
    v_mfma_f32_16x16x32_bf16 a[4:7], v[184:187], v[148:151], a[4:7]
    ds_read_b128 v[200:203], v233 offset:51200
    v_add_f32_e64 v32, v32, v212
    v_mfma_f32_16x16x32_bf16 a[8:11], v[184:187], v[152:155], a[8:11]
    v_exp_f32_e64 v213, v69
    v_mfma_f32_16x16x32_bf16 a[12:15], v[184:187], v[156:159], a[12:15]
    s_waitcnt lgkmcnt(3)
    v_add_f32 v32, v32, v213
    v_cvt_pk_bf16_f32 v130, v212, v213
    v_mfma_f32_16x16x32_bf16 a[28:31], v[188:191], v[156:159], a[28:31]
    v_exp_f32_e64 v214, v70
    v_mfma_f32_16x16x32_bf16 a[24:27], v[188:191], v[152:155], a[24:27]
    ds_read_b128 v[204:207], v233 offset:52224
    v_add_f32_e64 v32, v32, v214
    v_mfma_f32_16x16x32_bf16 a[20:23], v[188:191], v[148:151], a[20:23]
    v_exp_f32_e64 v215, v71
    v_mfma_f32_16x16x32_bf16 a[16:19], v[188:191], v[144:147], a[16:19]
    s_waitcnt lgkmcnt(2)
    buffer_load_dwordx4 v2, s[52:55], s95 offen offset:1024 sc1 lds
    v_add_f32 v32, v32, v215
    v_cvt_pk_bf16_f32 v131, v214, v215
    v_mfma_f32_16x16x32_bf16 v[96:99], v[192:195], a[160:163], v[96:99]
    v_exp_f32_e64 v216, v72
    v_mfma_f32_16x16x32_bf16 v[96:99], v[196:199], a[176:179], v[96:99]
    ds_read_b128 v[176:179], v232 offset:20480
    v_add_f32_e64 v33, v37, v216
    v_mfma_f32_16x16x32_bf16 v[104:107], v[196:199], a[180:183], v[104:107]
    v_exp_f32_e64 v217, v73
    v_mfma_f32_16x16x32_bf16 v[104:107], v[192:195], a[164:167], v[104:107]
    v_add_f32_e64 v33, v33, v217
    v_cvt_pk_bf16_f32 v132, v216, v217
    v_mfma_f32_16x16x32_bf16 v[112:115], v[192:195], a[168:171], v[112:115]
    v_exp_f32_e64 v218, v74
    v_mfma_f32_16x16x32_bf16 v[112:115], v[196:199], a[184:187], v[112:115]
    ds_read_b128 v[180:183], v232 offset:21504
    v_add_f32_e64 v33, v33, v218
    v_mfma_f32_16x16x32_bf16 v[120:123], v[196:199], a[188:191], v[120:123]
    v_exp_f32_e64 v219, v75
    v_mfma_f32_16x16x32_bf16 v[120:123], v[192:195], a[172:175], v[120:123]
    s_waitcnt lgkmcnt(3)
    buffer_load_dwordx4 v2, s[52:55], s95 offen offset:2048 sc1 lds
    v_add_f32 v33, v33, v219
    v_cvt_pk_bf16_f32 v133, v218, v219
    v_mfma_f32_16x16x32_bf16 a[32:35], v[200:203], v[144:147], a[32:35]
    v_exp_f32_e64 v220, v76
    v_mfma_f32_16x16x32_bf16 a[36:39], v[200:203], v[148:151], a[36:39]
    ds_read_b128 v[184:187], v233 offset:53248
    v_add_f32_e64 v33, v33, v220
    v_mfma_f32_16x16x32_bf16 a[40:43], v[200:203], v[152:155], a[40:43]
    v_exp_f32_e64 v221, v77
    v_mfma_f32_16x16x32_bf16 a[44:47], v[200:203], v[156:159], a[44:47]
    s_waitcnt lgkmcnt(3)
    v_add_f32 v33, v33, v221
    v_cvt_pk_bf16_f32 v134, v220, v221
    v_mfma_f32_16x16x32_bf16 a[60:63], v[204:207], v[156:159], a[60:63]
    v_exp_f32_e64 v222, v78
    v_mfma_f32_16x16x32_bf16 a[56:59], v[204:207], v[152:155], a[56:59]
    ds_read_b128 v[188:191], v233 offset:54272
    v_add_f32_e64 v33, v33, v222
    v_mfma_f32_16x16x32_bf16 a[52:55], v[204:207], v[148:151], a[52:55]
    v_exp_f32_e64 v223, v79
    v_mfma_f32_16x16x32_bf16 a[48:51], v[204:207], v[144:147], a[48:51]
    s_waitcnt lgkmcnt(2)
    buffer_load_dwordx4 v2, s[52:55], s95 offen offset:3072 sc1 lds
    v_add_f32 v33, v33, v223
    v_cvt_pk_bf16_f32 v135, v222, v223
    v_mfma_f32_16x16x32_bf16 v[100:103], v[176:179], a[128:131], v[160:163]
    s_add_u32 m0, s81, 32768
    v_exp_f32_e64 v208, v80
    v_mfma_f32_16x16x32_bf16 v[100:103], v[180:183], a[144:147], v[100:103]
    ds_read_b128 v[192:195], v232 offset:22528
    v_add_f32_e64 v34, v38, v208
    v_mfma_f32_16x16x32_bf16 v[108:111], v[180:183], a[148:151], v[164:167]
    v_exp_f32_e64 v209, v81
    v_mfma_f32_16x16x32_bf16 v[108:111], v[176:179], a[132:135], v[108:111]
    v_add_f32_e64 v34, v34, v209
    v_cvt_pk_bf16_f32 v136, v208, v209
    v_mfma_f32_16x16x32_bf16 v[116:119], v[176:179], a[136:139], v[168:171]
    v_exp_f32_e64 v210, v82
    v_mfma_f32_16x16x32_bf16 v[116:119], v[180:183], a[152:155], v[116:119]
    ds_read_b128 v[196:199], v232 offset:23552
    v_add_f32_e64 v34, v34, v210
    v_mfma_f32_16x16x32_bf16 v[124:127], v[180:183], a[156:159], v[172:175]
    v_exp_f32_e64 v211, v83
    v_mfma_f32_16x16x32_bf16 v[124:127], v[176:179], a[140:143], v[124:127]
    s_waitcnt lgkmcnt(3)
    buffer_load_dwordx4 v2, s[52:55], s93 offen offset:0 sc1 lds
    v_add_f32 v34, v34, v211
    v_cvt_pk_bf16_f32 v137, v210, v211
    v_mfma_f32_16x16x32_bf16 a[64:67], v[184:187], v[144:147], a[64:67]
    v_exp_f32_e64 v212, v84
    v_mfma_f32_16x16x32_bf16 a[68:71], v[184:187], v[148:151], a[68:71]
    ds_read_b128 v[200:203], v233 offset:55296
    v_add_f32_e64 v34, v34, v212
    v_mfma_f32_16x16x32_bf16 a[72:75], v[184:187], v[152:155], a[72:75]
    v_exp_f32_e64 v213, v85
    v_mfma_f32_16x16x32_bf16 a[76:79], v[184:187], v[156:159], a[76:79]
    s_waitcnt lgkmcnt(3)
    v_add_f32 v34, v34, v213
    v_cvt_pk_bf16_f32 v138, v212, v213
    v_mfma_f32_16x16x32_bf16 a[92:95], v[188:191], v[156:159], a[92:95]
    v_exp_f32_e64 v214, v86
    v_mfma_f32_16x16x32_bf16 a[88:91], v[188:191], v[152:155], a[88:91]
    ds_read_b128 v[204:207], v233 offset:56320
    v_add_f32_e64 v34, v34, v214
    v_mfma_f32_16x16x32_bf16 a[84:87], v[188:191], v[148:151], a[84:87]
    v_exp_f32_e64 v215, v87
    v_mfma_f32_16x16x32_bf16 a[80:83], v[188:191], v[144:147], a[80:83]
    s_waitcnt lgkmcnt(2)
    buffer_load_dwordx4 v2, s[52:55], s93 offen offset:1024 sc1 lds
    v_add_f32 v34, v34, v215
    v_cvt_pk_bf16_f32 v139, v214, v215
    v_mfma_f32_16x16x32_bf16 v[100:103], v[192:195], a[160:163], v[100:103]
    v_exp_f32_e64 v216, v88
    v_mfma_f32_16x16x32_bf16 v[100:103], v[196:199], a[176:179], v[100:103]
    ds_read_b128 v[176:179], v233 offset:0
    v_add_f32_e64 v35, v39, v216
    v_mfma_f32_16x16x32_bf16 v[108:111], v[196:199], a[180:183], v[108:111]
    v_exp_f32_e64 v217, v89
    v_max3_f32 v224, v32, v33, v34
    v_mfma_f32_16x16x32_bf16 v[108:111], v[192:195], a[164:167], v[108:111]
    v_add_f32_e64 v35, v35, v217
    v_cvt_pk_bf16_f32 v140, v216, v217
    v_mfma_f32_16x16x32_bf16 v[116:119], v[192:195], a[168:171], v[116:119]
    v_exp_f32_e64 v218, v90
    v_mfma_f32_16x16x32_bf16 v[116:119], v[196:199], a[184:187], v[116:119]
    ds_read_b128 v[180:183], v233 offset:1024
    v_add_f32_e64 v35, v35, v218
    v_mfma_f32_16x16x32_bf16 v[124:127], v[196:199], a[188:191], v[124:127]
    v_exp_f32_e64 v219, v91
    v_mfma_f32_16x16x32_bf16 v[124:127], v[192:195], a[172:175], v[124:127]
    s_waitcnt lgkmcnt(3)
    buffer_load_dwordx4 v2, s[52:55], s93 offen offset:2048 sc1 lds
    v_add_f32 v35, v35, v219
    v_cvt_pk_bf16_f32 v141, v218, v219
    v_mfma_f32_16x16x32_bf16 a[96:99], v[200:203], v[144:147], a[96:99]
    v_exp_f32_e64 v220, v92
    v_mfma_f32_16x16x32_bf16 a[100:103], v[200:203], v[148:151], a[100:103]
    ds_read_b128 v[184:187], v232 offset:32768
    v_add_f32_e64 v35, v35, v220
    v_mfma_f32_16x16x32_bf16 a[104:107], v[200:203], v[152:155], a[104:107]
    v_exp_f32_e64 v221, v93
    v_mfma_f32_16x16x32_bf16 a[108:111], v[200:203], v[156:159], a[108:111]
    s_waitcnt lgkmcnt(3)
    v_add_f32 v35, v35, v221
    v_cvt_pk_bf16_f32 v142, v220, v221
    v_mfma_f32_16x16x32_bf16 a[124:127], v[204:207], v[156:159], a[124:127]
    v_exp_f32_e64 v222, v94
    v_mfma_f32_16x16x32_bf16 a[120:123], v[204:207], v[152:155], a[120:123]
    ds_read_b128 v[188:191], v232 offset:33792
    v_add_f32_e64 v35, v35, v222
    v_mfma_f32_16x16x32_bf16 a[116:119], v[204:207], v[148:151], a[116:119]
    v_exp_f32_e64 v223, v95
    v_mfma_f32_16x16x32_bf16 a[112:115], v[204:207], v[144:147], a[112:115]
    s_waitcnt lgkmcnt(2)
    buffer_load_dwordx4 v2, s[52:55], s93 offen offset:3072 sc1 lds
    v_add_f32 v35, v35, v223
    v_cvt_pk_bf16_f32 v143, v222, v223
    v_max_f32 v224, v224, v35
    v_cmp_nge_f32 vcc, s94, v224
    s_cbranch_vccz L_loop
    s_mov_b32 s25, 1
    s_branch L_rare0
L_chk_mid1:
    v_cmp_nge_f32 vcc, 0x4e800000, v224
    s_mov_b32 s25, 0
    s_cbranch_vccz L_ctl_mid1
    s_branch L_rare1
L_ctl_mid1:
    s_cmp_lg_u32 s90, 0
    s_cbranch_scc1 L_mid0
    s_mov_b32 s94, 0x4e800000
    v_cmp_lt_i32 s[8:9], 0, v234
    v_cmp_lt_i32 s[10:11], -1, v234
    v_cmp_lt_i32 s[12:13], -2, v234
    v_cmp_lt_i32 s[14:15], -3, v234
    s_cmp_eq_u32 s4, 1
    s_cbranch_scc1 L_mkm_1
    s_cmp_eq_u32 s4, 2
    s_cbranch_scc1 L_mkm_2
    s_cmp_eq_u32 s4, 3
    s_cbranch_scc1 L_mkm_3
    v_mov_b32 v68, v235
    v_mov_b32 v69, v235
    v_mov_b32 v70, v235
    v_mov_b32 v71, v235
    v_cndmask_b32 v64, v64, v235, s[8:9]
    v_cndmask_b32 v65, v65, v235, s[10:11]
    v_cndmask_b32 v66, v66, v235, s[12:13]
    v_cndmask_b32 v67, v67, v235, s[14:15]
    s_branch L_mkm_done
L_mkm_1:
    v_mov_b32 v64, v235
    v_mov_b32 v65, v235
    v_mov_b32 v66, v235
    v_mov_b32 v67, v235
    v_mov_b32 v68, v235
    v_mov_b32 v69, v235
    v_mov_b32 v70, v235
    v_mov_b32 v71, v235
    v_cndmask_b32 v76, v76, v235, s[8:9]
    v_cndmask_b32 v77, v77, v235, s[10:11]
    v_cndmask_b32 v78, v78, v235, s[12:13]
    v_cndmask_b32 v79, v79, v235, s[14:15]
    s_branch L_mkm_done
L_mkm_2:
    v_cndmask_b32 v68, v68, v235, s[8:9]
    v_cndmask_b32 v69, v69, v235, s[10:11]
    v_cndmask_b32 v70, v70, v235, s[12:13]
    v_cndmask_b32 v71, v71, v235, s[14:15]
    s_branch L_mkm_done
L_mkm_3:
    v_mov_b32 v64, v235
    v_mov_b32 v65, v235
    v_mov_b32 v66, v235
    v_mov_b32 v67, v235
    v_mov_b32 v68, v235
    v_mov_b32 v69, v235
    v_mov_b32 v70, v235
    v_mov_b32 v71, v235
    v_mov_b32 v76, v235
    v_mov_b32 v77, v235
    v_mov_b32 v78, v235
    v_mov_b32_e64 v79, v235
    v_cndmask_b32 v72, v72, v235, s[8:9]
    v_cndmask_b32 v73, v73, v235, s[10:11]
    v_cndmask_b32 v74, v74, v235, s[12:13]
    v_cndmask_b32 v75, v75, v235, s[14:15]
L_mkm_done:
L_mid0h:
    v_mfma_f32_16x16x32_bf16 v[112:115], v[176:179], a[136:139], v[168:171]
    s_waitcnt vmcnt(8)
    s_barrier
    v_exp_f32 v208, v64
    v_exp_f32 v209, v65
    v_mfma_f32_16x16x32_bf16 v[112:115], v[180:183], a[152:155], v[112:115]
    s_add_u32 m0, s80, 0
    s_add_u32 s95, s82, 0
    s_add_u32 s93, s86, 0
    v_add_f32 v32, v36, v208
    v_mfma_f32_16x16x32_bf16 v[120:123], v[180:183], a[156:159], v[172:175]
    ds_read_b128 v[192:195], v232 offset:18432
    v_exp_f32 v210, v66
    v_add_f32 v32, v32, v209
    v_cvt_pk_bf16_f32 v128, v208, v209
    v_mfma_f32_16x16x32_bf16 v[120:123], v[176:179], a[140:143], v[120:123]
    s_waitcnt lgkmcnt(2)
    ds_read_b128 v[196:199], v232 offset:19456
    v_exp_f32 v211, v67
    v_mfma_f32_16x16x32_bf16 a[0:3], v[184:187], v[144:147], a[0:3]
    buffer_load_dwordx4 v2, s[52:55], s95 offen offset:0 sc1 lds
    v_add_f32_e64 v32, v32, v210
    v_mfma_f32_16x16x32_bf16 a[4:7], v[184:187], v[148:151], a[4:7]
    v_exp_f32_e64 v212, v68
    v_mfma_f32_16x16x32_bf16 a[8:11], v[184:187], v[152:155], a[8:11]
    ds_read_b128 v[200:203], v233 offset:51200
    v_add_f32 v32, v32, v211
    v_cvt_pk_bf16_f32 v129, v210, v211
    v_exp_f32 v213, v69
    v_mfma_f32_16x16x32_bf16 a[12:15], v[184:187], v[156:159], a[12:15]
    s_waitcnt lgkmcnt(3)
    v_add_f32 v32, v32, v212
    v_mfma_f32_16x16x32_bf16 a[28:31], v[188:191], v[156:159], a[28:31]
    v_exp_f32 v214, v70
    v_add_f32 v32, v32, v213
    v_cvt_pk_bf16_f32 v130, v212, v213
    v_mfma_f32_16x16x32_bf16 a[24:27], v[188:191], v[152:155], a[24:27]
    v_exp_f32_e64 v215, v71
    v_mfma_f32_16x16x32_bf16 a[20:23], v[188:191], v[148:151], a[20:23]
    ds_read_b128 v[204:207], v233 offset:52224
    buffer_load_dwordx4 v2, s[52:55], s95 offen offset:1024 sc1 lds
    v_add_f32_e64 v32, v32, v214
    v_mfma_f32_16x16x32_bf16 a[16:19], v[188:191], v[144:147], a[16:19]
    s_waitcnt lgkmcnt(2)
    v_exp_f32 v216, v72
    v_mfma_f32_16x16x32_bf16 v[112:115], v[192:195], a[168:171], v[112:115]
    v_add_f32 v32, v32, v215
    v_cvt_pk_bf16_f32 v131, v214, v215
    v_exp_f32 v217, v73
    v_mfma_f32_16x16x32_bf16 v[112:115], v[196:199], a[184:187], v[112:115]
    v_add_f32_e64 v33, v37, v216
    v_mfma_f32_16x16x32_bf16 v[120:123], v[196:199], a[188:191], v[120:123]
    ds_read_b128 v[176:179], v232 offset:20480
    v_exp_f32 v218, v74
    v_add_f32 v33, v33, v217
    v_cvt_pk_bf16_f32 v132, v216, v217
    v_mfma_f32_16x16x32_bf16 v[120:123], v[192:195], a[172:175], v[120:123]
    s_waitcnt lgkmcnt(2)
    ds_read_b128 v[180:183], v232 offset:21504
    v_exp_f32 v219, v75
    v_mfma_f32_16x16x32_bf16 a[32:35], v[200:203], v[144:147], a[32:35]
    buffer_load_dwordx4 v2, s[52:55], s95 offen offset:2048 sc1 lds
    v_add_f32_e64 v33, v33, v218
    v_mfma_f32_16x16x32_bf16 a[36:39], v[200:203], v[148:151], a[36:39]
    v_exp_f32_e64 v220, v76
    v_mfma_f32_16x16x32_bf16 a[40:43], v[200:203], v[152:155], a[40:43]
    ds_read_b128 v[184:187], v233 offset:53248
    v_add_f32 v33, v33, v219
    v_cvt_pk_bf16_f32 v133, v218, v219
    v_exp_f32 v221, v77
    v_mfma_f32_16x16x32_bf16 a[44:47], v[200:203], v[156:159], a[44:47]
    s_waitcnt lgkmcnt(3)
    v_add_f32 v33, v33, v220
    v_mfma_f32_16x16x32_bf16 a[60:63], v[204:207], v[156:159], a[60:63]
    v_exp_f32 v222, v78
    v_add_f32 v33, v33, v221
    v_cvt_pk_bf16_f32 v134, v220, v221
    v_mfma_f32_16x16x32_bf16 a[56:59], v[204:207], v[152:155], a[56:59]
    v_exp_f32_e64 v223, v79
    v_mfma_f32_16x16x32_bf16 a[52:55], v[204:207], v[148:151], a[52:55]
    ds_read_b128 v[188:191], v233 offset:54272
    buffer_load_dwordx4 v2, s[52:55], s95 offen offset:3072 sc1 lds
    v_add_f32_e64 v33, v33, v222
    v_mfma_f32_16x16x32_bf16 a[48:51], v[204:207], v[144:147], a[48:51]
    s_waitcnt lgkmcnt(2)
    s_add_u32 m0, s81, 32768
    v_exp_f32 v208, v80
    v_mfma_f32_16x16x32_bf16 v[116:119], v[176:179], a[136:139], v[168:171]
    v_add_f32 v33, v33, v223
    v_cvt_pk_bf16_f32 v135, v222, v223
    v_exp_f32 v209, v81
    v_mfma_f32_16x16x32_bf16 v[116:119], v[180:183], a[152:155], v[116:119]
    v_add_f32_e64 v34, v38, v208
    v_mfma_f32_16x16x32_bf16 v[124:127], v[180:183], a[156:159], v[172:175]
    ds_read_b128 v[192:195], v232 offset:22528
    v_exp_f32 v210, v82
    v_add_f32 v34, v34, v209
    v_cvt_pk_bf16_f32 v136, v208, v209
    v_mfma_f32_16x16x32_bf16 v[124:127], v[176:179], a[140:143], v[124:127]
    s_waitcnt lgkmcnt(2)
    ds_read_b128 v[196:199], v232 offset:23552
    v_exp_f32 v211, v83
    v_mfma_f32_16x16x32_bf16 a[64:67], v[184:187], v[144:147], a[64:67]
    buffer_load_dwordx4 v2, s[52:55], s93 offen offset:0 sc1 lds
    v_add_f32_e64 v34, v34, v210
    v_mfma_f32_16x16x32_bf16 a[68:71], v[184:187], v[148:151], a[68:71]
    v_exp_f32_e64 v212, v84
    v_mfma_f32_16x16x32_bf16 a[72:75], v[184:187], v[152:155], a[72:75]
    ds_read_b128 v[200:203], v233 offset:55296
    v_add_f32 v34, v34, v211
    v_cvt_pk_bf16_f32 v137, v210, v211
    v_exp_f32 v213, v85
    v_mfma_f32_16x16x32_bf16 a[76:79], v[184:187], v[156:159], a[76:79]
    s_waitcnt lgkmcnt(3)
    v_add_f32 v34, v34, v212
    v_mfma_f32_16x16x32_bf16 a[92:95], v[188:191], v[156:159], a[92:95]
    v_exp_f32 v214, v86
    v_add_f32 v34, v34, v213
    v_cvt_pk_bf16_f32 v138, v212, v213
    v_mfma_f32_16x16x32_bf16 a[88:91], v[188:191], v[152:155], a[88:91]
    v_exp_f32_e64 v215, v87
    v_mfma_f32_16x16x32_bf16 a[84:87], v[188:191], v[148:151], a[84:87]
    ds_read_b128 v[204:207], v233 offset:56320
    buffer_load_dwordx4 v2, s[52:55], s93 offen offset:1024 sc1 lds
    v_add_f32_e64 v34, v34, v214
    v_mfma_f32_16x16x32_bf16 a[80:83], v[188:191], v[144:147], a[80:83]
    s_waitcnt lgkmcnt(2)
    v_exp_f32 v216, v88
    v_mfma_f32_16x16x32_bf16 v[116:119], v[192:195], a[168:171], v[116:119]
    v_add_f32 v34, v34, v215
    v_cvt_pk_bf16_f32 v139, v214, v215
    v_exp_f32 v217, v89
    v_mfma_f32_16x16x32_bf16 v[116:119], v[196:199], a[184:187], v[116:119]
    v_add_f32_e64 v35, v39, v216
    v_mfma_f32_16x16x32_bf16 v[124:127], v[196:199], a[188:191], v[124:127]
    ds_read_b128 v[184:187], v232 offset:32768
    v_exp_f32 v218, v90
    v_add_f32 v35, v35, v217
    v_cvt_pk_bf16_f32 v140, v216, v217
    v_mfma_f32_16x16x32_bf16 v[124:127], v[192:195], a[172:175], v[124:127]
    s_waitcnt lgkmcnt(2)
    v_exp_f32 v219, v91
    v_mfma_f32_16x16x32_bf16 a[96:99], v[200:203], v[144:147], a[96:99]
    ds_read_b128 v[188:191], v232 offset:33792
    buffer_load_dwordx4 v2, s[52:55], s93 offen offset:2048 sc1 lds
    v_add_f32_e64 v35, v35, v218
    v_mfma_f32_16x16x32_bf16 a[100:103], v[200:203], v[148:151], a[100:103]
    v_exp_f32_e64 v220, v92
    v_mfma_f32_16x16x32_bf16 a[104:107], v[200:203], v[152:155], a[104:107]
    v_add_f32 v35, v35, v219
    v_cvt_pk_bf16_f32 v141, v218, v219
    v_exp_f32 v221, v93
    v_mfma_f32_16x16x32_bf16 a[108:111], v[200:203], v[156:159], a[108:111]
    s_waitcnt lgkmcnt(2)
    v_add_f32 v35, v35, v220
    v_mfma_f32_16x16x32_bf16 a[124:127], v[204:207], v[156:159], a[124:127]
    v_exp_f32 v222, v94
    v_add_f32 v35, v35, v221
    v_cvt_pk_bf16_f32 v142, v220, v221
    v_mfma_f32_16x16x32_bf16 a[120:123], v[204:207], v[152:155], a[120:123]
    v_exp_f32_e64 v223, v95
    v_mfma_f32_16x16x32_bf16 a[116:119], v[204:207], v[148:151], a[116:119]
    buffer_load_dwordx4 v2, s[52:55], s93 offen offset:3072 sc1 lds
    v_add_f32_e64 v35, v35, v222
    v_mfma_f32_16x16x32_bf16 a[112:115], v[204:207], v[144:147], a[112:115]
    s_waitcnt lgkmcnt(1)
    v_add_f32 v35, v35, v223
    v_cvt_pk_bf16_f32 v143, v222, v223
    v_max3_f32 v224, v32, v33, v34
    v_max_f32 v224, v224, v35
    v_cmp_nge_f32 vcc, s94, v224
    s_cbranch_vccnz L_chk_mid0h
L_last:
    s_mov_b32 s94, 0x4e800000
    s_mov_b32 s12, s34
    s_mov_b32 s13, s35
    s_mov_b32 s14, 1409024
    s_mov_b32 s15, 0x00020000
    buffer_load_dword v236, v239, s[60:63], s97 offen
    buffer_load_dword v236, v247, s[12:15], s79 offen
    buffer_load_dword v236, v247, s[48:51], s72 offen
    s_mov_b32 s97, 1073741824
    s_mov_b32 s79, 1073741824
    s_mov_b32 s72, 1073741824
    v_cmp_lt_i32 s[8:9], 0, v234
    v_cmp_lt_i32 s[10:11], -1, v234
    v_cmp_lt_i32 s[12:13], -2, v234
    v_cmp_lt_i32 s[14:15], -3, v234
    s_cmp_eq_u32 s4, 1
    s_cbranch_scc1 L_mkl_1
    s_cmp_eq_u32 s4, 2
    s_cbranch_scc1 L_mkl_2
    s_cmp_eq_u32 s4, 3
    s_cbranch_scc1 L_mkl_3
    v_mov_b32 v116, v235
    v_mov_b32 v117, v235
    v_mov_b32 v118, v235
    v_mov_b32 v119, v235
    v_cndmask_b32 v112, v112, v235, s[8:9]
    v_cndmask_b32 v113, v113, v235, s[10:11]
    v_cndmask_b32 v114, v114, v235, s[12:13]
    v_cndmask_b32 v115, v115, v235, s[14:15]
    s_branch L_mkl_done
L_mkl_1:
    v_mov_b32 v112, v235
    v_mov_b32 v113, v235
    v_mov_b32 v114, v235
    v_mov_b32 v115, v235
    v_mov_b32 v116, v235
    v_mov_b32 v117, v235
    v_mov_b32 v118, v235
    v_mov_b32 v119, v235
    v_cndmask_b32 v124, v124, v235, s[8:9]
    v_cndmask_b32 v125, v125, v235, s[10:11]
    v_cndmask_b32 v126, v126, v235, s[12:13]
    v_cndmask_b32 v127, v127, v235, s[14:15]
    s_branch L_mkl_done
L_mkl_2:
    v_cndmask_b32 v116, v116, v235, s[8:9]
    v_cndmask_b32 v117, v117, v235, s[10:11]
    v_cndmask_b32 v118, v118, v235, s[12:13]
    v_cndmask_b32 v119, v119, v235, s[14:15]
    s_branch L_mkl_done
L_mkl_3:
    v_mov_b32 v112, v235
    v_mov_b32 v113, v235
    v_mov_b32 v114, v235
    v_mov_b32 v115, v235
    v_mov_b32 v116, v235
    v_mov_b32 v117, v235
    v_mov_b32 v118, v235
    v_mov_b32 v119, v235
    v_mov_b32 v124, v235
    v_mov_b32 v125, v235
    v_mov_b32 v126, v235
    v_mov_b32 v127, v235
    v_cndmask_b32 v120, v120, v235, s[8:9]
    v_cndmask_b32 v121, v121, v235, s[10:11]
    v_cndmask_b32 v122, v122, v235, s[12:13]
    v_cndmask_b32 v123, v123, v235, s[14:15]
L_mkl_done:
    s_waitcnt lgkmcnt(1)
    v_mfma_f32_16x16x32_bf16 a[0:3], v[184:187], v[128:131], a[0:3]
    s_waitcnt vmcnt(11)
    s_barrier
    s_cmp_lg_u32 s4, 0
    s_cbranch_scc1 L_sigA
    s_lshl_b32 s9, s5, 2
    s_lshl_b32 s8, s96, 8
    s_add_u32 s8, s8, 79706112
    s_lshl_b32 s10, s6, 8
    s_add_u32 s10, s10, 79704064
    s_cmp_eq_u32 s91, 0
    s_cselect_b32 s8, s10, s8
    s_add_u32 s8, s8, s9
    s_mov_b64 exec, 1
    v_mov_b32 v3, 1
    buffer_store_dword v3, off, s[52:55], s8 sc1
    s_mov_b64 exec, -1
L_sigA:
    ds_read_b128 v[200:203], v232 offset:34816
    v_mov_b32 v36, v32
    v_mov_b32_e64 v37, v33
    v_mfma_f32_16x16x32_bf16 a[4:7], v[184:187], v[132:135], a[4:7]
    s_add_u32 m0, s80, 16384
    s_add_u32 s95, s82, 32768
    s_add_u32 s93, s86, 32768
    v_exp_f32_e64 v208, v112
    v_mfma_f32_16x16x32_bf16 a[8:11], v[184:187], v[136:139], a[8:11]
    s_xor_b32 s80, s80, 0x10000
    s_add_u32 s82, s82, 65536
    s_sub_u32 s83, s83, 1
    ds_read_b128 v[204:207], v232 offset:35840
    v_exp_f32 v209, v113
    v_mfma_f32_16x16x32_bf16 a[12:15], v[184:187], v[140:143], a[12:15]
    s_waitcnt lgkmcnt(2)
    s_cmp_eq_u32 s83, 0
    s_cselect_b32 s82, s84, s82
    s_cselect_b32 s83, s85, s83
    buffer_load_dwordx4 v2, s[52:55], s95 offen offset:0 sc1 lds
    v_add_f32_e64 v38, v34, v208
    v_mfma_f32_16x16x32_bf16 a[28:31], v[188:191], v[140:143], a[28:31]
    s_cselect_b32 s84, 1073741824, s84
    s_cselect_b32 s85, -1, s85
    s_add_u32 s86, s86, 65536
    v_exp_f32_e64 v210, v114
    v_mfma_f32_16x16x32_bf16 a[24:27], v[188:191], v[136:139], a[24:27]
    s_sub_u32 s87, s87, 1
    s_cmp_eq_u32 s87, 0
    s_cselect_b32 s86, s88, s86
    v_add_f32 v38, v38, v209
    v_cvt_pk_bf16_f32 v152, v208, v209
    v_mfma_f32_16x16x32_bf16 a[20:23], v[188:191], v[132:135], a[20:23]
    s_cselect_b32 s87, s89, s87
    s_cselect_b32 s88, 1073741824, s88
    s_cselect_b32 s89, -1, s89
    ds_read_b128 v[184:187], v232 offset:36864
    v_exp_f32 v211, v115
    v_add_f32_e64 v38, v38, v210
    v_mfma_f32_16x16x32_bf16 a[16:19], v[188:191], v[128:131], a[16:19]
    s_nop 0
    s_waitcnt lgkmcnt(2)
    buffer_load_dwordx4 v2, s[52:55], s95 offen offset:1024 sc1 lds
    v_mfma_f32_16x16x32_bf16 a[32:35], v[200:203], v[128:131], a[32:35]
    v_exp_f32_e64 v212, v116
    v_mfma_f32_16x16x32_bf16 a[36:39], v[200:203], v[132:135], a[36:39]
    v_add_f32 v38, v38, v211
    v_cvt_pk_bf16_f32 v153, v210, v211
    v_exp_f32 v213, v117
    v_mfma_f32_16x16x32_bf16 a[40:43], v[200:203], v[136:139], a[40:43]
    ds_read_b128 v[188:191], v232 offset:37888
    v_add_f32_e64 v38, v38, v212
    v_mfma_f32_16x16x32_bf16 a[44:47], v[200:203], v[140:143], a[44:47]
    s_nop 0
    s_waitcnt lgkmcnt(2)
    buffer_load_dwordx4 v2, s[52:55], s95 offen offset:2048 sc1 lds
    v_mfma_f32_16x16x32_bf16 a[60:63], v[204:207], v[140:143], a[60:63]
    v_exp_f32 v214, v118
    v_add_f32 v38, v38, v213
    v_cvt_pk_bf16_f32 v154, v212, v213
    v_mfma_f32_16x16x32_bf16 a[56:59], v[204:207], v[136:139], a[56:59]
    v_exp_f32_e64 v215, v119
    v_mfma_f32_16x16x32_bf16 a[52:55], v[204:207], v[132:135], a[52:55]
    ds_read_b128 v[200:203], v232 offset:38912
    v_add_f32_e64 v38, v38, v214
    v_mfma_f32_16x16x32_bf16 a[48:51], v[204:207], v[128:131], a[48:51]
    s_nop 0
    s_waitcnt lgkmcnt(2)
    buffer_load_dwordx4 v2, s[52:55], s95 offen offset:3072 sc1 lds
    v_mfma_f32_16x16x32_bf16 a[64:67], v[184:187], v[128:131], a[64:67]
    s_add_u32 m0, s81, 49152
    s_xor_b32 s81, s81, 0x10000
    v_exp_f32 v216, v120
    v_add_f32 v38, v38, v215
    v_cvt_pk_bf16_f32 v155, v214, v215
    v_mfma_f32_16x16x32_bf16 a[68:71], v[184:187], v[132:135], a[68:71]
    v_exp_f32_e64 v217, v121
    v_mfma_f32_16x16x32_bf16 a[72:75], v[184:187], v[136:139], a[72:75]
    ds_read_b128 v[204:207], v232 offset:39936
    v_add_f32_e64 v39, v35, v216
    v_mfma_f32_16x16x32_bf16 a[76:79], v[184:187], v[140:143], a[76:79]
    s_waitcnt lgkmcnt(2)
    buffer_load_dwordx4 v2, s[52:55], s93 offen offset:0 sc1 lds
    v_exp_f32 v218, v122
    v_mfma_f32_16x16x32_bf16 a[92:95], v[188:191], v[140:143], a[92:95]
    v_add_f32_e64 v39, v39, v217
    v_cvt_pk_bf16_f32 v156, v216, v217
    v_mfma_f32_16x16x32_bf16 a[88:91], v[188:191], v[136:139], a[88:91]
    v_exp_f32_e64 v219, v123
    v_mfma_f32_16x16x32_bf16 a[84:87], v[188:191], v[132:135], a[84:87]
    ds_read_b128 v[184:187], v232 offset:49152
    buffer_load_dwordx4 v2, s[52:55], s93 offen offset:1024 sc1 lds
    v_add_f32_e64 v39, v39, v218
    v_mfma_f32_16x16x32_bf16 a[80:83], v[188:191], v[128:131], a[80:83]
    s_waitcnt lgkmcnt(2)
    v_exp_f32 v220, v124
    v_mfma_f32_16x16x32_bf16 a[96:99], v[200:203], v[128:131], a[96:99]
    ds_read_b128 v[188:191], v232 offset:50176
    v_add_f32_e64 v39, v39, v219
    v_cvt_pk_bf16_f32 v157, v218, v219
    v_mfma_f32_16x16x32_bf16 a[100:103], v[200:203], v[132:135], a[100:103]
    v_exp_f32 v221, v125
    v_add_f32 v39, v39, v220
    v_mfma_f32_16x16x32_bf16 a[104:107], v[200:203], v[136:139], a[104:107]
    buffer_load_dwordx4 v2, s[52:55], s93 offen offset:2048 sc1 lds
    v_mfma_f32_16x16x32_bf16 a[108:111], v[200:203], v[140:143], a[108:111]
    s_waitcnt lgkmcnt(2)
    v_exp_f32 v222, v126
    v_mfma_f32_16x16x32_bf16 a[124:127], v[204:207], v[140:143], a[124:127]
    v_add_f32 v39, v39, v221
    v_cvt_pk_bf16_f32 v158, v220, v221
    v_exp_f32 v223, v127
    v_mfma_f32_16x16x32_bf16 a[120:123], v[204:207], v[136:139], a[120:123]
    v_add_f32_e64 v39, v39, v222
    v_mfma_f32_16x16x32_bf16 a[116:119], v[204:207], v[132:135], a[116:119]
    buffer_load_dwordx4 v2, s[52:55], s93 offen offset:3072 sc1 lds
    v_mfma_f32_16x16x32_bf16 a[112:115], v[204:207], v[128:131], a[112:115]
    s_waitcnt lgkmcnt(1)
    v_add_f32 v39, v39, v223
    v_cvt_pk_bf16_f32 v159, v222, v223
    v_xor_b32 v232, 0x10000, v232
    v_xor_b32 v233, 0x10000, v233
    v_max3_f32 v224, v36, v37, v38
    v_max_f32 v224, v224, v39
    v_cmp_nge_f32 vcc, s94, v224
    s_cbranch_vccnz L_chk_last
L_ctl_last:
    s_lshl_b32 s3, s4, 11
    s_add_u32 s3, s3, 131072
    v_add_u32 v237, s3, v2
    v_xor_b32 v238, 2048, v237
    v_mov_b32 v208, v36
    v_mov_b32 v209, v37
    v_mov_b32 v210, v38
    v_mov_b32 v211, v39
    v_mov_b32 v212, v208
    v_mov_b32 v213, v209
    v_mov_b32 v214, v210
    v_mov_b32 v215, v211
    v_permlane16_swap_b32 v212, v208
    v_permlane16_swap_b32 v213, v209
    v_permlane16_swap_b32 v214, v210
    v_permlane16_swap_b32 v215, v211
    v_add_f32 v208, v208, v212
    v_add_f32 v209, v209, v213
    v_add_f32 v210, v210, v214
    v_add_f32 v211, v211, v215
    v_mov_b32 v212, v208
    v_mov_b32 v213, v209
    v_mov_b32 v214, v210
    v_mov_b32 v215, v211
    v_permlane32_swap_b32 v212, v208
    v_permlane32_swap_b32 v213, v209
    v_permlane32_swap_b32 v214, v210
    v_permlane32_swap_b32 v215, v211
    v_add_f32 v208, v208, v212
    v_add_f32 v209, v209, v213
    v_add_f32 v210, v210, v214
    v_add_f32 v211, v211, v215
    v_mov_b32 v212, v160
    v_mov_b32 v213, v164
    v_mov_b32 v214, v168
    v_mov_b32_e64 v215, v172
    ds_write_b128 v237, v[208:211]
    ds_write_b128 v237, v[212:215] offset:1024
    s_cmp_eq_u32 s91, 1
    s_cbranch_scc1 L_drain1
L_drain0:
    v_mfma_f32_16x16x32_bf16 a[8:11], v[184:187], v[152:155], a[8:11]
    ds_read_b128 v[176:179], v232 offset:0
    v_mfma_f32_16x16x32_bf16 a[12:15], v[184:187], v[156:159], a[12:15]
    s_waitcnt lgkmcnt(3)
    s_and_b32 s3, s81, 0x10000
    ds_read_b128 v[180:183], v232 offset:1024
    v_accvgpr_mov_b32 a128, a192
    v_mfma_f32_16x16x32_bf16 a[28:31], v[188:191], v[156:159], a[28:31]
    s_waitcnt lgkmcnt(2)
    s_barrier
    ds_read_b128 v[96:99], v238
    ds_read_b128 v[100:103], v238 offset:1024
    ds_read_b128 v[200:203], v233 offset:51200
    v_mfma_f32_16x16x32_bf16 a[24:27], v[188:191], v[152:155], a[24:27]
    s_waitcnt lgkmcnt(3)
    s_add_u32 s3, s3, 32768
    ds_read_b128 v[204:207], v233 offset:52224
    v_accvgpr_mov_b32 a129, a193
    v_mfma_f32_16x16x32_bf16 v[64:67], v[176:179], a[192:195], 0
    s_nop 0
    ds_read_b128 v[192:195], v232 offset:2048
    v_accvgpr_mov_b32 a130, a194
    v_mfma_f32_16x16x32_bf16 v[64:67], v[180:183], a[208:211], v[64:67]
    s_nop 0
    ds_read_b128 v[196:199], v232 offset:3072
    v_accvgpr_mov_b32 a131, a195
    v_mfma_f32_16x16x32_bf16 v[72:75], v[180:183], a[212:215], 0
    s_waitcnt lgkmcnt(4)
    s_cmp_lt_u32 s4, 2
    s_cselect_b32 s3, 131072, s3
    v_accvgpr_mov_b32 a132, a196
    v_accvgpr_mov_b32 a133, a197
    v_mfma_f32_16x16x32_bf16 v[72:75], v[176:179], a[196:199], v[72:75]
    v_min_f32 v104, v212, v100
    v_min_f32 v105, v213, v101
    v_mfma_f32_16x16x32_bf16 v[80:83], v[176:179], a[200:203], 0
    s_lshl_b32 s8, s7, 14
    v_min_f32 v106, v214, v102
    v_min_f32_e64 v107, v215, v103
    v_mfma_f32_16x16x32_bf16 v[80:83], v[180:183], a[216:219], v[80:83]
    v_sub_f32 v108, v104, v212
    v_sub_f32 v112, v104, v100
    v_mfma_f32_16x16x32_bf16 v[88:91], v[180:183], a[220:223], 0
    v_sub_f32 v109, v105, v213
    v_sub_f32 v113, v105, v101
    v_mfma_f32_16x16x32_bf16 v[88:91], v[176:179], a[204:207], v[88:91]
    s_waitcnt lgkmcnt(3)
    s_add_u32 s10, s3, s8
    v_sub_f32 v110, v106, v214
    v_sub_f32 v114, v106, v102
    v_mfma_f32_16x16x32_bf16 a[40:43], v[200:203], v[152:155], a[40:43]
    ds_read_b128 v[184:187], v233 offset:53248
    v_sub_f32_e64 v111, v107, v215
    v_mfma_f32_16x16x32_bf16 a[44:47], v[200:203], v[156:159], a[44:47]
    s_waitcnt lgkmcnt(3)
    s_mul_i32 s24, s92, 1400832
    v_sub_f32 v115, v107, v103
    v_mfma_f32_16x16x32_bf16 a[60:63], v[204:207], v[156:159], a[60:63]
    ds_read_b128 v[188:191], v233 offset:54272
    v_mfma_f32_16x16x32_bf16 a[56:59], v[204:207], v[152:155], a[56:59]
    s_waitcnt lgkmcnt(2)
    v_exp_f32 v108, v108
    v_mfma_f32_16x16x32_bf16 v[64:67], v[192:195], a[224:227], v[64:67]
    s_nop 0
    s_lshl_b32 s9, s5, 15
    ds_read_b128 v[176:179], v232 offset:4096
    v_mfma_f32_16x16x32_bf16 v[64:67], v[196:199], a[240:243], v[64:67]
    ds_read_b128 v[180:183], v232 offset:5120
    v_mfma_f32_16x16x32_bf16 v[72:75], v[196:199], a[244:247], v[72:75]
    s_add_u32 s24, s24, s9
    v_exp_f32 v112, v112
    v_mfma_f32_16x16x32_bf16 v[72:75], v[192:195], a[228:231], v[72:75]
    v_exp_f32_e64 v109, v109
    v_mfma_f32_16x16x32_bf16 v[80:83], v[192:195], a[232:235], v[80:83]
    v_exp_f32_e64 v113, v113
    v_mfma_f32_16x16x32_bf16 v[80:83], v[196:199], a[248:251], v[80:83]
    s_add_u32 s24, s24, s8
    v_exp_f32 v110, v110
    v_mfma_f32_16x16x32_bf16 v[88:91], v[196:199], a[252:255], v[88:91]
    v_exp_f32_e64 v114, v114
    v_mfma_f32_16x16x32_bf16 v[88:91], v[192:195], a[236:239], v[88:91]
    s_waitcnt lgkmcnt(3)
    v_exp_f32 v111, v111
    v_mfma_f32_16x16x32_bf16 a[72:75], v[184:187], v[152:155], a[72:75]
    s_add_u32 s16, s24, 35651584
    ds_read_b128 v[200:203], v233 offset:55296
    v_mfma_f32_16x16x32_bf16 a[76:79], v[184:187], v[156:159], a[76:79]
    s_waitcnt lgkmcnt(3)
    v_exp_f32 v115, v115
    v_mfma_f32_16x16x32_bf16 a[92:95], v[188:191], v[156:159], a[92:95]
    s_add_u32 s17, s16, 4096
    ds_read_b128 v[204:207], v233 offset:56320
    v_mul_f32_e64 v104, v108, v208
    v_mfma_f32_16x16x32_bf16 a[88:91], v[188:191], v[152:155], a[88:91]
    s_waitcnt lgkmcnt(2)
    v_mul_f32 v105, v109, v209
    v_mul_f32_e64 v106, v110, v210
    v_mfma_f32_16x16x32_bf16 v[68:71], v[176:179], a[192:195], 0
    ds_read_b128 v[192:195], v232 offset:6144
    v_mul_f32_e64 v107, v111, v211
    v_mfma_f32_16x16x32_bf16 v[68:71], v[180:183], a[208:211], v[68:71]
    s_add_u32 s18, s16, 8192
    ds_read_b128 v[196:199], v232 offset:7168
    v_fmac_f32_e64 v104, v112, v96
    v_mfma_f32_16x16x32_bf16 v[76:79], v[180:183], a[212:215], 0
    v_fmac_f32 v105, v113, v97
    v_fmac_f32 v106, v114, v98
    v_mfma_f32_16x16x32_bf16 v[76:79], v[176:179], a[196:199], v[76:79]
    s_add_u32 s19, s18, 4096
    v_fmac_f32_e64 v107, v115, v99
    v_mfma_f32_16x16x32_bf16 v[84:87], v[176:179], a[200:203], 0
    v_rcp_f32_e64 v104, v104
    v_mfma_f32_16x16x32_bf16 v[84:87], v[180:183], a[216:219], v[84:87]
    v_rcp_f32_e64 v105, v105
    v_mfma_f32_16x16x32_bf16 v[92:95], v[180:183], a[220:223], 0
    s_mov_b32 s91, 1
    v_rcp_f32 v106, v106
    v_mfma_f32_16x16x32_bf16 v[92:95], v[176:179], a[204:207], v[92:95]
    s_waitcnt lgkmcnt(3)
    v_rcp_f32 v107, v107
    v_mfma_f32_16x16x32_bf16 a[104:107], v[200:203], v[152:155], a[104:107]
    s_mov_b32 s96, s92
    v_mul_f32 v216, v108, v104
    v_mul_f32_e64 v220, v112, v104
    v_mfma_f32_16x16x32_bf16 a[108:111], v[200:203], v[156:159], a[108:111]
    s_waitcnt lgkmcnt(2)
    v_mul_f32 v217, v109, v105
    v_mul_f32_e64 v221, v113, v105
    v_mfma_f32_16x16x32_bf16 a[124:127], v[204:207], v[156:159], a[124:127]
    v_mul_f32 v218, v110, v106
    v_mul_f32 v222, v114, v106
    v_mfma_f32_16x16x32_bf16 a[120:123], v[204:207], v[152:155], a[120:123]
    s_waitcnt lgkmcnt(0)
    s_mov_b32 s92, s6
    v_mul_f32 v219, v111, v107
    v_mul_f32 v223, v115, v107
    v_mfma_f32_16x16x32_bf16 v[68:71], v[192:195], a[224:227], v[68:71]
    v_accvgpr_mov_b32 a134, a198
    v_accvgpr_mov_b32 a135, a199
    v_mfma_f32_16x16x32_bf16 v[68:71], v[196:199], a[240:243], v[68:71]
    s_nop 0
    s_mov_b32 s90, s6
    v_accvgpr_mov_b32 a136, a200
    v_accvgpr_mov_b32 a137, a201
    v_mfma_f32_16x16x32_bf16 v[76:79], v[196:199], a[244:247], v[76:79]
    v_accvgpr_mov_b32 a138, a202
    v_accvgpr_mov_b32 a139, a203
    v_mfma_f32_16x16x32_bf16 v[76:79], v[192:195], a[228:231], v[76:79]
    v_accvgpr_mov_b32 a140, a204
    v_accvgpr_mov_b32 a141, a205
    v_mfma_f32_16x16x32_bf16 v[84:87], v[192:195], a[232:235], v[84:87]
    s_cmp_eq_u32 s6, 0
    s_cselect_b32 s94, -1.0, s94
    v_accvgpr_mov_b32 a142, a206
    v_accvgpr_mov_b32 a143, a207
    v_mfma_f32_16x16x32_bf16 v[84:87], v[196:199], a[248:251], v[84:87]
    v_accvgpr_mov_b32 a144, a208
    v_accvgpr_mov_b32 a145, a209
    v_mfma_f32_16x16x32_bf16 v[92:95], v[196:199], a[252:255], v[92:95]
    v_accvgpr_mov_b32 a146, a210
    v_accvgpr_mov_b32 a147, a211
    v_mfma_f32_16x16x32_bf16 v[92:95], v[192:195], a[236:239], v[92:95]
    v_accvgpr_mov_b32 a148, a212
    v_accvgpr_mov_b32 a149, a213
    v_accvgpr_mov_b32 a150, a214
    v_accvgpr_mov_b32 a151, a215
    v_accvgpr_mov_b32 a152, a216
    v_accvgpr_mov_b32 a153, a217
    v_accvgpr_mov_b32 a154, a218
    v_accvgpr_mov_b32 a155, a219
    v_accvgpr_mov_b32 a156, a220
    v_accvgpr_mov_b32 a157, a221
    v_accvgpr_mov_b32 a158, a222
    v_accvgpr_mov_b32 a159, a223
    v_accvgpr_mov_b32 a160, a224
    v_accvgpr_mov_b32 a161, a225
    v_accvgpr_mov_b32 a162, a226
    v_accvgpr_mov_b32 a163, a227
    v_accvgpr_mov_b32 a164, a228
    v_accvgpr_mov_b32 a165, a229
    v_accvgpr_mov_b32 a166, a230
    v_accvgpr_mov_b32 a167, a231
    v_accvgpr_mov_b32 a168, a232
    v_accvgpr_mov_b32 a169, a233
    v_accvgpr_mov_b32 a170, a234
    v_accvgpr_mov_b32 a171, a235
    v_accvgpr_mov_b32 a172, a236
    v_accvgpr_mov_b32 a173, a237
    v_accvgpr_mov_b32 a174, a238
    v_accvgpr_mov_b32 a175, a239
    v_accvgpr_mov_b32 a176, a240
    v_accvgpr_mov_b32 a177, a241
    v_accvgpr_mov_b32 a178, a242
    v_accvgpr_mov_b32 a179, a243
    v_accvgpr_mov_b32 a180, a244
    v_accvgpr_mov_b32 a181, a245
    v_accvgpr_mov_b32 a182, a246
    v_accvgpr_mov_b32 a183, a247
    v_accvgpr_mov_b32 a184, a248
    v_accvgpr_mov_b32 a185, a249
    v_accvgpr_mov_b32 a186, a250
    v_accvgpr_mov_b32 a187, a251
    v_accvgpr_mov_b32 a188, a252
    v_accvgpr_mov_b32 a189, a253
    v_accvgpr_mov_b32 a190, a254
    v_accvgpr_mov_b32 a191, a255
    v_add_u32 v237, s10, v2
    v_xor_b32 v238, 16384, v237
    s_barrier
    s_cmp_eq_u32 s92, 0
    s_cbranch_scc1 L_mask_pre
L_mask_pre_ret:
    s_cmp_eq_u32 s7, 1
    s_cbranch_scc1 L_epi0_1
L_epi0_0:
    v_max3_f32 v208, v64, v65, v66
    v_max3_f32 v209, v72, v73, v74
    v_max3_f32 v210, v80, v81, v82
    v_max3_f32 v211, v88, v89, v90
    v_max3_f32 v208, v208, v67, v68
    v_max3_f32 v209, v209, v75, v76
    v_max3_f32 v210, v210, v83, v84
    v_max3_f32 v211, v211, v91, v92
    v_max3_f32 v208, v208, v69, v70
    v_max3_f32 v209, v209, v77, v78
    v_max3_f32 v210, v210, v85, v86
    v_max3_f32 v211, v211, v93, v94
    ds_write_b128 v237, a[64:67] offset:0
    v_max_f32 v208, v208, v71
    v_max_f32 v209, v209, v79
    v_max_f32 v210, v210, v87
    v_max_f32 v211, v211, v95
    v_mov_b32 v212, v208
    v_mov_b32 v213, v209
    v_mov_b32 v214, v210
    v_mov_b32 v215, v211
    v_permlane16_swap_b32 v212, v208
    v_permlane16_swap_b32 v213, v209
    v_permlane16_swap_b32 v214, v210
    v_permlane16_swap_b32 v215, v211
    ds_write_b128 v237, a[68:71] offset:1024
    v_max_f32 v208, v208, v212
    v_max_f32 v209, v209, v213
    v_max_f32 v210, v210, v214
    v_max_f32 v211, v211, v215
    v_mov_b32 v212, v208
    v_mov_b32 v213, v209
    v_mov_b32 v214, v210
    v_mov_b32 v215, v211
    v_permlane32_swap_b32 v212, v208
    v_permlane32_swap_b32 v213, v209
    v_permlane32_swap_b32 v214, v210
    v_permlane32_swap_b32 v215, v211
    ds_write_b128 v237, a[72:75] offset:2048
    v_max_f32 v208, v208, v212
    v_max_f32 v209, v209, v213
    v_max_f32 v210, v210, v214
    v_max_f32 v211, v211, v215
    v_max_f32 v208, 0xff61b1e6, v208
    v_max_f32 v209, 0xff61b1e6, v209
    v_max_f32 v210, 0xff61b1e6, v210
    v_max_f32 v211, 0xff61b1e6, v211
    v_sub_f32 v160, 0, v208
    v_sub_f32 v161, 0, v208
    v_sub_f32 v162, 0, v208
    v_sub_f32 v163, 0, v208
    ds_write_b128 v237, a[76:79] offset:3072
    v_sub_f32 v64, v64, v208
    v_sub_f32 v65, v65, v208
    v_sub_f32 v66, v66, v208
    v_sub_f32 v67, v67, v208
    v_sub_f32 v68, v68, v208
    v_sub_f32 v69, v69, v208
    v_sub_f32 v70, v70, v208
    v_sub_f32 v71, v71, v208
    v_sub_f32 v164, 0, v209
    v_sub_f32 v165, 0, v209
    v_sub_f32 v166, 0, v209
    v_sub_f32 v167, 0, v209
    ds_write_b128 v237, a[80:83] offset:4096
    v_sub_f32 v72, v72, v209
    v_sub_f32 v73, v73, v209
    v_sub_f32 v74, v74, v209
    v_sub_f32 v75, v75, v209
    v_sub_f32 v76, v76, v209
    v_sub_f32 v77, v77, v209
    v_sub_f32 v78, v78, v209
    v_sub_f32 v79, v79, v209
    v_sub_f32 v168, 0, v210
    v_sub_f32 v169, 0, v210
    v_sub_f32 v170, 0, v210
    v_sub_f32 v171, 0, v210
    ds_write_b128 v237, a[84:87] offset:5120
    v_sub_f32 v80, v80, v210
    v_sub_f32 v81, v81, v210
    v_sub_f32 v82, v82, v210
    v_sub_f32 v83, v83, v210
    v_sub_f32 v84, v84, v210
    v_sub_f32 v85, v85, v210
    v_sub_f32 v86, v86, v210
    v_sub_f32 v87, v87, v210
    v_sub_f32 v172, 0, v211
    v_sub_f32 v173, 0, v211
    v_sub_f32 v174, 0, v211
    v_sub_f32 v175, 0, v211
    ds_write_b128 v237, a[88:91] offset:6144
    v_sub_f32 v88, v88, v211
    v_sub_f32 v89, v89, v211
    v_sub_f32 v90, v90, v211
    v_sub_f32 v91, v91, v211
    v_sub_f32 v92, v92, v211
    v_sub_f32 v93, v93, v211
    v_sub_f32 v94, v94, v211
    v_sub_f32 v95, v95, v211
    v_accvgpr_read_b32 v128, a0
    v_accvgpr_read_b32 v129, a1
    v_accvgpr_read_b32 v130, a2
    v_accvgpr_read_b32 v131, a3
    ds_write_b128 v237, a[92:95] offset:7168
    v_accvgpr_read_b32 v132, a4
    v_accvgpr_read_b32 v133, a5
    v_accvgpr_read_b32 v134, a6
    v_accvgpr_read_b32 v135, a7
    v_accvgpr_read_b32 v136, a8
    v_accvgpr_read_b32 v137, a9
    v_accvgpr_read_b32 v138, a10
    v_accvgpr_read_b32 v139, a11
    v_accvgpr_read_b32 v140, a12
    v_accvgpr_read_b32 v141, a13
    v_accvgpr_read_b32 v142, a14
    v_accvgpr_read_b32 v143, a15
    ds_write_b128 v237, a[96:99] offset:8192
    v_accvgpr_read_b32 v144, a16
    v_accvgpr_read_b32 v145, a17
    v_accvgpr_read_b32 v146, a18
    v_accvgpr_read_b32 v147, a19
    v_accvgpr_read_b32 v148, a20
    v_accvgpr_read_b32 v149, a21
    v_accvgpr_read_b32 v150, a22
    v_accvgpr_read_b32 v151, a23
    v_accvgpr_read_b32 v152, a24
    v_accvgpr_read_b32 v153, a25
    v_accvgpr_read_b32 v154, a26
    v_accvgpr_read_b32 v155, a27
    ds_write_b128 v237, a[100:103] offset:9216
    v_accvgpr_read_b32 v156, a28
    v_accvgpr_read_b32 v157, a29
    v_accvgpr_read_b32 v158, a30
    v_accvgpr_read_b32 v159, a31
    v_accvgpr_read_b32 v192, a32
    v_accvgpr_read_b32 v193, a33
    v_accvgpr_read_b32 v194, a34
    v_accvgpr_read_b32 v195, a35
    v_accvgpr_read_b32 v196, a36
    v_accvgpr_read_b32 v197, a37
    v_accvgpr_read_b32 v198, a38
    v_accvgpr_read_b32 v199, a39
    ds_write_b128 v237, a[104:107] offset:10240
    v_accvgpr_read_b32 v200, a40
    v_accvgpr_read_b32 v201, a41
    v_accvgpr_read_b32 v202, a42
    v_accvgpr_read_b32 v203, a43
    v_accvgpr_read_b32 v204, a44
    v_accvgpr_read_b32 v205, a45
    v_accvgpr_read_b32 v206, a46
    v_accvgpr_read_b32 v207, a47
    v_accvgpr_read_b32 v248, a48
    v_accvgpr_read_b32 v249, a49
    v_accvgpr_read_b32 v250, a50
    v_accvgpr_read_b32 v251, a51
    ds_write_b128 v237, a[108:111] offset:11264
    v_accvgpr_read_b32 v252, a52
    v_accvgpr_read_b32 v253, a53
    v_accvgpr_read_b32 v254, a54
    v_accvgpr_read_b32 v255, a55
    v_accvgpr_read_b32 v224, a56
    v_accvgpr_read_b32 v225, a57
    v_accvgpr_read_b32 v226, a58
    v_accvgpr_read_b32 v227, a59
    v_accvgpr_read_b32 v228, a60
    v_accvgpr_read_b32 v229, a61
    v_accvgpr_read_b32 v230, a62
    v_accvgpr_read_b32 v231, a63
    ds_write_b128 v237, a[112:115] offset:12288
    v_pk_mul_f32 v[128:129], v[128:129], v[216:217] op_sel_hi:[1,0]
    v_pk_mul_f32 v[130:131], v[130:131], v[216:217] op_sel_hi:[1,0]
    v_pk_mul_f32 v[132:133], v[132:133], v[216:217] op_sel:[0,1] op_sel_hi:[1,1]
    v_pk_mul_f32 v[134:135], v[134:135], v[216:217] op_sel:[0,1] op_sel_hi:[1,1]
    v_pk_mul_f32 v[136:137], v[136:137], v[218:219] op_sel_hi:[1,0]
    v_pk_mul_f32 v[138:139], v[138:139], v[218:219] op_sel_hi:[1,0]
    v_pk_mul_f32 v[140:141], v[140:141], v[218:219] op_sel:[0,1] op_sel_hi:[1,1]
    v_pk_mul_f32 v[142:143], v[142:143], v[218:219] op_sel:[0,1] op_sel_hi:[1,1]
    v_pk_mul_f32 v[144:145], v[144:145], v[216:217] op_sel_hi:[1,0]
    v_pk_mul_f32 v[146:147], v[146:147], v[216:217] op_sel_hi:[1,0]
    v_pk_mul_f32 v[148:149], v[148:149], v[216:217] op_sel:[0,1] op_sel_hi:[1,1]
    v_pk_mul_f32 v[150:151], v[150:151], v[216:217] op_sel:[0,1] op_sel_hi:[1,1]
    ds_write_b128 v237, a[116:119] offset:13312
    v_pk_mul_f32 v[152:153], v[152:153], v[218:219] op_sel_hi:[1,0]
    v_pk_mul_f32 v[154:155], v[154:155], v[218:219] op_sel_hi:[1,0]
    v_pk_mul_f32 v[156:157], v[156:157], v[218:219] op_sel:[0,1] op_sel_hi:[1,1]
    v_pk_mul_f32 v[158:159], v[158:159], v[218:219] op_sel:[0,1] op_sel_hi:[1,1]
    v_pk_mul_f32 v[192:193], v[192:193], v[216:217] op_sel_hi:[1,0]
    v_pk_mul_f32 v[194:195], v[194:195], v[216:217] op_sel_hi:[1,0]
    v_pk_mul_f32 v[196:197], v[196:197], v[216:217] op_sel:[0,1] op_sel_hi:[1,1]
    v_pk_mul_f32 v[198:199], v[198:199], v[216:217] op_sel:[0,1] op_sel_hi:[1,1]
    v_pk_mul_f32 v[200:201], v[200:201], v[218:219] op_sel_hi:[1,0]
    v_pk_mul_f32 v[202:203], v[202:203], v[218:219] op_sel_hi:[1,0]
    v_pk_mul_f32 v[204:205], v[204:205], v[218:219] op_sel:[0,1] op_sel_hi:[1,1]
    v_pk_mul_f32 v[206:207], v[206:207], v[218:219] op_sel:[0,1] op_sel_hi:[1,1]
    ds_write_b128 v237, a[120:123] offset:14336
    v_pk_mul_f32 v[248:249], v[248:249], v[216:217] op_sel_hi:[1,0]
    v_pk_mul_f32 v[250:251], v[250:251], v[216:217] op_sel_hi:[1,0]
    v_pk_mul_f32 v[252:253], v[252:253], v[216:217] op_sel:[0,1] op_sel_hi:[1,1]
    v_pk_mul_f32 v[254:255], v[254:255], v[216:217] op_sel:[0,1] op_sel_hi:[1,1]
    v_pk_mul_f32 v[224:225], v[224:225], v[218:219] op_sel_hi:[1,0]
    v_pk_mul_f32 v[226:227], v[226:227], v[218:219] op_sel_hi:[1,0]
    v_pk_mul_f32 v[228:229], v[228:229], v[218:219] op_sel:[0,1] op_sel_hi:[1,1]
    v_pk_mul_f32 v[230:231], v[230:231], v[218:219] op_sel:[0,1] op_sel_hi:[1,1]
    ds_write_b128 v237, a[124:127] offset:15360
    s_waitcnt lgkmcnt(0)
    s_barrier
    ds_read_b128 v[96:99], v238 offset:0
    ds_read_b128 v[112:115], v238 offset:4096
    ds_read_b128 v[100:103], v238 offset:1024
    ds_read_b128 v[116:119], v238 offset:5120
    ds_read_b128 v[104:107], v238 offset:2048
    ds_read_b128 v[120:123], v238 offset:6144
    ds_read_b128 v[108:111], v238 offset:3072
    ds_read_b128 v[124:127], v238 offset:7168
    ds_read_b128 v[32:35], v238 offset:8192
    ds_read_b128 v[184:187], v238 offset:12288
    ds_read_b128 v[36:39], v238 offset:9216
    ds_read_b128 v[188:191], v238 offset:13312
    ds_read_b128 v[40:43], v238 offset:10240
    ds_read_b128 v[208:211], v238 offset:14336
    ds_read_b128 v[240:243], v238 offset:11264
    ds_read_b128 v[212:215], v238 offset:15360
    ds_read_b128 v[176:179], v232 offset:16384
    ds_read_b128 v[180:183], v232 offset:17408
    s_waitcnt lgkmcnt(15)
    v_pk_fma_f32 v[128:129], v[96:97], v[220:221], v[128:129] op_sel_hi:[1,0,1]
    v_pk_fma_f32 v[130:131], v[98:99], v[220:221], v[130:131] op_sel_hi:[1,0,1]
    v_pk_fma_f32 v[144:145], v[112:113], v[220:221], v[144:145] op_sel_hi:[1,0,1]
    v_pk_fma_f32 v[146:147], v[114:115], v[220:221], v[146:147] op_sel_hi:[1,0,1]
    v_cvt_pk_bf16_f32 v4, v128, v129
    v_cvt_pk_bf16_f32 v5, v130, v131
    v_cvt_pk_bf16_f32 v6, v144, v145
    v_cvt_pk_bf16_f32 v7, v146, v147
    s_waitcnt lgkmcnt(14)
    v_pk_fma_f32 v[132:133], v[100:101], v[220:221], v[132:133] op_sel:[0,1,0] op_sel_hi:[1,1,1]
    v_pk_fma_f32 v[134:135], v[102:103], v[220:221], v[134:135] op_sel:[0,1,0] op_sel_hi:[1,1,1]
    v_pk_fma_f32 v[148:149], v[116:117], v[220:221], v[148:149] op_sel:[0,1,0] op_sel_hi:[1,1,1]
    v_pk_fma_f32 v[150:151], v[118:119], v[220:221], v[150:151] op_sel:[0,1,0] op_sel_hi:[1,1,1]
    v_cvt_pk_bf16_f32 v8, v132, v133
    v_cvt_pk_bf16_f32 v9, v134, v135
    v_cvt_pk_bf16_f32 v10, v148, v149
    v_cvt_pk_bf16_f32 v11, v150, v151
    s_waitcnt lgkmcnt(12)
    v_pk_fma_f32 v[136:137], v[104:105], v[222:223], v[136:137] op_sel_hi:[1,0,1]
    v_pk_fma_f32 v[138:139], v[106:107], v[222:223], v[138:139] op_sel_hi:[1,0,1]
    v_pk_fma_f32 v[152:153], v[120:121], v[222:223], v[152:153] op_sel_hi:[1,0,1]
    v_pk_fma_f32 v[154:155], v[122:123], v[222:223], v[154:155] op_sel_hi:[1,0,1]
    v_cvt_pk_bf16_f32 v12, v136, v137
    v_cvt_pk_bf16_f32 v13, v138, v139
    v_cvt_pk_bf16_f32 v14, v152, v153
    v_cvt_pk_bf16_f32 v15, v154, v155
    s_waitcnt lgkmcnt(10)
    v_pk_fma_f32 v[140:141], v[108:109], v[222:223], v[140:141] op_sel:[0,1,0] op_sel_hi:[1,1,1]
    v_pk_fma_f32 v[142:143], v[110:111], v[222:223], v[142:143] op_sel:[0,1,0] op_sel_hi:[1,1,1]
    v_pk_fma_f32 v[156:157], v[124:125], v[222:223], v[156:157] op_sel:[0,1,0] op_sel_hi:[1,1,1]
    v_pk_fma_f32 v[158:159], v[126:127], v[222:223], v[158:159] op_sel:[0,1,0] op_sel_hi:[1,1,1]
    v_cvt_pk_bf16_f32 v16, v140, v141
    v_cvt_pk_bf16_f32 v17, v142, v143
    v_cvt_pk_bf16_f32 v18, v156, v157
    v_cvt_pk_bf16_f32 v19, v158, v159
    s_waitcnt lgkmcnt(8)
    v_pk_fma_f32 v[192:193], v[32:33], v[220:221], v[192:193] op_sel_hi:[1,0,1]
    v_pk_fma_f32 v[194:195], v[34:35], v[220:221], v[194:195] op_sel_hi:[1,0,1]
    v_pk_fma_f32 v[248:249], v[184:185], v[220:221], v[248:249] op_sel_hi:[1,0,1]
    v_pk_fma_f32 v[250:251], v[186:187], v[220:221], v[250:251] op_sel_hi:[1,0,1]
    v_cvt_pk_bf16_f32 v20, v192, v193
    v_cvt_pk_bf16_f32 v21, v194, v195
    v_cvt_pk_bf16_f32 v22, v248, v249
    v_cvt_pk_bf16_f32 v23, v250, v251
    s_waitcnt lgkmcnt(6)
    v_pk_fma_f32 v[196:197], v[36:37], v[220:221], v[196:197] op_sel:[0,1,0] op_sel_hi:[1,1,1]
    v_pk_fma_f32 v[198:199], v[38:39], v[220:221], v[198:199] op_sel:[0,1,0] op_sel_hi:[1,1,1]
    v_pk_fma_f32 v[252:253], v[188:189], v[220:221], v[252:253] op_sel:[0,1,0] op_sel_hi:[1,1,1]
    v_pk_fma_f32 v[254:255], v[190:191], v[220:221], v[254:255] op_sel:[0,1,0] op_sel_hi:[1,1,1]
    v_cvt_pk_bf16_f32 v24, v196, v197
    v_cvt_pk_bf16_f32 v25, v198, v199
    v_cvt_pk_bf16_f32 v26, v252, v253
    v_cvt_pk_bf16_f32 v27, v254, v255
    s_waitcnt lgkmcnt(4)
    v_pk_fma_f32 v[200:201], v[40:41], v[222:223], v[200:201] op_sel_hi:[1,0,1]
    v_pk_fma_f32 v[202:203], v[42:43], v[222:223], v[202:203] op_sel_hi:[1,0,1]
    v_pk_fma_f32 v[224:225], v[208:209], v[222:223], v[224:225] op_sel_hi:[1,0,1]
    v_pk_fma_f32 v[226:227], v[210:211], v[222:223], v[226:227] op_sel_hi:[1,0,1]
    v_cvt_pk_bf16_f32 v28, v200, v201
    v_cvt_pk_bf16_f32 v29, v202, v203
    v_cvt_pk_bf16_f32 v30, v224, v225
    v_cvt_pk_bf16_f32 v31, v226, v227
    s_waitcnt lgkmcnt(2)
    v_pk_fma_f32 v[204:205], v[240:241], v[222:223], v[204:205] op_sel:[0,1,0] op_sel_hi:[1,1,1]
    v_pk_fma_f32 v[206:207], v[242:243], v[222:223], v[206:207] op_sel:[0,1,0] op_sel_hi:[1,1,1]
    v_pk_fma_f32 v[228:229], v[212:213], v[222:223], v[228:229] op_sel:[0,1,0] op_sel_hi:[1,1,1]
    v_pk_fma_f32 v[230:231], v[214:215], v[222:223], v[230:231] op_sel:[0,1,0] op_sel_hi:[1,1,1]
    v_cvt_pk_bf16_f32 v44, v204, v205
    v_cvt_pk_bf16_f32 v45, v206, v207
    v_cvt_pk_bf16_f32 v46, v228, v229
    v_cvt_pk_bf16_f32 v47, v230, v231
    s_waitcnt lgkmcnt(0)
    s_branch L_first
L_epi0_1:
    v_max3_f32 v208, v64, v65, v66
    v_max3_f32 v209, v72, v73, v74
    v_max3_f32 v210, v80, v81, v82
    v_max3_f32 v211, v88, v89, v90
    v_max3_f32 v208, v208, v67, v68
    v_max3_f32 v209, v209, v75, v76
    v_max3_f32 v210, v210, v83, v84
    v_max3_f32 v211, v211, v91, v92
    v_max3_f32 v208, v208, v69, v70
    v_max3_f32 v209, v209, v77, v78
    v_max3_f32 v210, v210, v85, v86
    v_max3_f32 v211, v211, v93, v94
    ds_write_b128 v237, a[0:3] offset:0
    v_max_f32 v208, v208, v71
    v_max_f32 v209, v209, v79
    v_max_f32 v210, v210, v87
    v_max_f32 v211, v211, v95
    v_mov_b32 v212, v208
    v_mov_b32 v213, v209
    v_mov_b32 v214, v210
    v_mov_b32 v215, v211
    v_permlane16_swap_b32 v212, v208
    v_permlane16_swap_b32 v213, v209
    v_permlane16_swap_b32 v214, v210
    v_permlane16_swap_b32 v215, v211
    ds_write_b128 v237, a[4:7] offset:1024
    v_max_f32 v208, v208, v212
    v_max_f32 v209, v209, v213
    v_max_f32 v210, v210, v214
    v_max_f32 v211, v211, v215
    v_mov_b32 v212, v208
    v_mov_b32 v213, v209
    v_mov_b32 v214, v210
    v_mov_b32 v215, v211
    v_permlane32_swap_b32 v212, v208
    v_permlane32_swap_b32 v213, v209
    v_permlane32_swap_b32 v214, v210
    v_permlane32_swap_b32 v215, v211
    ds_write_b128 v237, a[8:11] offset:2048
    v_max_f32 v208, v208, v212
    v_max_f32 v209, v209, v213
    v_max_f32 v210, v210, v214
    v_max_f32 v211, v211, v215
    v_max_f32 v208, 0xff61b1e6, v208
    v_max_f32 v209, 0xff61b1e6, v209
    v_max_f32 v210, 0xff61b1e6, v210
    v_max_f32 v211, 0xff61b1e6, v211
    v_sub_f32 v160, 0, v208
    v_sub_f32 v161, 0, v208
    v_sub_f32 v162, 0, v208
    v_sub_f32 v163, 0, v208
    ds_write_b128 v237, a[12:15] offset:3072
    v_sub_f32 v64, v64, v208
    v_sub_f32 v65, v65, v208
    v_sub_f32 v66, v66, v208
    v_sub_f32 v67, v67, v208
    v_sub_f32 v68, v68, v208
    v_sub_f32 v69, v69, v208
    v_sub_f32 v70, v70, v208
    v_sub_f32 v71, v71, v208
    v_sub_f32 v164, 0, v209
    v_sub_f32 v165, 0, v209
    v_sub_f32 v166, 0, v209
    v_sub_f32 v167, 0, v209
    ds_write_b128 v237, a[16:19] offset:4096
    v_sub_f32 v72, v72, v209
    v_sub_f32 v73, v73, v209
    v_sub_f32 v74, v74, v209
    v_sub_f32 v75, v75, v209
    v_sub_f32 v76, v76, v209
    v_sub_f32 v77, v77, v209
    v_sub_f32 v78, v78, v209
    v_sub_f32 v79, v79, v209
    v_sub_f32 v168, 0, v210
    v_sub_f32 v169, 0, v210
    v_sub_f32 v170, 0, v210
    v_sub_f32 v171, 0, v210
    ds_write_b128 v237, a[20:23] offset:5120
    v_sub_f32 v80, v80, v210
    v_sub_f32 v81, v81, v210
    v_sub_f32 v82, v82, v210
    v_sub_f32 v83, v83, v210
    v_sub_f32 v84, v84, v210
    v_sub_f32 v85, v85, v210
    v_sub_f32 v86, v86, v210
    v_sub_f32 v87, v87, v210
    v_sub_f32 v172, 0, v211
    v_sub_f32 v173, 0, v211
    v_sub_f32 v174, 0, v211
    v_sub_f32 v175, 0, v211
    ds_write_b128 v237, a[24:27] offset:6144
    v_sub_f32 v88, v88, v211
    v_sub_f32 v89, v89, v211
    v_sub_f32 v90, v90, v211
    v_sub_f32 v91, v91, v211
    v_sub_f32 v92, v92, v211
    v_sub_f32 v93, v93, v211
    v_sub_f32 v94, v94, v211
    v_sub_f32 v95, v95, v211
    v_accvgpr_read_b32 v128, a64
    v_accvgpr_read_b32 v129, a65
    v_accvgpr_read_b32 v130, a66
    v_accvgpr_read_b32 v131, a67
    ds_write_b128 v237, a[28:31] offset:7168
    v_accvgpr_read_b32 v132, a68
    v_accvgpr_read_b32 v133, a69
    v_accvgpr_read_b32 v134, a70
    v_accvgpr_read_b32 v135, a71
    v_accvgpr_read_b32 v136, a72
    v_accvgpr_read_b32 v137, a73
    v_accvgpr_read_b32 v138, a74
    v_accvgpr_read_b32 v139, a75
    v_accvgpr_read_b32 v140, a76
    v_accvgpr_read_b32 v141, a77
    v_accvgpr_read_b32 v142, a78
    v_accvgpr_read_b32 v143, a79
    ds_write_b128 v237, a[32:35] offset:8192
    v_accvgpr_read_b32 v144, a80
    v_accvgpr_read_b32 v145, a81
    v_accvgpr_read_b32 v146, a82
    v_accvgpr_read_b32 v147, a83
    v_accvgpr_read_b32 v148, a84
    v_accvgpr_read_b32 v149, a85
    v_accvgpr_read_b32 v150, a86
    v_accvgpr_read_b32 v151, a87
    v_accvgpr_read_b32 v152, a88
    v_accvgpr_read_b32 v153, a89
    v_accvgpr_read_b32 v154, a90
    v_accvgpr_read_b32 v155, a91
    ds_write_b128 v237, a[36:39] offset:9216
    v_accvgpr_read_b32 v156, a92
    v_accvgpr_read_b32 v157, a93
    v_accvgpr_read_b32 v158, a94
    v_accvgpr_read_b32 v159, a95
    v_accvgpr_read_b32 v192, a96
    v_accvgpr_read_b32 v193, a97
    v_accvgpr_read_b32 v194, a98
    v_accvgpr_read_b32 v195, a99
    v_accvgpr_read_b32 v196, a100
    v_accvgpr_read_b32 v197, a101
    v_accvgpr_read_b32 v198, a102
    v_accvgpr_read_b32 v199, a103
    ds_write_b128 v237, a[40:43] offset:10240
    v_accvgpr_read_b32 v200, a104
    v_accvgpr_read_b32 v201, a105
    v_accvgpr_read_b32 v202, a106
    v_accvgpr_read_b32 v203, a107
    v_accvgpr_read_b32 v204, a108
    v_accvgpr_read_b32 v205, a109
    v_accvgpr_read_b32 v206, a110
    v_accvgpr_read_b32 v207, a111
    v_accvgpr_read_b32 v248, a112
    v_accvgpr_read_b32 v249, a113
    v_accvgpr_read_b32 v250, a114
    v_accvgpr_read_b32 v251, a115
    ds_write_b128 v237, a[44:47] offset:11264
    v_accvgpr_read_b32 v252, a116
    v_accvgpr_read_b32 v253, a117
    v_accvgpr_read_b32 v254, a118
    v_accvgpr_read_b32 v255, a119
    v_accvgpr_read_b32 v224, a120
    v_accvgpr_read_b32 v225, a121
    v_accvgpr_read_b32 v226, a122
    v_accvgpr_read_b32 v227, a123
    v_accvgpr_read_b32 v228, a124
    v_accvgpr_read_b32 v229, a125
    v_accvgpr_read_b32 v230, a126
    v_accvgpr_read_b32 v231, a127
    ds_write_b128 v237, a[48:51] offset:12288
    v_pk_mul_f32 v[128:129], v[128:129], v[216:217] op_sel_hi:[1,0]
    v_pk_mul_f32 v[130:131], v[130:131], v[216:217] op_sel_hi:[1,0]
    v_pk_mul_f32 v[132:133], v[132:133], v[216:217] op_sel:[0,1] op_sel_hi:[1,1]
    v_pk_mul_f32 v[134:135], v[134:135], v[216:217] op_sel:[0,1] op_sel_hi:[1,1]
    v_pk_mul_f32 v[136:137], v[136:137], v[218:219] op_sel_hi:[1,0]
    v_pk_mul_f32 v[138:139], v[138:139], v[218:219] op_sel_hi:[1,0]
    v_pk_mul_f32 v[140:141], v[140:141], v[218:219] op_sel:[0,1] op_sel_hi:[1,1]
    v_pk_mul_f32 v[142:143], v[142:143], v[218:219] op_sel:[0,1] op_sel_hi:[1,1]
    v_pk_mul_f32 v[144:145], v[144:145], v[216:217] op_sel_hi:[1,0]
    v_pk_mul_f32 v[146:147], v[146:147], v[216:217] op_sel_hi:[1,0]
    v_pk_mul_f32 v[148:149], v[148:149], v[216:217] op_sel:[0,1] op_sel_hi:[1,1]
    v_pk_mul_f32 v[150:151], v[150:151], v[216:217] op_sel:[0,1] op_sel_hi:[1,1]
    ds_write_b128 v237, a[52:55] offset:13312
    v_pk_mul_f32 v[152:153], v[152:153], v[218:219] op_sel_hi:[1,0]
    v_pk_mul_f32 v[154:155], v[154:155], v[218:219] op_sel_hi:[1,0]
    v_pk_mul_f32 v[156:157], v[156:157], v[218:219] op_sel:[0,1] op_sel_hi:[1,1]
    v_pk_mul_f32 v[158:159], v[158:159], v[218:219] op_sel:[0,1] op_sel_hi:[1,1]
    v_pk_mul_f32 v[192:193], v[192:193], v[216:217] op_sel_hi:[1,0]
    v_pk_mul_f32 v[194:195], v[194:195], v[216:217] op_sel_hi:[1,0]
    v_pk_mul_f32 v[196:197], v[196:197], v[216:217] op_sel:[0,1] op_sel_hi:[1,1]
    v_pk_mul_f32 v[198:199], v[198:199], v[216:217] op_sel:[0,1] op_sel_hi:[1,1]
    v_pk_mul_f32 v[200:201], v[200:201], v[218:219] op_sel_hi:[1,0]
    v_pk_mul_f32 v[202:203], v[202:203], v[218:219] op_sel_hi:[1,0]
    v_pk_mul_f32 v[204:205], v[204:205], v[218:219] op_sel:[0,1] op_sel_hi:[1,1]
    v_pk_mul_f32 v[206:207], v[206:207], v[218:219] op_sel:[0,1] op_sel_hi:[1,1]
    ds_write_b128 v237, a[56:59] offset:14336
    v_pk_mul_f32 v[248:249], v[248:249], v[216:217] op_sel_hi:[1,0]
    v_pk_mul_f32 v[250:251], v[250:251], v[216:217] op_sel_hi:[1,0]
    v_pk_mul_f32 v[252:253], v[252:253], v[216:217] op_sel:[0,1] op_sel_hi:[1,1]
    v_pk_mul_f32 v[254:255], v[254:255], v[216:217] op_sel:[0,1] op_sel_hi:[1,1]
    v_pk_mul_f32 v[224:225], v[224:225], v[218:219] op_sel_hi:[1,0]
    v_pk_mul_f32 v[226:227], v[226:227], v[218:219] op_sel_hi:[1,0]
    v_pk_mul_f32 v[228:229], v[228:229], v[218:219] op_sel:[0,1] op_sel_hi:[1,1]
    v_pk_mul_f32 v[230:231], v[230:231], v[218:219] op_sel:[0,1] op_sel_hi:[1,1]
    ds_write_b128 v237, a[60:63] offset:15360
    s_waitcnt lgkmcnt(0)
    s_barrier
    ds_read_b128 v[96:99], v238 offset:0
    ds_read_b128 v[112:115], v238 offset:4096
    ds_read_b128 v[100:103], v238 offset:1024
    ds_read_b128 v[116:119], v238 offset:5120
    ds_read_b128 v[104:107], v238 offset:2048
    ds_read_b128 v[120:123], v238 offset:6144
    ds_read_b128 v[108:111], v238 offset:3072
    ds_read_b128 v[124:127], v238 offset:7168
    ds_read_b128 v[32:35], v238 offset:8192
    ds_read_b128 v[184:187], v238 offset:12288
    ds_read_b128 v[36:39], v238 offset:9216
    ds_read_b128 v[188:191], v238 offset:13312
    ds_read_b128 v[40:43], v238 offset:10240
    ds_read_b128 v[208:211], v238 offset:14336
    ds_read_b128 v[240:243], v238 offset:11264
    ds_read_b128 v[212:215], v238 offset:15360
    ds_read_b128 v[176:179], v232 offset:16384
    ds_read_b128 v[180:183], v232 offset:17408
    s_waitcnt lgkmcnt(15)
    v_pk_fma_f32 v[128:129], v[96:97], v[220:221], v[128:129] op_sel_hi:[1,0,1]
    v_pk_fma_f32 v[130:131], v[98:99], v[220:221], v[130:131] op_sel_hi:[1,0,1]
    v_pk_fma_f32 v[144:145], v[112:113], v[220:221], v[144:145] op_sel_hi:[1,0,1]
    v_pk_fma_f32 v[146:147], v[114:115], v[220:221], v[146:147] op_sel_hi:[1,0,1]
    v_cvt_pk_bf16_f32 v4, v128, v129
    v_cvt_pk_bf16_f32 v5, v130, v131
    v_cvt_pk_bf16_f32 v6, v144, v145
    v_cvt_pk_bf16_f32 v7, v146, v147
    s_waitcnt lgkmcnt(14)
    v_pk_fma_f32 v[132:133], v[100:101], v[220:221], v[132:133] op_sel:[0,1,0] op_sel_hi:[1,1,1]
    v_pk_fma_f32 v[134:135], v[102:103], v[220:221], v[134:135] op_sel:[0,1,0] op_sel_hi:[1,1,1]
    v_pk_fma_f32 v[148:149], v[116:117], v[220:221], v[148:149] op_sel:[0,1,0] op_sel_hi:[1,1,1]
    v_pk_fma_f32 v[150:151], v[118:119], v[220:221], v[150:151] op_sel:[0,1,0] op_sel_hi:[1,1,1]
    v_cvt_pk_bf16_f32 v8, v132, v133
    v_cvt_pk_bf16_f32 v9, v134, v135
    v_cvt_pk_bf16_f32 v10, v148, v149
    v_cvt_pk_bf16_f32 v11, v150, v151
    s_waitcnt lgkmcnt(12)
    v_pk_fma_f32 v[136:137], v[104:105], v[222:223], v[136:137] op_sel_hi:[1,0,1]
    v_pk_fma_f32 v[138:139], v[106:107], v[222:223], v[138:139] op_sel_hi:[1,0,1]
    v_pk_fma_f32 v[152:153], v[120:121], v[222:223], v[152:153] op_sel_hi:[1,0,1]
    v_pk_fma_f32 v[154:155], v[122:123], v[222:223], v[154:155] op_sel_hi:[1,0,1]
    v_cvt_pk_bf16_f32 v12, v136, v137
    v_cvt_pk_bf16_f32 v13, v138, v139
    v_cvt_pk_bf16_f32 v14, v152, v153
    v_cvt_pk_bf16_f32 v15, v154, v155
    s_waitcnt lgkmcnt(10)
    v_pk_fma_f32 v[140:141], v[108:109], v[222:223], v[140:141] op_sel:[0,1,0] op_sel_hi:[1,1,1]
    v_pk_fma_f32 v[142:143], v[110:111], v[222:223], v[142:143] op_sel:[0,1,0] op_sel_hi:[1,1,1]
    v_pk_fma_f32 v[156:157], v[124:125], v[222:223], v[156:157] op_sel:[0,1,0] op_sel_hi:[1,1,1]
    v_pk_fma_f32 v[158:159], v[126:127], v[222:223], v[158:159] op_sel:[0,1,0] op_sel_hi:[1,1,1]
    v_cvt_pk_bf16_f32 v16, v140, v141
    v_cvt_pk_bf16_f32 v17, v142, v143
    v_cvt_pk_bf16_f32 v18, v156, v157
    v_cvt_pk_bf16_f32 v19, v158, v159
    s_waitcnt lgkmcnt(8)
    v_pk_fma_f32 v[192:193], v[32:33], v[220:221], v[192:193] op_sel_hi:[1,0,1]
    v_pk_fma_f32 v[194:195], v[34:35], v[220:221], v[194:195] op_sel_hi:[1,0,1]
    v_pk_fma_f32 v[248:249], v[184:185], v[220:221], v[248:249] op_sel_hi:[1,0,1]
    v_pk_fma_f32 v[250:251], v[186:187], v[220:221], v[250:251] op_sel_hi:[1,0,1]
    v_cvt_pk_bf16_f32 v20, v192, v193
    v_cvt_pk_bf16_f32 v21, v194, v195
    v_cvt_pk_bf16_f32 v22, v248, v249
    v_cvt_pk_bf16_f32 v23, v250, v251
    s_waitcnt lgkmcnt(6)
    v_pk_fma_f32 v[196:197], v[36:37], v[220:221], v[196:197] op_sel:[0,1,0] op_sel_hi:[1,1,1]
    v_pk_fma_f32 v[198:199], v[38:39], v[220:221], v[198:199] op_sel:[0,1,0] op_sel_hi:[1,1,1]
    v_pk_fma_f32 v[252:253], v[188:189], v[220:221], v[252:253] op_sel:[0,1,0] op_sel_hi:[1,1,1]
    v_pk_fma_f32 v[254:255], v[190:191], v[220:221], v[254:255] op_sel:[0,1,0] op_sel_hi:[1,1,1]
    v_cvt_pk_bf16_f32 v24, v196, v197
    v_cvt_pk_bf16_f32 v25, v198, v199
    v_cvt_pk_bf16_f32 v26, v252, v253
    v_cvt_pk_bf16_f32 v27, v254, v255
    s_waitcnt lgkmcnt(4)
    v_pk_fma_f32 v[200:201], v[40:41], v[222:223], v[200:201] op_sel_hi:[1,0,1]
    v_pk_fma_f32 v[202:203], v[42:43], v[222:223], v[202:203] op_sel_hi:[1,0,1]
    v_pk_fma_f32 v[224:225], v[208:209], v[222:223], v[224:225] op_sel_hi:[1,0,1]
    v_pk_fma_f32 v[226:227], v[210:211], v[222:223], v[226:227] op_sel_hi:[1,0,1]
    v_cvt_pk_bf16_f32 v28, v200, v201
    v_cvt_pk_bf16_f32 v29, v202, v203
    v_cvt_pk_bf16_f32 v30, v224, v225
    v_cvt_pk_bf16_f32 v31, v226, v227
    s_waitcnt lgkmcnt(2)
    v_pk_fma_f32 v[204:205], v[240:241], v[222:223], v[204:205] op_sel:[0,1,0] op_sel_hi:[1,1,1]
    v_pk_fma_f32 v[206:207], v[242:243], v[222:223], v[206:207] op_sel:[0,1,0] op_sel_hi:[1,1,1]
    v_pk_fma_f32 v[228:229], v[212:213], v[222:223], v[228:229] op_sel:[0,1,0] op_sel_hi:[1,1,1]
    v_pk_fma_f32 v[230:231], v[214:215], v[222:223], v[230:231] op_sel:[0,1,0] op_sel_hi:[1,1,1]
    v_cvt_pk_bf16_f32 v44, v204, v205
    v_cvt_pk_bf16_f32 v45, v206, v207
    v_cvt_pk_bf16_f32 v46, v228, v229
    v_cvt_pk_bf16_f32 v47, v230, v231
    s_waitcnt lgkmcnt(0)
    s_branch L_first
L_drain1:
    v_mfma_f32_16x16x32_bf16 a[8:11], v[184:187], v[152:155], a[8:11]
    ds_read_b128 v[200:203], v233 offset:51200
    v_mfma_f32_16x16x32_bf16 a[12:15], v[184:187], v[156:159], a[12:15]
    s_nop 0
    s_waitcnt lgkmcnt(3)
    s_and_b32 s3, s81, 0x10000
    ds_read_b128 v[204:207], v233 offset:52224
    v_mfma_f32_16x16x32_bf16 a[28:31], v[188:191], v[156:159], a[28:31]
    s_waitcnt lgkmcnt(2)
    s_barrier
    ds_read_b128 v[96:99], v238
    ds_read_b128 v[100:103], v238 offset:1024
    ds_read_b128 v[184:187], v233 offset:53248
    s_add_u32 s3, s3, 32768
    v_mfma_f32_16x16x32_bf16 a[24:27], v[188:191], v[152:155], a[24:27]
    s_waitcnt lgkmcnt(4)
    s_cmp_lt_u32 s4, 2
    s_cselect_b32 s3, 131072, s3
    ds_read_b128 v[188:191], v233 offset:54272
    v_mfma_f32_16x16x32_bf16 a[40:43], v[200:203], v[152:155], a[40:43]
    s_nop 0
    s_lshl_b32 s8, s7, 14
    v_mfma_f32_16x16x32_bf16 a[44:47], v[200:203], v[156:159], a[44:47]
    s_waitcnt lgkmcnt(4)
    s_add_u32 s10, s3, s8
    ds_read_b128 v[200:203], v233 offset:55296
    v_mfma_f32_16x16x32_bf16 a[60:63], v[204:207], v[156:159], a[60:63]
    s_nop 0
    s_waitcnt lgkmcnt(3)
    s_mul_i32 s24, s92, 1400832
    v_mfma_f32_16x16x32_bf16 a[56:59], v[204:207], v[152:155], a[56:59]
    s_waitcnt lgkmcnt(2)
    s_lshl_b32 s9, s5, 15
    ds_read_b128 v[204:207], v233 offset:56320
    v_min_f32_e64 v104, v212, v100
    v_mfma_f32_16x16x32_bf16 a[72:75], v[184:187], v[152:155], a[72:75]
    s_add_u32 s24, s24, s9
    v_min_f32 v105, v213, v101
    v_min_f32_e64 v106, v214, v102
    v_mfma_f32_16x16x32_bf16 a[76:79], v[184:187], v[156:159], a[76:79]
    s_waitcnt lgkmcnt(2)
    s_add_u32 s24, s24, s8
    v_min_f32 v107, v215, v103
    v_sub_f32 v108, v104, v212
    v_mfma_f32_16x16x32_bf16 a[92:95], v[188:191], v[156:159], a[92:95]
    s_add_u32 s16, s24, 35651584
    v_sub_f32 v112, v104, v100
    v_sub_f32 v109, v105, v213
    v_mfma_f32_16x16x32_bf16 a[88:91], v[188:191], v[152:155], a[88:91]
    s_waitcnt lgkmcnt(1)
    s_add_u32 s17, s16, 4096
    v_sub_f32 v113, v105, v101
    v_sub_f32_e64 v110, v106, v214
    v_mfma_f32_16x16x32_bf16 a[104:107], v[200:203], v[152:155], a[104:107]
    s_add_u32 s18, s16, 8192
    v_sub_f32 v114, v106, v102
    v_sub_f32 v111, v107, v215
    v_mfma_f32_16x16x32_bf16 a[108:111], v[200:203], v[156:159], a[108:111]
    s_waitcnt lgkmcnt(0)
    s_add_u32 s19, s18, 4096
    v_sub_f32 v115, v107, v103
    v_mfma_f32_16x16x32_bf16 a[124:127], v[204:207], v[156:159], a[124:127]
    v_exp_f32_e64 v108, v108
    v_mfma_f32_16x16x32_bf16 a[120:123], v[204:207], v[152:155], a[120:123]
    v_exp_f32 v112, v112
    v_exp_f32 v109, v109
    v_exp_f32 v113, v113
    v_exp_f32 v110, v110
    v_exp_f32 v114, v114
    v_exp_f32 v111, v111
    v_exp_f32 v115, v115
    v_mul_f32 v104, v108, v208
    v_mul_f32 v105, v109, v209
    v_mul_f32 v106, v110, v210
    v_mul_f32 v107, v111, v211
    v_fmac_f32 v104, v112, v96
    v_fmac_f32 v105, v113, v97
    v_fmac_f32 v106, v114, v98
    v_fmac_f32 v107, v115, v99
    v_rcp_f32 v104, v104
    v_rcp_f32 v105, v105
    v_rcp_f32 v106, v106
    v_rcp_f32 v107, v107
    v_mul_f32 v216, v108, v104
    v_mul_f32 v220, v112, v104
    v_mul_f32 v217, v109, v105
    v_mul_f32 v221, v113, v105
    v_mul_f32 v218, v110, v106
    v_mul_f32 v222, v114, v106
    v_mul_f32 v219, v111, v107
    v_mul_f32 v223, v115, v107
    v_add_u32 v237, s10, v2
    v_xor_b32 v238, 16384, v237
    s_waitcnt vmcnt(0)
    s_barrier
    s_cmp_eq_u32 s7, 1
    s_cbranch_scc1 L_epi1_1
L_epi1_0:
    v_accvgpr_read_b32 v128, a0
    v_accvgpr_read_b32 v129, a1
    v_accvgpr_read_b32 v130, a2
    v_accvgpr_read_b32 v131, a3
    v_accvgpr_read_b32 v132, a4
    v_accvgpr_read_b32 v133, a5
    ds_write_b128 v237, a[64:67] offset:0
    v_accvgpr_read_b32 v134, a6
    v_accvgpr_read_b32 v135, a7
    v_accvgpr_read_b32 v136, a8
    v_accvgpr_read_b32 v137, a9
    v_accvgpr_read_b32 v138, a10
    v_accvgpr_read_b32 v139, a11
    ds_write_b128 v237, a[68:71] offset:1024
    v_accvgpr_read_b32 v140, a12
    v_accvgpr_read_b32 v141, a13
    v_accvgpr_read_b32 v142, a14
    v_accvgpr_read_b32 v143, a15
    v_accvgpr_read_b32 v144, a16
    v_accvgpr_read_b32 v145, a17
    ds_write_b128 v237, a[72:75] offset:2048
    v_accvgpr_read_b32 v146, a18
    v_accvgpr_read_b32 v147, a19
    v_accvgpr_read_b32 v148, a20
    v_accvgpr_read_b32 v149, a21
    v_accvgpr_read_b32 v150, a22
    v_accvgpr_read_b32 v151, a23
    ds_write_b128 v237, a[76:79] offset:3072
    v_accvgpr_read_b32 v152, a24
    v_accvgpr_read_b32 v153, a25
    v_accvgpr_read_b32 v154, a26
    v_accvgpr_read_b32 v155, a27
    v_accvgpr_read_b32 v156, a28
    v_accvgpr_read_b32 v157, a29
    ds_write_b128 v237, a[80:83] offset:4096
    v_accvgpr_read_b32 v158, a30
    v_accvgpr_read_b32 v159, a31
    v_accvgpr_read_b32 v192, a32
    v_accvgpr_read_b32 v193, a33
    v_accvgpr_read_b32 v194, a34
    v_accvgpr_read_b32 v195, a35
    ds_write_b128 v237, a[84:87] offset:5120
    v_accvgpr_read_b32 v196, a36
    v_accvgpr_read_b32 v197, a37
    v_accvgpr_read_b32 v198, a38
    v_accvgpr_read_b32 v199, a39
    v_accvgpr_read_b32 v200, a40
    v_accvgpr_read_b32 v201, a41
    ds_write_b128 v237, a[88:91] offset:6144
    v_accvgpr_read_b32 v202, a42
    v_accvgpr_read_b32 v203, a43
    v_accvgpr_read_b32 v204, a44
    v_accvgpr_read_b32 v205, a45
    v_accvgpr_read_b32 v206, a46
    v_accvgpr_read_b32 v207, a47
    ds_write_b128 v237, a[92:95] offset:7168
    v_accvgpr_read_b32 v248, a48
    v_accvgpr_read_b32 v249, a49
    v_accvgpr_read_b32 v250, a50
    v_accvgpr_read_b32 v251, a51
    v_accvgpr_read_b32 v252, a52
    v_accvgpr_read_b32 v253, a53
    ds_write_b128 v237, a[96:99] offset:8192
    v_accvgpr_read_b32 v254, a54
    v_accvgpr_read_b32 v255, a55
    v_accvgpr_read_b32 v224, a56
    v_accvgpr_read_b32 v225, a57
    v_accvgpr_read_b32 v226, a58
    v_accvgpr_read_b32 v227, a59
    ds_write_b128 v237, a[100:103] offset:9216
    v_accvgpr_read_b32 v228, a60
    v_accvgpr_read_b32 v229, a61
    v_accvgpr_read_b32 v230, a62
    v_accvgpr_read_b32 v231, a63
    v_pk_mul_f32 v[128:129], v[128:129], v[216:217] op_sel_hi:[1,0]
    v_pk_mul_f32 v[130:131], v[130:131], v[216:217] op_sel_hi:[1,0]
    ds_write_b128 v237, a[104:107] offset:10240
    v_pk_mul_f32 v[132:133], v[132:133], v[216:217] op_sel:[0,1] op_sel_hi:[1,1]
    v_pk_mul_f32 v[134:135], v[134:135], v[216:217] op_sel:[0,1] op_sel_hi:[1,1]
    v_pk_mul_f32 v[136:137], v[136:137], v[218:219] op_sel_hi:[1,0]
    v_pk_mul_f32 v[138:139], v[138:139], v[218:219] op_sel_hi:[1,0]
    v_pk_mul_f32 v[140:141], v[140:141], v[218:219] op_sel:[0,1] op_sel_hi:[1,1]
    v_pk_mul_f32 v[142:143], v[142:143], v[218:219] op_sel:[0,1] op_sel_hi:[1,1]
    ds_write_b128 v237, a[108:111] offset:11264
    v_pk_mul_f32 v[144:145], v[144:145], v[216:217] op_sel_hi:[1,0]
    v_pk_mul_f32 v[146:147], v[146:147], v[216:217] op_sel_hi:[1,0]
    v_pk_mul_f32 v[148:149], v[148:149], v[216:217] op_sel:[0,1] op_sel_hi:[1,1]
    v_pk_mul_f32 v[150:151], v[150:151], v[216:217] op_sel:[0,1] op_sel_hi:[1,1]
    v_pk_mul_f32 v[152:153], v[152:153], v[218:219] op_sel_hi:[1,0]
    v_pk_mul_f32 v[154:155], v[154:155], v[218:219] op_sel_hi:[1,0]
    ds_write_b128 v237, a[112:115] offset:12288
    v_pk_mul_f32 v[156:157], v[156:157], v[218:219] op_sel:[0,1] op_sel_hi:[1,1]
    v_pk_mul_f32 v[158:159], v[158:159], v[218:219] op_sel:[0,1] op_sel_hi:[1,1]
    v_pk_mul_f32 v[192:193], v[192:193], v[216:217] op_sel_hi:[1,0]
    v_pk_mul_f32 v[194:195], v[194:195], v[216:217] op_sel_hi:[1,0]
    v_pk_mul_f32 v[196:197], v[196:197], v[216:217] op_sel:[0,1] op_sel_hi:[1,1]
    v_pk_mul_f32 v[198:199], v[198:199], v[216:217] op_sel:[0,1] op_sel_hi:[1,1]
    ds_write_b128 v237, a[116:119] offset:13312
    v_pk_mul_f32 v[200:201], v[200:201], v[218:219] op_sel_hi:[1,0]
    v_pk_mul_f32 v[202:203], v[202:203], v[218:219] op_sel_hi:[1,0]
    v_pk_mul_f32 v[204:205], v[204:205], v[218:219] op_sel:[0,1] op_sel_hi:[1,1]
    v_pk_mul_f32 v[206:207], v[206:207], v[218:219] op_sel:[0,1] op_sel_hi:[1,1]
    v_pk_mul_f32 v[248:249], v[248:249], v[216:217] op_sel_hi:[1,0]
    v_pk_mul_f32 v[250:251], v[250:251], v[216:217] op_sel_hi:[1,0]
    ds_write_b128 v237, a[120:123] offset:14336
    v_pk_mul_f32 v[252:253], v[252:253], v[216:217] op_sel:[0,1] op_sel_hi:[1,1]
    v_pk_mul_f32 v[254:255], v[254:255], v[216:217] op_sel:[0,1] op_sel_hi:[1,1]
    v_pk_mul_f32 v[224:225], v[224:225], v[218:219] op_sel_hi:[1,0]
    v_pk_mul_f32 v[226:227], v[226:227], v[218:219] op_sel_hi:[1,0]
    v_pk_mul_f32 v[228:229], v[228:229], v[218:219] op_sel:[0,1] op_sel_hi:[1,1]
    v_pk_mul_f32 v[230:231], v[230:231], v[218:219] op_sel:[0,1] op_sel_hi:[1,1]
    ds_write_b128 v237, a[124:127] offset:15360
    s_waitcnt lgkmcnt(0)
    s_barrier
    ds_read_b128 v[96:99], v238 offset:0
    ds_read_b128 v[112:115], v238 offset:4096
    ds_read_b128 v[100:103], v238 offset:1024
    ds_read_b128 v[116:119], v238 offset:5120
    ds_read_b128 v[104:107], v238 offset:2048
    ds_read_b128 v[120:123], v238 offset:6144
    ds_read_b128 v[108:111], v238 offset:3072
    ds_read_b128 v[124:127], v238 offset:7168
    ds_read_b128 v[32:35], v238 offset:8192
    ds_read_b128 v[184:187], v238 offset:12288
    ds_read_b128 v[36:39], v238 offset:9216
    ds_read_b128 v[188:191], v238 offset:13312
    ds_read_b128 v[40:43], v238 offset:10240
    ds_read_b128 v[208:211], v238 offset:14336
    ds_read_b128 v[240:243], v238 offset:11264
    ds_read_b128 v[212:215], v238 offset:15360
    s_waitcnt lgkmcnt(14)
    v_pk_fma_f32 v[128:129], v[96:97], v[220:221], v[128:129] op_sel_hi:[1,0,1]
    v_pk_fma_f32 v[130:131], v[98:99], v[220:221], v[130:131] op_sel_hi:[1,0,1]
    v_pk_fma_f32 v[144:145], v[112:113], v[220:221], v[144:145] op_sel_hi:[1,0,1]
    v_pk_fma_f32 v[146:147], v[114:115], v[220:221], v[146:147] op_sel_hi:[1,0,1]
    v_cvt_pk_bf16_f32 v4, v128, v129
    v_cvt_pk_bf16_f32 v5, v130, v131
    v_cvt_pk_bf16_f32 v6, v144, v145
    v_cvt_pk_bf16_f32 v7, v146, v147
    buffer_store_dwordx4 v[4:7], v245, s[52:55], s16 offen sc1
    s_waitcnt lgkmcnt(12)
    v_pk_fma_f32 v[132:133], v[100:101], v[220:221], v[132:133] op_sel:[0,1,0] op_sel_hi:[1,1,1]
    v_pk_fma_f32 v[134:135], v[102:103], v[220:221], v[134:135] op_sel:[0,1,0] op_sel_hi:[1,1,1]
    v_pk_fma_f32 v[148:149], v[116:117], v[220:221], v[148:149] op_sel:[0,1,0] op_sel_hi:[1,1,1]
    v_pk_fma_f32 v[150:151], v[118:119], v[220:221], v[150:151] op_sel:[0,1,0] op_sel_hi:[1,1,1]
    v_cvt_pk_bf16_f32 v8, v132, v133
    v_cvt_pk_bf16_f32 v9, v134, v135
    v_cvt_pk_bf16_f32 v10, v148, v149
    v_cvt_pk_bf16_f32 v11, v150, v151
    buffer_store_dwordx4 v[8:11], v246, s[52:55], s16 offen sc1
    s_waitcnt lgkmcnt(10)
    v_pk_fma_f32 v[136:137], v[104:105], v[222:223], v[136:137] op_sel_hi:[1,0,1]
    v_pk_fma_f32 v[138:139], v[106:107], v[222:223], v[138:139] op_sel_hi:[1,0,1]
    v_pk_fma_f32 v[152:153], v[120:121], v[222:223], v[152:153] op_sel_hi:[1,0,1]
    v_pk_fma_f32 v[154:155], v[122:123], v[222:223], v[154:155] op_sel_hi:[1,0,1]
    v_cvt_pk_bf16_f32 v12, v136, v137
    v_cvt_pk_bf16_f32 v13, v138, v139
    v_cvt_pk_bf16_f32 v14, v152, v153
    v_cvt_pk_bf16_f32 v15, v154, v155
    buffer_store_dwordx4 v[12:15], v245, s[52:55], s17 offen sc1
    s_waitcnt lgkmcnt(8)
    v_pk_fma_f32 v[140:141], v[108:109], v[222:223], v[140:141] op_sel:[0,1,0] op_sel_hi:[1,1,1]
    v_pk_fma_f32 v[142:143], v[110:111], v[222:223], v[142:143] op_sel:[0,1,0] op_sel_hi:[1,1,1]
    v_pk_fma_f32 v[156:157], v[124:125], v[222:223], v[156:157] op_sel:[0,1,0] op_sel_hi:[1,1,1]
    v_pk_fma_f32 v[158:159], v[126:127], v[222:223], v[158:159] op_sel:[0,1,0] op_sel_hi:[1,1,1]
    v_cvt_pk_bf16_f32 v16, v140, v141
    v_cvt_pk_bf16_f32 v17, v142, v143
    v_cvt_pk_bf16_f32 v18, v156, v157
    v_cvt_pk_bf16_f32 v19, v158, v159
    buffer_store_dwordx4 v[16:19], v246, s[52:55], s17 offen sc1
    s_waitcnt lgkmcnt(6)
    v_pk_fma_f32 v[192:193], v[32:33], v[220:221], v[192:193] op_sel_hi:[1,0,1]
    v_pk_fma_f32 v[194:195], v[34:35], v[220:221], v[194:195] op_sel_hi:[1,0,1]
    v_pk_fma_f32 v[248:249], v[184:185], v[220:221], v[248:249] op_sel_hi:[1,0,1]
    v_pk_fma_f32 v[250:251], v[186:187], v[220:221], v[250:251] op_sel_hi:[1,0,1]
    v_cvt_pk_bf16_f32 v20, v192, v193
    v_cvt_pk_bf16_f32 v21, v194, v195
    v_cvt_pk_bf16_f32 v22, v248, v249
    v_cvt_pk_bf16_f32 v23, v250, v251
    buffer_store_dwordx4 v[20:23], v245, s[52:55], s18 offen sc1
    s_waitcnt lgkmcnt(4)
    v_pk_fma_f32 v[196:197], v[36:37], v[220:221], v[196:197] op_sel:[0,1,0] op_sel_hi:[1,1,1]
    v_pk_fma_f32 v[198:199], v[38:39], v[220:221], v[198:199] op_sel:[0,1,0] op_sel_hi:[1,1,1]
    v_pk_fma_f32 v[252:253], v[188:189], v[220:221], v[252:253] op_sel:[0,1,0] op_sel_hi:[1,1,1]
    v_pk_fma_f32 v[254:255], v[190:191], v[220:221], v[254:255] op_sel:[0,1,0] op_sel_hi:[1,1,1]
    v_cvt_pk_bf16_f32 v24, v196, v197
    v_cvt_pk_bf16_f32 v25, v198, v199
    v_cvt_pk_bf16_f32 v26, v252, v253
    v_cvt_pk_bf16_f32 v27, v254, v255
    buffer_store_dwordx4 v[24:27], v246, s[52:55], s18 offen sc1
    s_waitcnt lgkmcnt(2)
    v_pk_fma_f32 v[200:201], v[40:41], v[222:223], v[200:201] op_sel_hi:[1,0,1]
    v_pk_fma_f32 v[202:203], v[42:43], v[222:223], v[202:203] op_sel_hi:[1,0,1]
    v_pk_fma_f32 v[224:225], v[208:209], v[222:223], v[224:225] op_sel_hi:[1,0,1]
    v_pk_fma_f32 v[226:227], v[210:211], v[222:223], v[226:227] op_sel_hi:[1,0,1]
    v_cvt_pk_bf16_f32 v28, v200, v201
    v_cvt_pk_bf16_f32 v29, v202, v203
    v_cvt_pk_bf16_f32 v30, v224, v225
    v_cvt_pk_bf16_f32 v31, v226, v227
    buffer_store_dwordx4 v[28:31], v245, s[52:55], s19 offen sc1
    s_waitcnt lgkmcnt(0)
    v_pk_fma_f32 v[204:205], v[240:241], v[222:223], v[204:205] op_sel:[0,1,0] op_sel_hi:[1,1,1]
    v_pk_fma_f32 v[206:207], v[242:243], v[222:223], v[206:207] op_sel:[0,1,0] op_sel_hi:[1,1,1]
    v_pk_fma_f32 v[228:229], v[212:213], v[222:223], v[228:229] op_sel:[0,1,0] op_sel_hi:[1,1,1]
    v_pk_fma_f32 v[230:231], v[214:215], v[222:223], v[230:231] op_sel:[0,1,0] op_sel_hi:[1,1,1]
    v_cvt_pk_bf16_f32 v44, v204, v205
    v_cvt_pk_bf16_f32 v45, v206, v207
    v_cvt_pk_bf16_f32 v46, v228, v229
    v_cvt_pk_bf16_f32 v47, v230, v231
    buffer_store_dwordx4 v[44:47], v246, s[52:55], s19 offen sc1
    s_branch L_att_done
L_epi1_1:
    v_accvgpr_read_b32 v128, a64
    v_accvgpr_read_b32 v129, a65
    v_accvgpr_read_b32 v130, a66
    v_accvgpr_read_b32 v131, a67
    v_accvgpr_read_b32 v132, a68
    v_accvgpr_read_b32 v133, a69
    ds_write_b128 v237, a[0:3] offset:0
    v_accvgpr_read_b32 v134, a70
    v_accvgpr_read_b32 v135, a71
    v_accvgpr_read_b32 v136, a72
    v_accvgpr_read_b32 v137, a73
    v_accvgpr_read_b32 v138, a74
    v_accvgpr_read_b32 v139, a75
    ds_write_b128 v237, a[4:7] offset:1024
    v_accvgpr_read_b32 v140, a76
    v_accvgpr_read_b32 v141, a77
    v_accvgpr_read_b32 v142, a78
    v_accvgpr_read_b32 v143, a79
    v_accvgpr_read_b32 v144, a80
    v_accvgpr_read_b32 v145, a81
    ds_write_b128 v237, a[8:11] offset:2048
    v_accvgpr_read_b32 v146, a82
    v_accvgpr_read_b32 v147, a83
    v_accvgpr_read_b32 v148, a84
    v_accvgpr_read_b32 v149, a85
    v_accvgpr_read_b32 v150, a86
    v_accvgpr_read_b32 v151, a87
    ds_write_b128 v237, a[12:15] offset:3072
    v_accvgpr_read_b32 v152, a88
    v_accvgpr_read_b32 v153, a89
    v_accvgpr_read_b32 v154, a90
    v_accvgpr_read_b32 v155, a91
    v_accvgpr_read_b32 v156, a92
    v_accvgpr_read_b32 v157, a93
    ds_write_b128 v237, a[16:19] offset:4096
    v_accvgpr_read_b32 v158, a94
    v_accvgpr_read_b32 v159, a95
    v_accvgpr_read_b32 v192, a96
    v_accvgpr_read_b32 v193, a97
    v_accvgpr_read_b32 v194, a98
    v_accvgpr_read_b32 v195, a99
    ds_write_b128 v237, a[20:23] offset:5120
    v_accvgpr_read_b32 v196, a100
    v_accvgpr_read_b32 v197, a101
    v_accvgpr_read_b32 v198, a102
    v_accvgpr_read_b32 v199, a103
    v_accvgpr_read_b32 v200, a104
    v_accvgpr_read_b32 v201, a105
    ds_write_b128 v237, a[24:27] offset:6144
    v_accvgpr_read_b32 v202, a106
    v_accvgpr_read_b32 v203, a107
    v_accvgpr_read_b32 v204, a108
    v_accvgpr_read_b32 v205, a109
    v_accvgpr_read_b32 v206, a110
    v_accvgpr_read_b32 v207, a111
    ds_write_b128 v237, a[28:31] offset:7168
    v_accvgpr_read_b32 v248, a112
    v_accvgpr_read_b32 v249, a113
    v_accvgpr_read_b32 v250, a114
    v_accvgpr_read_b32 v251, a115
    v_accvgpr_read_b32 v252, a116
    v_accvgpr_read_b32 v253, a117
    ds_write_b128 v237, a[32:35] offset:8192
    v_accvgpr_read_b32 v254, a118
    v_accvgpr_read_b32 v255, a119
    v_accvgpr_read_b32 v224, a120
    v_accvgpr_read_b32 v225, a121
    v_accvgpr_read_b32 v226, a122
    v_accvgpr_read_b32 v227, a123
    ds_write_b128 v237, a[36:39] offset:9216
    v_accvgpr_read_b32 v228, a124
    v_accvgpr_read_b32 v229, a125
    v_accvgpr_read_b32 v230, a126
    v_accvgpr_read_b32 v231, a127
    v_pk_mul_f32 v[128:129], v[128:129], v[216:217] op_sel_hi:[1,0]
    v_pk_mul_f32 v[130:131], v[130:131], v[216:217] op_sel_hi:[1,0]
    ds_write_b128 v237, a[40:43] offset:10240
    v_pk_mul_f32 v[132:133], v[132:133], v[216:217] op_sel:[0,1] op_sel_hi:[1,1]
    v_pk_mul_f32 v[134:135], v[134:135], v[216:217] op_sel:[0,1] op_sel_hi:[1,1]
    v_pk_mul_f32 v[136:137], v[136:137], v[218:219] op_sel_hi:[1,0]
    v_pk_mul_f32 v[138:139], v[138:139], v[218:219] op_sel_hi:[1,0]
    v_pk_mul_f32 v[140:141], v[140:141], v[218:219] op_sel:[0,1] op_sel_hi:[1,1]
    v_pk_mul_f32 v[142:143], v[142:143], v[218:219] op_sel:[0,1] op_sel_hi:[1,1]
    ds_write_b128 v237, a[44:47] offset:11264
    v_pk_mul_f32 v[144:145], v[144:145], v[216:217] op_sel_hi:[1,0]
    v_pk_mul_f32 v[146:147], v[146:147], v[216:217] op_sel_hi:[1,0]
    v_pk_mul_f32 v[148:149], v[148:149], v[216:217] op_sel:[0,1] op_sel_hi:[1,1]
    v_pk_mul_f32 v[150:151], v[150:151], v[216:217] op_sel:[0,1] op_sel_hi:[1,1]
    v_pk_mul_f32 v[152:153], v[152:153], v[218:219] op_sel_hi:[1,0]
    v_pk_mul_f32 v[154:155], v[154:155], v[218:219] op_sel_hi:[1,0]
    ds_write_b128 v237, a[48:51] offset:12288
    v_pk_mul_f32 v[156:157], v[156:157], v[218:219] op_sel:[0,1] op_sel_hi:[1,1]
    v_pk_mul_f32 v[158:159], v[158:159], v[218:219] op_sel:[0,1] op_sel_hi:[1,1]
    v_pk_mul_f32 v[192:193], v[192:193], v[216:217] op_sel_hi:[1,0]
    v_pk_mul_f32 v[194:195], v[194:195], v[216:217] op_sel_hi:[1,0]
    v_pk_mul_f32 v[196:197], v[196:197], v[216:217] op_sel:[0,1] op_sel_hi:[1,1]
    v_pk_mul_f32 v[198:199], v[198:199], v[216:217] op_sel:[0,1] op_sel_hi:[1,1]
    ds_write_b128 v237, a[52:55] offset:13312
    v_pk_mul_f32 v[200:201], v[200:201], v[218:219] op_sel_hi:[1,0]
    v_pk_mul_f32 v[202:203], v[202:203], v[218:219] op_sel_hi:[1,0]
    v_pk_mul_f32 v[204:205], v[204:205], v[218:219] op_sel:[0,1] op_sel_hi:[1,1]
    v_pk_mul_f32 v[206:207], v[206:207], v[218:219] op_sel:[0,1] op_sel_hi:[1,1]
    v_pk_mul_f32 v[248:249], v[248:249], v[216:217] op_sel_hi:[1,0]
    v_pk_mul_f32 v[250:251], v[250:251], v[216:217] op_sel_hi:[1,0]
    ds_write_b128 v237, a[56:59] offset:14336
    v_pk_mul_f32 v[252:253], v[252:253], v[216:217] op_sel:[0,1] op_sel_hi:[1,1]
    v_pk_mul_f32 v[254:255], v[254:255], v[216:217] op_sel:[0,1] op_sel_hi:[1,1]
    v_pk_mul_f32 v[224:225], v[224:225], v[218:219] op_sel_hi:[1,0]
    v_pk_mul_f32 v[226:227], v[226:227], v[218:219] op_sel_hi:[1,0]
    v_pk_mul_f32 v[228:229], v[228:229], v[218:219] op_sel:[0,1] op_sel_hi:[1,1]
    v_pk_mul_f32 v[230:231], v[230:231], v[218:219] op_sel:[0,1] op_sel_hi:[1,1]
    ds_write_b128 v237, a[60:63] offset:15360
    s_waitcnt lgkmcnt(0)
    s_barrier
    ds_read_b128 v[96:99], v238 offset:0
    ds_read_b128 v[112:115], v238 offset:4096
    ds_read_b128 v[100:103], v238 offset:1024
    ds_read_b128 v[116:119], v238 offset:5120
    ds_read_b128 v[104:107], v238 offset:2048
    ds_read_b128 v[120:123], v238 offset:6144
    ds_read_b128 v[108:111], v238 offset:3072
    ds_read_b128 v[124:127], v238 offset:7168
    ds_read_b128 v[32:35], v238 offset:8192
    ds_read_b128 v[184:187], v238 offset:12288
    ds_read_b128 v[36:39], v238 offset:9216
    ds_read_b128 v[188:191], v238 offset:13312
    ds_read_b128 v[40:43], v238 offset:10240
    ds_read_b128 v[208:211], v238 offset:14336
    ds_read_b128 v[240:243], v238 offset:11264
    ds_read_b128 v[212:215], v238 offset:15360
    s_waitcnt lgkmcnt(14)
    v_pk_fma_f32 v[128:129], v[96:97], v[220:221], v[128:129] op_sel_hi:[1,0,1]
    v_pk_fma_f32 v[130:131], v[98:99], v[220:221], v[130:131] op_sel_hi:[1,0,1]
    v_pk_fma_f32 v[144:145], v[112:113], v[220:221], v[144:145] op_sel_hi:[1,0,1]
    v_pk_fma_f32 v[146:147], v[114:115], v[220:221], v[146:147] op_sel_hi:[1,0,1]
    v_cvt_pk_bf16_f32 v4, v128, v129
    v_cvt_pk_bf16_f32 v5, v130, v131
    v_cvt_pk_bf16_f32 v6, v144, v145
    v_cvt_pk_bf16_f32 v7, v146, v147
    buffer_store_dwordx4 v[4:7], v245, s[52:55], s16 offen sc1
    s_waitcnt lgkmcnt(12)
    v_pk_fma_f32 v[132:133], v[100:101], v[220:221], v[132:133] op_sel:[0,1,0] op_sel_hi:[1,1,1]
    v_pk_fma_f32 v[134:135], v[102:103], v[220:221], v[134:135] op_sel:[0,1,0] op_sel_hi:[1,1,1]
    v_pk_fma_f32 v[148:149], v[116:117], v[220:221], v[148:149] op_sel:[0,1,0] op_sel_hi:[1,1,1]
    v_pk_fma_f32 v[150:151], v[118:119], v[220:221], v[150:151] op_sel:[0,1,0] op_sel_hi:[1,1,1]
    v_cvt_pk_bf16_f32 v8, v132, v133
    v_cvt_pk_bf16_f32 v9, v134, v135
    v_cvt_pk_bf16_f32 v10, v148, v149
    v_cvt_pk_bf16_f32 v11, v150, v151
    buffer_store_dwordx4 v[8:11], v246, s[52:55], s16 offen sc1
    s_waitcnt lgkmcnt(10)
    v_pk_fma_f32 v[136:137], v[104:105], v[222:223], v[136:137] op_sel_hi:[1,0,1]
    v_pk_fma_f32 v[138:139], v[106:107], v[222:223], v[138:139] op_sel_hi:[1,0,1]
    v_pk_fma_f32 v[152:153], v[120:121], v[222:223], v[152:153] op_sel_hi:[1,0,1]
    v_pk_fma_f32 v[154:155], v[122:123], v[222:223], v[154:155] op_sel_hi:[1,0,1]
    v_cvt_pk_bf16_f32 v12, v136, v137
    v_cvt_pk_bf16_f32 v13, v138, v139
    v_cvt_pk_bf16_f32 v14, v152, v153
    v_cvt_pk_bf16_f32 v15, v154, v155
    buffer_store_dwordx4 v[12:15], v245, s[52:55], s17 offen sc1
    s_waitcnt lgkmcnt(8)
    v_pk_fma_f32 v[140:141], v[108:109], v[222:223], v[140:141] op_sel:[0,1,0] op_sel_hi:[1,1,1]
    v_pk_fma_f32 v[142:143], v[110:111], v[222:223], v[142:143] op_sel:[0,1,0] op_sel_hi:[1,1,1]
    v_pk_fma_f32 v[156:157], v[124:125], v[222:223], v[156:157] op_sel:[0,1,0] op_sel_hi:[1,1,1]
    v_pk_fma_f32 v[158:159], v[126:127], v[222:223], v[158:159] op_sel:[0,1,0] op_sel_hi:[1,1,1]
    v_cvt_pk_bf16_f32 v16, v140, v141
    v_cvt_pk_bf16_f32 v17, v142, v143
    v_cvt_pk_bf16_f32 v18, v156, v157
    v_cvt_pk_bf16_f32 v19, v158, v159
    buffer_store_dwordx4 v[16:19], v246, s[52:55], s17 offen sc1
    s_waitcnt lgkmcnt(6)
    v_pk_fma_f32 v[192:193], v[32:33], v[220:221], v[192:193] op_sel_hi:[1,0,1]
    v_pk_fma_f32 v[194:195], v[34:35], v[220:221], v[194:195] op_sel_hi:[1,0,1]
    v_pk_fma_f32 v[248:249], v[184:185], v[220:221], v[248:249] op_sel_hi:[1,0,1]
    v_pk_fma_f32 v[250:251], v[186:187], v[220:221], v[250:251] op_sel_hi:[1,0,1]
    v_cvt_pk_bf16_f32 v20, v192, v193
    v_cvt_pk_bf16_f32 v21, v194, v195
    v_cvt_pk_bf16_f32 v22, v248, v249
    v_cvt_pk_bf16_f32 v23, v250, v251
    buffer_store_dwordx4 v[20:23], v245, s[52:55], s18 offen sc1
    s_waitcnt lgkmcnt(4)
    v_pk_fma_f32 v[196:197], v[36:37], v[220:221], v[196:197] op_sel:[0,1,0] op_sel_hi:[1,1,1]
    v_pk_fma_f32 v[198:199], v[38:39], v[220:221], v[198:199] op_sel:[0,1,0] op_sel_hi:[1,1,1]
    v_pk_fma_f32 v[252:253], v[188:189], v[220:221], v[252:253] op_sel:[0,1,0] op_sel_hi:[1,1,1]
    v_pk_fma_f32 v[254:255], v[190:191], v[220:221], v[254:255] op_sel:[0,1,0] op_sel_hi:[1,1,1]
    v_cvt_pk_bf16_f32 v24, v196, v197
    v_cvt_pk_bf16_f32 v25, v198, v199
    v_cvt_pk_bf16_f32 v26, v252, v253
    v_cvt_pk_bf16_f32 v27, v254, v255
    buffer_store_dwordx4 v[24:27], v246, s[52:55], s18 offen sc1
    s_waitcnt lgkmcnt(2)
    v_pk_fma_f32 v[200:201], v[40:41], v[222:223], v[200:201] op_sel_hi:[1,0,1]
    v_pk_fma_f32 v[202:203], v[42:43], v[222:223], v[202:203] op_sel_hi:[1,0,1]
    v_pk_fma_f32 v[224:225], v[208:209], v[222:223], v[224:225] op_sel_hi:[1,0,1]
    v_pk_fma_f32 v[226:227], v[210:211], v[222:223], v[226:227] op_sel_hi:[1,0,1]
    v_cvt_pk_bf16_f32 v28, v200, v201
    v_cvt_pk_bf16_f32 v29, v202, v203
    v_cvt_pk_bf16_f32 v30, v224, v225
    v_cvt_pk_bf16_f32 v31, v226, v227
    buffer_store_dwordx4 v[28:31], v245, s[52:55], s19 offen sc1
    s_waitcnt lgkmcnt(0)
    v_pk_fma_f32 v[204:205], v[240:241], v[222:223], v[204:205] op_sel:[0,1,0] op_sel_hi:[1,1,1]
    v_pk_fma_f32 v[206:207], v[242:243], v[222:223], v[206:207] op_sel:[0,1,0] op_sel_hi:[1,1,1]
    v_pk_fma_f32 v[228:229], v[212:213], v[222:223], v[228:229] op_sel:[0,1,0] op_sel_hi:[1,1,1]
    v_pk_fma_f32 v[230:231], v[214:215], v[222:223], v[230:231] op_sel:[0,1,0] op_sel_hi:[1,1,1]
    v_cvt_pk_bf16_f32 v44, v204, v205
    v_cvt_pk_bf16_f32 v45, v206, v207
    v_cvt_pk_bf16_f32 v46, v228, v229
    v_cvt_pk_bf16_f32 v47, v230, v231
    buffer_store_dwordx4 v[44:47], v246, s[52:55], s19 offen sc1
L_att_done:
    v_add_u32 v4, 131072, v50
    v_add_u32 v5, 131072, v51
    v_add_u32 v6, 131072, v52
    v_add_u32 v7, 131072, v53
    v_add_u32 v8, 131072, v54
    s_lshl_b32 s9, s76, 17
    s_add_u32 s9, s9, 60817408
    s_add_u32 s9, s9, s74
    s_lshl_b32 s22, s64, 13
    s_add_u32 s22, s22, s9
    s_lshl_b32 s23, s64, 15
    s_add_u32 s23, s23, s9
    s_lshl_b32 s9, s5, 2
    s_lshl_b32 s8, s92, 8
    s_add_u32 s8, s8, s9
    s_add_u32 s8, s8, 79706112
    s_add_u32 m0, s74, 0
    s_nop 0
    buffer_load_dwordx4 v48, s[44:47], s70 offen lds
    buffer_load_dwordx4 v49, s[44:47], s70 offen offset:1024 lds
    s_add_u32 s70, s70, 32768
    s_add_u32 m0, s74, 16384
    s_nop 0
    buffer_load_dwordx4 v48, s[44:47], s70 offen lds
    buffer_load_dwordx4 v49, s[44:47], s70 offen offset:1024 lds
    s_add_u32 s70, s70, 32768
    s_add_u32 m0, s74, 65536
    s_nop 0
    buffer_load_dwordx4 v48, s[44:47], s70 offen lds
    buffer_load_dwordx4 v49, s[44:47], s70 offen offset:1024 lds
    s_add_u32 s70, s70, 32768
    s_add_u32 m0, s74, 81920
    s_nop 0
    buffer_load_dwordx4 v48, s[44:47], s70 offen lds
    buffer_load_dwordx4 v49, s[44:47], s70 offen offset:1024 lds
    s_add_u32 s70, s70, 32768
    s_waitcnt vmcnt(8)
    s_barrier
    s_cmp_lg_u32 s4, 0
    s_cbranch_scc1 L_sigB
    s_mov_b64 exec, 1
    v_mov_b32 v3, 1
    buffer_store_dword v3, off, s[52:55], s8 sc1
    s_mov_b64 exec, -1
L_sigB:
    s_mov_b32 s100, 0x40000
L_poll3:
    buffer_load_dword v3, v55, s[52:55], s78 offen sc1
    s_sub_u32 s100, s100, 1
    s_waitcnt vmcnt(0)
    v_cmp_eq_u32 vcc, 0, v3
    s_cbranch_vccz L_poll3_ok
    s_cmp_lg_u32 s100, 0
    s_cbranch_scc1 L_poll3
L_poll3_ok:
    s_add_u32 m0, s74, 8192
    s_nop 0
    buffer_load_dwordx4 v2, s[52:55], s69 offen sc1 lds
    buffer_load_dwordx4 v2, s[52:55], s69 offen offset:1024 sc1 lds
    s_add_u32 s69, s69, 8192
    s_add_u32 m0, s74, 24576
    s_nop 0
    buffer_load_dwordx4 v2, s[52:55], s69 offen sc1 lds
    buffer_load_dwordx4 v2, s[52:55], s69 offen offset:1024 sc1 lds
    s_add_u32 s69, s69, 8192
    s_add_u32 m0, s74, 73728
    s_nop 0
    buffer_load_dwordx4 v2, s[52:55], s69 offen sc1 lds
    buffer_load_dwordx4 v2, s[52:55], s69 offen offset:1024 sc1 lds
    s_add_u32 s69, s69, 8192
    s_add_u32 m0, s74, 90112
    s_nop 0
    buffer_load_dwordx4 v2, s[52:55], s69 offen sc1 lds
    buffer_load_dwordx4 v2, s[52:55], s69 offen offset:1024 sc1 lds
    s_add_u32 s69, s69, 8192
    s_waitcnt vmcnt(4)
    s_barrier
    ds_read_b128 a[16:19], v54 offset:8192
    ds_read_b128 a[20:23], v54 offset:9216
    ds_read_b128 a[24:27], v54 offset:10240
    ds_read_b128 a[28:31], v54 offset:11264
    ds_read_b64_tr_b16 a[0:1], v50 offset:0
    ds_read_b64_tr_b16 a[2:3], v50 offset:4096
    ds_read_b64_tr_b16 a[4:5], v51 offset:0
    ds_read_b64_tr_b16 a[6:7], v51 offset:4096
    ds_read_b64_tr_b16 a[8:9], v52 offset:0
    ds_read_b64_tr_b16 a[10:11], v52 offset:4096
    ds_read_b64_tr_b16 a[12:13], v53 offset:0
    ds_read_b64_tr_b16 a[14:15], v53 offset:4096
    s_add_u32 m0, s74, 131072
    s_nop 0
    buffer_load_dwordx4 v48, s[44:47], s70 offen lds
    buffer_load_dwordx4 v49, s[44:47], s70 offen offset:1024 lds
    s_add_u32 s70, s70, 32768
    s_add_u32 m0, s74, 139264
    s_nop 0
    buffer_load_dwordx4 v2, s[52:55], s69 offen sc1 lds
    buffer_load_dwordx4 v2, s[52:55], s69 offen offset:1024 sc1 lds
    s_add_u32 s69, s69, 8192
    s_add_u32 m0, s74, 147456
    s_nop 0
    buffer_load_dwordx4 v48, s[44:47], s70 offen lds
    buffer_load_dwordx4 v49, s[44:47], s70 offen offset:1024 lds
    s_add_u32 s70, s70, 32768
    s_add_u32 m0, s74, 155648
    s_nop 0
    buffer_load_dwordx4 v2, s[52:55], s69 offen sc1 lds
    buffer_load_dwordx4 v2, s[52:55], s69 offen offset:1024 sc1 lds
    s_add_u32 s69, s69, 8192
    s_add_u32 m0, s74, 32768
    s_nop 0
    buffer_load_dwordx4 v48, s[44:47], s70 offen lds
    buffer_load_dwordx4 v49, s[44:47], s70 offen offset:1024 lds
    s_add_u32 s70, s70, 32768
    s_add_u32 m0, s74, 40960
    s_nop 0
    buffer_load_dwordx4 v2, s[52:55], s69 offen sc1 lds
    buffer_load_dwordx4 v2, s[52:55], s69 offen offset:1024 sc1 lds
    s_add_u32 s69, s69, 8192
    s_add_u32 m0, s74, 49152
    s_nop 0
    buffer_load_dwordx4 v48, s[44:47], s70 offen lds
    buffer_load_dwordx4 v49, s[44:47], s70 offen offset:1024 lds
    s_add_u32 s70, s70, 32768
    s_add_u32 m0, s74, 57344
    s_nop 0
    buffer_load_dwordx4 v2, s[52:55], s69 offen sc1 lds
    buffer_load_dwordx4 v2, s[52:55], s69 offen offset:1024 sc1 lds
    s_add_u32 s69, s69, 8192
    s_add_u32 m0, s74, 98304
    s_nop 0
    buffer_load_dwordx4 v48, s[44:47], s70 offen lds
    buffer_load_dwordx4 v49, s[44:47], s70 offen offset:1024 lds
    s_add_u32 s70, s70, 32768
    s_add_u32 m0, s74, 106496
    s_nop 0
    buffer_load_dwordx4 v2, s[52:55], s69 offen sc1 lds
    buffer_load_dwordx4 v2, s[52:55], s69 offen offset:1024 sc1 lds
    s_add_u32 s69, s69, 8192
    s_add_u32 m0, s74, 114688
    s_nop 0
    buffer_load_dwordx4 v48, s[44:47], s70 offen lds
    buffer_load_dwordx4 v49, s[44:47], s70 offen offset:1024 lds
    s_add_u32 s70, s70, 32768
    s_add_u32 m0, s74, 122880
    s_nop 0
    buffer_load_dwordx4 v2, s[52:55], s69 offen sc1 lds
    buffer_load_dwordx4 v2, s[52:55], s69 offen offset:1024 sc1 lds
    s_add_u32 s69, s69, 8192
    s_mov_b32 s73, 3
    s_waitcnt lgkmcnt(0)
    v_mfma_f32_16x16x32_bf16 v[64:67], a[0:3], a[16:19], 0
    v_mfma_f32_16x16x32_bf16 v[80:83], a[0:3], a[20:23], 0
    ds_read_b128 a[48:51], v54 offset:24576
    v_mfma_f32_16x16x32_bf16 v[96:99], a[0:3], a[24:27], 0
    ds_read_b128 a[52:55], v54 offset:25600
    v_mfma_f32_16x16x32_bf16 v[112:115], a[0:3], a[28:31], 0
    ds_read_b128 a[56:59], v54 offset:26624
    v_mfma_f32_16x16x32_bf16 v[116:119], a[4:7], a[28:31], 0
    ds_read_b128 a[60:63], v54 offset:27648
    v_mfma_f32_16x16x32_bf16 v[100:103], a[4:7], a[24:27], 0
    ds_read_b64_tr_b16 a[32:33], v50 offset:16384
    v_mfma_f32_16x16x32_bf16 v[84:87], a[4:7], a[20:23], 0
    ds_read_b64_tr_b16 a[34:35], v50 offset:20480
    v_mfma_f32_16x16x32_bf16 v[68:71], a[4:7], a[16:19], 0
    ds_read_b64_tr_b16 a[36:37], v51 offset:16384
    v_mfma_f32_16x16x32_bf16 v[72:75], a[8:11], a[16:19], 0
    ds_read_b64_tr_b16 a[38:39], v51 offset:20480
    v_mfma_f32_16x16x32_bf16 v[88:91], a[8:11], a[20:23], 0
    ds_read_b64_tr_b16 a[40:41], v52 offset:16384
    v_mfma_f32_16x16x32_bf16 v[104:107], a[8:11], a[24:27], 0
    ds_read_b64_tr_b16 a[42:43], v52 offset:20480
    v_mfma_f32_16x16x32_bf16 v[120:123], a[8:11], a[28:31], 0
    ds_read_b64_tr_b16 a[44:45], v53 offset:16384
    v_mfma_f32_16x16x32_bf16 v[124:127], a[12:15], a[28:31], 0
    ds_read_b64_tr_b16 a[46:47], v53 offset:20480
    v_mfma_f32_16x16x32_bf16 v[108:111], a[12:15], a[24:27], 0
    v_mfma_f32_16x16x32_bf16 v[92:95], a[12:15], a[20:23], 0
    v_mfma_f32_16x16x32_bf16 v[76:79], a[12:15], a[16:19], 0
    s_waitcnt lgkmcnt(6)
L_p3loop:
    s_nop 0
    v_mfma_f32_16x16x32_bf16 v[64:67], a[32:35], a[48:51], v[64:67]
    s_nop 0
    s_add_u32 m0, s74, 0
    v_mfma_f32_16x16x32_bf16 v[80:83], a[32:35], a[52:55], v[80:83]
    v_mfma_f32_16x16x32_bf16 v[96:99], a[32:35], a[56:59], v[96:99]
    s_waitcnt vmcnt(24) lgkmcnt(0)
    s_barrier
    buffer_load_dwordx4 v48, s[44:47], s70 offen lds
    v_mfma_f32_16x16x32_bf16 v[112:115], a[32:35], a[60:63], v[112:115]
    ds_read_b128 a[16:19], v60 offset:8192
    v_mfma_f32_16x16x32_bf16 v[116:119], a[36:39], a[60:63], v[116:119]
    ds_read_b128 a[20:23], v60 offset:9216
    v_mfma_f32_16x16x32_bf16 v[100:103], a[36:39], a[56:59], v[100:103]
    ds_read_b128 a[24:27], v60 offset:10240
    v_mfma_f32_16x16x32_bf16 v[84:87], a[36:39], a[52:55], v[84:87]
    buffer_load_dwordx4 v49, s[44:47], s70 offen offset:1024 lds
    v_mfma_f32_16x16x32_bf16 v[68:71], a[36:39], a[48:51], v[68:71]
    s_add_u32 s70, s70, 32768
    ds_read_b128 a[28:31], v60 offset:11264
    v_mfma_f32_16x16x32_bf16 v[72:75], a[40:43], a[48:51], v[72:75]
    s_add_u32 m0, s74, 8192
    ds_read_b64_tr_b16 a[0:1], v56 offset:0
    ds_read_b64_tr_b16 a[2:3], v56 offset:4096
    v_mfma_f32_16x16x32_bf16 v[88:91], a[40:43], a[52:55], v[88:91]
    ds_read_b64_tr_b16 a[4:5], v57 offset:0
    v_mfma_f32_16x16x32_bf16 v[104:107], a[40:43], a[56:59], v[104:107]
    buffer_load_dwordx4 v2, s[52:55], s69 offen sc1 lds
    v_mfma_f32_16x16x32_bf16 v[120:123], a[40:43], a[60:63], v[120:123]
    ds_read_b64_tr_b16 a[6:7], v57 offset:4096
    v_mfma_f32_16x16x32_bf16 v[124:127], a[44:47], a[60:63], v[124:127]
    ds_read_b64_tr_b16 a[8:9], v58 offset:0
    v_mfma_f32_16x16x32_bf16 v[108:111], a[44:47], a[56:59], v[108:111]
    ds_read_b64_tr_b16 a[10:11], v58 offset:4096
    v_mfma_f32_16x16x32_bf16 v[92:95], a[44:47], a[52:55], v[92:95]
    buffer_load_dwordx4 v2, s[52:55], s69 offen offset:1024 sc1 lds
    v_mfma_f32_16x16x32_bf16 v[76:79], a[44:47], a[48:51], v[76:79]
    s_nop 0
    s_waitcnt lgkmcnt(4)
    s_add_u32 s69, s69, 8192
    ds_read_b64_tr_b16 a[12:13], v59 offset:0
    v_mfma_f32_16x16x32_bf16 v[64:67], a[0:3], a[16:19], v[64:67]
    s_add_u32 m0, s74, 16384
    ds_read_b64_tr_b16 a[14:15], v59 offset:4096
    v_mfma_f32_16x16x32_bf16 v[80:83], a[0:3], a[20:23], v[80:83]
    ds_read_b128 a[48:51], v60 offset:24576
    v_mfma_f32_16x16x32_bf16 v[96:99], a[0:3], a[24:27], v[96:99]
    buffer_load_dwordx4 v48, s[44:47], s70 offen lds
    v_mfma_f32_16x16x32_bf16 v[112:115], a[0:3], a[28:31], v[112:115]
    s_nop 0
    s_waitcnt lgkmcnt(5)
    ds_read_b128 a[52:55], v60 offset:25600
    v_mfma_f32_16x16x32_bf16 v[116:119], a[4:7], a[28:31], v[116:119]
    ds_read_b128 a[56:59], v60 offset:26624
    v_mfma_f32_16x16x32_bf16 v[100:103], a[4:7], a[24:27], v[100:103]
    ds_read_b128 a[60:63], v60 offset:27648
    v_mfma_f32_16x16x32_bf16 v[84:87], a[4:7], a[20:23], v[84:87]
    buffer_load_dwordx4 v49, s[44:47], s70 offen offset:1024 lds
    v_mfma_f32_16x16x32_bf16 v[68:71], a[4:7], a[16:19], v[68:71]
    s_nop 0
    s_waitcnt lgkmcnt(6)
    s_add_u32 s70, s70, 32768
    ds_read_b64_tr_b16 a[32:33], v56 offset:16384
    v_mfma_f32_16x16x32_bf16 v[72:75], a[8:11], a[16:19], v[72:75]
    s_add_u32 m0, s74, 24576
    ds_read_b64_tr_b16 a[34:35], v56 offset:20480
    ds_read_b64_tr_b16 a[36:37], v57 offset:16384
    v_mfma_f32_16x16x32_bf16 v[88:91], a[8:11], a[20:23], v[88:91]
    ds_read_b64_tr_b16 a[38:39], v57 offset:20480
    v_mfma_f32_16x16x32_bf16 v[104:107], a[8:11], a[24:27], v[104:107]
    buffer_load_dwordx4 v2, s[52:55], s69 offen sc1 lds
    v_mfma_f32_16x16x32_bf16 v[120:123], a[8:11], a[28:31], v[120:123]
    s_nop 0
    s_waitcnt lgkmcnt(8)
    ds_read_b64_tr_b16 a[40:41], v58 offset:16384
    v_mfma_f32_16x16x32_bf16 v[124:127], a[12:15], a[28:31], v[124:127]
    ds_read_b64_tr_b16 a[42:43], v58 offset:20480
    v_mfma_f32_16x16x32_bf16 v[108:111], a[12:15], a[24:27], v[108:111]
    ds_read_b64_tr_b16 a[44:45], v59 offset:16384
    v_mfma_f32_16x16x32_bf16 v[92:95], a[12:15], a[20:23], v[92:95]
    buffer_load_dwordx4 v2, s[52:55], s69 offen offset:1024 sc1 lds
    v_mfma_f32_16x16x32_bf16 v[76:79], a[12:15], a[16:19], v[76:79]
    s_nop 0
    s_waitcnt lgkmcnt(5)
    s_add_u32 s69, s69, 8192
    ds_read_b64_tr_b16 a[46:47], v59 offset:20480
    v_mfma_f32_16x16x32_bf16 v[64:67], a[32:35], a[48:51], v[64:67]
    s_add_u32 m0, s74, 65536
    v_mfma_f32_16x16x32_bf16 v[80:83], a[32:35], a[52:55], v[80:83]
    v_mfma_f32_16x16x32_bf16 v[96:99], a[32:35], a[56:59], v[96:99]
    s_waitcnt vmcnt(24) lgkmcnt(0)
    s_barrier
    buffer_load_dwordx4 v48, s[44:47], s70 offen lds
    v_mfma_f32_16x16x32_bf16 v[112:115], a[32:35], a[60:63], v[112:115]
    ds_read_b128 a[16:19], v8 offset:8192
    v_mfma_f32_16x16x32_bf16 v[116:119], a[36:39], a[60:63], v[116:119]
    ds_read_b128 a[20:23], v8 offset:9216
    v_mfma_f32_16x16x32_bf16 v[100:103], a[36:39], a[56:59], v[100:103]
    ds_read_b128 a[24:27], v8 offset:10240
    v_mfma_f32_16x16x32_bf16 v[84:87], a[36:39], a[52:55], v[84:87]
    buffer_load_dwordx4 v49, s[44:47], s70 offen offset:1024 lds
    v_mfma_f32_16x16x32_bf16 v[68:71], a[36:39], a[48:51], v[68:71]
    s_add_u32 s70, s70, 32768
    ds_read_b128 a[28:31], v8 offset:11264
    v_mfma_f32_16x16x32_bf16 v[72:75], a[40:43], a[48:51], v[72:75]
    s_add_u32 m0, s74, 73728
    ds_read_b64_tr_b16 a[0:1], v4 offset:0
    ds_read_b64_tr_b16 a[2:3], v4 offset:4096
    v_mfma_f32_16x16x32_bf16 v[88:91], a[40:43], a[52:55], v[88:91]
    ds_read_b64_tr_b16 a[4:5], v5 offset:0
    v_mfma_f32_16x16x32_bf16 v[104:107], a[40:43], a[56:59], v[104:107]
    buffer_load_dwordx4 v2, s[52:55], s69 offen sc1 lds
    v_mfma_f32_16x16x32_bf16 v[120:123], a[40:43], a[60:63], v[120:123]
    ds_read_b64_tr_b16 a[6:7], v5 offset:4096
    v_mfma_f32_16x16x32_bf16 v[124:127], a[44:47], a[60:63], v[124:127]
    ds_read_b64_tr_b16 a[8:9], v6 offset:0
    v_mfma_f32_16x16x32_bf16 v[108:111], a[44:47], a[56:59], v[108:111]
    ds_read_b64_tr_b16 a[10:11], v6 offset:4096
    v_mfma_f32_16x16x32_bf16 v[92:95], a[44:47], a[52:55], v[92:95]
    buffer_load_dwordx4 v2, s[52:55], s69 offen offset:1024 sc1 lds
    v_mfma_f32_16x16x32_bf16 v[76:79], a[44:47], a[48:51], v[76:79]
    s_nop 0
    s_waitcnt lgkmcnt(4)
    s_add_u32 s69, s69, 8192
    ds_read_b64_tr_b16 a[12:13], v7 offset:0
    v_mfma_f32_16x16x32_bf16 v[64:67], a[0:3], a[16:19], v[64:67]
    s_add_u32 m0, s74, 81920
    ds_read_b64_tr_b16 a[14:15], v7 offset:4096
    v_mfma_f32_16x16x32_bf16 v[80:83], a[0:3], a[20:23], v[80:83]
    ds_read_b128 a[48:51], v8 offset:24576
    v_mfma_f32_16x16x32_bf16 v[96:99], a[0:3], a[24:27], v[96:99]
    buffer_load_dwordx4 v48, s[44:47], s70 offen lds
    v_mfma_f32_16x16x32_bf16 v[112:115], a[0:3], a[28:31], v[112:115]
    s_nop 0
    s_waitcnt lgkmcnt(5)
    ds_read_b128 a[52:55], v8 offset:25600
    v_mfma_f32_16x16x32_bf16 v[116:119], a[4:7], a[28:31], v[116:119]
    ds_read_b128 a[56:59], v8 offset:26624
    v_mfma_f32_16x16x32_bf16 v[100:103], a[4:7], a[24:27], v[100:103]
    ds_read_b128 a[60:63], v8 offset:27648
    v_mfma_f32_16x16x32_bf16 v[84:87], a[4:7], a[20:23], v[84:87]
    buffer_load_dwordx4 v49, s[44:47], s70 offen offset:1024 lds
    v_mfma_f32_16x16x32_bf16 v[68:71], a[4:7], a[16:19], v[68:71]
    s_nop 0
    s_waitcnt lgkmcnt(6)
    s_add_u32 s70, s70, 32768
    ds_read_b64_tr_b16 a[32:33], v4 offset:16384
    v_mfma_f32_16x16x32_bf16 v[72:75], a[8:11], a[16:19], v[72:75]
    s_add_u32 m0, s74, 90112
    ds_read_b64_tr_b16 a[34:35], v4 offset:20480
    ds_read_b64_tr_b16 a[36:37], v5 offset:16384
    v_mfma_f32_16x16x32_bf16 v[88:91], a[8:11], a[20:23], v[88:91]
    ds_read_b64_tr_b16 a[38:39], v5 offset:20480
    v_mfma_f32_16x16x32_bf16 v[104:107], a[8:11], a[24:27], v[104:107]
    buffer_load_dwordx4 v2, s[52:55], s69 offen sc1 lds
    v_mfma_f32_16x16x32_bf16 v[120:123], a[8:11], a[28:31], v[120:123]
    s_nop 0
    s_waitcnt lgkmcnt(8)
    ds_read_b64_tr_b16 a[40:41], v6 offset:16384
    v_mfma_f32_16x16x32_bf16 v[124:127], a[12:15], a[28:31], v[124:127]
    ds_read_b64_tr_b16 a[42:43], v6 offset:20480
    v_mfma_f32_16x16x32_bf16 v[108:111], a[12:15], a[24:27], v[108:111]
    ds_read_b64_tr_b16 a[44:45], v7 offset:16384
    v_mfma_f32_16x16x32_bf16 v[92:95], a[12:15], a[20:23], v[92:95]
    buffer_load_dwordx4 v2, s[52:55], s69 offen offset:1024 sc1 lds
    v_mfma_f32_16x16x32_bf16 v[76:79], a[12:15], a[16:19], v[76:79]
    s_nop 0
    s_waitcnt lgkmcnt(5)
    s_add_u32 s69, s69, 8192
    ds_read_b64_tr_b16 a[46:47], v7 offset:20480
    v_mfma_f32_16x16x32_bf16 v[64:67], a[32:35], a[48:51], v[64:67]
    s_add_u32 m0, s74, 131072
    v_mfma_f32_16x16x32_bf16 v[80:83], a[32:35], a[52:55], v[80:83]
    v_mfma_f32_16x16x32_bf16 v[96:99], a[32:35], a[56:59], v[96:99]
    s_waitcnt vmcnt(24) lgkmcnt(0)
    s_barrier
    buffer_load_dwordx4 v48, s[44:47], s70 offen lds
    v_mfma_f32_16x16x32_bf16 v[112:115], a[32:35], a[60:63], v[112:115]
    ds_read_b128 a[16:19], v54 offset:40960
    v_mfma_f32_16x16x32_bf16 v[116:119], a[36:39], a[60:63], v[116:119]
    ds_read_b128 a[20:23], v54 offset:41984
    v_mfma_f32_16x16x32_bf16 v[100:103], a[36:39], a[56:59], v[100:103]
    ds_read_b128 a[24:27], v54 offset:43008
    v_mfma_f32_16x16x32_bf16 v[84:87], a[36:39], a[52:55], v[84:87]
    buffer_load_dwordx4 v49, s[44:47], s70 offen offset:1024 lds
    v_mfma_f32_16x16x32_bf16 v[68:71], a[36:39], a[48:51], v[68:71]
    s_add_u32 s70, s70, 32768
    ds_read_b128 a[28:31], v54 offset:44032
    v_mfma_f32_16x16x32_bf16 v[72:75], a[40:43], a[48:51], v[72:75]
    s_add_u32 m0, s74, 139264
    ds_read_b64_tr_b16 a[0:1], v50 offset:32768
    ds_read_b64_tr_b16 a[2:3], v50 offset:36864
    v_mfma_f32_16x16x32_bf16 v[88:91], a[40:43], a[52:55], v[88:91]
    ds_read_b64_tr_b16 a[4:5], v51 offset:32768
    v_mfma_f32_16x16x32_bf16 v[104:107], a[40:43], a[56:59], v[104:107]
    buffer_load_dwordx4 v2, s[52:55], s69 offen sc1 lds
    v_mfma_f32_16x16x32_bf16 v[120:123], a[40:43], a[60:63], v[120:123]
    ds_read_b64_tr_b16 a[6:7], v51 offset:36864
    v_mfma_f32_16x16x32_bf16 v[124:127], a[44:47], a[60:63], v[124:127]
    ds_read_b64_tr_b16 a[8:9], v52 offset:32768
    v_mfma_f32_16x16x32_bf16 v[108:111], a[44:47], a[56:59], v[108:111]
    ds_read_b64_tr_b16 a[10:11], v52 offset:36864
    v_mfma_f32_16x16x32_bf16 v[92:95], a[44:47], a[52:55], v[92:95]
    buffer_load_dwordx4 v2, s[52:55], s69 offen offset:1024 sc1 lds
    v_mfma_f32_16x16x32_bf16 v[76:79], a[44:47], a[48:51], v[76:79]
    s_nop 0
    s_waitcnt lgkmcnt(4)
    s_add_u32 s69, s69, 8192
    ds_read_b64_tr_b16 a[12:13], v53 offset:32768
    v_mfma_f32_16x16x32_bf16 v[64:67], a[0:3], a[16:19], v[64:67]
    s_add_u32 m0, s74, 147456
    ds_read_b64_tr_b16 a[14:15], v53 offset:36864
    v_mfma_f32_16x16x32_bf16 v[80:83], a[0:3], a[20:23], v[80:83]
    ds_read_b128 a[48:51], v54 offset:57344
    v_mfma_f32_16x16x32_bf16 v[96:99], a[0:3], a[24:27], v[96:99]
    buffer_load_dwordx4 v48, s[44:47], s70 offen lds
    v_mfma_f32_16x16x32_bf16 v[112:115], a[0:3], a[28:31], v[112:115]
    s_nop 0
    s_waitcnt lgkmcnt(5)
    ds_read_b128 a[52:55], v54 offset:58368
    v_mfma_f32_16x16x32_bf16 v[116:119], a[4:7], a[28:31], v[116:119]
    ds_read_b128 a[56:59], v54 offset:59392
    v_mfma_f32_16x16x32_bf16 v[100:103], a[4:7], a[24:27], v[100:103]
    ds_read_b128 a[60:63], v54 offset:60416
    v_mfma_f32_16x16x32_bf16 v[84:87], a[4:7], a[20:23], v[84:87]
    buffer_load_dwordx4 v49, s[44:47], s70 offen offset:1024 lds
    v_mfma_f32_16x16x32_bf16 v[68:71], a[4:7], a[16:19], v[68:71]
    s_nop 0
    s_waitcnt lgkmcnt(6)
    s_add_u32 s70, s70, 32768
    ds_read_b64_tr_b16 a[32:33], v50 offset:49152
    v_mfma_f32_16x16x32_bf16 v[72:75], a[8:11], a[16:19], v[72:75]
    s_add_u32 m0, s74, 155648
    ds_read_b64_tr_b16 a[34:35], v50 offset:53248
    ds_read_b64_tr_b16 a[36:37], v51 offset:49152
    v_mfma_f32_16x16x32_bf16 v[88:91], a[8:11], a[20:23], v[88:91]
    ds_read_b64_tr_b16 a[38:39], v51 offset:53248
    v_mfma_f32_16x16x32_bf16 v[104:107], a[8:11], a[24:27], v[104:107]
    buffer_load_dwordx4 v2, s[52:55], s69 offen sc1 lds
    v_mfma_f32_16x16x32_bf16 v[120:123], a[8:11], a[28:31], v[120:123]
    s_nop 0
    s_waitcnt lgkmcnt(8)
    ds_read_b64_tr_b16 a[40:41], v52 offset:49152
    v_mfma_f32_16x16x32_bf16 v[124:127], a[12:15], a[28:31], v[124:127]
    ds_read_b64_tr_b16 a[42:43], v52 offset:53248
    v_mfma_f32_16x16x32_bf16 v[108:111], a[12:15], a[24:27], v[108:111]
    ds_read_b64_tr_b16 a[44:45], v53 offset:49152
    v_mfma_f32_16x16x32_bf16 v[92:95], a[12:15], a[20:23], v[92:95]
    buffer_load_dwordx4 v2, s[52:55], s69 offen offset:1024 sc1 lds
    v_mfma_f32_16x16x32_bf16 v[76:79], a[12:15], a[16:19], v[76:79]
    s_nop 0
    s_waitcnt lgkmcnt(5)
    s_add_u32 s69, s69, 8192
    ds_read_b64_tr_b16 a[46:47], v53 offset:53248
    v_mfma_f32_16x16x32_bf16 v[64:67], a[32:35], a[48:51], v[64:67]
    s_add_u32 m0, s74, 32768
    v_mfma_f32_16x16x32_bf16 v[80:83], a[32:35], a[52:55], v[80:83]
    v_mfma_f32_16x16x32_bf16 v[96:99], a[32:35], a[56:59], v[96:99]
    s_waitcnt vmcnt(24) lgkmcnt(0)
    s_barrier
    buffer_load_dwordx4 v48, s[44:47], s70 offen lds
    v_mfma_f32_16x16x32_bf16 v[112:115], a[32:35], a[60:63], v[112:115]
    ds_read_b128 a[16:19], v60 offset:40960
    v_mfma_f32_16x16x32_bf16 v[116:119], a[36:39], a[60:63], v[116:119]
    ds_read_b128 a[20:23], v60 offset:41984
    v_mfma_f32_16x16x32_bf16 v[100:103], a[36:39], a[56:59], v[100:103]
    ds_read_b128 a[24:27], v60 offset:43008
    v_mfma_f32_16x16x32_bf16 v[84:87], a[36:39], a[52:55], v[84:87]
    buffer_load_dwordx4 v49, s[44:47], s70 offen offset:1024 lds
    v_mfma_f32_16x16x32_bf16 v[68:71], a[36:39], a[48:51], v[68:71]
    s_add_u32 s70, s70, 32768
    ds_read_b128 a[28:31], v60 offset:44032
    v_mfma_f32_16x16x32_bf16 v[72:75], a[40:43], a[48:51], v[72:75]
    s_add_u32 m0, s74, 40960
    ds_read_b64_tr_b16 a[0:1], v56 offset:32768
    ds_read_b64_tr_b16 a[2:3], v56 offset:36864
    v_mfma_f32_16x16x32_bf16 v[88:91], a[40:43], a[52:55], v[88:91]
    ds_read_b64_tr_b16 a[4:5], v57 offset:32768
    v_mfma_f32_16x16x32_bf16 v[104:107], a[40:43], a[56:59], v[104:107]
    buffer_load_dwordx4 v2, s[52:55], s69 offen sc1 lds
    v_mfma_f32_16x16x32_bf16 v[120:123], a[40:43], a[60:63], v[120:123]
    ds_read_b64_tr_b16 a[6:7], v57 offset:36864
    v_mfma_f32_16x16x32_bf16 v[124:127], a[44:47], a[60:63], v[124:127]
    ds_read_b64_tr_b16 a[8:9], v58 offset:32768
    v_mfma_f32_16x16x32_bf16 v[108:111], a[44:47], a[56:59], v[108:111]
    ds_read_b64_tr_b16 a[10:11], v58 offset:36864
    v_mfma_f32_16x16x32_bf16 v[92:95], a[44:47], a[52:55], v[92:95]
    buffer_load_dwordx4 v2, s[52:55], s69 offen offset:1024 sc1 lds
    v_mfma_f32_16x16x32_bf16 v[76:79], a[44:47], a[48:51], v[76:79]
    s_nop 0
    s_waitcnt lgkmcnt(4)
    s_add_u32 s69, s69, 8192
    ds_read_b64_tr_b16 a[12:13], v59 offset:32768
    v_mfma_f32_16x16x32_bf16 v[64:67], a[0:3], a[16:19], v[64:67]
    s_add_u32 m0, s74, 49152
    ds_read_b64_tr_b16 a[14:15], v59 offset:36864
    v_mfma_f32_16x16x32_bf16 v[80:83], a[0:3], a[20:23], v[80:83]
    ds_read_b128 a[48:51], v60 offset:57344
    v_mfma_f32_16x16x32_bf16 v[96:99], a[0:3], a[24:27], v[96:99]
    buffer_load_dwordx4 v48, s[44:47], s70 offen lds
    v_mfma_f32_16x16x32_bf16 v[112:115], a[0:3], a[28:31], v[112:115]
    s_nop 0
    s_waitcnt lgkmcnt(5)
    ds_read_b128 a[52:55], v60 offset:58368
    v_mfma_f32_16x16x32_bf16 v[116:119], a[4:7], a[28:31], v[116:119]
    ds_read_b128 a[56:59], v60 offset:59392
    v_mfma_f32_16x16x32_bf16 v[100:103], a[4:7], a[24:27], v[100:103]
    ds_read_b128 a[60:63], v60 offset:60416
    v_mfma_f32_16x16x32_bf16 v[84:87], a[4:7], a[20:23], v[84:87]
    buffer_load_dwordx4 v49, s[44:47], s70 offen offset:1024 lds
    v_mfma_f32_16x16x32_bf16 v[68:71], a[4:7], a[16:19], v[68:71]
    s_nop 0
    s_waitcnt lgkmcnt(6)
    s_add_u32 s70, s70, 32768
    ds_read_b64_tr_b16 a[32:33], v56 offset:49152
    v_mfma_f32_16x16x32_bf16 v[72:75], a[8:11], a[16:19], v[72:75]
    s_add_u32 m0, s74, 57344
    ds_read_b64_tr_b16 a[34:35], v56 offset:53248
    ds_read_b64_tr_b16 a[36:37], v57 offset:49152
    v_mfma_f32_16x16x32_bf16 v[88:91], a[8:11], a[20:23], v[88:91]
    ds_read_b64_tr_b16 a[38:39], v57 offset:53248
    v_mfma_f32_16x16x32_bf16 v[104:107], a[8:11], a[24:27], v[104:107]
    buffer_load_dwordx4 v2, s[52:55], s69 offen sc1 lds
    v_mfma_f32_16x16x32_bf16 v[120:123], a[8:11], a[28:31], v[120:123]
    s_nop 0
    s_waitcnt lgkmcnt(8)
    ds_read_b64_tr_b16 a[40:41], v58 offset:49152
    v_mfma_f32_16x16x32_bf16 v[124:127], a[12:15], a[28:31], v[124:127]
    ds_read_b64_tr_b16 a[42:43], v58 offset:53248
    v_mfma_f32_16x16x32_bf16 v[108:111], a[12:15], a[24:27], v[108:111]
    ds_read_b64_tr_b16 a[44:45], v59 offset:49152
    v_mfma_f32_16x16x32_bf16 v[92:95], a[12:15], a[20:23], v[92:95]
    buffer_load_dwordx4 v2, s[52:55], s69 offen offset:1024 sc1 lds
    v_mfma_f32_16x16x32_bf16 v[76:79], a[12:15], a[16:19], v[76:79]
    s_nop 0
    s_waitcnt lgkmcnt(5)
    s_add_u32 s69, s69, 8192
    ds_read_b64_tr_b16 a[46:47], v59 offset:53248
    v_mfma_f32_16x16x32_bf16 v[64:67], a[32:35], a[48:51], v[64:67]
    s_add_u32 m0, s74, 98304
    v_mfma_f32_16x16x32_bf16 v[80:83], a[32:35], a[52:55], v[80:83]
    v_mfma_f32_16x16x32_bf16 v[96:99], a[32:35], a[56:59], v[96:99]
    s_waitcnt vmcnt(24) lgkmcnt(0)
    s_barrier
    buffer_load_dwordx4 v48, s[44:47], s70 offen lds
    v_mfma_f32_16x16x32_bf16 v[112:115], a[32:35], a[60:63], v[112:115]
    ds_read_b128 a[16:19], v54 offset:8192
    v_mfma_f32_16x16x32_bf16 v[116:119], a[36:39], a[60:63], v[116:119]
    ds_read_b128 a[20:23], v54 offset:9216
    v_mfma_f32_16x16x32_bf16 v[100:103], a[36:39], a[56:59], v[100:103]
    ds_read_b128 a[24:27], v54 offset:10240
    v_mfma_f32_16x16x32_bf16 v[84:87], a[36:39], a[52:55], v[84:87]
    buffer_load_dwordx4 v49, s[44:47], s70 offen offset:1024 lds
    v_mfma_f32_16x16x32_bf16 v[68:71], a[36:39], a[48:51], v[68:71]
    s_add_u32 s70, s70, 32768
    ds_read_b128 a[28:31], v54 offset:11264
    v_mfma_f32_16x16x32_bf16 v[72:75], a[40:43], a[48:51], v[72:75]
    s_add_u32 m0, s74, 106496
    ds_read_b64_tr_b16 a[0:1], v50 offset:0
    ds_read_b64_tr_b16 a[2:3], v50 offset:4096
    v_mfma_f32_16x16x32_bf16 v[88:91], a[40:43], a[52:55], v[88:91]
    ds_read_b64_tr_b16 a[4:5], v51 offset:0
    v_mfma_f32_16x16x32_bf16 v[104:107], a[40:43], a[56:59], v[104:107]
    buffer_load_dwordx4 v2, s[52:55], s69 offen sc1 lds
    v_mfma_f32_16x16x32_bf16 v[120:123], a[40:43], a[60:63], v[120:123]
    ds_read_b64_tr_b16 a[6:7], v51 offset:4096
    v_mfma_f32_16x16x32_bf16 v[124:127], a[44:47], a[60:63], v[124:127]
    ds_read_b64_tr_b16 a[8:9], v52 offset:0
    v_mfma_f32_16x16x32_bf16 v[108:111], a[44:47], a[56:59], v[108:111]
    ds_read_b64_tr_b16 a[10:11], v52 offset:4096
    v_mfma_f32_16x16x32_bf16 v[92:95], a[44:47], a[52:55], v[92:95]
    buffer_load_dwordx4 v2, s[52:55], s69 offen offset:1024 sc1 lds
    v_mfma_f32_16x16x32_bf16 v[76:79], a[44:47], a[48:51], v[76:79]
    s_nop 0
    s_waitcnt lgkmcnt(4)
    s_add_u32 s69, s69, 8192
    ds_read_b64_tr_b16 a[12:13], v53 offset:0
    v_mfma_f32_16x16x32_bf16 v[64:67], a[0:3], a[16:19], v[64:67]
    s_add_u32 m0, s74, 114688
    ds_read_b64_tr_b16 a[14:15], v53 offset:4096
    v_mfma_f32_16x16x32_bf16 v[80:83], a[0:3], a[20:23], v[80:83]
    ds_read_b128 a[48:51], v54 offset:24576
    v_mfma_f32_16x16x32_bf16 v[96:99], a[0:3], a[24:27], v[96:99]
    buffer_load_dwordx4 v48, s[44:47], s70 offen lds
    v_mfma_f32_16x16x32_bf16 v[112:115], a[0:3], a[28:31], v[112:115]
    s_nop 0
    s_waitcnt lgkmcnt(5)
    ds_read_b128 a[52:55], v54 offset:25600
    v_mfma_f32_16x16x32_bf16 v[116:119], a[4:7], a[28:31], v[116:119]
    ds_read_b128 a[56:59], v54 offset:26624
    v_mfma_f32_16x16x32_bf16 v[100:103], a[4:7], a[24:27], v[100:103]
    ds_read_b128 a[60:63], v54 offset:27648
    v_mfma_f32_16x16x32_bf16 v[84:87], a[4:7], a[20:23], v[84:87]
    buffer_load_dwordx4 v49, s[44:47], s70 offen offset:1024 lds
    v_mfma_f32_16x16x32_bf16 v[68:71], a[4:7], a[16:19], v[68:71]
    s_nop 0
    s_waitcnt lgkmcnt(6)
    s_add_u32 s70, s70, 32768
    ds_read_b64_tr_b16 a[32:33], v50 offset:16384
    v_mfma_f32_16x16x32_bf16 v[72:75], a[8:11], a[16:19], v[72:75]
    s_add_u32 m0, s74, 122880
    ds_read_b64_tr_b16 a[34:35], v50 offset:20480
    ds_read_b64_tr_b16 a[36:37], v51 offset:16384
    v_mfma_f32_16x16x32_bf16 v[88:91], a[8:11], a[20:23], v[88:91]
    ds_read_b64_tr_b16 a[38:39], v51 offset:20480
    v_mfma_f32_16x16x32_bf16 v[104:107], a[8:11], a[24:27], v[104:107]
    buffer_load_dwordx4 v2, s[52:55], s69 offen sc1 lds
    v_mfma_f32_16x16x32_bf16 v[120:123], a[8:11], a[28:31], v[120:123]
    s_nop 0
    s_waitcnt lgkmcnt(8)
    ds_read_b64_tr_b16 a[40:41], v52 offset:16384
    v_mfma_f32_16x16x32_bf16 v[124:127], a[12:15], a[28:31], v[124:127]
    ds_read_b64_tr_b16 a[42:43], v52 offset:20480
    v_mfma_f32_16x16x32_bf16 v[108:111], a[12:15], a[24:27], v[108:111]
    ds_read_b64_tr_b16 a[44:45], v53 offset:16384
    v_mfma_f32_16x16x32_bf16 v[92:95], a[12:15], a[20:23], v[92:95]
    buffer_load_dwordx4 v2, s[52:55], s69 offen offset:1024 sc1 lds
    v_mfma_f32_16x16x32_bf16 v[76:79], a[12:15], a[16:19], v[76:79]
    s_waitcnt lgkmcnt(5)
    s_add_u32 s69, s69, 8192
    ds_read_b64_tr_b16 a[46:47], v53 offset:20480
    s_sub_u32 s73, s73, 1
    s_cmp_lg_u32 s73, 0
    s_cbranch_scc1 L_p3loop
    v_mfma_f32_16x16x32_bf16 v[64:67], a[32:35], a[48:51], v[64:67]
    s_nop 0
    s_add_u32 m0, s74, 0
    v_mfma_f32_16x16x32_bf16 v[80:83], a[32:35], a[52:55], v[80:83]
    v_mfma_f32_16x16x32_bf16 v[96:99], a[32:35], a[56:59], v[96:99]
    s_waitcnt vmcnt(24) lgkmcnt(0)
    s_barrier
    buffer_load_dwordx4 v48, s[44:47], s70 offen lds
    v_mfma_f32_16x16x32_bf16 v[112:115], a[32:35], a[60:63], v[112:115]
    ds_read_b128 a[16:19], v60 offset:8192
    v_mfma_f32_16x16x32_bf16 v[116:119], a[36:39], a[60:63], v[116:119]
    ds_read_b128 a[20:23], v60 offset:9216
    v_mfma_f32_16x16x32_bf16 v[100:103], a[36:39], a[56:59], v[100:103]
    ds_read_b128 a[24:27], v60 offset:10240
    v_mfma_f32_16x16x32_bf16 v[84:87], a[36:39], a[52:55], v[84:87]
    buffer_load_dwordx4 v49, s[44:47], s70 offen offset:1024 lds
    v_mfma_f32_16x16x32_bf16 v[68:71], a[36:39], a[48:51], v[68:71]
    s_add_u32 s70, s70, 32768
    ds_read_b128 a[28:31], v60 offset:11264
    v_mfma_f32_16x16x32_bf16 v[72:75], a[40:43], a[48:51], v[72:75]
    s_add_u32 m0, s74, 8192
    ds_read_b64_tr_b16 a[0:1], v56 offset:0
    ds_read_b64_tr_b16 a[2:3], v56 offset:4096
    v_mfma_f32_16x16x32_bf16 v[88:91], a[40:43], a[52:55], v[88:91]
    ds_read_b64_tr_b16 a[4:5], v57 offset:0
    v_mfma_f32_16x16x32_bf16 v[104:107], a[40:43], a[56:59], v[104:107]
    buffer_load_dwordx4 v2, s[52:55], s69 offen sc1 lds
    v_mfma_f32_16x16x32_bf16 v[120:123], a[40:43], a[60:63], v[120:123]
    ds_read_b64_tr_b16 a[6:7], v57 offset:4096
    v_mfma_f32_16x16x32_bf16 v[124:127], a[44:47], a[60:63], v[124:127]
    ds_read_b64_tr_b16 a[8:9], v58 offset:0
    v_mfma_f32_16x16x32_bf16 v[108:111], a[44:47], a[56:59], v[108:111]
    ds_read_b64_tr_b16 a[10:11], v58 offset:4096
    v_mfma_f32_16x16x32_bf16 v[92:95], a[44:47], a[52:55], v[92:95]
    buffer_load_dwordx4 v2, s[52:55], s69 offen offset:1024 sc1 lds
    v_mfma_f32_16x16x32_bf16 v[76:79], a[44:47], a[48:51], v[76:79]
    s_nop 0
    s_waitcnt lgkmcnt(4)
    s_add_u32 s69, s69, 8192
    ds_read_b64_tr_b16 a[12:13], v59 offset:0
    v_mfma_f32_16x16x32_bf16 v[64:67], a[0:3], a[16:19], v[64:67]
    s_add_u32 m0, s74, 16384
    ds_read_b64_tr_b16 a[14:15], v59 offset:4096
    v_mfma_f32_16x16x32_bf16 v[80:83], a[0:3], a[20:23], v[80:83]
    ds_read_b128 a[48:51], v60 offset:24576
    v_mfma_f32_16x16x32_bf16 v[96:99], a[0:3], a[24:27], v[96:99]
    buffer_load_dwordx4 v48, s[44:47], s70 offen lds
    v_mfma_f32_16x16x32_bf16 v[112:115], a[0:3], a[28:31], v[112:115]
    s_nop 0
    s_waitcnt lgkmcnt(5)
    ds_read_b128 a[52:55], v60 offset:25600
    v_mfma_f32_16x16x32_bf16 v[116:119], a[4:7], a[28:31], v[116:119]
    ds_read_b128 a[56:59], v60 offset:26624
    v_mfma_f32_16x16x32_bf16 v[100:103], a[4:7], a[24:27], v[100:103]
    ds_read_b128 a[60:63], v60 offset:27648
    v_mfma_f32_16x16x32_bf16 v[84:87], a[4:7], a[20:23], v[84:87]
    buffer_load_dwordx4 v49, s[44:47], s70 offen offset:1024 lds
    v_mfma_f32_16x16x32_bf16 v[68:71], a[4:7], a[16:19], v[68:71]
    s_nop 0
    s_waitcnt lgkmcnt(6)
    s_add_u32 s70, s70, 32768
    ds_read_b64_tr_b16 a[32:33], v56 offset:16384
    v_mfma_f32_16x16x32_bf16 v[72:75], a[8:11], a[16:19], v[72:75]
    s_add_u32 m0, s74, 24576
    ds_read_b64_tr_b16 a[34:35], v56 offset:20480
    ds_read_b64_tr_b16 a[36:37], v57 offset:16384
    v_mfma_f32_16x16x32_bf16 v[88:91], a[8:11], a[20:23], v[88:91]
    ds_read_b64_tr_b16 a[38:39], v57 offset:20480
    v_mfma_f32_16x16x32_bf16 v[104:107], a[8:11], a[24:27], v[104:107]
    buffer_load_dwordx4 v2, s[52:55], s69 offen sc1 lds
    v_mfma_f32_16x16x32_bf16 v[120:123], a[8:11], a[28:31], v[120:123]
    s_nop 0
    s_waitcnt lgkmcnt(8)
    ds_read_b64_tr_b16 a[40:41], v58 offset:16384
    v_mfma_f32_16x16x32_bf16 v[124:127], a[12:15], a[28:31], v[124:127]
    ds_read_b64_tr_b16 a[42:43], v58 offset:20480
    v_mfma_f32_16x16x32_bf16 v[108:111], a[12:15], a[24:27], v[108:111]
    ds_read_b64_tr_b16 a[44:45], v59 offset:16384
    v_mfma_f32_16x16x32_bf16 v[92:95], a[12:15], a[20:23], v[92:95]
    buffer_load_dwordx4 v2, s[52:55], s69 offen offset:1024 sc1 lds
    v_mfma_f32_16x16x32_bf16 v[76:79], a[12:15], a[16:19], v[76:79]
    s_nop 0
    s_waitcnt lgkmcnt(5)
    s_add_u32 s69, s69, 8192
    ds_read_b64_tr_b16 a[46:47], v59 offset:20480
    v_mfma_f32_16x16x32_bf16 v[64:67], a[32:35], a[48:51], v[64:67]
    s_nop 0
    s_cmp_eq_u32 s64, 2
    s_cselect_b32 s70, 1073741824, s70
    s_cselect_b32 s69, 1073741824, s69
    s_add_u32 m0, s74, 65536
    v_mfma_f32_16x16x32_bf16 v[80:83], a[32:35], a[52:55], v[80:83]
    v_mfma_f32_16x16x32_bf16 v[96:99], a[32:35], a[56:59], v[96:99]
    s_waitcnt vmcnt(24) lgkmcnt(0)
    s_barrier
    buffer_load_dwordx4 v48, s[44:47], s70 offen lds
    v_mfma_f32_16x16x32_bf16 v[112:115], a[32:35], a[60:63], v[112:115]
    ds_read_b128 a[16:19], v8 offset:8192
    v_mfma_f32_16x16x32_bf16 v[116:119], a[36:39], a[60:63], v[116:119]
    ds_read_b128 a[20:23], v8 offset:9216
    v_mfma_f32_16x16x32_bf16 v[100:103], a[36:39], a[56:59], v[100:103]
    ds_read_b128 a[24:27], v8 offset:10240
    v_mfma_f32_16x16x32_bf16 v[84:87], a[36:39], a[52:55], v[84:87]
    buffer_load_dwordx4 v49, s[44:47], s70 offen offset:1024 lds
    v_mfma_f32_16x16x32_bf16 v[68:71], a[36:39], a[48:51], v[68:71]
    s_add_u32 s70, s70, 32768
    ds_read_b128 a[28:31], v8 offset:11264
    v_mfma_f32_16x16x32_bf16 v[72:75], a[40:43], a[48:51], v[72:75]
    s_add_u32 m0, s74, 73728
    ds_read_b64_tr_b16 a[0:1], v4 offset:0
    ds_read_b64_tr_b16 a[2:3], v4 offset:4096
    v_mfma_f32_16x16x32_bf16 v[88:91], a[40:43], a[52:55], v[88:91]
    ds_read_b64_tr_b16 a[4:5], v5 offset:0
    v_mfma_f32_16x16x32_bf16 v[104:107], a[40:43], a[56:59], v[104:107]
    buffer_load_dwordx4 v2, s[52:55], s69 offen sc1 lds
    v_mfma_f32_16x16x32_bf16 v[120:123], a[40:43], a[60:63], v[120:123]
    ds_read_b64_tr_b16 a[6:7], v5 offset:4096
    v_mfma_f32_16x16x32_bf16 v[124:127], a[44:47], a[60:63], v[124:127]
    ds_read_b64_tr_b16 a[8:9], v6 offset:0
    v_mfma_f32_16x16x32_bf16 v[108:111], a[44:47], a[56:59], v[108:111]
    ds_read_b64_tr_b16 a[10:11], v6 offset:4096
    v_mfma_f32_16x16x32_bf16 v[92:95], a[44:47], a[52:55], v[92:95]
    buffer_load_dwordx4 v2, s[52:55], s69 offen offset:1024 sc1 lds
    v_mfma_f32_16x16x32_bf16 v[76:79], a[44:47], a[48:51], v[76:79]
    s_nop 0
    s_waitcnt lgkmcnt(4)
    s_add_u32 s69, s69, 8192
    ds_read_b64_tr_b16 a[12:13], v7 offset:0
    v_mfma_f32_16x16x32_bf16 v[64:67], a[0:3], a[16:19], v[64:67]
    ds_read_b64_tr_b16 a[14:15], v7 offset:4096
    v_mfma_f32_16x16x32_bf16 v[80:83], a[0:3], a[20:23], v[80:83]
    ds_read_b128 a[48:51], v8 offset:24576
    v_mfma_f32_16x16x32_bf16 v[96:99], a[0:3], a[24:27], v[96:99]
    v_mfma_f32_16x16x32_bf16 v[112:115], a[0:3], a[28:31], v[112:115]
    s_nop 0
    s_waitcnt lgkmcnt(5)
    ds_read_b128 a[52:55], v8 offset:25600
    v_mfma_f32_16x16x32_bf16 v[116:119], a[4:7], a[28:31], v[116:119]
    ds_read_b128 a[56:59], v8 offset:26624
    v_mfma_f32_16x16x32_bf16 v[100:103], a[4:7], a[24:27], v[100:103]
    ds_read_b128 a[60:63], v8 offset:27648
    v_mfma_f32_16x16x32_bf16 v[84:87], a[4:7], a[20:23], v[84:87]
    v_mfma_f32_16x16x32_bf16 v[68:71], a[4:7], a[16:19], v[68:71]
    s_nop 0
    s_waitcnt lgkmcnt(6)
    ds_read_b64_tr_b16 a[32:33], v4 offset:16384
    v_mfma_f32_16x16x32_bf16 v[72:75], a[8:11], a[16:19], v[72:75]
    ds_read_b64_tr_b16 a[34:35], v4 offset:20480
    ds_read_b64_tr_b16 a[36:37], v5 offset:16384
    v_mfma_f32_16x16x32_bf16 v[88:91], a[8:11], a[20:23], v[88:91]
    ds_read_b64_tr_b16 a[38:39], v5 offset:20480
    v_mfma_f32_16x16x32_bf16 v[104:107], a[8:11], a[24:27], v[104:107]
    v_mfma_f32_16x16x32_bf16 v[120:123], a[8:11], a[28:31], v[120:123]
    s_nop 0
    s_waitcnt lgkmcnt(8)
    ds_read_b64_tr_b16 a[40:41], v6 offset:16384
    v_mfma_f32_16x16x32_bf16 v[124:127], a[12:15], a[28:31], v[124:127]
    ds_read_b64_tr_b16 a[42:43], v6 offset:20480
    v_mfma_f32_16x16x32_bf16 v[108:111], a[12:15], a[24:27], v[108:111]
    ds_read_b64_tr_b16 a[44:45], v7 offset:16384
    v_mfma_f32_16x16x32_bf16 v[92:95], a[12:15], a[20:23], v[92:95]
    v_mfma_f32_16x16x32_bf16 v[76:79], a[12:15], a[16:19], v[76:79]
    s_nop 0
    s_waitcnt lgkmcnt(5)
    ds_read_b64_tr_b16 a[46:47], v7 offset:20480
    v_mfma_f32_16x16x32_bf16 v[64:67], a[32:35], a[48:51], v[64:67]
    v_mfma_f32_16x16x32_bf16 v[80:83], a[32:35], a[52:55], v[80:83]
    v_mfma_f32_16x16x32_bf16 v[96:99], a[32:35], a[56:59], v[96:99]
    s_waitcnt vmcnt(20) lgkmcnt(0)
    s_barrier
    v_mfma_f32_16x16x32_bf16 v[112:115], a[32:35], a[60:63], v[112:115]
    ds_read_b128 a[16:19], v54 offset:40960
    v_mfma_f32_16x16x32_bf16 v[116:119], a[36:39], a[60:63], v[116:119]
    s_nop 0
    s_mov_b32 s44, s28
    ds_read_b128 a[20:23], v54 offset:41984
    v_mfma_f32_16x16x32_bf16 v[100:103], a[36:39], a[56:59], v[100:103]
    s_nop 0
    s_mov_b32 s45, s29
    ds_read_b128 a[24:27], v54 offset:43008
    v_mfma_f32_16x16x32_bf16 v[84:87], a[36:39], a[52:55], v[84:87]
    s_mov_b32 s46, 2097152
    v_lshlrev_b32_e64 v30, 3, v62
    v_lshl_add_u32 v31, v63, 10, v30
    v_mfma_f32_16x16x32_bf16 v[68:71], a[36:39], a[48:51], v[68:71]
    s_mov_b32 s47, 0x00020000
    ds_read_b128 a[28:31], v54 offset:44032
    v_and_b32_e64 v29, 3, v1
    v_mfma_f32_16x16x32_bf16 v[72:75], a[40:43], a[48:51], v[72:75]
    s_nop 0
    s_mov_b32 s60, s38
    ds_read_b64_tr_b16 a[0:1], v50 offset:32768
    ds_read_b64_tr_b16 a[2:3], v50 offset:36864
    v_mfma_f32_16x16x32_bf16 v[88:91], a[40:43], a[52:55], v[88:91]
    s_mov_b32 s61, s39
    ds_read_b64_tr_b16 a[4:5], v51 offset:32768
    v_lshlrev_b32 v29, 2, v29
    v_mfma_f32_16x16x32_bf16 v[104:107], a[40:43], a[56:59], v[104:107]
    s_mov_b32 s62, 2097152
    v_and_b32 v27, 1, v62
    v_lshlrev_b32 v27, 5, v27
    v_mfma_f32_16x16x32_bf16 v[120:123], a[40:43], a[60:63], v[120:123]
    s_mov_b32 s63, 0x00020000
    ds_read_b64_tr_b16 a[6:7], v51 offset:36864
    v_lshl_add_u32 v28, v63, 10, v27
    v_mfma_f32_16x16x32_bf16 v[124:127], a[44:47], a[60:63], v[124:127]
    s_lshl_b32 s12, s65, 7
    ds_read_b64_tr_b16 a[8:9], v52 offset:32768
    v_lshrrev_b32 v27, 1, v62
    v_mfma_f32_16x16x32_bf16 v[108:111], a[44:47], a[56:59], v[108:111]
    s_nop 0
    s_lshl_b32 s13, s7, 6
    ds_read_b64_tr_b16 a[10:11], v52 offset:36864
    v_lshl_add_u32 v28, v27, 4, v28
    v_mfma_f32_16x16x32_bf16 v[92:95], a[44:47], a[52:55], v[92:95]
    s_nop 0
    s_add_u32 s12, s12, s13
    v_mfma_f32_16x16x32_bf16 v[76:79], a[44:47], a[48:51], v[76:79]
    s_waitcnt lgkmcnt(4)
    s_lshl_b32 s13, s64, 4
    ds_read_b64_tr_b16 a[12:13], v53 offset:32768
    v_mfma_f32_16x16x32_bf16 v[64:67], a[0:3], a[16:19], v[64:67]
    s_nop 0
    s_add_u32 s12, s12, s13
    ds_read_b64_tr_b16 a[14:15], v53 offset:36864
    v_mfma_f32_16x16x32_bf16 v[80:83], a[0:3], a[20:23], v[80:83]
    s_nop 0
    s_lshl_b32 s12, s12, 10
    ds_read_b128 a[48:51], v54 offset:57344
    v_mfma_f32_16x16x32_bf16 v[96:99], a[0:3], a[24:27], v[96:99]
    s_nop 0
    s_lshl_b32 s13, s66, 8
    v_mfma_f32_16x16x32_bf16 v[112:115], a[0:3], a[28:31], v[112:115]
    s_waitcnt lgkmcnt(5)
    s_lshr_b32 s14, s4, 1
    ds_read_b128 a[52:55], v54 offset:58368
    v_mfma_f32_16x16x32_bf16 v[116:119], a[4:7], a[28:31], v[116:119]
    s_nop 0
    s_lshl_b32 s14, s14, 7
    ds_read_b128 a[56:59], v54 offset:59392
    v_mfma_f32_16x16x32_bf16 v[100:103], a[4:7], a[24:27], v[100:103]
    s_nop 0
    s_add_u32 s13, s13, s14
    ds_read_b128 a[60:63], v54 offset:60416
    v_mfma_f32_16x16x32_bf16 v[84:87], a[4:7], a[20:23], v[84:87]
    s_nop 0
    s_add_u32 s12, s12, s13
    v_mfma_f32_16x16x32_bf16 v[68:71], a[4:7], a[16:19], v[68:71]
    s_waitcnt lgkmcnt(6)
    s_lshl_b32 s78, s76, 8
    ds_read_b64_tr_b16 a[32:33], v50 offset:49152
    v_mfma_f32_16x16x32_bf16 v[72:75], a[8:11], a[16:19], v[72:75]
    s_add_u32 s78, s78, 79710208
    ds_read_b64_tr_b16 a[34:35], v50 offset:53248
    ds_read_b64_tr_b16 a[36:37], v51 offset:49152
    v_mfma_f32_16x16x32_bf16 v[88:91], a[8:11], a[20:23], v[88:91]
    s_nop 0
    s_lshl_b32 s79, s64, 2
    ds_read_b64_tr_b16 a[38:39], v51 offset:53248
    v_mfma_f32_16x16x32_bf16 v[104:107], a[8:11], a[24:27], v[104:107]
    s_nop 0
    s_add_u32 s79, s79, s78
    v_mfma_f32_16x16x32_bf16 v[120:123], a[8:11], a[28:31], v[120:123]
    s_nop 0
    s_waitcnt lgkmcnt(8)
    ds_read_b64_tr_b16 a[40:41], v52 offset:49152
    v_mfma_f32_16x16x32_bf16 v[124:127], a[12:15], a[28:31], v[124:127]
    ds_read_b64_tr_b16 a[42:43], v52 offset:53248
    v_mfma_f32_16x16x32_bf16 v[108:111], a[12:15], a[24:27], v[108:111]
    ds_read_b64_tr_b16 a[44:45], v53 offset:49152
    v_mfma_f32_16x16x32_bf16 v[92:95], a[12:15], a[20:23], v[92:95]
    v_mfma_f32_16x16x32_bf16 v[76:79], a[12:15], a[16:19], v[76:79]
    s_nop 0
    s_waitcnt lgkmcnt(5)
    ds_read_b64_tr_b16 a[46:47], v53 offset:53248
    v_mfma_f32_16x16x32_bf16 v[64:67], a[32:35], a[48:51], v[64:67]
    v_mfma_f32_16x16x32_bf16 v[80:83], a[32:35], a[52:55], v[80:83]
    v_mfma_f32_16x16x32_bf16 v[96:99], a[32:35], a[56:59], v[96:99]
    s_waitcnt vmcnt(12) lgkmcnt(0)
    s_barrier
    buffer_load_dwordx2 v[32:33], v31, s[44:47], s12 offen offset:0
    v_mfma_f32_16x16x32_bf16 v[112:115], a[32:35], a[60:63], v[112:115]
    ds_read_b128 a[16:19], v60 offset:40960
    v_mfma_f32_16x16x32_bf16 v[116:119], a[36:39], a[60:63], v[116:119]
    ds_read_b128 a[20:23], v60 offset:41984
    v_mfma_f32_16x16x32_bf16 v[100:103], a[36:39], a[56:59], v[100:103]
    ds_read_b128 a[24:27], v60 offset:43008
    v_mfma_f32_16x16x32_bf16 v[84:87], a[36:39], a[52:55], v[84:87]
    buffer_load_dwordx2 v[40:41], v30, s[48:51], s13 offen offset:0
    v_mfma_f32_16x16x32_bf16 v[68:71], a[36:39], a[48:51], v[68:71]
    ds_read_b128 a[28:31], v60 offset:44032
    v_mfma_f32_16x16x32_bf16 v[72:75], a[40:43], a[48:51], v[72:75]
    ds_read_b64_tr_b16 a[0:1], v56 offset:32768
    ds_read_b64_tr_b16 a[2:3], v56 offset:36864
    v_mfma_f32_16x16x32_bf16 v[88:91], a[40:43], a[52:55], v[88:91]
    ds_read_b64_tr_b16 a[4:5], v57 offset:32768
    v_mfma_f32_16x16x32_bf16 v[104:107], a[40:43], a[56:59], v[104:107]
    buffer_load_dwordx2 v[34:35], v31, s[44:47], s12 offen offset:32
    v_mfma_f32_16x16x32_bf16 v[120:123], a[40:43], a[60:63], v[120:123]
    ds_read_b64_tr_b16 a[6:7], v57 offset:36864
    v_mfma_f32_16x16x32_bf16 v[124:127], a[44:47], a[60:63], v[124:127]
    ds_read_b64_tr_b16 a[8:9], v58 offset:32768
    v_mfma_f32_16x16x32_bf16 v[108:111], a[44:47], a[56:59], v[108:111]
    ds_read_b64_tr_b16 a[10:11], v58 offset:36864
    v_mfma_f32_16x16x32_bf16 v[92:95], a[44:47], a[52:55], v[92:95]
    buffer_load_dwordx2 v[42:43], v30, s[48:51], s13 offen offset:32
    v_mfma_f32_16x16x32_bf16 v[76:79], a[44:47], a[48:51], v[76:79]
    s_nop 0
    s_waitcnt lgkmcnt(4)
    ds_read_b64_tr_b16 a[12:13], v59 offset:32768
    v_mfma_f32_16x16x32_bf16 v[64:67], a[0:3], a[16:19], v[64:67]
    ds_read_b64_tr_b16 a[14:15], v59 offset:36864
    v_mfma_f32_16x16x32_bf16 v[80:83], a[0:3], a[20:23], v[80:83]
    ds_read_b128 a[48:51], v60 offset:57344
    v_mfma_f32_16x16x32_bf16 v[96:99], a[0:3], a[24:27], v[96:99]
    buffer_load_dwordx2 v[36:37], v31, s[44:47], s12 offen offset:64
    v_mfma_f32_16x16x32_bf16 v[112:115], a[0:3], a[28:31], v[112:115]
    s_nop 0
    s_waitcnt lgkmcnt(5)
    ds_read_b128 a[52:55], v60 offset:58368
    v_mfma_f32_16x16x32_bf16 v[116:119], a[4:7], a[28:31], v[116:119]
    ds_read_b128 a[56:59], v60 offset:59392
    v_mfma_f32_16x16x32_bf16 v[100:103], a[4:7], a[24:27], v[100:103]
    ds_read_b128 a[60:63], v60 offset:60416
    v_mfma_f32_16x16x32_bf16 v[84:87], a[4:7], a[20:23], v[84:87]
    buffer_load_dwordx2 v[44:45], v30, s[48:51], s13 offen offset:64
    v_mfma_f32_16x16x32_bf16 v[68:71], a[4:7], a[16:19], v[68:71]
    s_nop 0
    s_waitcnt lgkmcnt(6)
    ds_read_b64_tr_b16 a[32:33], v56 offset:49152
    v_mfma_f32_16x16x32_bf16 v[72:75], a[8:11], a[16:19], v[72:75]
    ds_read_b64_tr_b16 a[34:35], v56 offset:53248
    ds_read_b64_tr_b16 a[36:37], v57 offset:49152
    v_mfma_f32_16x16x32_bf16 v[88:91], a[8:11], a[20:23], v[88:91]
    ds_read_b64_tr_b16 a[38:39], v57 offset:53248
    v_mfma_f32_16x16x32_bf16 v[104:107], a[8:11], a[24:27], v[104:107]
    buffer_load_dwordx2 v[38:39], v31, s[44:47], s12 offen offset:96
    v_mfma_f32_16x16x32_bf16 v[120:123], a[8:11], a[28:31], v[120:123]
    s_nop 0
    s_waitcnt lgkmcnt(8)
    ds_read_b64_tr_b16 a[40:41], v58 offset:49152
    v_mfma_f32_16x16x32_bf16 v[124:127], a[12:15], a[28:31], v[124:127]
    ds_read_b64_tr_b16 a[42:43], v58 offset:53248
    v_mfma_f32_16x16x32_bf16 v[108:111], a[12:15], a[24:27], v[108:111]
    ds_read_b64_tr_b16 a[44:45], v59 offset:49152
    v_mfma_f32_16x16x32_bf16 v[92:95], a[12:15], a[20:23], v[92:95]
    buffer_load_dwordx2 v[46:47], v30, s[48:51], s13 offen offset:96
    v_mfma_f32_16x16x32_bf16 v[76:79], a[12:15], a[16:19], v[76:79]
    s_nop 0
    s_waitcnt lgkmcnt(5)
    ds_read_b64_tr_b16 a[46:47], v59 offset:53248
    v_mfma_f32_16x16x32_bf16 v[64:67], a[32:35], a[48:51], v[64:67]
    v_mfma_f32_16x16x32_bf16 v[80:83], a[32:35], a[52:55], v[80:83]
    v_mfma_f32_16x16x32_bf16 v[96:99], a[32:35], a[56:59], v[96:99]
    s_waitcnt vmcnt(12) lgkmcnt(0)
    s_barrier
    v_mfma_f32_16x16x32_bf16 v[112:115], a[32:35], a[60:63], v[112:115]
    ds_read_b128 a[16:19], v54 offset:8192
    v_mfma_f32_16x16x32_bf16 v[116:119], a[36:39], a[60:63], v[116:119]
    ds_read_b128 a[20:23], v54 offset:9216
    v_mfma_f32_16x16x32_bf16 v[100:103], a[36:39], a[56:59], v[100:103]
    ds_read_b128 a[24:27], v54 offset:10240
    v_mfma_f32_16x16x32_bf16 v[84:87], a[36:39], a[52:55], v[84:87]
    v_mfma_f32_16x16x32_bf16 v[68:71], a[36:39], a[48:51], v[68:71]
    ds_read_b128 a[28:31], v54 offset:11264
    v_mfma_f32_16x16x32_bf16 v[72:75], a[40:43], a[48:51], v[72:75]
    ds_read_b64_tr_b16 a[0:1], v50 offset:0
    ds_read_b64_tr_b16 a[2:3], v50 offset:4096
    v_mfma_f32_16x16x32_bf16 v[88:91], a[40:43], a[52:55], v[88:91]
    ds_read_b64_tr_b16 a[4:5], v51 offset:0
    v_mfma_f32_16x16x32_bf16 v[104:107], a[40:43], a[56:59], v[104:107]
    v_mfma_f32_16x16x32_bf16 v[120:123], a[40:43], a[60:63], v[120:123]
    ds_read_b64_tr_b16 a[6:7], v51 offset:4096
    v_mfma_f32_16x16x32_bf16 v[124:127], a[44:47], a[60:63], v[124:127]
    ds_read_b64_tr_b16 a[8:9], v52 offset:0
    v_mfma_f32_16x16x32_bf16 v[108:111], a[44:47], a[56:59], v[108:111]
    ds_read_b64_tr_b16 a[10:11], v52 offset:4096
    v_mfma_f32_16x16x32_bf16 v[92:95], a[44:47], a[52:55], v[92:95]
    v_mfma_f32_16x16x32_bf16 v[76:79], a[44:47], a[48:51], v[76:79]
    s_nop 0
    s_waitcnt lgkmcnt(4)
    ds_read_b64_tr_b16 a[12:13], v53 offset:0
    v_mfma_f32_16x16x32_bf16 v[64:67], a[0:3], a[16:19], v[64:67]
    ds_read_b64_tr_b16 a[14:15], v53 offset:4096
    v_mfma_f32_16x16x32_bf16 v[80:83], a[0:3], a[20:23], v[80:83]
    ds_read_b128 a[48:51], v54 offset:24576
    v_mfma_f32_16x16x32_bf16 v[96:99], a[0:3], a[24:27], v[96:99]
    v_mfma_f32_16x16x32_bf16 v[112:115], a[0:3], a[28:31], v[112:115]
    s_nop 0
    s_waitcnt lgkmcnt(5)
    ds_read_b128 a[52:55], v54 offset:25600
    v_mfma_f32_16x16x32_bf16 v[116:119], a[4:7], a[28:31], v[116:119]
    ds_read_b128 a[56:59], v54 offset:26624
    v_mfma_f32_16x16x32_bf16 v[100:103], a[4:7], a[24:27], v[100:103]
    ds_read_b128 a[60:63], v54 offset:27648
    v_mfma_f32_16x16x32_bf16 v[84:87], a[4:7], a[20:23], v[84:87]
    v_mfma_f32_16x16x32_bf16 v[68:71], a[4:7], a[16:19], v[68:71]
    s_nop 0
    s_waitcnt lgkmcnt(6)
    ds_read_b64_tr_b16 a[32:33], v50 offset:16384
    v_mfma_f32_16x16x32_bf16 v[72:75], a[8:11], a[16:19], v[72:75]
    ds_read_b64_tr_b16 a[34:35], v50 offset:20480
    ds_read_b64_tr_b16 a[36:37], v51 offset:16384
    v_mfma_f32_16x16x32_bf16 v[88:91], a[8:11], a[20:23], v[88:91]
    ds_read_b64_tr_b16 a[38:39], v51 offset:20480
    v_mfma_f32_16x16x32_bf16 v[104:107], a[8:11], a[24:27], v[104:107]
    v_mfma_f32_16x16x32_bf16 v[120:123], a[8:11], a[28:31], v[120:123]
    s_nop 0
    s_waitcnt lgkmcnt(8)
    ds_read_b64_tr_b16 a[40:41], v52 offset:16384
    v_mfma_f32_16x16x32_bf16 v[124:127], a[12:15], a[28:31], v[124:127]
    ds_read_b64_tr_b16 a[42:43], v52 offset:20480
    v_mfma_f32_16x16x32_bf16 v[108:111], a[12:15], a[24:27], v[108:111]
    ds_read_b64_tr_b16 a[44:45], v53 offset:16384
    v_mfma_f32_16x16x32_bf16 v[92:95], a[12:15], a[20:23], v[92:95]
    v_mfma_f32_16x16x32_bf16 v[76:79], a[12:15], a[16:19], v[76:79]
    s_nop 0
    s_waitcnt lgkmcnt(5)
    ds_read_b64_tr_b16 a[46:47], v53 offset:20480
    v_mfma_f32_16x16x32_bf16 v[64:67], a[32:35], a[48:51], v[64:67]
    v_mfma_f32_16x16x32_bf16 v[80:83], a[32:35], a[52:55], v[80:83]
    v_mfma_f32_16x16x32_bf16 v[96:99], a[32:35], a[56:59], v[96:99]
    s_waitcnt vmcnt(8) lgkmcnt(0)
    s_barrier
    v_mfma_f32_16x16x32_bf16 v[112:115], a[32:35], a[60:63], v[112:115]
    ds_read_b128 a[16:19], v60 offset:8192
    v_mfma_f32_16x16x32_bf16 v[116:119], a[36:39], a[60:63], v[116:119]
    ds_read_b128 a[20:23], v60 offset:9216
    v_mfma_f32_16x16x32_bf16 v[100:103], a[36:39], a[56:59], v[100:103]
    ds_read_b128 a[24:27], v60 offset:10240
    v_mfma_f32_16x16x32_bf16 v[84:87], a[36:39], a[52:55], v[84:87]
    s_waitcnt vmcnt(0)
    v_lshlrev_b32 v208, 16, v32
    v_and_b32 v209, 0xffff0000, v32
    v_mfma_f32_16x16x32_bf16 v[68:71], a[36:39], a[48:51], v[68:71]
    ds_read_b128 a[28:31], v60 offset:11264
    v_lshlrev_b32_e64 v224, 16, v40
    v_mfma_f32_16x16x32_bf16 v[72:75], a[40:43], a[48:51], v[72:75]
    ds_read_b64_tr_b16 a[0:1], v56 offset:0
    ds_read_b64_tr_b16 a[2:3], v56 offset:4096
    v_mfma_f32_16x16x32_bf16 v[88:91], a[40:43], a[52:55], v[88:91]
    ds_read_b64_tr_b16 a[4:5], v57 offset:0
    v_and_b32 v225, 0xffff0000, v40
    v_mfma_f32_16x16x32_bf16 v[104:107], a[40:43], a[56:59], v[104:107]
    v_lshlrev_b32_e64 v210, 16, v33
    v_and_b32 v211, 0xffff0000, v33
    v_mfma_f32_16x16x32_bf16 v[120:123], a[40:43], a[60:63], v[120:123]
    ds_read_b64_tr_b16 a[6:7], v57 offset:4096
    v_lshlrev_b32_e64 v226, 16, v41
    v_mfma_f32_16x16x32_bf16 v[124:127], a[44:47], a[60:63], v[124:127]
    ds_read_b64_tr_b16 a[8:9], v58 offset:0
    v_and_b32 v227, 0xffff0000, v41
    v_mfma_f32_16x16x32_bf16 v[108:111], a[44:47], a[56:59], v[108:111]
    ds_read_b64_tr_b16 a[10:11], v58 offset:4096
    v_lshlrev_b32_e64 v212, 16, v34
    v_mfma_f32_16x16x32_bf16 v[92:95], a[44:47], a[52:55], v[92:95]
    v_and_b32 v213, 0xffff0000, v34
    v_lshlrev_b32_e64 v228, 16, v42
    v_mfma_f32_16x16x32_bf16 v[76:79], a[44:47], a[48:51], v[76:79]
    s_nop 0
    s_waitcnt lgkmcnt(4)
    ds_read_b64_tr_b16 a[12:13], v59 offset:0
    v_and_b32 v229, 0xffff0000, v42
    v_mfma_f32_16x16x32_bf16 v[64:67], a[0:3], a[16:19], v[64:67]
    ds_read_b64_tr_b16 a[14:15], v59 offset:4096
    v_lshlrev_b32_e64 v214, 16, v35
    v_mfma_f32_16x16x32_bf16 v[80:83], a[0:3], a[20:23], v[80:83]
    v_and_b32 v215, 0xffff0000, v35
    v_lshlrev_b32_e64 v230, 16, v43
    v_mfma_f32_16x16x32_bf16 v[96:99], a[0:3], a[24:27], v[96:99]
    v_and_b32 v231, 0xffff0000, v43
    v_lshlrev_b32_e64 v216, 16, v36
    v_mfma_f32_16x16x32_bf16 v[112:115], a[0:3], a[28:31], v[112:115]
    s_waitcnt lgkmcnt(4)
    v_and_b32 v217, 0xffff0000, v36
    v_lshlrev_b32 v232, 16, v44
    v_mfma_f32_16x16x32_bf16 v[116:119], a[4:7], a[28:31], v[116:119]
    v_and_b32 v233, 0xffff0000, v44
    v_lshlrev_b32_e64 v218, 16, v37
    v_mfma_f32_16x16x32_bf16 v[100:103], a[4:7], a[24:27], v[100:103]
    v_and_b32 v219, 0xffff0000, v37
    v_lshlrev_b32_e64 v234, 16, v45
    v_mfma_f32_16x16x32_bf16 v[84:87], a[4:7], a[20:23], v[84:87]
    v_and_b32 v235, 0xffff0000, v45
    v_lshlrev_b32_e64 v220, 16, v38
    v_mfma_f32_16x16x32_bf16 v[68:71], a[4:7], a[16:19], v[68:71]
    s_waitcnt lgkmcnt(2)
    v_and_b32 v221, 0xffff0000, v38
    v_lshlrev_b32 v236, 16, v46
    v_mfma_f32_16x16x32_bf16 v[72:75], a[8:11], a[16:19], v[72:75]
    v_and_b32 v237, 0xffff0000, v46
    v_lshlrev_b32_e64 v222, 16, v39
    v_mfma_f32_16x16x32_bf16 v[88:91], a[8:11], a[20:23], v[88:91]
    v_and_b32 v223, 0xffff0000, v39
    v_lshlrev_b32_e64 v238, 16, v47
    v_mfma_f32_16x16x32_bf16 v[104:107], a[8:11], a[24:27], v[104:107]
    v_and_b32 v239, 0xffff0000, v47
    v_mfma_f32_16x16x32_bf16 v[120:123], a[8:11], a[28:31], v[120:123]
    s_nop 0
    s_waitcnt lgkmcnt(0)
    v_mfma_f32_16x16x32_bf16 v[124:127], a[12:15], a[28:31], v[124:127]
    v_mfma_f32_16x16x32_bf16 v[108:111], a[12:15], a[24:27], v[108:111]
    v_mfma_f32_16x16x32_bf16 v[92:95], a[12:15], a[20:23], v[92:95]
    v_mfma_f32_16x16x32_bf16 v[76:79], a[12:15], a[16:19], v[76:79]
    s_nop 1
    s_cmp_eq_u32 s64, 1
    s_cbranch_scc1 L_p3x1
    s_cmp_eq_u32 s64, 2
    s_cbranch_scc1 L_p3x2
    s_cmp_eq_u32 s64, 3
    s_cbranch_scc1 L_p3x3
L_p3x0:
    s_add_u32 s3, s22, 32768
    v_cvt_pk_bf16_f32 v80, v80, v81
    v_cvt_pk_bf16_f32 v81, v82, v83
    v_cvt_pk_bf16_f32 v82, v84, v85
    v_cvt_pk_bf16_f32 v83, v86, v87
    buffer_store_dwordx4 v[80:83], v2, s[52:55], s3 offen offset:0 sc1
    v_cvt_pk_bf16_f32 v88, v88, v89
    v_cvt_pk_bf16_f32 v89, v90, v91
    v_cvt_pk_bf16_f32 v90, v92, v93
    v_cvt_pk_bf16_f32 v91, v94, v95
    buffer_store_dwordx4 v[88:91], v2, s[52:55], s3 offen offset:1024 sc1
    s_add_u32 s3, s22, 65536
    v_cvt_pk_bf16_f32 v96, v96, v97
    v_cvt_pk_bf16_f32 v97, v98, v99
    v_cvt_pk_bf16_f32 v98, v100, v101
    v_cvt_pk_bf16_f32 v99, v102, v103
    buffer_store_dwordx4 v[96:99], v2, s[52:55], s3 offen offset:0 sc1
    v_cvt_pk_bf16_f32 v104, v104, v105
    v_cvt_pk_bf16_f32 v105, v106, v107
    v_cvt_pk_bf16_f32 v106, v108, v109
    v_cvt_pk_bf16_f32 v107, v110, v111
    buffer_store_dwordx4 v[104:107], v2, s[52:55], s3 offen offset:1024 sc1
    s_add_u32 s3, s22, 98304
    v_cvt_pk_bf16_f32 v112, v112, v113
    v_cvt_pk_bf16_f32 v113, v114, v115
    v_cvt_pk_bf16_f32 v114, v116, v117
    v_cvt_pk_bf16_f32 v115, v118, v119
    buffer_store_dwordx4 v[112:115], v2, s[52:55], s3 offen offset:0 sc1
    v_cvt_pk_bf16_f32 v120, v120, v121
    v_cvt_pk_bf16_f32 v121, v122, v123
    v_cvt_pk_bf16_f32 v122, v124, v125
    v_cvt_pk_bf16_f32 v123, v126, v127
    buffer_store_dwordx4 v[120:123], v2, s[52:55], s3 offen offset:1024 sc1
    v_mov_b32 v192, v64
    v_mov_b32 v193, v65
    v_mov_b32 v194, v66
    v_mov_b32 v195, v67
    v_mov_b32 v196, v68
    v_mov_b32 v197, v69
    v_mov_b32 v198, v70
    v_mov_b32 v199, v71
    v_mov_b32 v200, v72
    v_mov_b32 v201, v73
    v_mov_b32 v202, v74
    v_mov_b32 v203, v75
    v_mov_b32 v204, v76
    v_mov_b32 v205, v77
    v_mov_b32 v206, v78
    v_mov_b32 v207, v79
    s_mov_b32 s16, 1073741824
    s_add_u32 s17, s23, 8192
    s_add_u32 s18, s23, 16384
    s_add_u32 s19, s23, 24576
    s_branch L_p3fin
L_p3x1:
    s_add_u32 s3, s22, 0
    v_cvt_pk_bf16_f32 v64, v64, v65
    v_cvt_pk_bf16_f32 v65, v66, v67
    v_cvt_pk_bf16_f32 v66, v68, v69
    v_cvt_pk_bf16_f32 v67, v70, v71
    buffer_store_dwordx4 v[64:67], v2, s[52:55], s3 offen offset:0 sc1
    v_cvt_pk_bf16_f32 v72, v72, v73
    v_cvt_pk_bf16_f32 v73, v74, v75
    v_cvt_pk_bf16_f32 v74, v76, v77
    v_cvt_pk_bf16_f32 v75, v78, v79
    buffer_store_dwordx4 v[72:75], v2, s[52:55], s3 offen offset:1024 sc1
    s_add_u32 s3, s22, 65536
    v_cvt_pk_bf16_f32 v96, v96, v97
    v_cvt_pk_bf16_f32 v97, v98, v99
    v_cvt_pk_bf16_f32 v98, v100, v101
    v_cvt_pk_bf16_f32 v99, v102, v103
    buffer_store_dwordx4 v[96:99], v2, s[52:55], s3 offen offset:0 sc1
    v_cvt_pk_bf16_f32 v104, v104, v105
    v_cvt_pk_bf16_f32 v105, v106, v107
    v_cvt_pk_bf16_f32 v106, v108, v109
    v_cvt_pk_bf16_f32 v107, v110, v111
    buffer_store_dwordx4 v[104:107], v2, s[52:55], s3 offen offset:1024 sc1
    s_add_u32 s3, s22, 98304
    v_cvt_pk_bf16_f32 v112, v112, v113
    v_cvt_pk_bf16_f32 v113, v114, v115
    v_cvt_pk_bf16_f32 v114, v116, v117
    v_cvt_pk_bf16_f32 v115, v118, v119
    buffer_store_dwordx4 v[112:115], v2, s[52:55], s3 offen offset:0 sc1
    v_cvt_pk_bf16_f32 v120, v120, v121
    v_cvt_pk_bf16_f32 v121, v122, v123
    v_cvt_pk_bf16_f32 v122, v124, v125
    v_cvt_pk_bf16_f32 v123, v126, v127
    buffer_store_dwordx4 v[120:123], v2, s[52:55], s3 offen offset:1024 sc1
    v_mov_b32 v192, v80
    v_mov_b32 v193, v81
    v_mov_b32 v194, v82
    v_mov_b32 v195, v83
    v_mov_b32 v196, v84
    v_mov_b32 v197, v85
    v_mov_b32 v198, v86
    v_mov_b32 v199, v87
    v_mov_b32 v200, v88
    v_mov_b32 v201, v89
    v_mov_b32 v202, v90
    v_mov_b32 v203, v91
    v_mov_b32 v204, v92
    v_mov_b32 v205, v93
    v_mov_b32 v206, v94
    v_mov_b32 v207, v95
    s_add_u32 s16, s23, 0
    s_mov_b32 s17, 1073741824
    s_add_u32 s18, s23, 16384
    s_add_u32 s19, s23, 24576
    s_branch L_p3fin
L_p3x2:
    s_add_u32 s3, s22, 0
    v_cvt_pk_bf16_f32 v64, v64, v65
    v_cvt_pk_bf16_f32 v65, v66, v67
    v_cvt_pk_bf16_f32 v66, v68, v69
    v_cvt_pk_bf16_f32 v67, v70, v71
    buffer_store_dwordx4 v[64:67], v2, s[52:55], s3 offen offset:0 sc1
    v_cvt_pk_bf16_f32 v72, v72, v73
    v_cvt_pk_bf16_f32 v73, v74, v75
    v_cvt_pk_bf16_f32 v74, v76, v77
    v_cvt_pk_bf16_f32 v75, v78, v79
    buffer_store_dwordx4 v[72:75], v2, s[52:55], s3 offen offset:1024 sc1
    s_add_u32 s3, s22, 32768
    v_cvt_pk_bf16_f32 v80, v80, v81
    v_cvt_pk_bf16_f32 v81, v82, v83
    v_cvt_pk_bf16_f32 v82, v84, v85
    v_cvt_pk_bf16_f32 v83, v86, v87
    buffer_store_dwordx4 v[80:83], v2, s[52:55], s3 offen offset:0 sc1
    v_cvt_pk_bf16_f32 v88, v88, v89
    v_cvt_pk_bf16_f32 v89, v90, v91
    v_cvt_pk_bf16_f32 v90, v92, v93
    v_cvt_pk_bf16_f32 v91, v94, v95
    buffer_store_dwordx4 v[88:91], v2, s[52:55], s3 offen offset:1024 sc1
    s_add_u32 s3, s22, 98304
    v_cvt_pk_bf16_f32 v112, v112, v113
    v_cvt_pk_bf16_f32 v113, v114, v115
    v_cvt_pk_bf16_f32 v114, v116, v117
    v_cvt_pk_bf16_f32 v115, v118, v119
    buffer_store_dwordx4 v[112:115], v2, s[52:55], s3 offen offset:0 sc1
    v_cvt_pk_bf16_f32 v120, v120, v121
    v_cvt_pk_bf16_f32 v121, v122, v123
    v_cvt_pk_bf16_f32 v122, v124, v125
    v_cvt_pk_bf16_f32 v123, v126, v127
    buffer_store_dwordx4 v[120:123], v2, s[52:55], s3 offen offset:1024 sc1
    v_mov_b32 v192, v96
    v_mov_b32 v193, v97
    v_mov_b32 v194, v98
    v_mov_b32 v195, v99
    v_mov_b32 v196, v100
    v_mov_b32 v197, v101
    v_mov_b32 v198, v102
    v_mov_b32 v199, v103
    v_mov_b32 v200, v104
    v_mov_b32 v201, v105
    v_mov_b32 v202, v106
    v_mov_b32 v203, v107
    v_mov_b32 v204, v108
    v_mov_b32 v205, v109
    v_mov_b32 v206, v110
    v_mov_b32 v207, v111
    s_add_u32 s16, s23, 0
    s_add_u32 s17, s23, 8192
    s_mov_b32 s18, 1073741824
    s_add_u32 s19, s23, 24576
    s_branch L_p3fin
L_p3x3:
    s_add_u32 s3, s22, 0
    v_cvt_pk_bf16_f32 v64, v64, v65
    v_cvt_pk_bf16_f32 v65, v66, v67
    v_cvt_pk_bf16_f32 v66, v68, v69
    v_cvt_pk_bf16_f32 v67, v70, v71
    buffer_store_dwordx4 v[64:67], v2, s[52:55], s3 offen offset:0 sc1
    v_cvt_pk_bf16_f32 v72, v72, v73
    v_cvt_pk_bf16_f32 v73, v74, v75
    v_cvt_pk_bf16_f32 v74, v76, v77
    v_cvt_pk_bf16_f32 v75, v78, v79
    buffer_store_dwordx4 v[72:75], v2, s[52:55], s3 offen offset:1024 sc1
    s_add_u32 s3, s22, 32768
    v_cvt_pk_bf16_f32 v80, v80, v81
    v_cvt_pk_bf16_f32 v81, v82, v83
    v_cvt_pk_bf16_f32 v82, v84, v85
    v_cvt_pk_bf16_f32 v83, v86, v87
    buffer_store_dwordx4 v[80:83], v2, s[52:55], s3 offen offset:0 sc1
    v_cvt_pk_bf16_f32 v88, v88, v89
    v_cvt_pk_bf16_f32 v89, v90, v91
    v_cvt_pk_bf16_f32 v90, v92, v93
    v_cvt_pk_bf16_f32 v91, v94, v95
    buffer_store_dwordx4 v[88:91], v2, s[52:55], s3 offen offset:1024 sc1
    s_add_u32 s3, s22, 65536
    v_cvt_pk_bf16_f32 v96, v96, v97
    v_cvt_pk_bf16_f32 v97, v98, v99
    v_cvt_pk_bf16_f32 v98, v100, v101
    v_cvt_pk_bf16_f32 v99, v102, v103
    buffer_store_dwordx4 v[96:99], v2, s[52:55], s3 offen offset:0 sc1
    v_cvt_pk_bf16_f32 v104, v104, v105
    v_cvt_pk_bf16_f32 v105, v106, v107
    v_cvt_pk_bf16_f32 v106, v108, v109
    v_cvt_pk_bf16_f32 v107, v110, v111
    buffer_store_dwordx4 v[104:107], v2, s[52:55], s3 offen offset:1024 sc1
    v_add_f32 v224, v224, v112
    v_add_f32 v225, v225, v113
    v_add_f32 v226, v226, v114
    v_add_f32 v227, v227, v115
    v_add_f32 v228, v228, v116
    v_add_f32 v229, v229, v117
    v_add_f32 v230, v230, v118
    v_add_f32 v231, v231, v119
    v_add_f32 v232, v232, v120
    v_add_f32 v233, v233, v121
    v_add_f32 v234, v234, v122
    v_add_f32 v235, v235, v123
    v_add_f32 v236, v236, v124
    v_add_f32 v237, v237, v125
    v_add_f32 v238, v238, v126
    v_add_f32 v239, v239, v127
    v_mov_b32 v192, 0
    v_mov_b32 v193, 0
    v_mov_b32 v194, 0
    v_mov_b32 v195, 0
    v_mov_b32 v196, 0
    v_mov_b32 v197, 0
    v_mov_b32 v198, 0
    v_mov_b32 v199, 0
    v_mov_b32 v200, 0
    v_mov_b32 v201, 0
    v_mov_b32 v202, 0
    v_mov_b32 v203, 0
    v_mov_b32 v204, 0
    v_mov_b32 v205, 0
    v_mov_b32 v206, 0
    v_mov_b32 v207, 0
    s_add_u32 s16, s23, 0
    s_add_u32 s17, s23, 8192
    s_add_u32 s18, s23, 16384
    s_mov_b32 s19, 1073741824
L_p3fin:
    s_waitcnt vmcnt(0)
    s_barrier
    s_cmp_lg_u32 s4, 0
    s_cbranch_scc1 L_sig3
    s_mov_b64 exec, 1
    v_mov_b32 v3, 1
    buffer_store_dword v3, off, s[52:55], s79 sc1
    s_mov_b64 exec, -1
L_sig3:
    s_mov_b32 s100, 0x40000
L_poll4:
    buffer_load_dword v3, v29, s[52:55], s78 offen sc1
    s_sub_u32 s100, s100, 1
    s_waitcnt vmcnt(0)
    v_cmp_eq_u32 vcc, 0, v3
    s_cbranch_vccz L_poll4_ok
    s_cmp_lg_u32 s100, 0
    s_cbranch_scc1 L_poll4
L_poll4_ok:
    buffer_load_dwordx4 v[152:155], v2, s[52:55], s19 offen offset:0 sc1
    buffer_load_dwordx4 v[156:159], v2, s[52:55], s19 offen offset:1024 sc1
    buffer_load_dwordx4 v[128:131], v2, s[52:55], s16 offen offset:0 sc1
    buffer_load_dwordx4 v[132:135], v2, s[52:55], s16 offen offset:1024 sc1
    buffer_load_dwordx4 v[136:139], v2, s[52:55], s17 offen offset:0 sc1
    buffer_load_dwordx4 v[140:143], v2, s[52:55], s17 offen offset:1024 sc1
    buffer_load_dwordx4 v[144:147], v2, s[52:55], s18 offen offset:0 sc1
    buffer_load_dwordx4 v[148:151], v2, s[52:55], s18 offen offset:1024 sc1
    s_waitcnt vmcnt(6)
    v_lshlrev_b32 v160, 16, v152
    v_and_b32 v161, 0xffff0000, v152
    v_lshlrev_b32 v162, 16, v153
    v_and_b32 v163, 0xffff0000, v153
    v_lshlrev_b32 v164, 16, v154
    v_and_b32 v165, 0xffff0000, v154
    v_lshlrev_b32 v166, 16, v155
    v_and_b32 v167, 0xffff0000, v155
    v_lshlrev_b32 v168, 16, v156
    v_and_b32 v169, 0xffff0000, v156
    v_lshlrev_b32 v170, 16, v157
    v_and_b32 v171, 0xffff0000, v157
    v_lshlrev_b32 v172, 16, v158
    v_and_b32 v173, 0xffff0000, v158
    v_lshlrev_b32 v174, 16, v159
    v_and_b32 v175, 0xffff0000, v159
    v_pk_add_f32 v[224:225], v[224:225], v[160:161]
    v_pk_add_f32 v[226:227], v[226:227], v[162:163]
    v_pk_add_f32 v[228:229], v[228:229], v[164:165]
    v_pk_add_f32 v[230:231], v[230:231], v[166:167]
    v_pk_add_f32 v[232:233], v[232:233], v[168:169]
    v_pk_add_f32 v[234:235], v[234:235], v[170:171]
    v_pk_add_f32 v[236:237], v[236:237], v[172:173]
    v_pk_add_f32 v[238:239], v[238:239], v[174:175]
    v_mul_f32 v176, 0xbfb8aa3b, v224
    v_mul_f32 v177, 0xbfb8aa3b, v225
    v_mul_f32 v178, 0xbfb8aa3b, v226
    v_mul_f32 v179, 0xbfb8aa3b, v227
    v_mul_f32 v180, 0xbfb8aa3b, v228
    v_mul_f32 v181, 0xbfb8aa3b, v229
    v_mul_f32 v182, 0xbfb8aa3b, v230
    v_mul_f32 v183, 0xbfb8aa3b, v231
    v_mul_f32 v184, 0xbfb8aa3b, v232
    v_mul_f32 v185, 0xbfb8aa3b, v233
    v_mul_f32 v186, 0xbfb8aa3b, v234
    v_mul_f32 v187, 0xbfb8aa3b, v235
    v_mul_f32 v188, 0xbfb8aa3b, v236
    v_mul_f32 v189, 0xbfb8aa3b, v237
    v_mul_f32 v190, 0xbfb8aa3b, v238
    v_mul_f32 v191, 0xbfb8aa3b, v239
    v_exp_f32 v176, v176
    v_exp_f32 v177, v177
    v_exp_f32 v178, v178
    v_exp_f32 v179, v179
    v_exp_f32 v180, v180
    v_exp_f32 v181, v181
    v_exp_f32 v182, v182
    v_exp_f32 v183, v183
    v_exp_f32 v184, v184
    v_exp_f32 v185, v185
    v_exp_f32 v186, v186
    v_exp_f32 v187, v187
    v_exp_f32 v188, v188
    v_exp_f32 v189, v189
    v_exp_f32 v190, v190
    v_exp_f32 v191, v191
    v_add_f32 v176, 1.0, v176
    v_add_f32 v177, 1.0, v177
    v_add_f32 v178, 1.0, v178
    v_add_f32 v179, 1.0, v179
    v_add_f32 v180, 1.0, v180
    v_add_f32 v181, 1.0, v181
    v_add_f32 v182, 1.0, v182
    v_add_f32 v183, 1.0, v183
    v_add_f32 v184, 1.0, v184
    v_add_f32 v185, 1.0, v185
    v_add_f32 v186, 1.0, v186
    v_add_f32 v187, 1.0, v187
    v_add_f32 v188, 1.0, v188
    v_add_f32 v189, 1.0, v189
    v_add_f32 v190, 1.0, v190
    v_add_f32 v191, 1.0, v191
    v_rcp_f32 v176, v176
    v_rcp_f32 v177, v177
    v_rcp_f32 v178, v178
    v_rcp_f32 v179, v179
    v_rcp_f32 v180, v180
    v_rcp_f32 v181, v181
    v_rcp_f32 v182, v182
    v_rcp_f32 v183, v183
    v_rcp_f32 v184, v184
    v_rcp_f32 v185, v185
    v_rcp_f32 v186, v186
    v_rcp_f32 v187, v187
    v_rcp_f32 v188, v188
    v_rcp_f32 v189, v189
    v_rcp_f32 v190, v190
    v_rcp_f32 v191, v191
    s_waitcnt vmcnt(4)
    v_lshlrev_b32 v160, 16, v128
    v_and_b32 v161, 0xffff0000, v128
    v_lshlrev_b32 v162, 16, v129
    v_and_b32 v163, 0xffff0000, v129
    v_lshlrev_b32 v164, 16, v130
    v_and_b32 v165, 0xffff0000, v130
    v_lshlrev_b32 v166, 16, v131
    v_and_b32 v167, 0xffff0000, v131
    v_lshlrev_b32 v168, 16, v132
    v_and_b32 v169, 0xffff0000, v132
    v_lshlrev_b32 v170, 16, v133
    v_and_b32 v171, 0xffff0000, v133
    v_lshlrev_b32 v172, 16, v134
    v_and_b32 v173, 0xffff0000, v134
    v_lshlrev_b32 v174, 16, v135
    v_and_b32 v175, 0xffff0000, v135
    v_pk_add_f32 v[192:193], v[192:193], v[160:161]
    v_pk_add_f32 v[194:195], v[194:195], v[162:163]
    v_pk_add_f32 v[196:197], v[196:197], v[164:165]
    v_pk_add_f32 v[198:199], v[198:199], v[166:167]
    v_pk_add_f32 v[200:201], v[200:201], v[168:169]
    v_pk_add_f32 v[202:203], v[202:203], v[170:171]
    v_pk_add_f32 v[204:205], v[204:205], v[172:173]
    v_pk_add_f32 v[206:207], v[206:207], v[174:175]
    s_waitcnt vmcnt(2)
    v_lshlrev_b32 v160, 16, v136
    v_and_b32 v161, 0xffff0000, v136
    v_lshlrev_b32 v162, 16, v137
    v_and_b32 v163, 0xffff0000, v137
    v_lshlrev_b32 v164, 16, v138
    v_and_b32 v165, 0xffff0000, v138
    v_lshlrev_b32 v166, 16, v139
    v_and_b32 v167, 0xffff0000, v139
    v_lshlrev_b32 v168, 16, v140
    v_and_b32 v169, 0xffff0000, v140
    v_lshlrev_b32 v170, 16, v141
    v_and_b32 v171, 0xffff0000, v141
    v_lshlrev_b32 v172, 16, v142
    v_and_b32 v173, 0xffff0000, v142
    v_lshlrev_b32 v174, 16, v143
    v_and_b32 v175, 0xffff0000, v143
    v_pk_add_f32 v[192:193], v[192:193], v[160:161]
    v_pk_add_f32 v[194:195], v[194:195], v[162:163]
    v_pk_add_f32 v[196:197], v[196:197], v[164:165]
    v_pk_add_f32 v[198:199], v[198:199], v[166:167]
    v_pk_add_f32 v[200:201], v[200:201], v[168:169]
    v_pk_add_f32 v[202:203], v[202:203], v[170:171]
    v_pk_add_f32 v[204:205], v[204:205], v[172:173]
    v_pk_add_f32 v[206:207], v[206:207], v[174:175]
    s_waitcnt vmcnt(0)
    v_lshlrev_b32 v160, 16, v144
    v_and_b32 v161, 0xffff0000, v144
    v_lshlrev_b32 v162, 16, v145
    v_and_b32 v163, 0xffff0000, v145
    v_lshlrev_b32 v164, 16, v146
    v_and_b32 v165, 0xffff0000, v146
    v_lshlrev_b32 v166, 16, v147
    v_and_b32 v167, 0xffff0000, v147
    v_lshlrev_b32 v168, 16, v148
    v_and_b32 v169, 0xffff0000, v148
    v_lshlrev_b32 v170, 16, v149
    v_and_b32 v171, 0xffff0000, v149
    v_lshlrev_b32 v172, 16, v150
    v_and_b32 v173, 0xffff0000, v150
    v_lshlrev_b32 v174, 16, v151
    v_and_b32 v175, 0xffff0000, v151
    v_pk_add_f32 v[192:193], v[192:193], v[160:161]
    v_pk_add_f32 v[194:195], v[194:195], v[162:163]
    v_pk_add_f32 v[196:197], v[196:197], v[164:165]
    v_pk_add_f32 v[198:199], v[198:199], v[166:167]
    v_pk_add_f32 v[200:201], v[200:201], v[168:169]
    v_pk_add_f32 v[202:203], v[202:203], v[170:171]
    v_pk_add_f32 v[204:205], v[204:205], v[172:173]
    v_pk_add_f32 v[206:207], v[206:207], v[174:175]
    v_pk_mul_f32 v[176:177], v[176:177], v[224:225]
    v_pk_mul_f32 v[178:179], v[178:179], v[226:227]
    v_pk_mul_f32 v[180:181], v[180:181], v[228:229]
    v_pk_mul_f32 v[182:183], v[182:183], v[230:231]
    v_pk_mul_f32 v[184:185], v[184:185], v[232:233]
    v_pk_mul_f32 v[186:187], v[186:187], v[234:235]
    v_pk_mul_f32 v[188:189], v[188:189], v[236:237]
    v_pk_mul_f32 v[190:191], v[190:191], v[238:239]
    v_pk_fma_f32 v[208:209], v[192:193], v[176:177], v[208:209]
    v_pk_fma_f32 v[210:211], v[194:195], v[178:179], v[210:211]
    v_pk_fma_f32 v[212:213], v[196:197], v[180:181], v[212:213]
    v_pk_fma_f32 v[214:215], v[198:199], v[182:183], v[214:215]
    v_pk_fma_f32 v[216:217], v[200:201], v[184:185], v[216:217]
    v_pk_fma_f32 v[218:219], v[202:203], v[186:187], v[218:219]
    v_pk_fma_f32 v[220:221], v[204:205], v[188:189], v[220:221]
    v_pk_fma_f32 v[222:223], v[206:207], v[190:191], v[222:223]
    v_cvt_pk_bf16_f32 v32, v208, v209
    v_cvt_pk_bf16_f32 v33, v210, v211
    v_cvt_pk_bf16_f32 v34, v212, v213
    v_cvt_pk_bf16_f32 v35, v214, v215
    v_cvt_pk_bf16_f32 v36, v216, v217
    v_cvt_pk_bf16_f32 v37, v218, v219
    v_cvt_pk_bf16_f32 v38, v220, v221
    v_cvt_pk_bf16_f32 v39, v222, v223
    s_nop 0
    v_permlane16_swap_b32 v32, v34
    v_permlane16_swap_b32 v33, v35
    v_permlane16_swap_b32 v36, v38
    v_permlane16_swap_b32 v37, v39
    buffer_store_dwordx4 v[32:35], v28, s[60:63], s12 offen offset:0
    buffer_store_dwordx4 v[36:39], v28, s[60:63], s12 offen offset:64
L_end:
    s_endpgm
L_mask_pre:
    v_cmp_lt_i32 s[8:9], 0, v234
    v_cmp_lt_i32 s[10:11], -1, v234
    v_cmp_lt_i32 s[12:13], -2, v234
    v_cmp_lt_i32 s[14:15], -3, v234
    s_cmp_eq_u32 s4, 1
    s_cbranch_scc1 L_mkp_1
    s_cmp_eq_u32 s4, 2
    s_cbranch_scc1 L_mkp_2
    s_cmp_eq_u32 s4, 3
    s_cbranch_scc1 L_mkp_3
    v_mov_b32 v68, v235
    v_mov_b32 v69, v235
    v_mov_b32 v70, v235
    v_mov_b32 v71, v235
    v_cndmask_b32 v64, v64, v235, s[8:9]
    v_cndmask_b32 v65, v65, v235, s[10:11]
    v_cndmask_b32 v66, v66, v235, s[12:13]
    v_cndmask_b32 v67, v67, v235, s[14:15]
    s_branch L_mkp_done
L_mkp_1:
    v_mov_b32 v64, v235
    v_mov_b32 v65, v235
    v_mov_b32 v66, v235
    v_mov_b32 v67, v235
    v_mov_b32 v68, v235
    v_mov_b32 v69, v235
    v_mov_b32 v70, v235
    v_mov_b32 v71, v235
    v_cndmask_b32 v76, v76, v235, s[8:9]
    v_cndmask_b32 v77, v77, v235, s[10:11]
    v_cndmask_b32 v78, v78, v235, s[12:13]
    v_cndmask_b32 v79, v79, v235, s[14:15]
    s_branch L_mkp_done
L_mkp_2:
    v_cndmask_b32 v68, v68, v235, s[8:9]
    v_cndmask_b32 v69, v69, v235, s[10:11]
    v_cndmask_b32 v70, v70, v235, s[12:13]
    v_cndmask_b32 v71, v71, v235, s[14:15]
    s_branch L_mkp_done
L_mkp_3:
    v_mov_b32 v64, v235
    v_mov_b32 v65, v235
    v_mov_b32 v66, v235
    v_mov_b32 v67, v235
    v_mov_b32 v68, v235
    v_mov_b32 v69, v235
    v_mov_b32 v70, v235
    v_mov_b32 v71, v235
    v_mov_b32 v76, v235
    v_mov_b32 v77, v235
    v_mov_b32 v78, v235
    v_mov_b32 v79, v235
    v_cndmask_b32 v72, v72, v235, s[8:9]
    v_cndmask_b32 v73, v73, v235, s[10:11]
    v_cndmask_b32 v74, v74, v235, s[12:13]
    v_cndmask_b32 v75, v75, v235, s[14:15]
L_mkp_done:
    s_branch L_mask_pre_ret
L_chk_first:
    v_cmp_nge_f32 vcc, 0x4e800000, v224
    s_mov_b32 s25, 0
    s_cbranch_vccz L_ctl_first
    v_mov_b32 v36, 0
    v_mov_b32 v37, 0
    v_mov_b32 v38, 0
    v_mov_b32 v39, 0
    s_branch L_rare0
L_ctl_first:
    s_cmp_lg_u32 s90, 0
    s_cbranch_scc1 L_second
    v_accvgpr_write_b32 a0, 0
    v_accvgpr_write_b32 a1, 0
    v_accvgpr_write_b32 a2, 0
    v_accvgpr_write_b32 a3, 0
    v_accvgpr_write_b32 a4, 0
    v_accvgpr_write_b32 a5, 0
    v_accvgpr_write_b32 a6, 0
    v_accvgpr_write_b32 a7, 0
    v_accvgpr_write_b32 a8, 0
    v_accvgpr_write_b32 a9, 0
    v_accvgpr_write_b32 a10, 0
    v_accvgpr_write_b32 a11, 0
    v_accvgpr_write_b32 a12, 0
    v_accvgpr_write_b32 a13, 0
    v_accvgpr_write_b32 a14, 0
    v_accvgpr_write_b32 a15, 0
    v_accvgpr_write_b32 a16, 0
    v_accvgpr_write_b32 a17, 0
    v_accvgpr_write_b32 a18, 0
    v_accvgpr_write_b32 a19, 0
    v_accvgpr_write_b32 a20, 0
    v_accvgpr_write_b32 a21, 0
    v_accvgpr_write_b32 a22, 0
    v_accvgpr_write_b32 a23, 0
    v_accvgpr_write_b32 a24, 0
    v_accvgpr_write_b32 a25, 0
    v_accvgpr_write_b32 a26, 0
    v_accvgpr_write_b32 a27, 0
    v_accvgpr_write_b32 a28, 0
    v_accvgpr_write_b32 a29, 0
    buffer_store_dwordx4 v[20:23], v245, s[52:55], s18 offen sc1
    v_accvgpr_write_b32 a30, 0
    v_accvgpr_write_b32 a31, 0
    v_accvgpr_write_b32 a32, 0
    v_accvgpr_write_b32 a33, 0
    v_accvgpr_write_b32 a34, 0
    v_accvgpr_write_b32 a35, 0
    v_accvgpr_write_b32 a36, 0
    v_accvgpr_write_b32 a37, 0
    v_accvgpr_write_b32 a38, 0
    v_accvgpr_write_b32 a39, 0
    v_accvgpr_write_b32 a40, 0
    v_accvgpr_write_b32 a41, 0
    v_accvgpr_write_b32 a42, 0
    v_accvgpr_write_b32 a43, 0
    v_accvgpr_write_b32 a44, 0
    v_accvgpr_write_b32 a45, 0
    v_accvgpr_write_b32 a46, 0
    v_accvgpr_write_b32 a47, 0
    v_accvgpr_write_b32 a48, 0
    v_accvgpr_write_b32 a49, 0
    v_accvgpr_write_b32 a50, 0
    v_accvgpr_write_b32 a51, 0
    v_accvgpr_write_b32 a52, 0
    v_accvgpr_write_b32 a53, 0
    v_accvgpr_write_b32 a54, 0
    v_accvgpr_write_b32 a55, 0
    v_accvgpr_write_b32 a56, 0
    v_accvgpr_write_b32 a57, 0
    v_accvgpr_write_b32 a58, 0
    v_accvgpr_write_b32 a59, 0
    buffer_store_dwordx4 v[24:27], v246, s[52:55], s18 offen sc1
    v_accvgpr_write_b32 a60, 0
    v_accvgpr_write_b32 a61, 0
    v_accvgpr_write_b32 a62, 0
    v_accvgpr_write_b32 a63, 0
    v_accvgpr_write_b32 a64, 0
    v_accvgpr_write_b32 a65, 0
    v_accvgpr_write_b32 a66, 0
    v_accvgpr_write_b32 a67, 0
    v_accvgpr_write_b32 a68, 0
    v_accvgpr_write_b32 a69, 0
    v_accvgpr_write_b32 a70, 0
    v_accvgpr_write_b32 a71, 0
    v_accvgpr_write_b32 a72, 0
    v_accvgpr_write_b32 a73, 0
    v_accvgpr_write_b32 a74, 0
    v_accvgpr_write_b32 a75, 0
    v_accvgpr_write_b32 a76, 0
    v_accvgpr_write_b32 a77, 0
    v_accvgpr_write_b32 a78, 0
    v_accvgpr_write_b32 a79, 0
    v_accvgpr_write_b32 a80, 0
    v_accvgpr_write_b32 a81, 0
    v_accvgpr_write_b32 a82, 0
    v_accvgpr_write_b32 a83, 0
    v_accvgpr_write_b32 a84, 0
    v_accvgpr_write_b32 a85, 0
    v_accvgpr_write_b32 a86, 0
    v_accvgpr_write_b32 a87, 0
    v_accvgpr_write_b32 a88, 0
    v_accvgpr_write_b32 a89, 0
    buffer_store_dwordx4 v[28:31], v245, s[52:55], s19 offen sc1
    v_accvgpr_write_b32 a90, 0
    v_accvgpr_write_b32 a91, 0
    v_accvgpr_write_b32 a92, 0
    v_accvgpr_write_b32 a93, 0
    v_accvgpr_write_b32 a94, 0
    v_accvgpr_write_b32 a95, 0
    v_accvgpr_write_b32 a96, 0
    v_accvgpr_write_b32 a97, 0
    v_accvgpr_write_b32 a98, 0
    v_accvgpr_write_b32 a99, 0
    v_accvgpr_write_b32 a100, 0
    v_accvgpr_write_b32 a101, 0
    v_accvgpr_write_b32 a102, 0
    v_accvgpr_write_b32 a103, 0
    v_accvgpr_write_b32 a104, 0
    v_accvgpr_write_b32 a105, 0
    v_accvgpr_write_b32 a106, 0
    v_accvgpr_write_b32 a107, 0
    v_accvgpr_write_b32 a108, 0
    v_accvgpr_write_b32 a109, 0
    v_accvgpr_write_b32 a110, 0
    v_accvgpr_write_b32 a111, 0
    v_accvgpr_write_b32 a112, 0
    v_accvgpr_write_b32 a113, 0
    v_accvgpr_write_b32 a114, 0
    v_accvgpr_write_b32 a115, 0
    v_accvgpr_write_b32 a116, 0
    v_accvgpr_write_b32 a117, 0
    v_accvgpr_write_b32 a118, 0
    v_accvgpr_write_b32 a119, 0
    buffer_store_dwordx4 v[44:47], v246, s[52:55], s19 offen sc1
    v_accvgpr_write_b32 a120, 0
    v_accvgpr_write_b32 a121, 0
    v_accvgpr_write_b32 a122, 0
    v_accvgpr_write_b32 a123, 0
    v_accvgpr_write_b32 a124, 0
    v_accvgpr_write_b32 a125, 0
    v_accvgpr_write_b32 a126, 0
    v_accvgpr_write_b32 a127, 0
    s_waitcnt vmcnt(0)
    s_branch L_last
L_rare0:
    s_nop 7
    v_max3_f32 v208, v64, v65, v66
    v_max3_f32 v209, v72, v73, v74
    v_max3_f32 v210, v80, v81, v82
    v_max3_f32 v211, v88, v89, v90
    v_max3_f32 v208, v208, v67, v68
    v_max3_f32 v209, v209, v75, v76
    v_max3_f32 v210, v210, v83, v84
    v_max3_f32 v211, v211, v91, v92
    v_max3_f32 v208, v208, v69, v70
    v_max3_f32 v209, v209, v77, v78
    v_max3_f32 v210, v210, v85, v86
    v_max3_f32 v211, v211, v93, v94
    v_max_f32 v208, v208, v71
    v_max_f32 v209, v209, v79
    v_max_f32 v210, v210, v87
    v_max_f32 v211, v211, v95
    v_mov_b32 v212, v208
    v_mov_b32 v213, v209
    v_mov_b32 v214, v210
    v_mov_b32 v215, v211
    v_permlane16_swap_b32 v212, v208
    v_permlane16_swap_b32 v213, v209
    v_permlane16_swap_b32 v214, v210
    v_permlane16_swap_b32 v215, v211
    v_max_f32 v208, v208, v212
    v_max_f32 v209, v209, v213
    v_max_f32 v210, v210, v214
    v_max_f32 v211, v211, v215
    v_mov_b32 v212, v208
    v_mov_b32 v213, v209
    v_mov_b32 v214, v210
    v_mov_b32 v215, v211
    v_permlane32_swap_b32 v212, v208
    v_permlane32_swap_b32 v213, v209
    v_permlane32_swap_b32 v214, v210
    v_permlane32_swap_b32 v215, v211
    v_max_f32 v208, v208, v212
    v_max_f32 v209, v209, v213
    v_max_f32 v210, v210, v214
    v_max_f32 v211, v211, v215
    v_max_f32 v208, 0, v208
    v_max_f32 v209, 0, v209
    v_max_f32 v210, 0, v210
    v_max_f32 v211, 0, v211
    v_exp_f32 v212, -v208
    v_exp_f32 v213, -v209
    v_exp_f32 v214, -v210
    v_exp_f32 v215, -v211
    v_sub_f32 v160, v160, v208
    v_sub_f32 v161, v161, v208
    v_sub_f32 v162, v162, v208
    v_sub_f32 v163, v163, v208
    v_sub_f32 v64, v64, v208
    v_sub_f32 v65, v65, v208
    v_sub_f32 v66, v66, v208
    v_sub_f32 v67, v67, v208
    v_sub_f32 v68, v68, v208
    v_sub_f32 v69, v69, v208
    v_sub_f32 v70, v70, v208
    v_sub_f32 v71, v71, v208
    v_sub_f32 v96, v96, v208
    v_sub_f32 v97, v97, v208
    v_sub_f32 v98, v98, v208
    v_sub_f32 v99, v99, v208
    v_sub_f32 v100, v100, v208
    v_sub_f32 v101, v101, v208
    v_sub_f32 v102, v102, v208
    v_sub_f32 v103, v103, v208
    v_mul_f32 v36, v36, v212
    v_sub_f32 v164, v164, v209
    v_sub_f32 v165, v165, v209
    v_sub_f32 v166, v166, v209
    v_sub_f32 v167, v167, v209
    v_sub_f32 v72, v72, v209
    v_sub_f32 v73, v73, v209
    v_sub_f32 v74, v74, v209
    v_sub_f32 v75, v75, v209
    v_sub_f32 v76, v76, v209
    v_sub_f32 v77, v77, v209
    v_sub_f32 v78, v78, v209
    v_sub_f32 v79, v79, v209
    v_sub_f32 v104, v104, v209
    v_sub_f32 v105, v105, v209
    v_sub_f32 v106, v106, v209
    v_sub_f32 v107, v107, v209
    v_sub_f32 v108, v108, v209
    v_sub_f32 v109, v109, v209
    v_sub_f32 v110, v110, v209
    v_sub_f32 v111, v111, v209
    v_mul_f32 v37, v37, v213
    v_sub_f32 v168, v168, v210
    v_sub_f32 v169, v169, v210
    v_sub_f32 v170, v170, v210
    v_sub_f32 v171, v171, v210
    v_sub_f32 v80, v80, v210
    v_sub_f32 v81, v81, v210
    v_sub_f32 v82, v82, v210
    v_sub_f32 v83, v83, v210
    v_sub_f32 v84, v84, v210
    v_sub_f32 v85, v85, v210
    v_sub_f32 v86, v86, v210
    v_sub_f32 v87, v87, v210
    v_sub_f32 v112, v112, v210
    v_sub_f32 v113, v113, v210
    v_sub_f32 v114, v114, v210
    v_sub_f32 v115, v115, v210
    v_sub_f32 v116, v116, v210
    v_sub_f32 v117, v117, v210
    v_sub_f32 v118, v118, v210
    v_sub_f32 v119, v119, v210
    v_mul_f32 v38, v38, v214
    v_sub_f32 v172, v172, v211
    v_sub_f32 v173, v173, v211
    v_sub_f32 v174, v174, v211
    v_sub_f32 v175, v175, v211
    v_sub_f32 v88, v88, v211
    v_sub_f32 v89, v89, v211
    v_sub_f32 v90, v90, v211
    v_sub_f32 v91, v91, v211
    v_sub_f32 v92, v92, v211
    v_sub_f32 v93, v93, v211
    v_sub_f32 v94, v94, v211
    v_sub_f32 v95, v95, v211
    v_sub_f32 v120, v120, v211
    v_sub_f32 v121, v121, v211
    v_sub_f32 v122, v122, v211
    v_sub_f32 v123, v123, v211
    v_sub_f32 v124, v124, v211
    v_sub_f32 v125, v125, v211
    v_sub_f32 v126, v126, v211
    v_sub_f32 v127, v127, v211
    v_mul_f32 v39, v39, v215
    v_accvgpr_read_b32 v216, a0
    v_accvgpr_read_b32 v217, a1
    v_accvgpr_read_b32 v218, a2
    v_accvgpr_read_b32 v219, a3
    v_mul_f32 v216, v216, v212
    v_mul_f32 v217, v217, v212
    v_mul_f32 v218, v218, v212
    v_mul_f32 v219, v219, v212
    v_accvgpr_write_b32 a0, v216
    v_accvgpr_write_b32 a1, v217
    v_accvgpr_write_b32 a2, v218
    v_accvgpr_write_b32 a3, v219
    v_accvgpr_read_b32 v216, a4
    v_accvgpr_read_b32 v217, a5
    v_accvgpr_read_b32 v218, a6
    v_accvgpr_read_b32 v219, a7
    v_mul_f32 v216, v216, v213
    v_mul_f32 v217, v217, v213
    v_mul_f32 v218, v218, v213
    v_mul_f32 v219, v219, v213
    v_accvgpr_write_b32 a4, v216
    v_accvgpr_write_b32 a5, v217
    v_accvgpr_write_b32 a6, v218
    v_accvgpr_write_b32 a7, v219
    v_accvgpr_read_b32 v216, a8
    v_accvgpr_read_b32 v217, a9
    v_accvgpr_read_b32 v218, a10
    v_accvgpr_read_b32 v219, a11
    v_mul_f32 v216, v216, v214
    v_mul_f32 v217, v217, v214
    v_mul_f32 v218, v218, v214
    v_mul_f32 v219, v219, v214
    v_accvgpr_write_b32 a8, v216
    v_accvgpr_write_b32 a9, v217
    v_accvgpr_write_b32 a10, v218
    v_accvgpr_write_b32 a11, v219
    v_accvgpr_read_b32 v216, a12
    v_accvgpr_read_b32 v217, a13
    v_accvgpr_read_b32 v218, a14
    v_accvgpr_read_b32 v219, a15
    v_mul_f32 v216, v216, v215
    v_mul_f32 v217, v217, v215
    v_mul_f32 v218, v218, v215
    v_mul_f32 v219, v219, v215
    v_accvgpr_write_b32 a12, v216
    v_accvgpr_write_b32 a13, v217
    v_accvgpr_write_b32 a14, v218
    v_accvgpr_write_b32 a15, v219
    v_accvgpr_read_b32 v216, a16
    v_accvgpr_read_b32 v217, a17
    v_accvgpr_read_b32 v218, a18
    v_accvgpr_read_b32 v219, a19
    v_mul_f32 v216, v216, v212
    v_mul_f32 v217, v217, v212
    v_mul_f32 v218, v218, v212
    v_mul_f32 v219, v219, v212
    v_accvgpr_write_b32 a16, v216
    v_accvgpr_write_b32 a17, v217
    v_accvgpr_write_b32 a18, v218
    v_accvgpr_write_b32 a19, v219
    v_accvgpr_read_b32 v216, a20
    v_accvgpr_read_b32 v217, a21
    v_accvgpr_read_b32 v218, a22
    v_accvgpr_read_b32 v219, a23
    v_mul_f32 v216, v216, v213
    v_mul_f32 v217, v217, v213
    v_mul_f32 v218, v218, v213
    v_mul_f32 v219, v219, v213
    v_accvgpr_write_b32 a20, v216
    v_accvgpr_write_b32 a21, v217
    v_accvgpr_write_b32 a22, v218
    v_accvgpr_write_b32 a23, v219
    v_accvgpr_read_b32 v216, a24
    v_accvgpr_read_b32 v217, a25
    v_accvgpr_read_b32 v218, a26
    v_accvgpr_read_b32 v219, a27
    v_mul_f32 v216, v216, v214
    v_mul_f32 v217, v217, v214
    v_mul_f32 v218, v218, v214
    v_mul_f32 v219, v219, v214
    v_accvgpr_write_b32 a24, v216
    v_accvgpr_write_b32 a25, v217
    v_accvgpr_write_b32 a26, v218
    v_accvgpr_write_b32 a27, v219
    v_accvgpr_read_b32 v216, a28
    v_accvgpr_read_b32 v217, a29
    v_accvgpr_read_b32 v218, a30
    v_accvgpr_read_b32 v219, a31
    v_mul_f32 v216, v216, v215
    v_mul_f32 v217, v217, v215
    v_mul_f32 v218, v218, v215
    v_mul_f32 v219, v219, v215
    v_accvgpr_write_b32 a28, v216
    v_accvgpr_write_b32 a29, v217
    v_accvgpr_write_b32 a30, v218
    v_accvgpr_write_b32 a31, v219
    v_accvgpr_read_b32 v216, a32
    v_accvgpr_read_b32 v217, a33
    v_accvgpr_read_b32 v218, a34
    v_accvgpr_read_b32 v219, a35
    v_mul_f32 v216, v216, v212
    v_mul_f32 v217, v217, v212
    v_mul_f32 v218, v218, v212
    v_mul_f32 v219, v219, v212
    v_accvgpr_write_b32 a32, v216
    v_accvgpr_write_b32 a33, v217
    v_accvgpr_write_b32 a34, v218
    v_accvgpr_write_b32 a35, v219
    v_accvgpr_read_b32 v216, a36
    v_accvgpr_read_b32 v217, a37
    v_accvgpr_read_b32 v218, a38
    v_accvgpr_read_b32 v219, a39
    v_mul_f32 v216, v216, v213
    v_mul_f32 v217, v217, v213
    v_mul_f32 v218, v218, v213
    v_mul_f32 v219, v219, v213
    v_accvgpr_write_b32 a36, v216
    v_accvgpr_write_b32 a37, v217
    v_accvgpr_write_b32 a38, v218
    v_accvgpr_write_b32 a39, v219
    v_accvgpr_read_b32 v216, a40
    v_accvgpr_read_b32 v217, a41
    v_accvgpr_read_b32 v218, a42
    v_accvgpr_read_b32 v219, a43
    v_mul_f32 v216, v216, v214
    v_mul_f32 v217, v217, v214
    v_mul_f32 v218, v218, v214
    v_mul_f32 v219, v219, v214
    v_accvgpr_write_b32 a40, v216
    v_accvgpr_write_b32 a41, v217
    v_accvgpr_write_b32 a42, v218
    v_accvgpr_write_b32 a43, v219
    v_accvgpr_read_b32 v216, a44
    v_accvgpr_read_b32 v217, a45
    v_accvgpr_read_b32 v218, a46
    v_accvgpr_read_b32 v219, a47
    v_mul_f32 v216, v216, v215
    v_mul_f32 v217, v217, v215
    v_mul_f32 v218, v218, v215
    v_mul_f32 v219, v219, v215
    v_accvgpr_write_b32 a44, v216
    v_accvgpr_write_b32 a45, v217
    v_accvgpr_write_b32 a46, v218
    v_accvgpr_write_b32 a47, v219
    v_accvgpr_read_b32 v216, a48
    v_accvgpr_read_b32 v217, a49
    v_accvgpr_read_b32 v218, a50
    v_accvgpr_read_b32 v219, a51
    v_mul_f32 v216, v216, v212
    v_mul_f32 v217, v217, v212
    v_mul_f32 v218, v218, v212
    v_mul_f32 v219, v219, v212
    v_accvgpr_write_b32 a48, v216
    v_accvgpr_write_b32 a49, v217
    v_accvgpr_write_b32 a50, v218
    v_accvgpr_write_b32 a51, v219
    v_accvgpr_read_b32 v216, a52
    v_accvgpr_read_b32 v217, a53
    v_accvgpr_read_b32 v218, a54
    v_accvgpr_read_b32 v219, a55
    v_mul_f32 v216, v216, v213
    v_mul_f32 v217, v217, v213
    v_mul_f32 v218, v218, v213
    v_mul_f32 v219, v219, v213
    v_accvgpr_write_b32 a52, v216
    v_accvgpr_write_b32 a53, v217
    v_accvgpr_write_b32 a54, v218
    v_accvgpr_write_b32 a55, v219
    v_accvgpr_read_b32 v216, a56
    v_accvgpr_read_b32 v217, a57
    v_accvgpr_read_b32 v218, a58
    v_accvgpr_read_b32 v219, a59
    v_mul_f32 v216, v216, v214
    v_mul_f32 v217, v217, v214
    v_mul_f32 v218, v218, v214
    v_mul_f32 v219, v219, v214
    v_accvgpr_write_b32 a56, v216
    v_accvgpr_write_b32 a57, v217
    v_accvgpr_write_b32 a58, v218
    v_accvgpr_write_b32 a59, v219
    v_accvgpr_read_b32 v216, a60
    v_accvgpr_read_b32 v217, a61
    v_accvgpr_read_b32 v218, a62
    v_accvgpr_read_b32 v219, a63
    v_mul_f32 v216, v216, v215
    v_mul_f32 v217, v217, v215
    v_mul_f32 v218, v218, v215
    v_mul_f32 v219, v219, v215
    v_accvgpr_write_b32 a60, v216
    v_accvgpr_write_b32 a61, v217
    v_accvgpr_write_b32 a62, v218
    v_accvgpr_write_b32 a63, v219
    v_accvgpr_read_b32 v216, a64
    v_accvgpr_read_b32 v217, a65
    v_accvgpr_read_b32 v218, a66
    v_accvgpr_read_b32 v219, a67
    v_mul_f32 v216, v216, v212
    v_mul_f32 v217, v217, v212
    v_mul_f32 v218, v218, v212
    v_mul_f32 v219, v219, v212
    v_accvgpr_write_b32 a64, v216
    v_accvgpr_write_b32 a65, v217
    v_accvgpr_write_b32 a66, v218
    v_accvgpr_write_b32 a67, v219
    v_accvgpr_read_b32 v216, a68
    v_accvgpr_read_b32 v217, a69
    v_accvgpr_read_b32 v218, a70
    v_accvgpr_read_b32 v219, a71
    v_mul_f32 v216, v216, v213
    v_mul_f32 v217, v217, v213
    v_mul_f32 v218, v218, v213
    v_mul_f32 v219, v219, v213
    v_accvgpr_write_b32 a68, v216
    v_accvgpr_write_b32 a69, v217
    v_accvgpr_write_b32 a70, v218
    v_accvgpr_write_b32 a71, v219
    v_accvgpr_read_b32 v216, a72
    v_accvgpr_read_b32 v217, a73
    v_accvgpr_read_b32 v218, a74
    v_accvgpr_read_b32 v219, a75
    v_mul_f32 v216, v216, v214
    v_mul_f32 v217, v217, v214
    v_mul_f32 v218, v218, v214
    v_mul_f32 v219, v219, v214
    v_accvgpr_write_b32 a72, v216
    v_accvgpr_write_b32 a73, v217
    v_accvgpr_write_b32 a74, v218
    v_accvgpr_write_b32 a75, v219
    v_accvgpr_read_b32 v216, a76
    v_accvgpr_read_b32 v217, a77
    v_accvgpr_read_b32 v218, a78
    v_accvgpr_read_b32 v219, a79
    v_mul_f32 v216, v216, v215
    v_mul_f32 v217, v217, v215
    v_mul_f32 v218, v218, v215
    v_mul_f32 v219, v219, v215
    v_accvgpr_write_b32 a76, v216
    v_accvgpr_write_b32 a77, v217
    v_accvgpr_write_b32 a78, v218
    v_accvgpr_write_b32 a79, v219
    v_accvgpr_read_b32 v216, a80
    v_accvgpr_read_b32 v217, a81
    v_accvgpr_read_b32 v218, a82
    v_accvgpr_read_b32 v219, a83
    v_mul_f32 v216, v216, v212
    v_mul_f32 v217, v217, v212
    v_mul_f32 v218, v218, v212
    v_mul_f32 v219, v219, v212
    v_accvgpr_write_b32 a80, v216
    v_accvgpr_write_b32 a81, v217
    v_accvgpr_write_b32 a82, v218
    v_accvgpr_write_b32 a83, v219
    v_accvgpr_read_b32 v216, a84
    v_accvgpr_read_b32 v217, a85
    v_accvgpr_read_b32 v218, a86
    v_accvgpr_read_b32 v219, a87
    v_mul_f32 v216, v216, v213
    v_mul_f32 v217, v217, v213
    v_mul_f32 v218, v218, v213
    v_mul_f32 v219, v219, v213
    v_accvgpr_write_b32 a84, v216
    v_accvgpr_write_b32 a85, v217
    v_accvgpr_write_b32 a86, v218
    v_accvgpr_write_b32 a87, v219
    v_accvgpr_read_b32 v216, a88
    v_accvgpr_read_b32 v217, a89
    v_accvgpr_read_b32 v218, a90
    v_accvgpr_read_b32 v219, a91
    v_mul_f32 v216, v216, v214
    v_mul_f32 v217, v217, v214
    v_mul_f32 v218, v218, v214
    v_mul_f32 v219, v219, v214
    v_accvgpr_write_b32 a88, v216
    v_accvgpr_write_b32 a89, v217
    v_accvgpr_write_b32 a90, v218
    v_accvgpr_write_b32 a91, v219
    v_accvgpr_read_b32 v216, a92
    v_accvgpr_read_b32 v217, a93
    v_accvgpr_read_b32 v218, a94
    v_accvgpr_read_b32 v219, a95
    v_mul_f32 v216, v216, v215
    v_mul_f32 v217, v217, v215
    v_mul_f32 v218, v218, v215
    v_mul_f32 v219, v219, v215
    v_accvgpr_write_b32 a92, v216
    v_accvgpr_write_b32 a93, v217
    v_accvgpr_write_b32 a94, v218
    v_accvgpr_write_b32 a95, v219
    v_accvgpr_read_b32 v216, a96
    v_accvgpr_read_b32 v217, a97
    v_accvgpr_read_b32 v218, a98
    v_accvgpr_read_b32 v219, a99
    v_mul_f32 v216, v216, v212
    v_mul_f32 v217, v217, v212
    v_mul_f32 v218, v218, v212
    v_mul_f32 v219, v219, v212
    v_accvgpr_write_b32 a96, v216
    v_accvgpr_write_b32 a97, v217
    v_accvgpr_write_b32 a98, v218
    v_accvgpr_write_b32 a99, v219
    v_accvgpr_read_b32 v216, a100
    v_accvgpr_read_b32 v217, a101
    v_accvgpr_read_b32 v218, a102
    v_accvgpr_read_b32 v219, a103
    v_mul_f32 v216, v216, v213
    v_mul_f32 v217, v217, v213
    v_mul_f32 v218, v218, v213
    v_mul_f32 v219, v219, v213
    v_accvgpr_write_b32 a100, v216
    v_accvgpr_write_b32 a101, v217
    v_accvgpr_write_b32 a102, v218
    v_accvgpr_write_b32 a103, v219
    v_accvgpr_read_b32 v216, a104
    v_accvgpr_read_b32 v217, a105
    v_accvgpr_read_b32 v218, a106
    v_accvgpr_read_b32 v219, a107
    v_mul_f32 v216, v216, v214
    v_mul_f32 v217, v217, v214
    v_mul_f32 v218, v218, v214
    v_mul_f32 v219, v219, v214
    v_accvgpr_write_b32 a104, v216
    v_accvgpr_write_b32 a105, v217
    v_accvgpr_write_b32 a106, v218
    v_accvgpr_write_b32 a107, v219
    v_accvgpr_read_b32 v216, a108
    v_accvgpr_read_b32 v217, a109
    v_accvgpr_read_b32 v218, a110
    v_accvgpr_read_b32 v219, a111
    v_mul_f32 v216, v216, v215
    v_mul_f32 v217, v217, v215
    v_mul_f32 v218, v218, v215
    v_mul_f32 v219, v219, v215
    v_accvgpr_write_b32 a108, v216
    v_accvgpr_write_b32 a109, v217
    v_accvgpr_write_b32 a110, v218
    v_accvgpr_write_b32 a111, v219
    v_accvgpr_read_b32 v216, a112
    v_accvgpr_read_b32 v217, a113
    v_accvgpr_read_b32 v218, a114
    v_accvgpr_read_b32 v219, a115
    v_mul_f32 v216, v216, v212
    v_mul_f32 v217, v217, v212
    v_mul_f32 v218, v218, v212
    v_mul_f32 v219, v219, v212
    v_accvgpr_write_b32 a112, v216
    v_accvgpr_write_b32 a113, v217
    v_accvgpr_write_b32 a114, v218
    v_accvgpr_write_b32 a115, v219
    v_accvgpr_read_b32 v216, a116
    v_accvgpr_read_b32 v217, a117
    v_accvgpr_read_b32 v218, a118
    v_accvgpr_read_b32 v219, a119
    v_mul_f32 v216, v216, v213
    v_mul_f32 v217, v217, v213
    v_mul_f32 v218, v218, v213
    v_mul_f32 v219, v219, v213
    v_accvgpr_write_b32 a116, v216
    v_accvgpr_write_b32 a117, v217
    v_accvgpr_write_b32 a118, v218
    v_accvgpr_write_b32 a119, v219
    v_accvgpr_read_b32 v216, a120
    v_accvgpr_read_b32 v217, a121
    v_accvgpr_read_b32 v218, a122
    v_accvgpr_read_b32 v219, a123
    v_mul_f32 v216, v216, v214
    v_mul_f32 v217, v217, v214
    v_mul_f32 v218, v218, v214
    v_mul_f32 v219, v219, v214
    v_accvgpr_write_b32 a120, v216
    v_accvgpr_write_b32 a121, v217
    v_accvgpr_write_b32 a122, v218
    v_accvgpr_write_b32 a123, v219
    v_accvgpr_read_b32 v216, a124
    v_accvgpr_read_b32 v217, a125
    v_accvgpr_read_b32 v218, a126
    v_accvgpr_read_b32 v219, a127
    v_mul_f32 v216, v216, v215
    v_mul_f32 v217, v217, v215
    v_mul_f32 v218, v218, v215
    v_mul_f32 v219, v219, v215
    v_accvgpr_write_b32 a124, v216
    v_accvgpr_write_b32 a125, v217
    v_accvgpr_write_b32 a126, v218
    v_accvgpr_write_b32 a127, v219
    v_exp_f32 v208, v64
    v_exp_f32 v209, v65
    v_exp_f32 v210, v66
    v_exp_f32 v211, v67
    v_exp_f32 v212, v68
    v_exp_f32 v213, v69
    v_exp_f32 v214, v70
    v_exp_f32 v215, v71
    s_nop 0
    v_cvt_pk_bf16_f32 v128, v208, v209
    v_cvt_pk_bf16_f32 v129, v210, v211
    v_cvt_pk_bf16_f32 v130, v212, v213
    v_cvt_pk_bf16_f32 v131, v214, v215
    v_add_f32 v32, v36, v208
    v_add_f32 v32, v32, v209
    v_add_f32 v32, v32, v210
    v_add_f32 v32, v32, v211
    v_add_f32 v32, v32, v212
    v_add_f32 v32, v32, v213
    v_add_f32 v32, v32, v214
    v_add_f32 v32, v32, v215
    v_exp_f32 v216, v72
    v_exp_f32 v217, v73
    v_exp_f32 v218, v74
    v_exp_f32 v219, v75
    v_exp_f32 v220, v76
    v_exp_f32 v221, v77
    v_exp_f32 v222, v78
    v_exp_f32 v223, v79
    s_nop 0
    v_cvt_pk_bf16_f32 v132, v216, v217
    v_cvt_pk_bf16_f32 v133, v218, v219
    v_cvt_pk_bf16_f32 v134, v220, v221
    v_cvt_pk_bf16_f32 v135, v222, v223
    v_add_f32 v33, v37, v216
    v_add_f32 v33, v33, v217
    v_add_f32 v33, v33, v218
    v_add_f32 v33, v33, v219
    v_add_f32 v33, v33, v220
    v_add_f32 v33, v33, v221
    v_add_f32 v33, v33, v222
    v_add_f32 v33, v33, v223
    v_exp_f32 v208, v80
    v_exp_f32 v209, v81
    v_exp_f32 v210, v82
    v_exp_f32 v211, v83
    v_exp_f32 v212, v84
    v_exp_f32 v213, v85
    v_exp_f32 v214, v86
    v_exp_f32 v215, v87
    s_nop 0
    v_cvt_pk_bf16_f32 v136, v208, v209
    v_cvt_pk_bf16_f32 v137, v210, v211
    v_cvt_pk_bf16_f32 v138, v212, v213
    v_cvt_pk_bf16_f32 v139, v214, v215
    v_add_f32 v34, v38, v208
    v_add_f32 v34, v34, v209
    v_add_f32 v34, v34, v210
    v_add_f32 v34, v34, v211
    v_add_f32 v34, v34, v212
    v_add_f32 v34, v34, v213
    v_add_f32 v34, v34, v214
    v_add_f32 v34, v34, v215
    v_exp_f32 v216, v88
    v_exp_f32 v217, v89
    v_exp_f32 v218, v90
    v_exp_f32 v219, v91
    v_exp_f32 v220, v92
    v_exp_f32 v221, v93
    v_exp_f32 v222, v94
    v_exp_f32 v223, v95
    s_nop 0
    v_cvt_pk_bf16_f32 v140, v216, v217
    v_cvt_pk_bf16_f32 v141, v218, v219
    v_cvt_pk_bf16_f32 v142, v220, v221
    v_cvt_pk_bf16_f32 v143, v222, v223
    v_add_f32 v35, v39, v216
    v_add_f32 v35, v35, v217
    v_add_f32 v35, v35, v218
    v_add_f32 v35, v35, v219
    v_add_f32 v35, v35, v220
    v_add_f32 v35, v35, v221
    v_add_f32 v35, v35, v222
    v_add_f32 v35, v35, v223
    s_nop 1
    s_cmp_eq_u32 s25, 0
    s_cbranch_scc1 L_ctl_first
    s_cmp_eq_u32 s25, 1
    s_cbranch_scc1 L_loop
    s_branch L_last
L_rare1:
    s_nop 7
    v_max3_f32 v208, v96, v97, v98
    v_max3_f32 v209, v104, v105, v106
    v_max3_f32 v210, v112, v113, v114
    v_max3_f32 v211, v120, v121, v122
    v_max3_f32 v208, v208, v99, v100
    v_max3_f32 v209, v209, v107, v108
    v_max3_f32 v210, v210, v115, v116
    v_max3_f32 v211, v211, v123, v124
    v_max3_f32 v208, v208, v101, v102
    v_max3_f32 v209, v209, v109, v110
    v_max3_f32 v210, v210, v117, v118
    v_max3_f32 v211, v211, v125, v126
    v_max_f32 v208, v208, v103
    v_max_f32 v209, v209, v111
    v_max_f32 v210, v210, v119
    v_max_f32 v211, v211, v127
    v_mov_b32 v212, v208
    v_mov_b32 v213, v209
    v_mov_b32 v214, v210
    v_mov_b32 v215, v211
    v_permlane16_swap_b32 v212, v208
    v_permlane16_swap_b32 v213, v209
    v_permlane16_swap_b32 v214, v210
    v_permlane16_swap_b32 v215, v211
    v_max_f32 v208, v208, v212
    v_max_f32 v209, v209, v213
    v_max_f32 v210, v210, v214
    v_max_f32 v211, v211, v215
    v_mov_b32 v212, v208
    v_mov_b32 v213, v209
    v_mov_b32 v214, v210
    v_mov_b32 v215, v211
    v_permlane32_swap_b32 v212, v208
    v_permlane32_swap_b32 v213, v209
    v_permlane32_swap_b32 v214, v210
    v_permlane32_swap_b32 v215, v211
    v_max_f32 v208, v208, v212
    v_max_f32 v209, v209, v213
    v_max_f32 v210, v210, v214
    v_max_f32 v211, v211, v215
    v_max_f32 v208, 0, v208
    v_max_f32 v209, 0, v209
    v_max_f32 v210, 0, v210
    v_max_f32 v211, 0, v211
    v_exp_f32 v212, -v208
    v_exp_f32 v213, -v209
    v_exp_f32 v214, -v210
    v_exp_f32 v215, -v211
    v_sub_f32 v160, v160, v208
    v_sub_f32 v161, v161, v208
    v_sub_f32 v162, v162, v208
    v_sub_f32 v163, v163, v208
    v_sub_f32 v64, v64, v208
    v_sub_f32 v65, v65, v208
    v_sub_f32 v66, v66, v208
    v_sub_f32 v67, v67, v208
    v_sub_f32 v68, v68, v208
    v_sub_f32 v69, v69, v208
    v_sub_f32 v70, v70, v208
    v_sub_f32 v71, v71, v208
    v_sub_f32 v96, v96, v208
    v_sub_f32 v97, v97, v208
    v_sub_f32 v98, v98, v208
    v_sub_f32 v99, v99, v208
    v_sub_f32 v100, v100, v208
    v_sub_f32 v101, v101, v208
    v_sub_f32 v102, v102, v208
    v_sub_f32 v103, v103, v208
    v_mul_f32 v32, v32, v212
    v_sub_f32 v164, v164, v209
    v_sub_f32 v165, v165, v209
    v_sub_f32 v166, v166, v209
    v_sub_f32 v167, v167, v209
    v_sub_f32 v72, v72, v209
    v_sub_f32 v73, v73, v209
    v_sub_f32 v74, v74, v209
    v_sub_f32 v75, v75, v209
    v_sub_f32 v76, v76, v209
    v_sub_f32 v77, v77, v209
    v_sub_f32 v78, v78, v209
    v_sub_f32 v79, v79, v209
    v_sub_f32 v104, v104, v209
    v_sub_f32 v105, v105, v209
    v_sub_f32 v106, v106, v209
    v_sub_f32 v107, v107, v209
    v_sub_f32 v108, v108, v209
    v_sub_f32 v109, v109, v209
    v_sub_f32 v110, v110, v209
    v_sub_f32 v111, v111, v209
    v_mul_f32 v33, v33, v213
    v_sub_f32 v168, v168, v210
    v_sub_f32 v169, v169, v210
    v_sub_f32 v170, v170, v210
    v_sub_f32 v171, v171, v210
    v_sub_f32 v80, v80, v210
    v_sub_f32 v81, v81, v210
    v_sub_f32 v82, v82, v210
    v_sub_f32 v83, v83, v210
    v_sub_f32 v84, v84, v210
    v_sub_f32 v85, v85, v210
    v_sub_f32 v86, v86, v210
    v_sub_f32 v87, v87, v210
    v_sub_f32 v112, v112, v210
    v_sub_f32 v113, v113, v210
    v_sub_f32 v114, v114, v210
    v_sub_f32 v115, v115, v210
    v_sub_f32 v116, v116, v210
    v_sub_f32 v117, v117, v210
    v_sub_f32 v118, v118, v210
    v_sub_f32 v119, v119, v210
    v_mul_f32 v34, v34, v214
    v_sub_f32 v172, v172, v211
    v_sub_f32 v173, v173, v211
    v_sub_f32 v174, v174, v211
    v_sub_f32 v175, v175, v211
    v_sub_f32 v88, v88, v211
    v_sub_f32 v89, v89, v211
    v_sub_f32 v90, v90, v211
    v_sub_f32 v91, v91, v211
    v_sub_f32 v92, v92, v211
    v_sub_f32 v93, v93, v211
    v_sub_f32 v94, v94, v211
    v_sub_f32 v95, v95, v211
    v_sub_f32 v120, v120, v211
    v_sub_f32 v121, v121, v211
    v_sub_f32 v122, v122, v211
    v_sub_f32 v123, v123, v211
    v_sub_f32 v124, v124, v211
    v_sub_f32 v125, v125, v211
    v_sub_f32 v126, v126, v211
    v_sub_f32 v127, v127, v211
    v_mul_f32 v35, v35, v215
    v_accvgpr_read_b32 v216, a0
    v_accvgpr_read_b32 v217, a1
    v_accvgpr_read_b32 v218, a2
    v_accvgpr_read_b32 v219, a3
    v_mul_f32 v216, v216, v212
    v_mul_f32 v217, v217, v212
    v_mul_f32 v218, v218, v212
    v_mul_f32 v219, v219, v212
    v_accvgpr_write_b32 a0, v216
    v_accvgpr_write_b32 a1, v217
    v_accvgpr_write_b32 a2, v218
    v_accvgpr_write_b32 a3, v219
    v_accvgpr_read_b32 v216, a4
    v_accvgpr_read_b32 v217, a5
    v_accvgpr_read_b32 v218, a6
    v_accvgpr_read_b32 v219, a7
    v_mul_f32 v216, v216, v213
    v_mul_f32 v217, v217, v213
    v_mul_f32 v218, v218, v213
    v_mul_f32 v219, v219, v213
    v_accvgpr_write_b32 a4, v216
    v_accvgpr_write_b32 a5, v217
    v_accvgpr_write_b32 a6, v218
    v_accvgpr_write_b32 a7, v219
    v_accvgpr_read_b32 v216, a8
    v_accvgpr_read_b32 v217, a9
    v_accvgpr_read_b32 v218, a10
    v_accvgpr_read_b32 v219, a11
    v_mul_f32 v216, v216, v214
    v_mul_f32 v217, v217, v214
    v_mul_f32 v218, v218, v214
    v_mul_f32 v219, v219, v214
    v_accvgpr_write_b32 a8, v216
    v_accvgpr_write_b32 a9, v217
    v_accvgpr_write_b32 a10, v218
    v_accvgpr_write_b32 a11, v219
    v_accvgpr_read_b32 v216, a12
    v_accvgpr_read_b32 v217, a13
    v_accvgpr_read_b32 v218, a14
    v_accvgpr_read_b32 v219, a15
    v_mul_f32 v216, v216, v215
    v_mul_f32 v217, v217, v215
    v_mul_f32 v218, v218, v215
    v_mul_f32 v219, v219, v215
    v_accvgpr_write_b32 a12, v216
    v_accvgpr_write_b32 a13, v217
    v_accvgpr_write_b32 a14, v218
    v_accvgpr_write_b32 a15, v219
    v_accvgpr_read_b32 v216, a16
    v_accvgpr_read_b32 v217, a17
    v_accvgpr_read_b32 v218, a18
    v_accvgpr_read_b32 v219, a19
    v_mul_f32 v216, v216, v212
    v_mul_f32 v217, v217, v212
    v_mul_f32 v218, v218, v212
    v_mul_f32 v219, v219, v212
    v_accvgpr_write_b32 a16, v216
    v_accvgpr_write_b32 a17, v217
    v_accvgpr_write_b32 a18, v218
    v_accvgpr_write_b32 a19, v219
    v_accvgpr_read_b32 v216, a20
    v_accvgpr_read_b32 v217, a21
    v_accvgpr_read_b32 v218, a22
    v_accvgpr_read_b32 v219, a23
    v_mul_f32 v216, v216, v213
    v_mul_f32 v217, v217, v213
    v_mul_f32 v218, v218, v213
    v_mul_f32 v219, v219, v213
    v_accvgpr_write_b32 a20, v216
    v_accvgpr_write_b32 a21, v217
    v_accvgpr_write_b32 a22, v218
    v_accvgpr_write_b32 a23, v219
    v_accvgpr_read_b32 v216, a24
    v_accvgpr_read_b32 v217, a25
    v_accvgpr_read_b32 v218, a26
    v_accvgpr_read_b32 v219, a27
    v_mul_f32 v216, v216, v214
    v_mul_f32 v217, v217, v214
    v_mul_f32 v218, v218, v214
    v_mul_f32 v219, v219, v214
    v_accvgpr_write_b32 a24, v216
    v_accvgpr_write_b32 a25, v217
    v_accvgpr_write_b32 a26, v218
    v_accvgpr_write_b32 a27, v219
    v_accvgpr_read_b32 v216, a28
    v_accvgpr_read_b32 v217, a29
    v_accvgpr_read_b32 v218, a30
    v_accvgpr_read_b32 v219, a31
    v_mul_f32 v216, v216, v215
    v_mul_f32 v217, v217, v215
    v_mul_f32 v218, v218, v215
    v_mul_f32 v219, v219, v215
    v_accvgpr_write_b32 a28, v216
    v_accvgpr_write_b32 a29, v217
    v_accvgpr_write_b32 a30, v218
    v_accvgpr_write_b32 a31, v219
    v_accvgpr_read_b32 v216, a32
    v_accvgpr_read_b32 v217, a33
    v_accvgpr_read_b32 v218, a34
    v_accvgpr_read_b32 v219, a35
    v_mul_f32 v216, v216, v212
    v_mul_f32 v217, v217, v212
    v_mul_f32 v218, v218, v212
    v_mul_f32 v219, v219, v212
    v_accvgpr_write_b32 a32, v216
    v_accvgpr_write_b32 a33, v217
    v_accvgpr_write_b32 a34, v218
    v_accvgpr_write_b32 a35, v219
    v_accvgpr_read_b32 v216, a36
    v_accvgpr_read_b32 v217, a37
    v_accvgpr_read_b32 v218, a38
    v_accvgpr_read_b32 v219, a39
    v_mul_f32 v216, v216, v213
    v_mul_f32 v217, v217, v213
    v_mul_f32 v218, v218, v213
    v_mul_f32 v219, v219, v213
    v_accvgpr_write_b32 a36, v216
    v_accvgpr_write_b32 a37, v217
    v_accvgpr_write_b32 a38, v218
    v_accvgpr_write_b32 a39, v219
    v_accvgpr_read_b32 v216, a40
    v_accvgpr_read_b32 v217, a41
    v_accvgpr_read_b32 v218, a42
    v_accvgpr_read_b32 v219, a43
    v_mul_f32 v216, v216, v214
    v_mul_f32 v217, v217, v214
    v_mul_f32 v218, v218, v214
    v_mul_f32 v219, v219, v214
    v_accvgpr_write_b32 a40, v216
    v_accvgpr_write_b32 a41, v217
    v_accvgpr_write_b32 a42, v218
    v_accvgpr_write_b32 a43, v219
    v_accvgpr_read_b32 v216, a44
    v_accvgpr_read_b32 v217, a45
    v_accvgpr_read_b32 v218, a46
    v_accvgpr_read_b32 v219, a47
    v_mul_f32 v216, v216, v215
    v_mul_f32 v217, v217, v215
    v_mul_f32 v218, v218, v215
    v_mul_f32 v219, v219, v215
    v_accvgpr_write_b32 a44, v216
    v_accvgpr_write_b32 a45, v217
    v_accvgpr_write_b32 a46, v218
    v_accvgpr_write_b32 a47, v219
    v_accvgpr_read_b32 v216, a48
    v_accvgpr_read_b32 v217, a49
    v_accvgpr_read_b32 v218, a50
    v_accvgpr_read_b32 v219, a51
    v_mul_f32 v216, v216, v212
    v_mul_f32 v217, v217, v212
    v_mul_f32 v218, v218, v212
    v_mul_f32 v219, v219, v212
    v_accvgpr_write_b32 a48, v216
    v_accvgpr_write_b32 a49, v217
    v_accvgpr_write_b32 a50, v218
    v_accvgpr_write_b32 a51, v219
    v_accvgpr_read_b32 v216, a52
    v_accvgpr_read_b32 v217, a53
    v_accvgpr_read_b32 v218, a54
    v_accvgpr_read_b32 v219, a55
    v_mul_f32 v216, v216, v213
    v_mul_f32 v217, v217, v213
    v_mul_f32 v218, v218, v213
    v_mul_f32 v219, v219, v213
    v_accvgpr_write_b32 a52, v216
    v_accvgpr_write_b32 a53, v217
    v_accvgpr_write_b32 a54, v218
    v_accvgpr_write_b32 a55, v219
    v_accvgpr_read_b32 v216, a56
    v_accvgpr_read_b32 v217, a57
    v_accvgpr_read_b32 v218, a58
    v_accvgpr_read_b32 v219, a59
    v_mul_f32 v216, v216, v214
    v_mul_f32 v217, v217, v214
    v_mul_f32 v218, v218, v214
    v_mul_f32 v219, v219, v214
    v_accvgpr_write_b32 a56, v216
    v_accvgpr_write_b32 a57, v217
    v_accvgpr_write_b32 a58, v218
    v_accvgpr_write_b32 a59, v219
    v_accvgpr_read_b32 v216, a60
    v_accvgpr_read_b32 v217, a61
    v_accvgpr_read_b32 v218, a62
    v_accvgpr_read_b32 v219, a63
    v_mul_f32 v216, v216, v215
    v_mul_f32 v217, v217, v215
    v_mul_f32 v218, v218, v215
    v_mul_f32 v219, v219, v215
    v_accvgpr_write_b32 a60, v216
    v_accvgpr_write_b32 a61, v217
    v_accvgpr_write_b32 a62, v218
    v_accvgpr_write_b32 a63, v219
    v_accvgpr_read_b32 v216, a64
    v_accvgpr_read_b32 v217, a65
    v_accvgpr_read_b32 v218, a66
    v_accvgpr_read_b32 v219, a67
    v_mul_f32 v216, v216, v212
    v_mul_f32 v217, v217, v212
    v_mul_f32 v218, v218, v212
    v_mul_f32 v219, v219, v212
    v_accvgpr_write_b32 a64, v216
    v_accvgpr_write_b32 a65, v217
    v_accvgpr_write_b32 a66, v218
    v_accvgpr_write_b32 a67, v219
    v_accvgpr_read_b32 v216, a68
    v_accvgpr_read_b32 v217, a69
    v_accvgpr_read_b32 v218, a70
    v_accvgpr_read_b32 v219, a71
    v_mul_f32 v216, v216, v213
    v_mul_f32 v217, v217, v213
    v_mul_f32 v218, v218, v213
    v_mul_f32 v219, v219, v213
    v_accvgpr_write_b32 a68, v216
    v_accvgpr_write_b32 a69, v217
    v_accvgpr_write_b32 a70, v218
    v_accvgpr_write_b32 a71, v219
    v_accvgpr_read_b32 v216, a72
    v_accvgpr_read_b32 v217, a73
    v_accvgpr_read_b32 v218, a74
    v_accvgpr_read_b32 v219, a75
    v_mul_f32 v216, v216, v214
    v_mul_f32 v217, v217, v214
    v_mul_f32 v218, v218, v214
    v_mul_f32 v219, v219, v214
    v_accvgpr_write_b32 a72, v216
    v_accvgpr_write_b32 a73, v217
    v_accvgpr_write_b32 a74, v218
    v_accvgpr_write_b32 a75, v219
    v_accvgpr_read_b32 v216, a76
    v_accvgpr_read_b32 v217, a77
    v_accvgpr_read_b32 v218, a78
    v_accvgpr_read_b32 v219, a79
    v_mul_f32 v216, v216, v215
    v_mul_f32 v217, v217, v215
    v_mul_f32 v218, v218, v215
    v_mul_f32 v219, v219, v215
    v_accvgpr_write_b32 a76, v216
    v_accvgpr_write_b32 a77, v217
    v_accvgpr_write_b32 a78, v218
    v_accvgpr_write_b32 a79, v219
    v_accvgpr_read_b32 v216, a80
    v_accvgpr_read_b32 v217, a81
    v_accvgpr_read_b32 v218, a82
    v_accvgpr_read_b32 v219, a83
    v_mul_f32 v216, v216, v212
    v_mul_f32 v217, v217, v212
    v_mul_f32 v218, v218, v212
    v_mul_f32 v219, v219, v212
    v_accvgpr_write_b32 a80, v216
    v_accvgpr_write_b32 a81, v217
    v_accvgpr_write_b32 a82, v218
    v_accvgpr_write_b32 a83, v219
    v_accvgpr_read_b32 v216, a84
    v_accvgpr_read_b32 v217, a85
    v_accvgpr_read_b32 v218, a86
    v_accvgpr_read_b32 v219, a87
    v_mul_f32 v216, v216, v213
    v_mul_f32 v217, v217, v213
    v_mul_f32 v218, v218, v213
    v_mul_f32 v219, v219, v213
    v_accvgpr_write_b32 a84, v216
    v_accvgpr_write_b32 a85, v217
    v_accvgpr_write_b32 a86, v218
    v_accvgpr_write_b32 a87, v219
    v_accvgpr_read_b32 v216, a88
    v_accvgpr_read_b32 v217, a89
    v_accvgpr_read_b32 v218, a90
    v_accvgpr_read_b32 v219, a91
    v_mul_f32 v216, v216, v214
    v_mul_f32 v217, v217, v214
    v_mul_f32 v218, v218, v214
    v_mul_f32 v219, v219, v214
    v_accvgpr_write_b32 a88, v216
    v_accvgpr_write_b32 a89, v217
    v_accvgpr_write_b32 a90, v218
    v_accvgpr_write_b32 a91, v219
    v_accvgpr_read_b32 v216, a92
    v_accvgpr_read_b32 v217, a93
    v_accvgpr_read_b32 v218, a94
    v_accvgpr_read_b32 v219, a95
    v_mul_f32 v216, v216, v215
    v_mul_f32 v217, v217, v215
    v_mul_f32 v218, v218, v215
    v_mul_f32 v219, v219, v215
    v_accvgpr_write_b32 a92, v216
    v_accvgpr_write_b32 a93, v217
    v_accvgpr_write_b32 a94, v218
    v_accvgpr_write_b32 a95, v219
    v_accvgpr_read_b32 v216, a96
    v_accvgpr_read_b32 v217, a97
    v_accvgpr_read_b32 v218, a98
    v_accvgpr_read_b32 v219, a99
    v_mul_f32 v216, v216, v212
    v_mul_f32 v217, v217, v212
    v_mul_f32 v218, v218, v212
    v_mul_f32 v219, v219, v212
    v_accvgpr_write_b32 a96, v216
    v_accvgpr_write_b32 a97, v217
    v_accvgpr_write_b32 a98, v218
    v_accvgpr_write_b32 a99, v219
    v_accvgpr_read_b32 v216, a100
    v_accvgpr_read_b32 v217, a101
    v_accvgpr_read_b32 v218, a102
    v_accvgpr_read_b32 v219, a103
    v_mul_f32 v216, v216, v213
    v_mul_f32 v217, v217, v213
    v_mul_f32 v218, v218, v213
    v_mul_f32 v219, v219, v213
    v_accvgpr_write_b32 a100, v216
    v_accvgpr_write_b32 a101, v217
    v_accvgpr_write_b32 a102, v218
    v_accvgpr_write_b32 a103, v219
    v_accvgpr_read_b32 v216, a104
    v_accvgpr_read_b32 v217, a105
    v_accvgpr_read_b32 v218, a106
    v_accvgpr_read_b32 v219, a107
    v_mul_f32 v216, v216, v214
    v_mul_f32 v217, v217, v214
    v_mul_f32 v218, v218, v214
    v_mul_f32 v219, v219, v214
    v_accvgpr_write_b32 a104, v216
    v_accvgpr_write_b32 a105, v217
    v_accvgpr_write_b32 a106, v218
    v_accvgpr_write_b32 a107, v219
    v_accvgpr_read_b32 v216, a108
    v_accvgpr_read_b32 v217, a109
    v_accvgpr_read_b32 v218, a110
    v_accvgpr_read_b32 v219, a111
    v_mul_f32 v216, v216, v215
    v_mul_f32 v217, v217, v215
    v_mul_f32 v218, v218, v215
    v_mul_f32 v219, v219, v215
    v_accvgpr_write_b32 a108, v216
    v_accvgpr_write_b32 a109, v217
    v_accvgpr_write_b32 a110, v218
    v_accvgpr_write_b32 a111, v219
    v_accvgpr_read_b32 v216, a112
    v_accvgpr_read_b32 v217, a113
    v_accvgpr_read_b32 v218, a114
    v_accvgpr_read_b32 v219, a115
    v_mul_f32 v216, v216, v212
    v_mul_f32 v217, v217, v212
    v_mul_f32 v218, v218, v212
    v_mul_f32 v219, v219, v212
    v_accvgpr_write_b32 a112, v216
    v_accvgpr_write_b32 a113, v217
    v_accvgpr_write_b32 a114, v218
    v_accvgpr_write_b32 a115, v219
    v_accvgpr_read_b32 v216, a116
    v_accvgpr_read_b32 v217, a117
    v_accvgpr_read_b32 v218, a118
    v_accvgpr_read_b32 v219, a119
    v_mul_f32 v216, v216, v213
    v_mul_f32 v217, v217, v213
    v_mul_f32 v218, v218, v213
    v_mul_f32 v219, v219, v213
    v_accvgpr_write_b32 a116, v216
    v_accvgpr_write_b32 a117, v217
    v_accvgpr_write_b32 a118, v218
    v_accvgpr_write_b32 a119, v219
    v_accvgpr_read_b32 v216, a120
    v_accvgpr_read_b32 v217, a121
    v_accvgpr_read_b32 v218, a122
    v_accvgpr_read_b32 v219, a123
    v_mul_f32 v216, v216, v214
    v_mul_f32 v217, v217, v214
    v_mul_f32 v218, v218, v214
    v_mul_f32 v219, v219, v214
    v_accvgpr_write_b32 a120, v216
    v_accvgpr_write_b32 a121, v217
    v_accvgpr_write_b32 a122, v218
    v_accvgpr_write_b32 a123, v219
    v_accvgpr_read_b32 v216, a124
    v_accvgpr_read_b32 v217, a125
    v_accvgpr_read_b32 v218, a126
    v_accvgpr_read_b32 v219, a127
    v_mul_f32 v216, v216, v215
    v_mul_f32 v217, v217, v215
    v_mul_f32 v218, v218, v215
    v_mul_f32 v219, v219, v215
    v_accvgpr_write_b32 a124, v216
    v_accvgpr_write_b32 a125, v217
    v_accvgpr_write_b32 a126, v218
    v_accvgpr_write_b32 a127, v219
    v_exp_f32 v208, v96
    v_exp_f32 v209, v97
    v_exp_f32 v210, v98
    v_exp_f32 v211, v99
    v_exp_f32 v212, v100
    v_exp_f32 v213, v101
    v_exp_f32 v214, v102
    v_exp_f32 v215, v103
    s_nop 0
    v_cvt_pk_bf16_f32 v144, v208, v209
    v_cvt_pk_bf16_f32 v145, v210, v211
    v_cvt_pk_bf16_f32 v146, v212, v213
    v_cvt_pk_bf16_f32 v147, v214, v215
    v_add_f32 v36, v32, v208
    v_add_f32 v36, v36, v209
    v_add_f32 v36, v36, v210
    v_add_f32 v36, v36, v211
    v_add_f32 v36, v36, v212
    v_add_f32 v36, v36, v213
    v_add_f32 v36, v36, v214
    v_add_f32 v36, v36, v215
    v_exp_f32 v216, v104
    v_exp_f32 v217, v105
    v_exp_f32 v218, v106
    v_exp_f32 v219, v107
    v_exp_f32 v220, v108
    v_exp_f32 v221, v109
    v_exp_f32 v222, v110
    v_exp_f32 v223, v111
    s_nop 0
    v_cvt_pk_bf16_f32 v148, v216, v217
    v_cvt_pk_bf16_f32 v149, v218, v219
    v_cvt_pk_bf16_f32 v150, v220, v221
    v_cvt_pk_bf16_f32 v151, v222, v223
    v_add_f32 v37, v33, v216
    v_add_f32 v37, v37, v217
    v_add_f32 v37, v37, v218
    v_add_f32 v37, v37, v219
    v_add_f32 v37, v37, v220
    v_add_f32 v37, v37, v221
    v_add_f32 v37, v37, v222
    v_add_f32 v37, v37, v223
    v_exp_f32 v208, v112
    v_exp_f32 v209, v113
    v_exp_f32 v210, v114
    v_exp_f32 v211, v115
    v_exp_f32 v212, v116
    v_exp_f32 v213, v117
    v_exp_f32 v214, v118
    v_exp_f32 v215, v119
    s_nop 0
    v_cvt_pk_bf16_f32 v152, v208, v209
    v_cvt_pk_bf16_f32 v153, v210, v211
    v_cvt_pk_bf16_f32 v154, v212, v213
    v_cvt_pk_bf16_f32 v155, v214, v215
    v_add_f32 v38, v34, v208
    v_add_f32 v38, v38, v209
    v_add_f32 v38, v38, v210
    v_add_f32 v38, v38, v211
    v_add_f32 v38, v38, v212
    v_add_f32 v38, v38, v213
    v_add_f32 v38, v38, v214
    v_add_f32 v38, v38, v215
    v_exp_f32 v216, v120
    v_exp_f32 v217, v121
    v_exp_f32 v218, v122
    v_exp_f32 v219, v123
    v_exp_f32 v220, v124
    v_exp_f32 v221, v125
    v_exp_f32 v222, v126
    v_exp_f32 v223, v127
    s_nop 0
    v_cvt_pk_bf16_f32 v156, v216, v217
    v_cvt_pk_bf16_f32 v157, v218, v219
    v_cvt_pk_bf16_f32 v158, v220, v221
    v_cvt_pk_bf16_f32 v159, v222, v223
    v_add_f32 v39, v35, v216
    v_add_f32 v39, v39, v217
    v_add_f32 v39, v39, v218
    v_add_f32 v39, v39, v219
    v_add_f32 v39, v39, v220
    v_add_f32 v39, v39, v221
    v_add_f32 v39, v39, v222
    v_add_f32 v39, v39, v223
    s_nop 1
    s_cmp_eq_u32 s25, 0
    s_cbranch_scc1 L_ctl_mid1
    s_branch L_ctl_last
L_chk_last:
    s_mov_b32 s25, 1
    v_mov_b32 v96, v235
    v_mov_b32 v97, v235
    v_mov_b32 v98, v235
    v_mov_b32 v99, v235
    v_mov_b32 v100, v235
    v_mov_b32 v101, v235
    v_mov_b32 v102, v235
    v_mov_b32 v103, v235
    v_mov_b32 v104, v235
    v_mov_b32 v105, v235
    v_mov_b32 v106, v235
    v_mov_b32 v107, v235
    v_mov_b32 v108, v235
    v_mov_b32 v109, v235
    v_mov_b32 v110, v235
    v_mov_b32 v111, v235
    s_branch L_rare1
L_chk_mid0h:
    s_mov_b32 s25, 2
    s_branch L_rare0
L_zero:
    v_mov_b32 v56, 0
    v_mov_b32 v57, 0
    v_mov_b32 v58, 0
    v_mov_b32 v59, 0
    s_lshl_b32 s10, s4, 10
    s_add_u32 s10, s10, 79691776
    buffer_store_dwordx4 v[56:59], v2, s[52:55], s10 offen sc1
    s_add_u32 s10, s10, 4096
    buffer_store_dwordx4 v[56:59], v2, s[52:55], s10 offen sc1
    s_add_u32 s10, s10, 4096
    buffer_store_dwordx4 v[56:59], v2, s[52:55], s10 offen sc1
    s_add_u32 s10, s10, 4096
    buffer_store_dwordx4 v[56:59], v2, s[52:55], s10 offen sc1
    s_add_u32 s10, s10, 4096
    buffer_store_dwordx4 v[56:59], v2, s[52:55], s10 offen sc1
    s_add_u32 s10, s10, 4096
    buffer_store_dwordx4 v[56:59], v2, s[52:55], s10 offen sc1
    s_add_u32 s10, s10, 4096
    buffer_store_dwordx4 v[56:59], v2, s[52:55], s10 offen sc1
    s_add_u32 s10, s10, 4096
    buffer_store_dwordx4 v[56:59], v2, s[52:55], s10 offen sc1
    s_add_u32 s10, s10, 4096
    buffer_store_dwordx4 v[56:59], v2, s[52:55], s10 offen sc1
    s_add_u32 s10, s10, 4096
    s_branch L_zero_ret
L_zpub_0:
    s_waitcnt vmcnt(0)
    s_lshl_b32 s10, s4, 2
    v_mov_b32 v3, 1
    buffer_store_dword v3, off, s[56:59], s10 sc1
    s_branch L_zpub_0_ret
L_pollz_0:
    s_mov_b32 s100, 0x40000
L_pollz_0_l:
    buffer_load_dword v3, v35, s[56:59], 0 offen sc1
    s_waitcnt vmcnt(0)
    v_cmp_ne_u32 vcc, 0, v3
    s_cmp_eq_u64 vcc, -1
    s_cbranch_scc1 L_pollz_0_ret
    s_sub_u32 s100, s100, 1
    s_cmp_lg_u32 s100, 0
    s_cbranch_scc1 L_pollz_0_l
    s_branch L_pollz_0_ret
L_pollxn_0:
    s_mov_b32 s100, 0x40000
L_pollxn_0_l:
    buffer_load_dword v3, v35, s[52:55], s78 offen sc1
    s_waitcnt vmcnt(0)
    v_cmp_ne_u32 vcc, 0, v3
    s_cmp_eq_u64 vcc, -1
    s_cbranch_scc1 L_pollxn_0_ret
    s_sub_u32 s100, s100, 1
    s_cmp_lg_u32 s100, 0
    s_cbranch_scc1 L_pollxn_0_l
    s_branch L_pollxn_0_ret
L_zpub_1:
    s_waitcnt vmcnt(0)
    s_lshl_b32 s10, s4, 2
    v_mov_b32 v3, 1
    buffer_store_dword v3, off, s[56:59], s10 sc1
    s_branch L_zpub_1_ret
L_pollz_1:
    s_mov_b32 s100, 0x40000
L_pollz_1_l:
    buffer_load_dword v3, v35, s[56:59], 0 offen sc1
    s_waitcnt vmcnt(0)
    v_cmp_ne_u32 vcc, 0, v3
    s_cmp_eq_u64 vcc, -1
    s_cbranch_scc1 L_pollz_1_ret
    s_sub_u32 s100, s100, 1
    s_cmp_lg_u32 s100, 0
    s_cbranch_scc1 L_pollz_1_l
    s_branch L_pollz_1_ret
L_pollxn_1:
    s_mov_b32 s100, 0x40000
L_pollxn_1_l:
    buffer_load_dword v3, v35, s[52:55], s78 offen sc1
    s_waitcnt vmcnt(0)
    v_cmp_ne_u32 vcc, 0, v3
    s_cmp_eq_u64 vcc, -1
    s_cbranch_scc1 L_pollxn_1_ret
    s_sub_u32 s100, s100, 1
    s_cmp_lg_u32 s100, 0
    s_cbranch_scc1 L_pollxn_1_l
    s_branch L_pollxn_1_ret
L_pollkv:
    s_mov_b32 s100, 0x40000
L_pollkv_l:
    buffer_load_dword v3, v39, s[52:55], s78 offen sc1
    s_waitcnt vmcnt(0)
    v_cmp_ne_u32 vcc, 0, v3
    s_cmp_eq_u64 vcc, -1
    s_cbranch_scc1 L_pollkv_ret
    s_sub_u32 s100, s100, 1
    s_cmp_lg_u32 s100, 0
    s_cbranch_scc1 L_pollkv_l
    s_branch L_pollkv_ret
L_code_end:
.section .rodata,"a"
.p2align 6
.amdhsa_kernel recurrent_scan__compressed_kv_cla__dense_activation_gelu__prompt_kernel
  .amdhsa_next_free_vgpr 512
  .amdhsa_next_free_sgpr 102
  .amdhsa_accum_offset 256
  .amdhsa_group_segment_fixed_size 0
  .amdhsa_kernarg_size 112
  .amdhsa_user_sgpr_count 2
  .amdhsa_user_sgpr_kernarg_segment_ptr 1
  .amdhsa_system_sgpr_workgroup_id_x 1
.end_amdhsa_kernel
```
